```python
import torch

def _softmax(x, axis=-1):
    return torch.softmax(x, dim=axis)

def _gelu(x):
    return torch.nn.functional.gelu(x, approximate='tanh')

def _silu(x):
    return torch.nn.functional.silu(x)

def _sigmoid(x):
    return torch.sigmoid(x)

def _layernorm(x, axis=-1, eps=1e-05):
    m = x.mean(dim=axis, keepdim=True)
    v = x.var(dim=axis, keepdim=True, unbiased=False)
    return (x - m) / torch.sqrt(v + eps)

def _scatter_add(tgt, idx, src, axis=0):
    return tgt.clone().index_add_(axis, idx, src)

def _segment_sum(src, seg, n):
    out = torch.zeros((n,) + src.shape[1:], dtype=src.dtype)
    return out.index_add_(0, seg, src)

def _pad(x, pw):
    flat = tuple((v for pair in reversed(pw) for v in pair))
    return torch.nn.functional.pad(x, flat)
kernel_name = 'standalone__varlen_attn_packed__ragged'

def setup_inputs():

    _w = lambda a: (lambda t: t.to(torch.bfloat16) if t.is_floating_point() else t)(torch.as_tensor(a))
    cu = torch.tensor([0, 534, 1426, 1714, 2675, 3469, 4036, 4628, 4845], dtype=torch.int64)
    T, H, D = (int(cu[-1]), 16, 128)
    return {'q': _w((lambda *s: torch.randn(*s, dtype=torch.bfloat16) * 0.8)(T, H, D)), 'k': _w((lambda *s: torch.randn(*s, dtype=torch.bfloat16) * 0.8)(T, H, D)), 'v': _w((lambda *s: torch.randn(*s, dtype=torch.bfloat16) * 0.05)(T, H, D)), 'cu': _w(cu)}

def reference(q, k, v, cu):
    T, H, D = q.shape
    out = torch.zeros_like(q)
    scale = D ** (-0.5)
    outs = []
    for i in range(len(cu) - 1):
        s, e = (int(cu[i]), int(cu[i + 1]))
        qi, ki, vi = (q[s:e].clone(), k[s:e].clone(), v[s:e].clone())
        p = _softmax(torch.einsum('qhd,khd->hqk', qi, ki) * scale, axis=-1)
        outs.append(torch.einsum('hqk,khd->qhd', p, vi))
    return torch.concatenate(outs, axis=0)
```

```asm
; @launch grid=(256,1,1) block=(256,1,1) lds=139264
.amdgcn_target "amdgcn-amd-amdhsa--gfx950"
.text
.globl standalone__varlen_attn_packed__ragged_kernel
.p2align 8
.type standalone__varlen_attn_packed__ragged_kernel,@function
standalone__varlen_attn_packed__ragged_kernel:
    s_cmp_ge_u32 s2, 256
    s_cbranch_scc1 L_end
    s_getpc_b64 s[74:75]
L_pc:
    s_load_dwordx4 s[64:67], s[0:1], 0
    s_and_b32 s76, s2, 0xf8
    v_lshrrev_b32 v14, 3, v0
    v_lshl_add_u32 v14, s76, 2, v14
    v_lshlrev_b32 v14, 7, v14
    v_min_u32 v14, L_cold-L_pc, v14
    global_load_dword v14, v14, s[74:75]
    s_lshl_b32 s76, s76, 2
    s_add_u32 s76, s76, L_table-L_pc
    s_load_dwordx8 s[56:63], s[74:75], s76
    v_lshrrev_b32 v116, 6, v0
    v_bfe_u32 v16, v0, 4, 2
    v_readfirstlane_b32 s87, v116
    v_and_b32 v17, 15, v0
    v_mul_u32_u24 v19, 5, v16
    v_and_b32 v19, 9, v19
    v_xor_b32 v19, v19, v17
    v_lshrrev_b32 v20, 4, v0
    v_lshlrev_b32 v20, 12, v20
    v_lshl_add_u32 v4, v19, 4, v20
    v_add_u32 v5, 65536, v4
    s_mul_i32 s30, s87, 1056
    s_mul_i32 s33, s87, 17408
    s_add_u32 s33, s33, 69632
    s_and_b32 s45, s2, 7
    s_lshl_b32 s45, s45, 9
    s_mov_b32 s11, 0x20000
    s_mov_b32 s7, s11
    s_add_u32 m0, s30, 8704
    s_waitcnt lgkmcnt(0)
    s_mov_b64 s[8:9], s[66:67]
    s_mov_b32 s10, s61
    s_add_u32 s28, s60, s45
    buffer_load_dwordx4 v4, s[8:11], s28 offen lds
    s_load_dwordx2 s[68:69], s[0:1], 16
    s_load_dwordx2 s[70:71], s[0:1], 32
    s_add_u32 m0, s30, 12928
    s_mov_b32 s89, s28
    buffer_load_dwordx4 v5, s[8:11], s28 offen lds
    s_add_u32 s28, s28, 131072
    s_add_u32 m0, s30, 0
    s_mov_b64 s[4:5], s[64:65]
    buffer_load_dwordx4 v4, s[8:11], s28 offen lds
    s_add_u32 m0, s30, 4224
    s_mov_b32 s6, s61
    buffer_load_dwordx4 v5, s[8:11], s28 offen lds
    s_add_u32 s28, s28, 131072
    s_mul_i32 s86, s87, s63
    s_add_u32 s86, s86, s62
    s_add_u32 s86, s86, s45
    s_lshl_b32 s91, s87, 14
    s_add_u32 s91, s91, s86
    s_add_u32 m0, s33, 0
    s_nop 0
    buffer_load_dwordx4 v4, s[4:7], s86 offen lds
    s_add_u32 s86, s86, 16384
    s_add_u32 m0, s33, 1056
    s_nop 0
    buffer_load_dwordx4 v4, s[4:7], s86 offen lds
    s_add_u32 s86, s86, 16384
    s_add_u32 m0, s33, 2112
    s_nop 0
    buffer_load_dwordx4 v4, s[4:7], s86 offen lds
    s_add_u32 s86, s86, 16384
    s_add_u32 m0, s33, 3168
    s_nop 0
    buffer_load_dwordx4 v4, s[4:7], s86 offen lds
    s_add_u32 s86, s86, 16384
    s_add_u32 m0, s33, 4224
    s_nop 0
    buffer_load_dwordx4 v4, s[4:7], s86 offen lds
    s_add_u32 s86, s86, 16384
    s_add_u32 m0, s33, 5280
    s_nop 0
    buffer_load_dwordx4 v4, s[4:7], s86 offen lds
    s_add_u32 s86, s86, 16384
    s_add_u32 m0, s33, 6336
    s_nop 0
    buffer_load_dwordx4 v4, s[4:7], s86 offen lds
    s_add_u32 s86, s86, 16384
    s_add_u32 m0, s33, 7392
    s_nop 0
    buffer_load_dwordx4 v4, s[4:7], s86 offen lds
    s_add_u32 s86, s86, 16384
    s_mov_b64 s[80:81], s[56:57]
    s_mov_b64 s[82:83], s[58:59]
    s_mov_b32 s90, s61
    s_bfe_u32 s93, s56, 0x3001b
    s_mov_b32 s29, s89
    s_mov_b32 s14, s61
    s_mov_b32 s101, 131072
    s_mov_b32 s47, 0
    s_mov_b32 s15, 0x20000
    s_mov_b32 s19, 0x20000
    v_and_b32 v22, 63, v0
    v_and_b32 v18, 3, v22
    v_lshl_add_u32 v20, v16, 3, s87
    v_lshlrev_b32 v20, 12, v20
    v_lshl_add_u32 v6, v17, 4, v20
    v_add_u32 v7, 16384, v6
    s_waitcnt lgkmcnt(0)
    s_mov_b64 s[12:13], s[68:69]
    s_mov_b64 s[16:17], s[70:71]
    v_and_b32 v20, 2, v18
    v_and_b32 v19, 1, v18
    v_lshl_add_u32 v19, v20, 2, v19
    v_xor_b32 v19, v19, v16
    v_lshrrev_b32 v21, 2, v17
    v_mul_u32_u24 v20, 1056, v21
    v_lshl_add_u32 v20, v18, 8, v20
    v_lshl_add_u32 v1, v19, 4, v20
    v_xor_b32 v19, 8, v19
    v_lshl_add_u32 v2, v19, 4, v20
    v_add_u32 v9, s33, v1
    v_add_u32 v10, s33, v2
    v_and_b32 v19, 1, v16
    v_lshl_add_u32 v19, v19, 2, v21
    v_mul_u32_u24 v19, 1056, v19
    v_lshrrev_b32 v20, 1, v16
    v_lshl_add_u32 v19, v20, 8, v19
    v_lshl_add_u32 v19, v18, 3, v19
    v_add_u32 v3, 8704, v19
    v_mul_u32_u24 v19, 272, v17
    v_lshl_add_u32 v19, v16, 3, v19
    v_add_u32 v11, s33, v19
    v_mul_u32_u24 v19, 272, v16
    v_lshl_add_u32 v19, v17, 4, v19
    v_add_u32 v12, s33, v19
    v_lshlrev_b32 v19, 12, v16
    v_lshl_add_u32 v13, v17, 4, v19
    v_lshlrev_b32 v8, 2, v16
    v_bfe_u32 v19, v22, 1, 1
    v_lshrrev_b32 v20, 5, v22
    v_cmp_eq_u32 vcc, v19, v20
    v_and_b32 v21, 1, v22
    v_bfe_u32 v20, v22, 4, 1
    v_cndmask_b32 v110, 0, -1, vcc
    v_lshlrev_b32 v20, 3, v20
    v_lshl_add_u32 v109, v21, 1, v20
    v_mul_u32_u24 v21, 0xaaaa, v21
    v_add_u32 v15, 0x4444, v21
    v_mov_b32 v19, 0x3f803f80
    v_and_b32 v20, v19, v110
    v_accvgpr_write_b32 a224, v19
    v_accvgpr_write_b32 a228, v20
    v_mov_b32 v124, 0
    v_accvgpr_write_b32 a225, v19
    v_accvgpr_write_b32 a229, v20
    v_mov_b32 v125, 0
    v_accvgpr_write_b32 a226, v19
    v_accvgpr_write_b32 a230, v20
    v_mov_b32 v126, 0
    v_accvgpr_write_b32 a227, v19
    v_accvgpr_write_b32 a231, v20
    v_mov_b32 v127, 0
    v_bfe_u32 v19, v22, 2, 1
    v_lshrrev_b32 v20, 5, v22
    v_xor_b32 v19, v19, v20
    v_bfe_u32 v20, v22, 3, 2
    v_bfe_u32 v21, v22, 1, 1
    v_lshl_add_u32 v20, v20, 1, v21
    v_lshl_add_u32 v20, v19, 4, v20
    v_and_b32 v21, 1, v22
    v_lshlrev_b32 v21, 4, v21
    v_mov_b32 v25, 0x3e03
    v_mov_b32 v26, 0xb9d8
    v_lshlrev_b32 v25, v21, v25
    v_lshlrev_b32 v26, v21, v26
    v_cmp_eq_u32 vcc, 0, v20
    s_nop 1
    v_cndmask_b32 v27, 0, v25, vcc
    v_cndmask_b32 v28, 0, v26, vcc
    v_accvgpr_write_b32 a192, v27
    v_accvgpr_write_b32 a200, v28
    v_cmp_eq_u32 vcc, 1, v20
    s_nop 1
    v_cndmask_b32 v27, 0, v25, vcc
    v_cndmask_b32 v28, 0, v26, vcc
    v_accvgpr_write_b32 a193, v27
    v_accvgpr_write_b32 a201, v28
    v_cmp_eq_u32 vcc, 2, v20
    s_nop 1
    v_cndmask_b32 v27, 0, v25, vcc
    v_cndmask_b32 v28, 0, v26, vcc
    v_accvgpr_write_b32 a194, v27
    v_accvgpr_write_b32 a202, v28
    v_cmp_eq_u32 vcc, 3, v20
    s_nop 1
    v_cndmask_b32 v27, 0, v25, vcc
    v_cndmask_b32 v28, 0, v26, vcc
    v_accvgpr_write_b32 a195, v27
    v_accvgpr_write_b32 a203, v28
    v_cmp_eq_u32 vcc, 4, v20
    s_nop 1
    v_cndmask_b32 v27, 0, v25, vcc
    v_cndmask_b32 v28, 0, v26, vcc
    v_accvgpr_write_b32 a196, v27
    v_accvgpr_write_b32 a204, v28
    v_cmp_eq_u32 vcc, 5, v20
    s_nop 1
    v_cndmask_b32 v27, 0, v25, vcc
    v_cndmask_b32 v28, 0, v26, vcc
    v_accvgpr_write_b32 a197, v27
    v_accvgpr_write_b32 a205, v28
    v_cmp_eq_u32 vcc, 6, v20
    s_nop 1
    v_cndmask_b32 v27, 0, v25, vcc
    v_cndmask_b32 v28, 0, v26, vcc
    v_accvgpr_write_b32 a198, v27
    v_accvgpr_write_b32 a206, v28
    v_cmp_eq_u32 vcc, 7, v20
    s_nop 1
    v_cndmask_b32 v27, 0, v25, vcc
    v_cndmask_b32 v28, 0, v26, vcc
    v_accvgpr_write_b32 a199, v27
    v_accvgpr_write_b32 a207, v28
    s_cmp_le_u32 s93, 2
    s_cbranch_scc1 L_qdone
    s_add_u32 m0, s33, 8448
    s_nop 0
    buffer_load_dwordx4 v4, s[4:7], s86 offen lds
    s_add_u32 s86, s86, 16384
    s_add_u32 m0, s33, 9504
    s_nop 0
    buffer_load_dwordx4 v4, s[4:7], s86 offen lds
    s_add_u32 s86, s86, 16384
    s_add_u32 m0, s33, 10560
    s_nop 0
    buffer_load_dwordx4 v4, s[4:7], s86 offen lds
    s_add_u32 s86, s86, 16384
    s_add_u32 m0, s33, 11616
    s_nop 0
    buffer_load_dwordx4 v4, s[4:7], s86 offen lds
    s_add_u32 s86, s86, 16384
    s_cmp_le_u32 s93, 3
    s_cbranch_scc1 L_qdone
    s_add_u32 m0, s33, 12672
    s_nop 0
    buffer_load_dwordx4 v4, s[4:7], s86 offen lds
    s_add_u32 s86, s86, 16384
    s_add_u32 m0, s33, 13728
    s_nop 0
    buffer_load_dwordx4 v4, s[4:7], s86 offen lds
    s_add_u32 s86, s86, 16384
    s_add_u32 m0, s33, 14784
    s_nop 0
    buffer_load_dwordx4 v4, s[4:7], s86 offen lds
    s_add_u32 s86, s86, 16384
    s_add_u32 m0, s33, 15840
    s_nop 0
    buffer_load_dwordx4 v4, s[4:7], s86 offen lds
    s_add_u32 s86, s86, 16384
L_qdone:
    s_mov_b32 s42, s89
    s_mov_b32 s43, s90
    s_mov_b32 s18, s90
    s_mov_b32 s34, s91
    s_mov_b32 s88, s93
    s_bfe_u32 s37, s80, 0xa000d
    s_add_u32 s36, s37, 31
    s_lshr_b32 s36, s36, 5
    s_sub_u32 s31, s36, 1
    s_lshl_b32 s39, s31, 5
    s_sub_u32 s35, s37, s39
    s_mov_b32 s46, 0
    s_mov_b32 s99, s33
    s_and_b32 s38, s81, 0x1fff
    s_bfe_u32 s39, s81, 0xa000d
    s_add_u32 s39, s38, s39
    s_lshl_b32 s90, s39, 12
    s_bfe_u32 s39, s81, 0x1001e
    s_lshl_b32 s39, s39, 8
    s_add_u32 s39, s39, s45
    s_lshl_b32 s89, s38, 12
    s_add_u32 s89, s89, s39
    s_bfe_u32 s93, s81, 0x3001b
    s_bfe_u32 s39, s81, 0x40017
    s_lshl_b32 s39, s39, 2
    s_mul_i32 s38, s87, s93
    s_add_u32 s39, s39, s38
    s_lshl_b32 s91, s39, 16
    s_add_u32 s91, s91, s89
    s_lshl_b32 s38, s87, 14
    s_sub_u32 s86, s91, s38
    s_mov_b64 s[4:5], s[64:65]
    s_mov_b32 s6, s90
    s_cmp_eq_u32 s90, 0
    s_cselect_b32 s32, 4, 4
    s_subb_u32 s31, s31, 0
    s_lshl_b32 s38, s93, 2
    s_max_u32 s38, s38, 1
    s_sub_u32 s38, s38, 1
    s_mul_i32 s100, s38, 1056
    s_add_u32 s100, s100, s99
    s_lshl_b32 s96, s38, 14
    s_add_u32 s96, s96, s86
    s_bfe_u32 s40, s80, 0xa000d
    s_add_u32 s40, s40, 31
    s_and_b32 s40, s40, 31
    s_add_u32 s40, s40, 1
    v_mov_b32 v121, 0x3f80
    v_mov_b32 v122, 0x3f803f80
    v_sub_u32 v120, s40, v8
    v_cmp_lt_i32 vcc, 0, v120
    v_cmp_lt_i32 s[38:39], 1, v120
    s_nop 0
    v_cndmask_b32 v123, 0, v121, vcc
    v_cndmask_b32 v123, v123, v122, s[38:39]
    v_accvgpr_write_b32 a232, v123
    v_cmp_lt_i32 vcc, 2, v120
    v_cmp_lt_i32 s[38:39], 3, v120
    s_nop 0
    v_cndmask_b32 v123, 0, v121, vcc
    v_cndmask_b32 v123, v123, v122, s[38:39]
    v_accvgpr_write_b32 a233, v123
    v_cmp_lt_i32 vcc, 16, v120
    v_cmp_lt_i32 s[38:39], 17, v120
    s_nop 0
    v_cndmask_b32 v123, 0, v121, vcc
    v_cndmask_b32 v123, v123, v122, s[38:39]
    v_accvgpr_write_b32 a234, v123
    v_cmp_lt_i32 vcc, 18, v120
    v_cmp_lt_i32 s[38:39], 19, v120
    s_nop 0
    v_cndmask_b32 v123, 0, v121, vcc
    v_cndmask_b32 v123, v123, v122, s[38:39]
    v_accvgpr_write_b32 a235, v123
    v_sub_u32 v120, s40, v109
    v_cmp_lt_i32 vcc, 0, v120
    v_cmp_lt_i32 s[38:39], 1, v120
    s_nop 0
    v_cndmask_b32 v123, 0, v121, vcc
    v_cndmask_b32 v123, v123, v122, s[38:39]
    v_and_b32 v123, v123, v110
    v_accvgpr_write_b32 a236, v123
    v_cmp_lt_i32 vcc, 16, v120
    v_cmp_lt_i32 s[38:39], 17, v120
    s_nop 0
    v_cndmask_b32 v123, 0, v121, vcc
    v_cndmask_b32 v123, v123, v122, s[38:39]
    v_and_b32 v123, v123, v110
    v_accvgpr_write_b32 a237, v123
    v_cmp_lt_i32 vcc, 4, v120
    v_cmp_lt_i32 s[38:39], 5, v120
    s_nop 0
    v_cndmask_b32 v123, 0, v121, vcc
    v_cndmask_b32 v123, v123, v122, s[38:39]
    v_and_b32 v123, v123, v110
    v_accvgpr_write_b32 a238, v123
    v_cmp_lt_i32 vcc, 20, v120
    v_cmp_lt_i32 s[38:39], 21, v120
    s_nop 0
    v_cndmask_b32 v123, 0, v121, vcc
    v_cndmask_b32 v123, v123, v122, s[38:39]
    v_and_b32 v123, v123, v110
    v_accvgpr_write_b32 a239, v123
    s_bfe_u32 s40, s81, 0xa000d
    s_add_u32 s40, s40, 31
    s_and_b32 s40, s40, 31
    s_add_u32 s40, s40, 1
    v_mov_b32 v121, 0x3f80
    v_mov_b32 v122, 0x3f803f80
    v_sub_u32 v120, s40, v8
    v_cmp_lt_i32 vcc, 0, v120
    v_cmp_lt_i32 s[38:39], 1, v120
    s_nop 0
    v_cndmask_b32 v123, 0, v121, vcc
    v_cndmask_b32 v123, v123, v122, s[38:39]
    v_accvgpr_write_b32 a240, v123
    v_cmp_lt_i32 vcc, 2, v120
    v_cmp_lt_i32 s[38:39], 3, v120
    s_nop 0
    v_cndmask_b32 v123, 0, v121, vcc
    v_cndmask_b32 v123, v123, v122, s[38:39]
    v_accvgpr_write_b32 a241, v123
    v_cmp_lt_i32 vcc, 16, v120
    v_cmp_lt_i32 s[38:39], 17, v120
    s_nop 0
    v_cndmask_b32 v123, 0, v121, vcc
    v_cndmask_b32 v123, v123, v122, s[38:39]
    v_accvgpr_write_b32 a242, v123
    v_cmp_lt_i32 vcc, 18, v120
    v_cmp_lt_i32 s[38:39], 19, v120
    s_nop 0
    v_cndmask_b32 v123, 0, v121, vcc
    v_cndmask_b32 v123, v123, v122, s[38:39]
    v_accvgpr_write_b32 a243, v123
    v_sub_u32 v120, s40, v109
    v_cmp_lt_i32 vcc, 0, v120
    v_cmp_lt_i32 s[38:39], 1, v120
    s_nop 0
    v_cndmask_b32 v123, 0, v121, vcc
    v_cndmask_b32 v123, v123, v122, s[38:39]
    v_and_b32 v123, v123, v110
    v_accvgpr_write_b32 a244, v123
    v_cmp_lt_i32 vcc, 16, v120
    v_cmp_lt_i32 s[38:39], 17, v120
    s_nop 0
    v_cndmask_b32 v123, 0, v121, vcc
    v_cndmask_b32 v123, v123, v122, s[38:39]
    v_and_b32 v123, v123, v110
    v_accvgpr_write_b32 a245, v123
    v_cmp_lt_i32 vcc, 4, v120
    v_cmp_lt_i32 s[38:39], 5, v120
    s_nop 0
    v_cndmask_b32 v123, 0, v121, vcc
    v_cndmask_b32 v123, v123, v122, s[38:39]
    v_and_b32 v123, v123, v110
    v_accvgpr_write_b32 a246, v123
    v_cmp_lt_i32 vcc, 20, v120
    v_cmp_lt_i32 s[38:39], 21, v120
    s_nop 0
    v_cndmask_b32 v123, 0, v121, vcc
    v_cndmask_b32 v123, v123, v122, s[38:39]
    v_and_b32 v123, v123, v110
    v_accvgpr_write_b32 a247, v123
    v_mfma_f32_32x32x16_bf16 a[208:223], v[124:127], v[124:127], 0
    s_cmp_eq_u32 s88, 3
    s_cbranch_scc1 L_f3
    s_waitcnt vmcnt(12)
    ds_read_b128 a[64:67], v9 offset:0
    ds_read_b128 a[68:71], v9 offset:64
    ds_read_b128 a[72:75], v10 offset:0
    ds_read_b128 a[76:79], v10 offset:64
    s_barrier
    ds_read_b128 a[128:131], v1 offset:8704
    ds_read_b128 a[132:135], v1 offset:8768
    ds_read_b128 a[136:139], v2 offset:8704
    ds_read_b128 a[140:143], v2 offset:8768
    ds_read_b128 a[144:147], v1 offset:12928
    ds_read_b128 a[148:151], v1 offset:12992
    ds_read_b128 a[152:155], v2 offset:12928
    ds_read_b128 a[156:159], v2 offset:12992
    s_waitcnt lgkmcnt(8)
    v_mfma_f32_32x32x16_bf16 v[128:143], a[192:195], a[64:67], 0
    v_mfma_f32_32x32x16_bf16 v[128:143], a[196:199], a[68:71], v[128:143]
    s_nop 3
    v_mfma_f32_32x32x16_bf16 v[128:143], a[200:203], a[64:67], v[128:143]
    v_mfma_f32_32x32x16_bf16 v[128:143], a[204:207], a[68:71], v[128:143]
    v_mfma_f32_32x32x16_bf16 v[144:159], a[192:195], a[72:75], 0
    v_mfma_f32_32x32x16_bf16 v[144:159], a[196:199], a[76:79], v[144:159]
    v_mfma_f32_32x32x16_bf16 v[144:159], a[200:203], a[72:75], v[144:159]
    v_mfma_f32_32x32x16_bf16 v[144:159], a[204:207], a[76:79], v[144:159]
    s_nop 0
    s_nop 6
    v_cvt_pk_bf16_f32 v128, v128, v129
    v_cvt_pk_bf16_f32 v129, v130, v131
    v_cvt_pk_bf16_f32 v130, v132, v133
    v_cvt_pk_bf16_f32 v131, v134, v135
    v_cvt_pk_bf16_f32 v132, v136, v137
    v_cvt_pk_bf16_f32 v133, v138, v139
    v_cvt_pk_bf16_f32 v134, v140, v141
    v_cvt_pk_bf16_f32 v135, v142, v143
    v_accvgpr_write_b32 a0, v128
    v_accvgpr_write_b32 a1, v129
    v_accvgpr_write_b32 a2, v130
    v_accvgpr_write_b32 a3, v131
    v_accvgpr_write_b32 a4, v132
    v_accvgpr_write_b32 a5, v133
    v_accvgpr_write_b32 a6, v134
    v_accvgpr_write_b32 a7, v135
    v_mfma_f32_32x32x16_bf16 v[128:143], v[124:127], v[124:127], 0
    v_cvt_pk_bf16_f32 v144, v144, v145
    v_cvt_pk_bf16_f32 v145, v146, v147
    v_cvt_pk_bf16_f32 v146, v148, v149
    v_cvt_pk_bf16_f32 v147, v150, v151
    v_cvt_pk_bf16_f32 v148, v152, v153
    v_cvt_pk_bf16_f32 v149, v154, v155
    v_cvt_pk_bf16_f32 v150, v156, v157
    v_cvt_pk_bf16_f32 v151, v158, v159
    v_accvgpr_write_b32 a8, v144
    v_accvgpr_write_b32 a9, v145
    v_accvgpr_write_b32 a10, v146
    v_accvgpr_write_b32 a11, v147
    v_accvgpr_write_b32 a12, v148
    v_accvgpr_write_b32 a13, v149
    v_accvgpr_write_b32 a14, v150
    v_accvgpr_write_b32 a15, v151
    v_mfma_f32_32x32x16_bf16 v[144:159], v[124:127], v[124:127], 0
    s_waitcnt lgkmcnt(0)
    v_mfma_f32_16x16x32_bf16 v[16:19], a[128:131], a[0:3], 0
    v_mfma_f32_16x16x32_bf16 v[16:19], a[132:135], a[4:7], v[16:19]
    v_mfma_f32_16x16x32_bf16 v[16:19], a[136:139], a[8:11], v[16:19]
    v_mfma_f32_16x16x32_bf16 v[16:19], a[140:143], a[12:15], v[16:19]
    v_mfma_f32_16x16x32_bf16 v[20:23], a[144:147], a[0:3], 0
    v_mfma_f32_16x16x32_bf16 v[20:23], a[148:151], a[4:7], v[20:23]
    v_mfma_f32_16x16x32_bf16 v[20:23], a[152:155], a[8:11], v[20:23]
    v_mfma_f32_16x16x32_bf16 v[20:23], a[156:159], a[12:15], v[20:23]
    s_waitcnt vmcnt(8)
    ds_read_b128 a[80:83], v9 offset:4224
    ds_read_b128 a[84:87], v9 offset:4288
    ds_read_b128 a[88:91], v10 offset:4224
    ds_read_b128 a[92:95], v10 offset:4288
    s_waitcnt lgkmcnt(0)
    v_mfma_f32_32x32x16_bf16 v[160:175], a[192:195], a[80:83], 0
    v_mfma_f32_32x32x16_bf16 v[160:175], a[196:199], a[84:87], v[160:175]
    s_nop 3
    v_mfma_f32_32x32x16_bf16 v[160:175], a[200:203], a[80:83], v[160:175]
    v_max3_f32 v112, v16, v17, v18
    v_max3_f32 v116, v19, v20, v21
    v_max3_f32 v112, v112, v22, v23
    v_max_f32 v112, v112, v116
    v_mov_b32 v116, v112
    s_nop 1
    v_permlane32_swap_b32 v112, v116
    v_mfma_f32_32x32x16_bf16 v[160:175], a[204:207], a[84:87], v[160:175]
    v_max_f32 v112, v112, v116
    v_mov_b32 v116, v112
    s_nop 1
    v_permlane16_swap_b32 v112, v116
    v_max_f32 v112, v112, v116
    v_sub_f32 v16, v16, v112
    v_sub_f32 v17, v17, v112
    v_mfma_f32_32x32x16_bf16 v[176:191], a[192:195], a[88:91], 0
    v_sub_f32 v18, v18, v112
    v_sub_f32 v19, v19, v112
    v_sub_f32 v20, v20, v112
    v_sub_f32 v21, v21, v112
    v_sub_f32 v22, v22, v112
    v_sub_f32 v23, v23, v112
    v_sub_f32 v80, 0, v112
    v_mfma_f32_32x32x16_bf16 v[176:191], a[196:199], a[92:95], v[176:191]
    v_sub_f32 v81, 0, v112
    v_sub_f32 v82, 0, v112
    v_sub_f32 v83, 0, v112
    v_exp_f32 v16, v16
    v_exp_f32 v17, v17
    v_exp_f32 v18, v18
    v_cvt_pk_bf16_f32 v16, v16, v17
    v_mfma_f32_32x32x16_bf16 v[176:191], a[200:203], a[88:91], v[176:191]
    v_exp_f32 v19, v19
    v_exp_f32 v20, v20
    v_cvt_pk_bf16_f32 v17, v18, v19
    v_exp_f32 v21, v21
    v_exp_f32 v22, v22
    v_cvt_pk_bf16_f32 v18, v20, v21
    v_exp_f32 v23, v23
    v_mfma_f32_32x32x16_bf16 v[176:191], a[204:207], a[92:95], v[176:191]
    s_nop 0
    v_cvt_pk_bf16_f32 v19, v22, v23
    s_nop 0
    v_cvt_pk_bf16_f32 v160, v160, v161
    v_cvt_pk_bf16_f32 v161, v162, v163
    v_cvt_pk_bf16_f32 v162, v164, v165
    v_cvt_pk_bf16_f32 v163, v166, v167
    v_cvt_pk_bf16_f32 v164, v168, v169
    v_cvt_pk_bf16_f32 v165, v170, v171
    v_cvt_pk_bf16_f32 v166, v172, v173
    v_cvt_pk_bf16_f32 v167, v174, v175
    v_accvgpr_write_b32 a16, v160
    v_accvgpr_write_b32 a17, v161
    v_accvgpr_write_b32 a18, v162
    v_accvgpr_write_b32 a19, v163
    v_accvgpr_write_b32 a20, v164
    v_accvgpr_write_b32 a21, v165
    v_accvgpr_write_b32 a22, v166
    v_accvgpr_write_b32 a23, v167
    v_mfma_f32_32x32x16_bf16 v[160:175], v[124:127], v[124:127], 0
    v_cvt_pk_bf16_f32 v176, v176, v177
    v_cvt_pk_bf16_f32 v177, v178, v179
    v_cvt_pk_bf16_f32 v178, v180, v181
    v_cvt_pk_bf16_f32 v179, v182, v183
    v_cvt_pk_bf16_f32 v180, v184, v185
    v_cvt_pk_bf16_f32 v181, v186, v187
    v_cvt_pk_bf16_f32 v182, v188, v189
    v_cvt_pk_bf16_f32 v183, v190, v191
    v_accvgpr_write_b32 a24, v176
    v_accvgpr_write_b32 a25, v177
    v_accvgpr_write_b32 a26, v178
    v_accvgpr_write_b32 a27, v179
    v_accvgpr_write_b32 a28, v180
    v_accvgpr_write_b32 a29, v181
    v_accvgpr_write_b32 a30, v182
    v_accvgpr_write_b32 a31, v183
    v_mfma_f32_32x32x16_bf16 v[176:191], v[124:127], v[124:127], 0
    s_nop 0
    v_mfma_f32_16x16x32_bf16 v[24:27], a[128:131], a[16:19], 0
    v_mfma_f32_16x16x32_bf16 v[24:27], a[132:135], a[20:23], v[24:27]
    v_mfma_f32_16x16x32_bf16 v[24:27], a[136:139], a[24:27], v[24:27]
    v_mfma_f32_16x16x32_bf16 v[24:27], a[140:143], a[28:31], v[24:27]
    v_mfma_f32_16x16x32_bf16 v[28:31], a[144:147], a[16:19], 0
    v_mfma_f32_16x16x32_bf16 v[28:31], a[148:151], a[20:23], v[28:31]
    v_mfma_f32_16x16x32_bf16 v[28:31], a[152:155], a[24:27], v[28:31]
    v_mfma_f32_16x16x32_bf16 v[28:31], a[156:159], a[28:31], v[28:31]
    s_waitcnt vmcnt(4)
    ds_read_b128 a[96:99], v9 offset:8448
    ds_read_b128 a[100:103], v9 offset:8512
    ds_read_b128 a[104:107], v10 offset:8448
    ds_read_b128 a[108:111], v10 offset:8512
    s_waitcnt lgkmcnt(0)
    v_mfma_f32_32x32x16_bf16 v[192:207], a[192:195], a[96:99], 0
    v_mfma_f32_32x32x16_bf16 v[192:207], a[196:199], a[100:103], v[192:207]
    s_nop 3
    v_mfma_f32_32x32x16_bf16 v[192:207], a[200:203], a[96:99], v[192:207]
    v_max3_f32 v113, v24, v25, v26
    v_max3_f32 v117, v27, v28, v29
    v_max3_f32 v113, v113, v30, v31
    v_max_f32 v113, v113, v117
    v_mov_b32 v117, v113
    s_nop 1
    v_permlane32_swap_b32 v113, v117
    v_mfma_f32_32x32x16_bf16 v[192:207], a[204:207], a[100:103], v[192:207]
    v_max_f32 v113, v113, v117
    v_mov_b32 v117, v113
    s_nop 1
    v_permlane16_swap_b32 v113, v117
    v_max_f32 v113, v113, v117
    v_sub_f32 v24, v24, v113
    v_sub_f32 v25, v25, v113
    v_mfma_f32_32x32x16_bf16 v[208:223], a[192:195], a[104:107], 0
    v_sub_f32 v26, v26, v113
    v_sub_f32 v27, v27, v113
    v_sub_f32 v28, v28, v113
    v_sub_f32 v29, v29, v113
    v_sub_f32 v30, v30, v113
    v_sub_f32 v31, v31, v113
    v_sub_f32 v84, 0, v113
    v_mfma_f32_32x32x16_bf16 v[208:223], a[196:199], a[108:111], v[208:223]
    v_sub_f32 v85, 0, v113
    v_sub_f32 v86, 0, v113
    v_sub_f32 v87, 0, v113
    v_exp_f32 v24, v24
    v_exp_f32 v25, v25
    v_exp_f32 v26, v26
    v_cvt_pk_bf16_f32 v20, v24, v25
    v_mfma_f32_32x32x16_bf16 v[208:223], a[200:203], a[104:107], v[208:223]
    v_exp_f32 v27, v27
    v_exp_f32 v28, v28
    v_cvt_pk_bf16_f32 v21, v26, v27
    v_exp_f32 v29, v29
    v_exp_f32 v30, v30
    v_cvt_pk_bf16_f32 v22, v28, v29
    v_exp_f32 v31, v31
    v_mfma_f32_32x32x16_bf16 v[208:223], a[204:207], a[108:111], v[208:223]
    s_nop 0
    v_cvt_pk_bf16_f32 v23, v30, v31
    s_nop 0
    v_cvt_pk_bf16_f32 v192, v192, v193
    v_cvt_pk_bf16_f32 v193, v194, v195
    v_cvt_pk_bf16_f32 v194, v196, v197
    v_cvt_pk_bf16_f32 v195, v198, v199
    v_cvt_pk_bf16_f32 v196, v200, v201
    v_cvt_pk_bf16_f32 v197, v202, v203
    v_cvt_pk_bf16_f32 v198, v204, v205
    v_cvt_pk_bf16_f32 v199, v206, v207
    v_accvgpr_write_b32 a32, v192
    v_accvgpr_write_b32 a33, v193
    v_accvgpr_write_b32 a34, v194
    v_accvgpr_write_b32 a35, v195
    v_accvgpr_write_b32 a36, v196
    v_accvgpr_write_b32 a37, v197
    v_accvgpr_write_b32 a38, v198
    v_accvgpr_write_b32 a39, v199
    v_mfma_f32_32x32x16_bf16 v[192:207], v[124:127], v[124:127], 0
    v_cvt_pk_bf16_f32 v208, v208, v209
    v_cvt_pk_bf16_f32 v209, v210, v211
    v_cvt_pk_bf16_f32 v210, v212, v213
    v_cvt_pk_bf16_f32 v211, v214, v215
    v_cvt_pk_bf16_f32 v212, v216, v217
    v_cvt_pk_bf16_f32 v213, v218, v219
    v_cvt_pk_bf16_f32 v214, v220, v221
    v_cvt_pk_bf16_f32 v215, v222, v223
    v_accvgpr_write_b32 a40, v208
    v_accvgpr_write_b32 a41, v209
    v_accvgpr_write_b32 a42, v210
    v_accvgpr_write_b32 a43, v211
    v_accvgpr_write_b32 a44, v212
    v_accvgpr_write_b32 a45, v213
    v_accvgpr_write_b32 a46, v214
    v_accvgpr_write_b32 a47, v215
    v_mfma_f32_32x32x16_bf16 v[208:223], v[124:127], v[124:127], 0
    s_nop 0
    v_mfma_f32_16x16x32_bf16 v[32:35], a[128:131], a[32:35], 0
    v_mfma_f32_16x16x32_bf16 v[32:35], a[132:135], a[36:39], v[32:35]
    v_mfma_f32_16x16x32_bf16 v[32:35], a[136:139], a[40:43], v[32:35]
    v_mfma_f32_16x16x32_bf16 v[32:35], a[140:143], a[44:47], v[32:35]
    v_mfma_f32_16x16x32_bf16 v[36:39], a[144:147], a[32:35], 0
    v_mfma_f32_16x16x32_bf16 v[36:39], a[148:151], a[36:39], v[36:39]
    v_mfma_f32_16x16x32_bf16 v[36:39], a[152:155], a[40:43], v[36:39]
    v_mfma_f32_16x16x32_bf16 v[36:39], a[156:159], a[44:47], v[36:39]
    s_add_u32 m0, s30, 17408
    s_nop 0
    buffer_load_dwordx4 v4, s[8:11], s28 offen lds
    s_add_u32 m0, s30, 21632
    s_nop 0
    buffer_load_dwordx4 v5, s[8:11], s28 offen lds
    s_add_u32 m0, s30, 26112
    s_nop 0
    buffer_load_dwordx4 v6, s[12:15], s29 offen lds
    s_add_u32 m0, s30, 30336
    s_nop 0
    buffer_load_dwordx4 v7, s[12:15], s29 offen lds
    s_add_u32 s28, s28, s101
    s_add_u32 s29, s29, s101
    s_waitcnt vmcnt(4)
    ds_read_b128 a[112:115], v9 offset:12672
    ds_read_b128 a[116:119], v9 offset:12736
    ds_read_b128 a[120:123], v10 offset:12672
    ds_read_b128 a[124:127], v10 offset:12736
    s_waitcnt lgkmcnt(0)
    v_mfma_f32_32x32x16_bf16 v[224:239], a[192:195], a[112:115], 0
    v_mfma_f32_32x32x16_bf16 v[224:239], a[196:199], a[116:119], v[224:239]
    s_nop 3
    v_mfma_f32_32x32x16_bf16 v[224:239], a[200:203], a[112:115], v[224:239]
    s_add_u32 m0, s30, 34816
    v_max3_f32 v114, v32, v33, v34
    v_max3_f32 v118, v35, v36, v37
    v_max3_f32 v114, v114, v38, v39
    v_max_f32 v114, v114, v118
    v_mov_b32 v118, v114
    s_nop 1
    v_permlane32_swap_b32 v114, v118
    v_mfma_f32_32x32x16_bf16 v[224:239], a[204:207], a[116:119], v[224:239]
    buffer_load_dwordx4 v4, s[8:11], s28 offen lds
    v_max_f32 v114, v114, v118
    v_mov_b32 v118, v114
    s_nop 1
    v_permlane16_swap_b32 v114, v118
    v_max_f32 v114, v114, v118
    v_sub_f32 v32, v32, v114
    v_sub_f32 v33, v33, v114
    v_mfma_f32_32x32x16_bf16 v[240:255], a[192:195], a[120:123], 0
    s_add_u32 m0, s30, 39040
    v_sub_f32 v34, v34, v114
    v_sub_f32 v35, v35, v114
    v_sub_f32 v36, v36, v114
    v_sub_f32 v37, v37, v114
    v_sub_f32 v38, v38, v114
    v_sub_f32 v39, v39, v114
    v_sub_f32 v88, 0, v114
    v_mfma_f32_32x32x16_bf16 v[240:255], a[196:199], a[124:127], v[240:255]
    buffer_load_dwordx4 v5, s[8:11], s28 offen lds
    v_sub_f32 v89, 0, v114
    v_sub_f32 v90, 0, v114
    v_sub_f32 v91, 0, v114
    v_exp_f32 v32, v32
    v_exp_f32 v33, v33
    v_exp_f32 v34, v34
    v_cvt_pk_bf16_f32 v32, v32, v33
    v_mfma_f32_32x32x16_bf16 v[240:255], a[200:203], a[120:123], v[240:255]
    s_add_u32 m0, s30, 43520
    v_exp_f32 v35, v35
    v_exp_f32 v36, v36
    v_cvt_pk_bf16_f32 v33, v34, v35
    v_exp_f32 v37, v37
    v_exp_f32 v38, v38
    v_cvt_pk_bf16_f32 v34, v36, v37
    v_exp_f32 v39, v39
    v_mfma_f32_32x32x16_bf16 v[240:255], a[204:207], a[124:127], v[240:255]
    buffer_load_dwordx4 v6, s[12:15], s29 offen lds
    s_nop 0
    v_cvt_pk_bf16_f32 v35, v38, v39
    s_add_u32 m0, s30, 47744
    s_nop 0
    buffer_load_dwordx4 v7, s[12:15], s29 offen lds
    s_add_u32 s28, s28, s101
    s_add_u32 s29, s29, s101
    v_cvt_pk_bf16_f32 v224, v224, v225
    v_cvt_pk_bf16_f32 v225, v226, v227
    v_cvt_pk_bf16_f32 v226, v228, v229
    v_cvt_pk_bf16_f32 v227, v230, v231
    v_cvt_pk_bf16_f32 v228, v232, v233
    v_cvt_pk_bf16_f32 v229, v234, v235
    v_cvt_pk_bf16_f32 v230, v236, v237
    v_cvt_pk_bf16_f32 v231, v238, v239
    v_accvgpr_write_b32 a48, v224
    v_accvgpr_write_b32 a49, v225
    v_accvgpr_write_b32 a50, v226
    v_accvgpr_write_b32 a51, v227
    v_accvgpr_write_b32 a52, v228
    v_accvgpr_write_b32 a53, v229
    v_accvgpr_write_b32 a54, v230
    v_accvgpr_write_b32 a55, v231
    v_mfma_f32_32x32x16_bf16 v[224:239], v[124:127], v[124:127], 0
    v_cvt_pk_bf16_f32 v240, v240, v241
    v_cvt_pk_bf16_f32 v241, v242, v243
    v_cvt_pk_bf16_f32 v242, v244, v245
    v_cvt_pk_bf16_f32 v243, v246, v247
    v_cvt_pk_bf16_f32 v244, v248, v249
    v_cvt_pk_bf16_f32 v245, v250, v251
    v_cvt_pk_bf16_f32 v246, v252, v253
    v_cvt_pk_bf16_f32 v247, v254, v255
    v_accvgpr_write_b32 a56, v240
    v_accvgpr_write_b32 a57, v241
    v_accvgpr_write_b32 a58, v242
    v_accvgpr_write_b32 a59, v243
    v_accvgpr_write_b32 a60, v244
    v_accvgpr_write_b32 a61, v245
    v_accvgpr_write_b32 a62, v246
    v_accvgpr_write_b32 a63, v247
    v_mfma_f32_32x32x16_bf16 v[240:255], v[124:127], v[124:127], 0
    s_nop 0
    v_mfma_f32_16x16x32_bf16 v[40:43], a[128:131], a[48:51], 0
    ds_read_b128 a[128:131], v1 offset:0
    v_mfma_f32_16x16x32_bf16 v[40:43], a[132:135], a[52:55], v[40:43]
    ds_read_b128 a[132:135], v1 offset:64
    v_mfma_f32_16x16x32_bf16 v[40:43], a[136:139], a[56:59], v[40:43]
    ds_read_b128 a[136:139], v2 offset:0
    v_mfma_f32_16x16x32_bf16 v[40:43], a[140:143], a[60:63], v[40:43]
    ds_read_b128 a[140:143], v2 offset:64
    v_mfma_f32_16x16x32_bf16 v[44:47], a[144:147], a[48:51], 0
    ds_read_b128 a[144:147], v1 offset:4224
    v_mfma_f32_16x16x32_bf16 v[44:47], a[148:151], a[52:55], v[44:47]
    ds_read_b128 a[148:151], v1 offset:4288
    v_mfma_f32_16x16x32_bf16 v[44:47], a[152:155], a[56:59], v[44:47]
    ds_read_b128 a[152:155], v2 offset:4224
    v_mfma_f32_16x16x32_bf16 v[44:47], a[156:159], a[60:63], v[44:47]
    ds_read_b128 a[156:159], v2 offset:4288
    s_nop 6
    v_max3_f32 v115, v40, v41, v42
    s_mov_b32 m0, s99
    v_max3_f32 v119, v43, v44, v45
    buffer_load_dwordx4 v4, s[4:7], s86 offen lds
    v_max3_f32 v115, v115, v46, v47
    s_add_u32 s99, s99, 1056
    v_max_f32 v115, v115, v119
    s_min_u32 s99, s99, s100
    v_mov_b32 v119, v115
    s_add_u32 s86, s86, 16384
    s_nop 1
    s_min_u32 s86, s86, s96
    v_permlane32_swap_b32 v115, v119
    s_add_u32 m0, s30, 52224
    v_max_f32 v115, v115, v119
    buffer_load_dwordx4 v4, s[8:11], s28 offen lds
    v_mov_b32 v119, v115
    s_add_u32 m0, s30, 56448
    s_nop 1
    buffer_load_dwordx4 v5, s[8:11], s28 offen lds
    v_permlane16_swap_b32 v115, v119
    s_add_u32 m0, s30, 60928
    v_max_f32 v115, v115, v119
    buffer_load_dwordx4 v6, s[12:15], s29 offen lds
    v_sub_f32 v40, v40, v115
    s_add_u32 m0, s30, 65152
    v_sub_f32 v41, v41, v115
    buffer_load_dwordx4 v7, s[12:15], s29 offen lds
    v_sub_f32 v42, v42, v115
    s_add_u32 s28, s28, s101
    v_sub_f32 v43, v43, v115
    s_add_u32 s29, s29, s101
    v_sub_f32 v44, v44, v115
    v_sub_f32 v45, v45, v115
    v_sub_f32 v46, v46, v115
    v_sub_f32 v47, v47, v115
    v_sub_f32 v92, 0, v115
    v_sub_f32 v93, 0, v115
    v_sub_f32 v94, 0, v115
    v_sub_f32 v95, 0, v115
    v_exp_f32 v40, v40
    s_waitcnt vmcnt(9) lgkmcnt(0)
    s_cmp_lg_u32 s90, 0
    s_cbranch_scc1 L_itb4x_1
    s_branch L_itb4_1
L_f3:
    s_waitcnt vmcnt(8)
    ds_read_b128 a[64:67], v9 offset:0
    ds_read_b128 a[68:71], v9 offset:64
    ds_read_b128 a[72:75], v10 offset:0
    ds_read_b128 a[76:79], v10 offset:64
    s_barrier
    ds_read_b128 a[128:131], v1 offset:8704
    ds_read_b128 a[132:135], v1 offset:8768
    ds_read_b128 a[136:139], v2 offset:8704
    ds_read_b128 a[140:143], v2 offset:8768
    ds_read_b128 a[144:147], v1 offset:12928
    ds_read_b128 a[148:151], v1 offset:12992
    ds_read_b128 a[152:155], v2 offset:12928
    ds_read_b128 a[156:159], v2 offset:12992
    s_waitcnt lgkmcnt(8)
    v_mfma_f32_32x32x16_bf16 v[128:143], a[192:195], a[64:67], 0
    v_mfma_f32_32x32x16_bf16 v[128:143], a[196:199], a[68:71], v[128:143]
    s_nop 3
    v_mfma_f32_32x32x16_bf16 v[128:143], a[200:203], a[64:67], v[128:143]
    v_mfma_f32_32x32x16_bf16 v[128:143], a[204:207], a[68:71], v[128:143]
    v_mfma_f32_32x32x16_bf16 v[144:159], a[192:195], a[72:75], 0
    v_mfma_f32_32x32x16_bf16 v[144:159], a[196:199], a[76:79], v[144:159]
    v_mfma_f32_32x32x16_bf16 v[144:159], a[200:203], a[72:75], v[144:159]
    v_mfma_f32_32x32x16_bf16 v[144:159], a[204:207], a[76:79], v[144:159]
    s_nop 0
    s_nop 6
    v_cvt_pk_bf16_f32 v128, v128, v129
    v_cvt_pk_bf16_f32 v129, v130, v131
    v_cvt_pk_bf16_f32 v130, v132, v133
    v_cvt_pk_bf16_f32 v131, v134, v135
    v_cvt_pk_bf16_f32 v132, v136, v137
    v_cvt_pk_bf16_f32 v133, v138, v139
    v_cvt_pk_bf16_f32 v134, v140, v141
    v_cvt_pk_bf16_f32 v135, v142, v143
    v_accvgpr_write_b32 a0, v128
    v_accvgpr_write_b32 a1, v129
    v_accvgpr_write_b32 a2, v130
    v_accvgpr_write_b32 a3, v131
    v_accvgpr_write_b32 a4, v132
    v_accvgpr_write_b32 a5, v133
    v_accvgpr_write_b32 a6, v134
    v_accvgpr_write_b32 a7, v135
    v_mfma_f32_32x32x16_bf16 v[128:143], v[124:127], v[124:127], 0
    v_cvt_pk_bf16_f32 v144, v144, v145
    v_cvt_pk_bf16_f32 v145, v146, v147
    v_cvt_pk_bf16_f32 v146, v148, v149
    v_cvt_pk_bf16_f32 v147, v150, v151
    v_cvt_pk_bf16_f32 v148, v152, v153
    v_cvt_pk_bf16_f32 v149, v154, v155
    v_cvt_pk_bf16_f32 v150, v156, v157
    v_cvt_pk_bf16_f32 v151, v158, v159
    v_accvgpr_write_b32 a8, v144
    v_accvgpr_write_b32 a9, v145
    v_accvgpr_write_b32 a10, v146
    v_accvgpr_write_b32 a11, v147
    v_accvgpr_write_b32 a12, v148
    v_accvgpr_write_b32 a13, v149
    v_accvgpr_write_b32 a14, v150
    v_accvgpr_write_b32 a15, v151
    v_mfma_f32_32x32x16_bf16 v[144:159], v[124:127], v[124:127], 0
    s_waitcnt lgkmcnt(0)
    v_mfma_f32_16x16x32_bf16 v[16:19], a[128:131], a[0:3], 0
    v_mfma_f32_16x16x32_bf16 v[16:19], a[132:135], a[4:7], v[16:19]
    v_mfma_f32_16x16x32_bf16 v[16:19], a[136:139], a[8:11], v[16:19]
    v_mfma_f32_16x16x32_bf16 v[16:19], a[140:143], a[12:15], v[16:19]
    v_mfma_f32_16x16x32_bf16 v[20:23], a[144:147], a[0:3], 0
    v_mfma_f32_16x16x32_bf16 v[20:23], a[148:151], a[4:7], v[20:23]
    v_mfma_f32_16x16x32_bf16 v[20:23], a[152:155], a[8:11], v[20:23]
    v_mfma_f32_16x16x32_bf16 v[20:23], a[156:159], a[12:15], v[20:23]
    s_waitcnt vmcnt(4)
    ds_read_b128 a[80:83], v9 offset:4224
    ds_read_b128 a[84:87], v9 offset:4288
    ds_read_b128 a[88:91], v10 offset:4224
    ds_read_b128 a[92:95], v10 offset:4288
    s_waitcnt lgkmcnt(0)
    v_mfma_f32_32x32x16_bf16 v[160:175], a[192:195], a[80:83], 0
    v_mfma_f32_32x32x16_bf16 v[160:175], a[196:199], a[84:87], v[160:175]
    s_nop 3
    v_mfma_f32_32x32x16_bf16 v[160:175], a[200:203], a[80:83], v[160:175]
    v_max3_f32 v112, v16, v17, v18
    v_max3_f32 v116, v19, v20, v21
    v_max3_f32 v112, v112, v22, v23
    v_max_f32 v112, v112, v116
    v_mov_b32 v116, v112
    s_nop 1
    v_permlane32_swap_b32 v112, v116
    v_mfma_f32_32x32x16_bf16 v[160:175], a[204:207], a[84:87], v[160:175]
    v_max_f32 v112, v112, v116
    v_mov_b32 v116, v112
    s_nop 1
    v_permlane16_swap_b32 v112, v116
    v_max_f32 v112, v112, v116
    v_sub_f32 v16, v16, v112
    v_sub_f32 v17, v17, v112
    v_mfma_f32_32x32x16_bf16 v[176:191], a[192:195], a[88:91], 0
    v_sub_f32 v18, v18, v112
    v_sub_f32 v19, v19, v112
    v_sub_f32 v20, v20, v112
    v_sub_f32 v21, v21, v112
    v_sub_f32 v22, v22, v112
    v_sub_f32 v23, v23, v112
    v_sub_f32 v80, 0, v112
    v_mfma_f32_32x32x16_bf16 v[176:191], a[196:199], a[92:95], v[176:191]
    v_sub_f32 v81, 0, v112
    v_sub_f32 v82, 0, v112
    v_sub_f32 v83, 0, v112
    v_exp_f32 v16, v16
    v_exp_f32 v17, v17
    v_exp_f32 v18, v18
    v_cvt_pk_bf16_f32 v16, v16, v17
    v_mfma_f32_32x32x16_bf16 v[176:191], a[200:203], a[88:91], v[176:191]
    v_exp_f32 v19, v19
    v_exp_f32 v20, v20
    v_cvt_pk_bf16_f32 v17, v18, v19
    v_exp_f32 v21, v21
    v_exp_f32 v22, v22
    v_cvt_pk_bf16_f32 v18, v20, v21
    v_exp_f32 v23, v23
    v_mfma_f32_32x32x16_bf16 v[176:191], a[204:207], a[92:95], v[176:191]
    s_nop 0
    v_cvt_pk_bf16_f32 v19, v22, v23
    s_nop 0
    v_cvt_pk_bf16_f32 v160, v160, v161
    v_cvt_pk_bf16_f32 v161, v162, v163
    v_cvt_pk_bf16_f32 v162, v164, v165
    v_cvt_pk_bf16_f32 v163, v166, v167
    v_cvt_pk_bf16_f32 v164, v168, v169
    v_cvt_pk_bf16_f32 v165, v170, v171
    v_cvt_pk_bf16_f32 v166, v172, v173
    v_cvt_pk_bf16_f32 v167, v174, v175
    v_accvgpr_write_b32 a16, v160
    v_accvgpr_write_b32 a17, v161
    v_accvgpr_write_b32 a18, v162
    v_accvgpr_write_b32 a19, v163
    v_accvgpr_write_b32 a20, v164
    v_accvgpr_write_b32 a21, v165
    v_accvgpr_write_b32 a22, v166
    v_accvgpr_write_b32 a23, v167
    v_mfma_f32_32x32x16_bf16 v[160:175], v[124:127], v[124:127], 0
    v_cvt_pk_bf16_f32 v176, v176, v177
    v_cvt_pk_bf16_f32 v177, v178, v179
    v_cvt_pk_bf16_f32 v178, v180, v181
    v_cvt_pk_bf16_f32 v179, v182, v183
    v_cvt_pk_bf16_f32 v180, v184, v185
    v_cvt_pk_bf16_f32 v181, v186, v187
    v_cvt_pk_bf16_f32 v182, v188, v189
    v_cvt_pk_bf16_f32 v183, v190, v191
    v_accvgpr_write_b32 a24, v176
    v_accvgpr_write_b32 a25, v177
    v_accvgpr_write_b32 a26, v178
    v_accvgpr_write_b32 a27, v179
    v_accvgpr_write_b32 a28, v180
    v_accvgpr_write_b32 a29, v181
    v_accvgpr_write_b32 a30, v182
    v_accvgpr_write_b32 a31, v183
    v_mfma_f32_32x32x16_bf16 v[176:191], v[124:127], v[124:127], 0
    s_nop 0
    v_mfma_f32_16x16x32_bf16 v[24:27], a[128:131], a[16:19], 0
    v_mfma_f32_16x16x32_bf16 v[24:27], a[132:135], a[20:23], v[24:27]
    v_mfma_f32_16x16x32_bf16 v[24:27], a[136:139], a[24:27], v[24:27]
    v_mfma_f32_16x16x32_bf16 v[24:27], a[140:143], a[28:31], v[24:27]
    v_mfma_f32_16x16x32_bf16 v[28:31], a[144:147], a[16:19], 0
    v_mfma_f32_16x16x32_bf16 v[28:31], a[148:151], a[20:23], v[28:31]
    v_mfma_f32_16x16x32_bf16 v[28:31], a[152:155], a[24:27], v[28:31]
    v_mfma_f32_16x16x32_bf16 v[28:31], a[156:159], a[28:31], v[28:31]
    s_add_u32 m0, s30, 17408
    s_nop 0
    buffer_load_dwordx4 v4, s[8:11], s28 offen lds
    s_add_u32 m0, s30, 21632
    s_nop 0
    buffer_load_dwordx4 v5, s[8:11], s28 offen lds
    s_add_u32 m0, s30, 26112
    s_nop 0
    buffer_load_dwordx4 v6, s[12:15], s29 offen lds
    s_add_u32 m0, s30, 30336
    s_nop 0
    buffer_load_dwordx4 v7, s[12:15], s29 offen lds
    s_add_u32 s28, s28, s101
    s_add_u32 s29, s29, s101
    s_waitcnt vmcnt(4)
    ds_read_b128 a[96:99], v9 offset:8448
    ds_read_b128 a[100:103], v9 offset:8512
    ds_read_b128 a[104:107], v10 offset:8448
    ds_read_b128 a[108:111], v10 offset:8512
    s_waitcnt lgkmcnt(0)
    v_mfma_f32_32x32x16_bf16 v[192:207], a[192:195], a[96:99], 0
    v_mfma_f32_32x32x16_bf16 v[192:207], a[196:199], a[100:103], v[192:207]
    s_nop 3
    v_mfma_f32_32x32x16_bf16 v[192:207], a[200:203], a[96:99], v[192:207]
    s_add_u32 m0, s30, 34816
    v_max3_f32 v113, v24, v25, v26
    v_max3_f32 v117, v27, v28, v29
    v_max3_f32 v113, v113, v30, v31
    v_max_f32 v113, v113, v117
    v_mov_b32 v117, v113
    v_mfma_f32_32x32x16_bf16 v[192:207], a[204:207], a[100:103], v[192:207]
    buffer_load_dwordx4 v4, s[8:11], s28 offen lds
    s_nop 1
    v_permlane32_swap_b32 v113, v117
    v_max_f32 v113, v113, v117
    v_mov_b32 v117, v113
    s_nop 1
    v_mfma_f32_32x32x16_bf16 v[208:223], a[192:195], a[104:107], 0
    s_add_u32 m0, s30, 39040
    v_permlane16_swap_b32 v113, v117
    v_max_f32 v113, v113, v117
    v_sub_f32 v24, v24, v113
    v_sub_f32 v25, v25, v113
    v_sub_f32 v26, v26, v113
    v_mfma_f32_32x32x16_bf16 v[208:223], a[196:199], a[108:111], v[208:223]
    buffer_load_dwordx4 v5, s[8:11], s28 offen lds
    v_sub_f32 v27, v27, v113
    v_sub_f32 v28, v28, v113
    v_sub_f32 v29, v29, v113
    v_sub_f32 v30, v30, v113
    v_sub_f32 v31, v31, v113
    v_mfma_f32_32x32x16_bf16 v[208:223], a[200:203], a[104:107], v[208:223]
    s_add_u32 m0, s30, 43520
    v_sub_f32 v84, 0, v113
    v_sub_f32 v85, 0, v113
    v_sub_f32 v86, 0, v113
    v_sub_f32 v87, 0, v113
    v_exp_f32 v24, v24
    v_mfma_f32_32x32x16_bf16 v[208:223], a[204:207], a[108:111], v[208:223]
    buffer_load_dwordx4 v6, s[12:15], s29 offen lds
    v_exp_f32 v25, v25
    v_exp_f32 v26, v26
    v_cvt_pk_bf16_f32 v20, v24, v25
    s_add_u32 m0, s30, 47744
    s_nop 0
    buffer_load_dwordx4 v7, s[12:15], s29 offen lds
    s_add_u32 s28, s28, s101
    s_add_u32 s29, s29, s101
    v_cvt_pk_bf16_f32 v192, v192, v193
    v_cvt_pk_bf16_f32 v193, v194, v195
    v_cvt_pk_bf16_f32 v194, v196, v197
    v_cvt_pk_bf16_f32 v195, v198, v199
    v_cvt_pk_bf16_f32 v196, v200, v201
    v_cvt_pk_bf16_f32 v197, v202, v203
    v_cvt_pk_bf16_f32 v198, v204, v205
    v_cvt_pk_bf16_f32 v199, v206, v207
    v_accvgpr_write_b32 a32, v192
    v_accvgpr_write_b32 a33, v193
    v_accvgpr_write_b32 a34, v194
    v_accvgpr_write_b32 a35, v195
    v_accvgpr_write_b32 a36, v196
    v_accvgpr_write_b32 a37, v197
    v_accvgpr_write_b32 a38, v198
    v_accvgpr_write_b32 a39, v199
    v_mfma_f32_32x32x16_bf16 v[192:207], v[124:127], v[124:127], 0
    v_cvt_pk_bf16_f32 v208, v208, v209
    v_cvt_pk_bf16_f32 v209, v210, v211
    v_cvt_pk_bf16_f32 v210, v212, v213
    v_cvt_pk_bf16_f32 v211, v214, v215
    v_cvt_pk_bf16_f32 v212, v216, v217
    v_cvt_pk_bf16_f32 v213, v218, v219
    v_cvt_pk_bf16_f32 v214, v220, v221
    v_cvt_pk_bf16_f32 v215, v222, v223
    v_accvgpr_write_b32 a40, v208
    v_accvgpr_write_b32 a41, v209
    v_accvgpr_write_b32 a42, v210
    v_accvgpr_write_b32 a43, v211
    v_accvgpr_write_b32 a44, v212
    v_accvgpr_write_b32 a45, v213
    v_accvgpr_write_b32 a46, v214
    v_accvgpr_write_b32 a47, v215
    v_mfma_f32_32x32x16_bf16 v[208:223], v[124:127], v[124:127], 0
    s_nop 0
    v_mfma_f32_16x16x32_bf16 v[32:35], a[128:131], a[32:35], 0
    ds_read_b128 a[128:131], v1 offset:0
    v_mfma_f32_16x16x32_bf16 v[32:35], a[132:135], a[36:39], v[32:35]
    ds_read_b128 a[132:135], v1 offset:64
    v_mfma_f32_16x16x32_bf16 v[32:35], a[136:139], a[40:43], v[32:35]
    ds_read_b128 a[136:139], v2 offset:0
    v_mfma_f32_16x16x32_bf16 v[32:35], a[140:143], a[44:47], v[32:35]
    ds_read_b128 a[140:143], v2 offset:64
    v_mfma_f32_16x16x32_bf16 v[36:39], a[144:147], a[32:35], 0
    ds_read_b128 a[144:147], v1 offset:4224
    v_mfma_f32_16x16x32_bf16 v[36:39], a[148:151], a[36:39], v[36:39]
    ds_read_b128 a[148:151], v1 offset:4288
    v_mfma_f32_16x16x32_bf16 v[36:39], a[152:155], a[40:43], v[36:39]
    ds_read_b128 a[152:155], v2 offset:4224
    v_mfma_f32_16x16x32_bf16 v[36:39], a[156:159], a[44:47], v[36:39]
    ds_read_b128 a[156:159], v2 offset:4288
    s_nop 6
    v_max3_f32 v114, v32, v33, v34
    s_mov_b32 m0, s99
    v_max3_f32 v118, v35, v36, v37
    buffer_load_dwordx4 v4, s[4:7], s86 offen lds
    v_max3_f32 v114, v114, v38, v39
    s_add_u32 s99, s99, 1056
    v_max_f32 v114, v114, v118
    s_min_u32 s99, s99, s100
    v_mov_b32 v118, v114
    s_add_u32 s86, s86, 16384
    s_nop 1
    s_min_u32 s86, s86, s96
    v_permlane32_swap_b32 v114, v118
    s_add_u32 m0, s30, 52224
    v_max_f32 v114, v114, v118
    buffer_load_dwordx4 v4, s[8:11], s28 offen lds
    v_mov_b32 v118, v114
    s_add_u32 m0, s30, 56448
    s_nop 1
    buffer_load_dwordx4 v5, s[8:11], s28 offen lds
    v_permlane16_swap_b32 v114, v118
    s_add_u32 m0, s30, 60928
    v_max_f32 v114, v114, v118
    buffer_load_dwordx4 v6, s[12:15], s29 offen lds
    v_sub_f32 v32, v32, v114
    s_add_u32 m0, s30, 65152
    v_sub_f32 v33, v33, v114
    buffer_load_dwordx4 v7, s[12:15], s29 offen lds
    v_sub_f32 v34, v34, v114
    s_add_u32 s28, s28, s101
    v_sub_f32 v35, v35, v114
    s_add_u32 s29, s29, s101
    v_sub_f32 v36, v36, v114
    v_sub_f32 v37, v37, v114
    v_sub_f32 v38, v38, v114
    v_sub_f32 v39, v39, v114
    v_sub_f32 v88, 0, v114
    v_sub_f32 v89, 0, v114
    v_sub_f32 v90, 0, v114
    v_sub_f32 v91, 0, v114
    s_waitcnt vmcnt(9) lgkmcnt(0)
    s_cmp_lg_u32 s90, 0
    s_cbranch_scc1 L_itb3x_1
    s_branch L_itb3_1
.p2align 6
    s_nop 0
L_itb4x_1:
    s_barrier
    v_mfma_f32_16x16x32_bf16 v[48:51], a[128:131], a[0:3], v[80:83]
    v_exp_f32 v41, v41
    v_mfma_f32_16x16x32_bf16 v[48:51], a[132:135], a[4:7], v[48:51]
    v_cvt_pk_bf16_f32 v36, v40, v41
    v_mfma_f32_16x16x32_bf16 v[48:51], a[136:139], a[8:11], v[48:51]
    v_exp_f32 v42, v42
    v_mfma_f32_16x16x32_bf16 v[48:51], a[140:143], a[12:15], v[48:51]
    ds_read_b64_tr_b16 a[160:161], v3 offset:17408
    v_mfma_f32_16x16x32_bf16 v[52:55], a[144:147], a[0:3], v[80:83]
    v_exp_f32 v43, v43
    v_mfma_f32_16x16x32_bf16 v[52:55], a[148:151], a[4:7], v[52:55]
    ds_read_b64_tr_b16 a[162:163], v3 offset:17920
    v_cvt_pk_bf16_f32 v37, v42, v43
    v_mfma_f32_16x16x32_bf16 v[52:55], a[152:155], a[8:11], v[52:55]
    v_exp_f32 v44, v44
    v_mfma_f32_16x16x32_bf16 v[52:55], a[156:159], a[12:15], v[52:55]
    ds_read_b64_tr_b16 a[164:165], v3 offset:17440
    v_mfma_f32_16x16x32_bf16 v[56:59], a[128:131], a[16:19], v[84:87]
    v_exp_f32 v45, v45
    v_mfma_f32_16x16x32_bf16 v[56:59], a[132:135], a[20:23], v[56:59]
    ds_read_b64_tr_b16 a[166:167], v3 offset:17952
    v_cvt_pk_bf16_f32 v38, v44, v45
    v_mfma_f32_16x16x32_bf16 v[56:59], a[136:139], a[24:27], v[56:59]
    v_exp_f32 v46, v46
    v_mfma_f32_16x16x32_bf16 v[56:59], a[140:143], a[28:31], v[56:59]
    ds_read_b64_tr_b16 a[168:169], v3 offset:17472
    v_mfma_f32_16x16x32_bf16 v[60:63], a[144:147], a[16:19], v[84:87]
    v_exp_f32 v47, v47
    v_mfma_f32_16x16x32_bf16 v[60:63], a[148:151], a[20:23], v[60:63]
    ds_read_b64_tr_b16 a[170:171], v3 offset:17984
    v_cvt_pk_bf16_f32 v39, v46, v47
    v_mfma_f32_16x16x32_bf16 v[60:63], a[152:155], a[24:27], v[60:63]
    ds_read_b64_tr_b16 a[172:173], v3 offset:17504
    v_mfma_f32_16x16x32_bf16 v[60:63], a[156:159], a[28:31], v[60:63]
    v_exp_f32 v48, v48
    v_mfma_f32_16x16x32_bf16 v[64:67], a[128:131], a[32:35], v[88:91]
    ds_read_b64_tr_b16 a[174:175], v3 offset:18016
    v_mfma_f32_16x16x32_bf16 v[64:67], a[132:135], a[36:39], v[64:67]
    v_exp_f32 v49, v49
    v_mfma_f32_16x16x32_bf16 v[64:67], a[136:139], a[40:43], v[64:67]
    ds_read_b64_tr_b16 a[176:177], v3 offset:17536
    v_cvt_pk_bf16_f32 v48, v48, v49
    v_mfma_f32_16x16x32_bf16 v[64:67], a[140:143], a[44:47], v[64:67]
    v_exp_f32 v50, v50
    v_mfma_f32_16x16x32_bf16 v[68:71], a[144:147], a[32:35], v[88:91]
    ds_read_b64_tr_b16 a[178:179], v3 offset:18048
    v_mfma_f32_16x16x32_bf16 v[68:71], a[148:151], a[36:39], v[68:71]
    s_mov_b32 m0, s99
    v_exp_f32 v51, v51
    v_mfma_f32_16x16x32_bf16 v[68:71], a[152:155], a[40:43], v[68:71]
    ds_read_b64_tr_b16 a[180:181], v3 offset:17568
    v_cvt_pk_bf16_f32 v49, v50, v51
    v_mfma_f32_16x16x32_bf16 v[68:71], a[156:159], a[44:47], v[68:71]
    v_exp_f32 v52, v52
    v_mfma_f32_16x16x32_bf16 v[72:75], a[128:131], a[48:51], v[92:95]
    ds_read_b64_tr_b16 a[182:183], v3 offset:18080
    buffer_load_dwordx4 v4, s[4:7], s86 offen lds
    v_mfma_f32_16x16x32_bf16 v[72:75], a[132:135], a[52:55], v[72:75]
    v_exp_f32 v53, v53
    v_mfma_f32_16x16x32_bf16 v[72:75], a[136:139], a[56:59], v[72:75]
    ds_read_b64_tr_b16 a[184:185], v3 offset:17600
    v_cvt_pk_bf16_f32 v50, v52, v53
    v_mfma_f32_16x16x32_bf16 v[72:75], a[140:143], a[60:63], v[72:75]
    s_add_u32 m0, s30, 0
    v_exp_f32 v54, v54
    v_mfma_f32_16x16x32_bf16 v[76:79], a[144:147], a[48:51], v[92:95]
    ds_read_b64_tr_b16 a[186:187], v3 offset:18112
    s_add_u32 s99, s99, 1056
    v_mfma_f32_16x16x32_bf16 v[76:79], a[148:151], a[52:55], v[76:79]
    v_exp_f32 v55, v55
    v_mfma_f32_16x16x32_bf16 v[76:79], a[152:155], a[56:59], v[76:79]
    ds_read_b64_tr_b16 a[188:189], v3 offset:17632
    v_cvt_pk_bf16_f32 v51, v54, v55
    v_mfma_f32_16x16x32_bf16 v[76:79], a[156:159], a[60:63], v[76:79]
    ds_read_b64_tr_b16 a[190:191], v3 offset:18144
    v_exp_f32 v56, v56
    s_waitcnt lgkmcnt(2)
    v_mfma_f32_16x16x32_bf16 v[128:131], a[160:163], v[16:19], v[128:131]
    buffer_load_dwordx4 v4, s[8:11], s28 offen lds
    v_mfma_f32_16x16x32_bf16 v[132:135], a[164:167], v[16:19], v[132:135]
    v_exp_f32 v57, v57
    v_mfma_f32_16x16x32_bf16 v[136:139], a[168:171], v[16:19], v[136:139]
    s_add_u32 m0, s30, 4224
    v_cvt_pk_bf16_f32 v52, v56, v57
    v_mfma_f32_16x16x32_bf16 v[140:143], a[172:175], v[16:19], v[140:143]
    v_exp_f32 v58, v58
    v_mfma_f32_16x16x32_bf16 v[144:147], a[176:179], v[16:19], v[144:147]
    buffer_load_dwordx4 v5, s[8:11], s28 offen lds
    v_mfma_f32_16x16x32_bf16 v[148:151], a[180:183], v[16:19], v[148:151]
    s_min_u32 s99, s99, s100
    v_exp_f32 v59, v59
    v_mfma_f32_16x16x32_bf16 v[152:155], a[184:187], v[16:19], v[152:155]
    s_add_u32 m0, s30, 8704
    v_cvt_pk_bf16_f32 v53, v58, v59
    s_waitcnt lgkmcnt(0)
    v_mfma_f32_16x16x32_bf16 v[156:159], a[188:191], v[16:19], v[156:159]
    v_exp_f32 v60, v60
    v_mfma_f32_16x16x32_bf16 v[160:163], a[160:163], v[20:23], v[160:163]
    ds_read_b128 a[128:131], v1 offset:17408
    v_mfma_f32_16x16x32_bf16 v[164:167], a[164:167], v[20:23], v[164:167]
    v_exp_f32 v61, v61
    v_mfma_f32_16x16x32_bf16 v[168:171], a[168:171], v[20:23], v[168:171]
    buffer_load_dwordx4 v6, s[12:15], s29 offen lds
    v_cvt_pk_bf16_f32 v54, v60, v61
    v_mfma_f32_16x16x32_bf16 v[172:175], a[172:175], v[20:23], v[172:175]
    v_exp_f32 v62, v62
    v_mfma_f32_16x16x32_bf16 v[176:179], a[176:179], v[20:23], v[176:179]
    ds_read_b128 a[132:135], v1 offset:17472
    v_mfma_f32_16x16x32_bf16 v[180:183], a[180:183], v[20:23], v[180:183]
    s_add_u32 s86, s86, 16384
    v_exp_f32 v63, v63
    v_mfma_f32_16x16x32_bf16 v[184:187], a[184:187], v[20:23], v[184:187]
    s_add_u32 m0, s30, 12928
    v_cvt_pk_bf16_f32 v55, v62, v63
    v_mfma_f32_16x16x32_bf16 v[188:191], a[188:191], v[20:23], v[188:191]
    ds_read_b128 a[136:139], v2 offset:17408
    v_smfmac_f32_16x16x64_bf16 a[208:211], a[228:231], v[16:23], v15
    buffer_load_dwordx4 v7, s[12:15], s29 offen lds
    v_exp_f32 v64, v64
    v_mfma_f32_16x16x32_bf16 v[192:195], a[160:163], v[32:35], v[192:195]
    ds_read_b128 a[140:143], v2 offset:17472
    v_mfma_f32_16x16x32_bf16 v[196:199], a[164:167], v[32:35], v[196:199]
    v_exp_f32 v65, v65
    v_mfma_f32_16x16x32_bf16 v[200:203], a[168:171], v[32:35], v[200:203]
    ds_read_b128 a[144:147], v1 offset:21632
    v_cvt_pk_bf16_f32 v64, v64, v65
    v_mfma_f32_16x16x32_bf16 v[204:207], a[172:175], v[32:35], v[204:207]
    v_exp_f32 v66, v66
    v_mfma_f32_16x16x32_bf16 v[208:211], a[176:179], v[32:35], v[208:211]
    ds_read_b128 a[148:151], v1 offset:21696
    v_mfma_f32_16x16x32_bf16 v[212:215], a[180:183], v[32:35], v[212:215]
    v_exp_f32 v67, v67
    v_mfma_f32_16x16x32_bf16 v[216:219], a[184:187], v[32:35], v[216:219]
    s_min_u32 s86, s86, s96
    v_cvt_pk_bf16_f32 v65, v66, v67
    v_mfma_f32_16x16x32_bf16 v[220:223], a[188:191], v[32:35], v[220:223]
    v_exp_f32 v68, v68
    v_mfma_f32_16x16x32_bf16 v[224:227], a[160:163], v[36:39], v[224:227]
    ds_read_b128 a[152:155], v2 offset:21632
    v_mfma_f32_16x16x32_bf16 v[228:231], a[164:167], v[36:39], v[228:231]
    v_exp_f32 v69, v69
    v_mfma_f32_16x16x32_bf16 v[232:235], a[168:171], v[36:39], v[232:235]
    ds_read_b128 a[156:159], v2 offset:21696
    v_cvt_pk_bf16_f32 v66, v68, v69
    v_mfma_f32_16x16x32_bf16 v[236:239], a[172:175], v[36:39], v[236:239]
    s_add_u32 s28, s28, s101
    v_exp_f32 v70, v70
    v_mfma_f32_16x16x32_bf16 v[240:243], a[176:179], v[36:39], v[240:243]
    s_add_u32 s29, s29, s101
    v_mfma_f32_16x16x32_bf16 v[244:247], a[180:183], v[36:39], v[244:247]
    s_sub_u32 s31, s31, 1
    v_exp_f32 v71, v71
    v_mfma_f32_16x16x32_bf16 v[248:251], a[184:187], v[36:39], v[248:251]
    s_cmp_le_u32 s31, s32
    v_cvt_pk_bf16_f32 v67, v70, v71
    v_mfma_f32_16x16x32_bf16 v[252:255], a[188:191], v[36:39], v[252:255]
    s_waitcnt vmcnt(10) lgkmcnt(0)
    v_exp_f32 v72, v72
    v_smfmac_f32_16x16x64_bf16 a[212:215], a[228:231], v[32:39], v15
    s_cbranch_scc1 L_sp4x_2
L_itb4x_2:
    s_barrier
    v_mfma_f32_16x16x32_bf16 v[16:19], a[128:131], a[0:3], v[80:83]
    v_exp_f32 v73, v73
    v_mfma_f32_16x16x32_bf16 v[16:19], a[132:135], a[4:7], v[16:19]
    v_cvt_pk_bf16_f32 v68, v72, v73
    v_mfma_f32_16x16x32_bf16 v[16:19], a[136:139], a[8:11], v[16:19]
    v_exp_f32 v74, v74
    v_mfma_f32_16x16x32_bf16 v[16:19], a[140:143], a[12:15], v[16:19]
    ds_read_b64_tr_b16 a[160:161], v3 offset:34816
    v_mfma_f32_16x16x32_bf16 v[20:23], a[144:147], a[0:3], v[80:83]
    v_exp_f32 v75, v75
    v_mfma_f32_16x16x32_bf16 v[20:23], a[148:151], a[4:7], v[20:23]
    ds_read_b64_tr_b16 a[162:163], v3 offset:35328
    v_cvt_pk_bf16_f32 v69, v74, v75
    v_mfma_f32_16x16x32_bf16 v[20:23], a[152:155], a[8:11], v[20:23]
    v_exp_f32 v76, v76
    v_mfma_f32_16x16x32_bf16 v[20:23], a[156:159], a[12:15], v[20:23]
    ds_read_b64_tr_b16 a[164:165], v3 offset:34848
    v_mfma_f32_16x16x32_bf16 v[24:27], a[128:131], a[16:19], v[84:87]
    v_exp_f32 v77, v77
    v_mfma_f32_16x16x32_bf16 v[24:27], a[132:135], a[20:23], v[24:27]
    ds_read_b64_tr_b16 a[166:167], v3 offset:35360
    v_cvt_pk_bf16_f32 v70, v76, v77
    v_mfma_f32_16x16x32_bf16 v[24:27], a[136:139], a[24:27], v[24:27]
    v_exp_f32 v78, v78
    v_mfma_f32_16x16x32_bf16 v[24:27], a[140:143], a[28:31], v[24:27]
    ds_read_b64_tr_b16 a[168:169], v3 offset:34880
    v_mfma_f32_16x16x32_bf16 v[28:31], a[144:147], a[16:19], v[84:87]
    v_exp_f32 v79, v79
    v_mfma_f32_16x16x32_bf16 v[28:31], a[148:151], a[20:23], v[28:31]
    ds_read_b64_tr_b16 a[170:171], v3 offset:35392
    v_cvt_pk_bf16_f32 v71, v78, v79
    v_mfma_f32_16x16x32_bf16 v[28:31], a[152:155], a[24:27], v[28:31]
    ds_read_b64_tr_b16 a[172:173], v3 offset:34912
    v_mfma_f32_16x16x32_bf16 v[28:31], a[156:159], a[28:31], v[28:31]
    v_exp_f32 v16, v16
    v_mfma_f32_16x16x32_bf16 v[32:35], a[128:131], a[32:35], v[88:91]
    ds_read_b64_tr_b16 a[174:175], v3 offset:35424
    v_mfma_f32_16x16x32_bf16 v[32:35], a[132:135], a[36:39], v[32:35]
    v_exp_f32 v17, v17
    v_mfma_f32_16x16x32_bf16 v[32:35], a[136:139], a[40:43], v[32:35]
    ds_read_b64_tr_b16 a[176:177], v3 offset:34944
    v_cvt_pk_bf16_f32 v16, v16, v17
    v_mfma_f32_16x16x32_bf16 v[32:35], a[140:143], a[44:47], v[32:35]
    v_exp_f32 v18, v18
    v_mfma_f32_16x16x32_bf16 v[36:39], a[144:147], a[32:35], v[88:91]
    ds_read_b64_tr_b16 a[178:179], v3 offset:35456
    v_mfma_f32_16x16x32_bf16 v[36:39], a[148:151], a[36:39], v[36:39]
    s_mov_b32 m0, s99
    v_exp_f32 v19, v19
    v_mfma_f32_16x16x32_bf16 v[36:39], a[152:155], a[40:43], v[36:39]
    ds_read_b64_tr_b16 a[180:181], v3 offset:34976
    v_cvt_pk_bf16_f32 v17, v18, v19
    v_mfma_f32_16x16x32_bf16 v[36:39], a[156:159], a[44:47], v[36:39]
    v_exp_f32 v20, v20
    v_mfma_f32_16x16x32_bf16 v[40:43], a[128:131], a[48:51], v[92:95]
    ds_read_b64_tr_b16 a[182:183], v3 offset:35488
    buffer_load_dwordx4 v4, s[4:7], s86 offen lds
    v_mfma_f32_16x16x32_bf16 v[40:43], a[132:135], a[52:55], v[40:43]
    v_exp_f32 v21, v21
    v_mfma_f32_16x16x32_bf16 v[40:43], a[136:139], a[56:59], v[40:43]
    ds_read_b64_tr_b16 a[184:185], v3 offset:35008
    v_cvt_pk_bf16_f32 v18, v20, v21
    v_mfma_f32_16x16x32_bf16 v[40:43], a[140:143], a[60:63], v[40:43]
    s_add_u32 m0, s30, 17408
    v_exp_f32 v22, v22
    v_mfma_f32_16x16x32_bf16 v[44:47], a[144:147], a[48:51], v[92:95]
    ds_read_b64_tr_b16 a[186:187], v3 offset:35520
    s_add_u32 s99, s99, 1056
    v_mfma_f32_16x16x32_bf16 v[44:47], a[148:151], a[52:55], v[44:47]
    v_exp_f32 v23, v23
    v_mfma_f32_16x16x32_bf16 v[44:47], a[152:155], a[56:59], v[44:47]
    ds_read_b64_tr_b16 a[188:189], v3 offset:35040
    v_cvt_pk_bf16_f32 v19, v22, v23
    v_mfma_f32_16x16x32_bf16 v[44:47], a[156:159], a[60:63], v[44:47]
    ds_read_b64_tr_b16 a[190:191], v3 offset:35552
    v_exp_f32 v24, v24
    s_waitcnt lgkmcnt(2)
    v_mfma_f32_16x16x32_bf16 v[128:131], a[160:163], v[48:51], v[128:131]
    buffer_load_dwordx4 v4, s[8:11], s28 offen lds
    v_mfma_f32_16x16x32_bf16 v[132:135], a[164:167], v[48:51], v[132:135]
    v_exp_f32 v25, v25
    v_mfma_f32_16x16x32_bf16 v[136:139], a[168:171], v[48:51], v[136:139]
    s_add_u32 m0, s30, 21632
    v_cvt_pk_bf16_f32 v20, v24, v25
    v_mfma_f32_16x16x32_bf16 v[140:143], a[172:175], v[48:51], v[140:143]
    v_exp_f32 v26, v26
    v_mfma_f32_16x16x32_bf16 v[144:147], a[176:179], v[48:51], v[144:147]
    buffer_load_dwordx4 v5, s[8:11], s28 offen lds
    v_mfma_f32_16x16x32_bf16 v[148:151], a[180:183], v[48:51], v[148:151]
    s_min_u32 s99, s99, s100
    v_exp_f32 v27, v27
    v_mfma_f32_16x16x32_bf16 v[152:155], a[184:187], v[48:51], v[152:155]
    s_add_u32 m0, s30, 26112
    v_cvt_pk_bf16_f32 v21, v26, v27
    s_waitcnt lgkmcnt(0)
    v_mfma_f32_16x16x32_bf16 v[156:159], a[188:191], v[48:51], v[156:159]
    v_exp_f32 v28, v28
    v_mfma_f32_16x16x32_bf16 v[160:163], a[160:163], v[52:55], v[160:163]
    ds_read_b128 a[128:131], v1 offset:34816
    v_mfma_f32_16x16x32_bf16 v[164:167], a[164:167], v[52:55], v[164:167]
    v_exp_f32 v29, v29
    v_mfma_f32_16x16x32_bf16 v[168:171], a[168:171], v[52:55], v[168:171]
    buffer_load_dwordx4 v6, s[12:15], s29 offen lds
    v_cvt_pk_bf16_f32 v22, v28, v29
    v_mfma_f32_16x16x32_bf16 v[172:175], a[172:175], v[52:55], v[172:175]
    v_exp_f32 v30, v30
    v_mfma_f32_16x16x32_bf16 v[176:179], a[176:179], v[52:55], v[176:179]
    ds_read_b128 a[132:135], v1 offset:34880
    v_mfma_f32_16x16x32_bf16 v[180:183], a[180:183], v[52:55], v[180:183]
    s_add_u32 s86, s86, 16384
    v_exp_f32 v31, v31
    v_mfma_f32_16x16x32_bf16 v[184:187], a[184:187], v[52:55], v[184:187]
    s_add_u32 m0, s30, 30336
    v_cvt_pk_bf16_f32 v23, v30, v31
    v_mfma_f32_16x16x32_bf16 v[188:191], a[188:191], v[52:55], v[188:191]
    ds_read_b128 a[136:139], v2 offset:34816
    v_smfmac_f32_16x16x64_bf16 a[208:211], a[228:231], v[48:55], v15
    buffer_load_dwordx4 v7, s[12:15], s29 offen lds
    v_exp_f32 v32, v32
    v_mfma_f32_16x16x32_bf16 v[192:195], a[160:163], v[64:67], v[192:195]
    ds_read_b128 a[140:143], v2 offset:34880
    v_mfma_f32_16x16x32_bf16 v[196:199], a[164:167], v[64:67], v[196:199]
    v_exp_f32 v33, v33
    v_mfma_f32_16x16x32_bf16 v[200:203], a[168:171], v[64:67], v[200:203]
    ds_read_b128 a[144:147], v1 offset:39040
    v_cvt_pk_bf16_f32 v32, v32, v33
    v_mfma_f32_16x16x32_bf16 v[204:207], a[172:175], v[64:67], v[204:207]
    v_exp_f32 v34, v34
    v_mfma_f32_16x16x32_bf16 v[208:211], a[176:179], v[64:67], v[208:211]
    ds_read_b128 a[148:151], v1 offset:39104
    v_mfma_f32_16x16x32_bf16 v[212:215], a[180:183], v[64:67], v[212:215]
    v_exp_f32 v35, v35
    v_mfma_f32_16x16x32_bf16 v[216:219], a[184:187], v[64:67], v[216:219]
    s_min_u32 s86, s86, s96
    v_cvt_pk_bf16_f32 v33, v34, v35
    v_mfma_f32_16x16x32_bf16 v[220:223], a[188:191], v[64:67], v[220:223]
    v_exp_f32 v36, v36
    v_mfma_f32_16x16x32_bf16 v[224:227], a[160:163], v[68:71], v[224:227]
    ds_read_b128 a[152:155], v2 offset:39040
    v_mfma_f32_16x16x32_bf16 v[228:231], a[164:167], v[68:71], v[228:231]
    v_exp_f32 v37, v37
    v_mfma_f32_16x16x32_bf16 v[232:235], a[168:171], v[68:71], v[232:235]
    ds_read_b128 a[156:159], v2 offset:39104
    v_cvt_pk_bf16_f32 v34, v36, v37
    v_mfma_f32_16x16x32_bf16 v[236:239], a[172:175], v[68:71], v[236:239]
    s_add_u32 s28, s28, s101
    v_exp_f32 v38, v38
    v_mfma_f32_16x16x32_bf16 v[240:243], a[176:179], v[68:71], v[240:243]
    s_add_u32 s29, s29, s101
    v_mfma_f32_16x16x32_bf16 v[244:247], a[180:183], v[68:71], v[244:247]
    s_sub_u32 s31, s31, 1
    v_exp_f32 v39, v39
    v_mfma_f32_16x16x32_bf16 v[248:251], a[184:187], v[68:71], v[248:251]
    s_cmp_le_u32 s31, s32
    v_cvt_pk_bf16_f32 v35, v38, v39
    v_mfma_f32_16x16x32_bf16 v[252:255], a[188:191], v[68:71], v[252:255]
    s_waitcnt vmcnt(10) lgkmcnt(0)
    v_exp_f32 v40, v40
    v_smfmac_f32_16x16x64_bf16 a[212:215], a[228:231], v[64:71], v15
    s_cbranch_scc1 L_sp4x_3
L_itb4x_3:
    s_barrier
    v_mfma_f32_16x16x32_bf16 v[48:51], a[128:131], a[0:3], v[80:83]
    v_exp_f32 v41, v41
    v_mfma_f32_16x16x32_bf16 v[48:51], a[132:135], a[4:7], v[48:51]
    v_cvt_pk_bf16_f32 v36, v40, v41
    v_mfma_f32_16x16x32_bf16 v[48:51], a[136:139], a[8:11], v[48:51]
    v_exp_f32 v42, v42
    v_mfma_f32_16x16x32_bf16 v[48:51], a[140:143], a[12:15], v[48:51]
    ds_read_b64_tr_b16 a[160:161], v3 offset:52224
    v_mfma_f32_16x16x32_bf16 v[52:55], a[144:147], a[0:3], v[80:83]
    v_exp_f32 v43, v43
    v_mfma_f32_16x16x32_bf16 v[52:55], a[148:151], a[4:7], v[52:55]
    ds_read_b64_tr_b16 a[162:163], v3 offset:52736
    v_cvt_pk_bf16_f32 v37, v42, v43
    v_mfma_f32_16x16x32_bf16 v[52:55], a[152:155], a[8:11], v[52:55]
    v_exp_f32 v44, v44
    v_mfma_f32_16x16x32_bf16 v[52:55], a[156:159], a[12:15], v[52:55]
    ds_read_b64_tr_b16 a[164:165], v3 offset:52256
    v_mfma_f32_16x16x32_bf16 v[56:59], a[128:131], a[16:19], v[84:87]
    v_exp_f32 v45, v45
    v_mfma_f32_16x16x32_bf16 v[56:59], a[132:135], a[20:23], v[56:59]
    ds_read_b64_tr_b16 a[166:167], v3 offset:52768
    v_cvt_pk_bf16_f32 v38, v44, v45
    v_mfma_f32_16x16x32_bf16 v[56:59], a[136:139], a[24:27], v[56:59]
    v_exp_f32 v46, v46
    v_mfma_f32_16x16x32_bf16 v[56:59], a[140:143], a[28:31], v[56:59]
    ds_read_b64_tr_b16 a[168:169], v3 offset:52288
    v_mfma_f32_16x16x32_bf16 v[60:63], a[144:147], a[16:19], v[84:87]
    v_exp_f32 v47, v47
    v_mfma_f32_16x16x32_bf16 v[60:63], a[148:151], a[20:23], v[60:63]
    ds_read_b64_tr_b16 a[170:171], v3 offset:52800
    v_cvt_pk_bf16_f32 v39, v46, v47
    v_mfma_f32_16x16x32_bf16 v[60:63], a[152:155], a[24:27], v[60:63]
    ds_read_b64_tr_b16 a[172:173], v3 offset:52320
    v_mfma_f32_16x16x32_bf16 v[60:63], a[156:159], a[28:31], v[60:63]
    v_exp_f32 v48, v48
    v_mfma_f32_16x16x32_bf16 v[64:67], a[128:131], a[32:35], v[88:91]
    ds_read_b64_tr_b16 a[174:175], v3 offset:52832
    v_mfma_f32_16x16x32_bf16 v[64:67], a[132:135], a[36:39], v[64:67]
    v_exp_f32 v49, v49
    v_mfma_f32_16x16x32_bf16 v[64:67], a[136:139], a[40:43], v[64:67]
    ds_read_b64_tr_b16 a[176:177], v3 offset:52352
    v_cvt_pk_bf16_f32 v48, v48, v49
    v_mfma_f32_16x16x32_bf16 v[64:67], a[140:143], a[44:47], v[64:67]
    v_exp_f32 v50, v50
    v_mfma_f32_16x16x32_bf16 v[68:71], a[144:147], a[32:35], v[88:91]
    ds_read_b64_tr_b16 a[178:179], v3 offset:52864
    v_mfma_f32_16x16x32_bf16 v[68:71], a[148:151], a[36:39], v[68:71]
    s_mov_b32 m0, s99
    v_exp_f32 v51, v51
    v_mfma_f32_16x16x32_bf16 v[68:71], a[152:155], a[40:43], v[68:71]
    ds_read_b64_tr_b16 a[180:181], v3 offset:52384
    v_cvt_pk_bf16_f32 v49, v50, v51
    v_mfma_f32_16x16x32_bf16 v[68:71], a[156:159], a[44:47], v[68:71]
    v_exp_f32 v52, v52
    v_mfma_f32_16x16x32_bf16 v[72:75], a[128:131], a[48:51], v[92:95]
    ds_read_b64_tr_b16 a[182:183], v3 offset:52896
    buffer_load_dwordx4 v4, s[4:7], s86 offen lds
    v_mfma_f32_16x16x32_bf16 v[72:75], a[132:135], a[52:55], v[72:75]
    v_exp_f32 v53, v53
    v_mfma_f32_16x16x32_bf16 v[72:75], a[136:139], a[56:59], v[72:75]
    ds_read_b64_tr_b16 a[184:185], v3 offset:52416
    v_cvt_pk_bf16_f32 v50, v52, v53
    v_mfma_f32_16x16x32_bf16 v[72:75], a[140:143], a[60:63], v[72:75]
    s_add_u32 m0, s30, 34816
    v_exp_f32 v54, v54
    v_mfma_f32_16x16x32_bf16 v[76:79], a[144:147], a[48:51], v[92:95]
    ds_read_b64_tr_b16 a[186:187], v3 offset:52928
    s_add_u32 s99, s99, 1056
    v_mfma_f32_16x16x32_bf16 v[76:79], a[148:151], a[52:55], v[76:79]
    v_exp_f32 v55, v55
    v_mfma_f32_16x16x32_bf16 v[76:79], a[152:155], a[56:59], v[76:79]
    ds_read_b64_tr_b16 a[188:189], v3 offset:52448
    v_cvt_pk_bf16_f32 v51, v54, v55
    v_mfma_f32_16x16x32_bf16 v[76:79], a[156:159], a[60:63], v[76:79]
    ds_read_b64_tr_b16 a[190:191], v3 offset:52960
    v_exp_f32 v56, v56
    s_waitcnt lgkmcnt(2)
    v_mfma_f32_16x16x32_bf16 v[128:131], a[160:163], v[16:19], v[128:131]
    buffer_load_dwordx4 v4, s[8:11], s28 offen lds
    v_mfma_f32_16x16x32_bf16 v[132:135], a[164:167], v[16:19], v[132:135]
    v_exp_f32 v57, v57
    v_mfma_f32_16x16x32_bf16 v[136:139], a[168:171], v[16:19], v[136:139]
    s_add_u32 m0, s30, 39040
    v_cvt_pk_bf16_f32 v52, v56, v57
    v_mfma_f32_16x16x32_bf16 v[140:143], a[172:175], v[16:19], v[140:143]
    v_exp_f32 v58, v58
    v_mfma_f32_16x16x32_bf16 v[144:147], a[176:179], v[16:19], v[144:147]
    buffer_load_dwordx4 v5, s[8:11], s28 offen lds
    v_mfma_f32_16x16x32_bf16 v[148:151], a[180:183], v[16:19], v[148:151]
    s_min_u32 s99, s99, s100
    v_exp_f32 v59, v59
    v_mfma_f32_16x16x32_bf16 v[152:155], a[184:187], v[16:19], v[152:155]
    s_add_u32 m0, s30, 43520
    v_cvt_pk_bf16_f32 v53, v58, v59
    s_waitcnt lgkmcnt(0)
    v_mfma_f32_16x16x32_bf16 v[156:159], a[188:191], v[16:19], v[156:159]
    v_exp_f32 v60, v60
    v_mfma_f32_16x16x32_bf16 v[160:163], a[160:163], v[20:23], v[160:163]
    ds_read_b128 a[128:131], v1 offset:52224
    v_mfma_f32_16x16x32_bf16 v[164:167], a[164:167], v[20:23], v[164:167]
    v_exp_f32 v61, v61
    v_mfma_f32_16x16x32_bf16 v[168:171], a[168:171], v[20:23], v[168:171]
    buffer_load_dwordx4 v6, s[12:15], s29 offen lds
    v_cvt_pk_bf16_f32 v54, v60, v61
    v_mfma_f32_16x16x32_bf16 v[172:175], a[172:175], v[20:23], v[172:175]
    v_exp_f32 v62, v62
    v_mfma_f32_16x16x32_bf16 v[176:179], a[176:179], v[20:23], v[176:179]
    ds_read_b128 a[132:135], v1 offset:52288
    v_mfma_f32_16x16x32_bf16 v[180:183], a[180:183], v[20:23], v[180:183]
    s_add_u32 s86, s86, 16384
    v_exp_f32 v63, v63
    v_mfma_f32_16x16x32_bf16 v[184:187], a[184:187], v[20:23], v[184:187]
    s_add_u32 m0, s30, 47744
    v_cvt_pk_bf16_f32 v55, v62, v63
    v_mfma_f32_16x16x32_bf16 v[188:191], a[188:191], v[20:23], v[188:191]
    ds_read_b128 a[136:139], v2 offset:52224
    v_smfmac_f32_16x16x64_bf16 a[208:211], a[228:231], v[16:23], v15
    buffer_load_dwordx4 v7, s[12:15], s29 offen lds
    v_exp_f32 v64, v64
    v_mfma_f32_16x16x32_bf16 v[192:195], a[160:163], v[32:35], v[192:195]
    ds_read_b128 a[140:143], v2 offset:52288
    v_mfma_f32_16x16x32_bf16 v[196:199], a[164:167], v[32:35], v[196:199]
    v_exp_f32 v65, v65
    v_mfma_f32_16x16x32_bf16 v[200:203], a[168:171], v[32:35], v[200:203]
    ds_read_b128 a[144:147], v1 offset:56448
    v_cvt_pk_bf16_f32 v64, v64, v65
    v_mfma_f32_16x16x32_bf16 v[204:207], a[172:175], v[32:35], v[204:207]
    v_exp_f32 v66, v66
    v_mfma_f32_16x16x32_bf16 v[208:211], a[176:179], v[32:35], v[208:211]
    ds_read_b128 a[148:151], v1 offset:56512
    v_mfma_f32_16x16x32_bf16 v[212:215], a[180:183], v[32:35], v[212:215]
    v_exp_f32 v67, v67
    v_mfma_f32_16x16x32_bf16 v[216:219], a[184:187], v[32:35], v[216:219]
    s_min_u32 s86, s86, s96
    v_cvt_pk_bf16_f32 v65, v66, v67
    v_mfma_f32_16x16x32_bf16 v[220:223], a[188:191], v[32:35], v[220:223]
    v_exp_f32 v68, v68
    v_mfma_f32_16x16x32_bf16 v[224:227], a[160:163], v[36:39], v[224:227]
    ds_read_b128 a[152:155], v2 offset:56448
    v_mfma_f32_16x16x32_bf16 v[228:231], a[164:167], v[36:39], v[228:231]
    v_exp_f32 v69, v69
    v_mfma_f32_16x16x32_bf16 v[232:235], a[168:171], v[36:39], v[232:235]
    ds_read_b128 a[156:159], v2 offset:56512
    v_cvt_pk_bf16_f32 v66, v68, v69
    v_mfma_f32_16x16x32_bf16 v[236:239], a[172:175], v[36:39], v[236:239]
    s_add_u32 s28, s28, s101
    v_exp_f32 v70, v70
    v_mfma_f32_16x16x32_bf16 v[240:243], a[176:179], v[36:39], v[240:243]
    s_add_u32 s29, s29, s101
    v_mfma_f32_16x16x32_bf16 v[244:247], a[180:183], v[36:39], v[244:247]
    s_sub_u32 s31, s31, 1
    v_exp_f32 v71, v71
    v_mfma_f32_16x16x32_bf16 v[248:251], a[184:187], v[36:39], v[248:251]
    s_cmp_le_u32 s31, s32
    v_cvt_pk_bf16_f32 v67, v70, v71
    v_mfma_f32_16x16x32_bf16 v[252:255], a[188:191], v[36:39], v[252:255]
    s_waitcnt vmcnt(10) lgkmcnt(0)
    v_exp_f32 v72, v72
    v_smfmac_f32_16x16x64_bf16 a[212:215], a[228:231], v[32:39], v15
    s_cbranch_scc1 L_sp4x_0
L_itb4x_0:
    s_barrier
    v_mfma_f32_16x16x32_bf16 v[16:19], a[128:131], a[0:3], v[80:83]
    v_exp_f32 v73, v73
    v_mfma_f32_16x16x32_bf16 v[16:19], a[132:135], a[4:7], v[16:19]
    v_cvt_pk_bf16_f32 v68, v72, v73
    v_mfma_f32_16x16x32_bf16 v[16:19], a[136:139], a[8:11], v[16:19]
    v_exp_f32 v74, v74
    v_mfma_f32_16x16x32_bf16 v[16:19], a[140:143], a[12:15], v[16:19]
    ds_read_b64_tr_b16 a[160:161], v3 offset:0
    v_mfma_f32_16x16x32_bf16 v[20:23], a[144:147], a[0:3], v[80:83]
    v_exp_f32 v75, v75
    v_mfma_f32_16x16x32_bf16 v[20:23], a[148:151], a[4:7], v[20:23]
    ds_read_b64_tr_b16 a[162:163], v3 offset:512
    v_cvt_pk_bf16_f32 v69, v74, v75
    v_mfma_f32_16x16x32_bf16 v[20:23], a[152:155], a[8:11], v[20:23]
    v_exp_f32 v76, v76
    v_mfma_f32_16x16x32_bf16 v[20:23], a[156:159], a[12:15], v[20:23]
    ds_read_b64_tr_b16 a[164:165], v3 offset:32
    v_mfma_f32_16x16x32_bf16 v[24:27], a[128:131], a[16:19], v[84:87]
    v_exp_f32 v77, v77
    v_mfma_f32_16x16x32_bf16 v[24:27], a[132:135], a[20:23], v[24:27]
    ds_read_b64_tr_b16 a[166:167], v3 offset:544
    v_cvt_pk_bf16_f32 v70, v76, v77
    v_mfma_f32_16x16x32_bf16 v[24:27], a[136:139], a[24:27], v[24:27]
    v_exp_f32 v78, v78
    v_mfma_f32_16x16x32_bf16 v[24:27], a[140:143], a[28:31], v[24:27]
    ds_read_b64_tr_b16 a[168:169], v3 offset:64
    v_mfma_f32_16x16x32_bf16 v[28:31], a[144:147], a[16:19], v[84:87]
    v_exp_f32 v79, v79
    v_mfma_f32_16x16x32_bf16 v[28:31], a[148:151], a[20:23], v[28:31]
    ds_read_b64_tr_b16 a[170:171], v3 offset:576
    v_cvt_pk_bf16_f32 v71, v78, v79
    v_mfma_f32_16x16x32_bf16 v[28:31], a[152:155], a[24:27], v[28:31]
    ds_read_b64_tr_b16 a[172:173], v3 offset:96
    v_mfma_f32_16x16x32_bf16 v[28:31], a[156:159], a[28:31], v[28:31]
    v_exp_f32 v16, v16
    v_mfma_f32_16x16x32_bf16 v[32:35], a[128:131], a[32:35], v[88:91]
    ds_read_b64_tr_b16 a[174:175], v3 offset:608
    v_mfma_f32_16x16x32_bf16 v[32:35], a[132:135], a[36:39], v[32:35]
    v_exp_f32 v17, v17
    v_mfma_f32_16x16x32_bf16 v[32:35], a[136:139], a[40:43], v[32:35]
    ds_read_b64_tr_b16 a[176:177], v3 offset:128
    v_cvt_pk_bf16_f32 v16, v16, v17
    v_mfma_f32_16x16x32_bf16 v[32:35], a[140:143], a[44:47], v[32:35]
    v_exp_f32 v18, v18
    v_mfma_f32_16x16x32_bf16 v[36:39], a[144:147], a[32:35], v[88:91]
    ds_read_b64_tr_b16 a[178:179], v3 offset:640
    v_mfma_f32_16x16x32_bf16 v[36:39], a[148:151], a[36:39], v[36:39]
    s_mov_b32 m0, s99
    v_exp_f32 v19, v19
    v_mfma_f32_16x16x32_bf16 v[36:39], a[152:155], a[40:43], v[36:39]
    ds_read_b64_tr_b16 a[180:181], v3 offset:160
    v_cvt_pk_bf16_f32 v17, v18, v19
    v_mfma_f32_16x16x32_bf16 v[36:39], a[156:159], a[44:47], v[36:39]
    v_exp_f32 v20, v20
    v_mfma_f32_16x16x32_bf16 v[40:43], a[128:131], a[48:51], v[92:95]
    ds_read_b64_tr_b16 a[182:183], v3 offset:672
    buffer_load_dwordx4 v4, s[4:7], s86 offen lds
    v_mfma_f32_16x16x32_bf16 v[40:43], a[132:135], a[52:55], v[40:43]
    v_exp_f32 v21, v21
    v_mfma_f32_16x16x32_bf16 v[40:43], a[136:139], a[56:59], v[40:43]
    ds_read_b64_tr_b16 a[184:185], v3 offset:192
    v_cvt_pk_bf16_f32 v18, v20, v21
    v_mfma_f32_16x16x32_bf16 v[40:43], a[140:143], a[60:63], v[40:43]
    s_add_u32 m0, s30, 52224
    v_exp_f32 v22, v22
    v_mfma_f32_16x16x32_bf16 v[44:47], a[144:147], a[48:51], v[92:95]
    ds_read_b64_tr_b16 a[186:187], v3 offset:704
    s_add_u32 s99, s99, 1056
    v_mfma_f32_16x16x32_bf16 v[44:47], a[148:151], a[52:55], v[44:47]
    v_exp_f32 v23, v23
    v_mfma_f32_16x16x32_bf16 v[44:47], a[152:155], a[56:59], v[44:47]
    ds_read_b64_tr_b16 a[188:189], v3 offset:224
    v_cvt_pk_bf16_f32 v19, v22, v23
    v_mfma_f32_16x16x32_bf16 v[44:47], a[156:159], a[60:63], v[44:47]
    ds_read_b64_tr_b16 a[190:191], v3 offset:736
    v_exp_f32 v24, v24
    s_waitcnt lgkmcnt(2)
    v_mfma_f32_16x16x32_bf16 v[128:131], a[160:163], v[48:51], v[128:131]
    buffer_load_dwordx4 v4, s[8:11], s28 offen lds
    v_mfma_f32_16x16x32_bf16 v[132:135], a[164:167], v[48:51], v[132:135]
    v_exp_f32_e64 v25, v25
    v_mfma_f32_16x16x32_bf16 v[136:139], a[168:171], v[48:51], v[136:139]
    s_add_u32 m0, s30, 56448
    v_cvt_pk_bf16_f32 v20, v24, v25
    v_mfma_f32_16x16x32_bf16 v[140:143], a[172:175], v[48:51], v[140:143]
    v_exp_f32 v26, v26
    v_mfma_f32_16x16x32_bf16 v[144:147], a[176:179], v[48:51], v[144:147]
    buffer_load_dwordx4 v5, s[8:11], s28 offen lds
    v_mfma_f32_16x16x32_bf16 v[148:151], a[180:183], v[48:51], v[148:151]
    s_min_u32 s99, s99, s100
    v_exp_f32 v27, v27
    v_mfma_f32_16x16x32_bf16 v[152:155], a[184:187], v[48:51], v[152:155]
    s_add_u32 m0, s30, 60928
    v_cvt_pk_bf16_f32 v21, v26, v27
    s_waitcnt lgkmcnt(0)
    v_mfma_f32_16x16x32_bf16 v[156:159], a[188:191], v[48:51], v[156:159]
    v_exp_f32 v28, v28
    v_mfma_f32_16x16x32_bf16 v[160:163], a[160:163], v[52:55], v[160:163]
    ds_read_b128 a[128:131], v1 offset:0
    v_mfma_f32_16x16x32_bf16 v[164:167], a[164:167], v[52:55], v[164:167]
    v_exp_f32 v29, v29
    v_mfma_f32_16x16x32_bf16 v[168:171], a[168:171], v[52:55], v[168:171]
    buffer_load_dwordx4 v6, s[12:15], s29 offen lds
    v_cvt_pk_bf16_f32 v22, v28, v29
    v_mfma_f32_16x16x32_bf16 v[172:175], a[172:175], v[52:55], v[172:175]
    v_exp_f32 v30, v30
    v_mfma_f32_16x16x32_bf16 v[176:179], a[176:179], v[52:55], v[176:179]
    ds_read_b128 a[132:135], v1 offset:64
    v_mfma_f32_16x16x32_bf16 v[180:183], a[180:183], v[52:55], v[180:183]
    s_add_u32 s86, s86, 16384
    v_exp_f32 v31, v31
    v_mfma_f32_16x16x32_bf16 v[184:187], a[184:187], v[52:55], v[184:187]
    s_add_u32 m0, s30, 65152
    v_cvt_pk_bf16_f32 v23, v30, v31
    v_mfma_f32_16x16x32_bf16 v[188:191], a[188:191], v[52:55], v[188:191]
    ds_read_b128 a[136:139], v2 offset:0
    v_smfmac_f32_16x16x64_bf16 a[208:211], a[228:231], v[48:55], v15
    buffer_load_dwordx4 v7, s[12:15], s29 offen lds
    v_exp_f32 v32, v32
    v_mfma_f32_16x16x32_bf16 v[192:195], a[160:163], v[64:67], v[192:195]
    ds_read_b128 a[140:143], v2 offset:64
    v_mfma_f32_16x16x32_bf16 v[196:199], a[164:167], v[64:67], v[196:199]
    v_exp_f32 v33, v33
    v_mfma_f32_16x16x32_bf16 v[200:203], a[168:171], v[64:67], v[200:203]
    ds_read_b128 a[144:147], v1 offset:4224
    v_cvt_pk_bf16_f32 v32, v32, v33
    v_mfma_f32_16x16x32_bf16 v[204:207], a[172:175], v[64:67], v[204:207]
    v_exp_f32 v34, v34
    v_mfma_f32_16x16x32_bf16 v[208:211], a[176:179], v[64:67], v[208:211]
    ds_read_b128 a[148:151], v1 offset:4288
    v_mfma_f32_16x16x32_bf16 v[212:215], a[180:183], v[64:67], v[212:215]
    v_exp_f32 v35, v35
    v_mfma_f32_16x16x32_bf16 v[216:219], a[184:187], v[64:67], v[216:219]
    s_min_u32 s86, s86, s96
    v_cvt_pk_bf16_f32 v33, v34, v35
    v_mfma_f32_16x16x32_bf16 v[220:223], a[188:191], v[64:67], v[220:223]
    v_exp_f32 v36, v36
    v_mfma_f32_16x16x32_bf16 v[224:227], a[160:163], v[68:71], v[224:227]
    ds_read_b128 a[152:155], v2 offset:4224
    v_mfma_f32_16x16x32_bf16 v[228:231], a[164:167], v[68:71], v[228:231]
    v_exp_f32 v37, v37
    v_mfma_f32_16x16x32_bf16 v[232:235], a[168:171], v[68:71], v[232:235]
    ds_read_b128 a[156:159], v2 offset:4288
    v_cvt_pk_bf16_f32 v34, v36, v37
    v_mfma_f32_16x16x32_bf16 v[236:239], a[172:175], v[68:71], v[236:239]
    s_add_u32 s28, s28, s101
    v_exp_f32 v38, v38
    v_mfma_f32_16x16x32_bf16 v[240:243], a[176:179], v[68:71], v[240:243]
    s_add_u32 s29, s29, s101
    v_mfma_f32_16x16x32_bf16 v[244:247], a[180:183], v[68:71], v[244:247]
    s_sub_u32 s31, s31, 1
    v_exp_f32 v39, v39
    v_mfma_f32_16x16x32_bf16 v[248:251], a[184:187], v[68:71], v[248:251]
    s_cmp_le_u32 s31, s32
    v_cvt_pk_bf16_f32 v35, v38, v39
    v_mfma_f32_16x16x32_bf16 v[252:255], a[188:191], v[68:71], v[252:255]
    s_waitcnt vmcnt(10) lgkmcnt(0)
    v_exp_f32 v40, v40
    v_smfmac_f32_16x16x64_bf16 a[212:215], a[228:231], v[64:71], v15
    s_cbranch_scc0 L_itb4x_1
L_sp4x_1:
    s_cmp_eq_u32 s31, 0
    s_cbranch_scc1 L_e4x_1
    s_cmp_eq_u32 s31, 2
    s_cbranch_scc1 L_sv4x_1
    s_mov_b32 s10, s90
    s_mov_b32 s28, s89
    s_mov_b32 s32, 2
    s_mov_b32 s38, L_e4x_1-L_pc
    s_cmp_eq_u32 s87, 1
    s_cselect_b32 s38, L_e4x_1-L_pc+8192, s38
    s_cmp_eq_u32 s87, 2
    s_cselect_b32 s38, L_e4x_1-L_pc+16384, s38
    s_mov_b32 s39, L_itb1_1-L_pc
    s_cmp_eq_u32 s87, 3
    s_cselect_b32 s38, s39, s38
    v_mbcnt_lo_u32_b32 v116, -1, 0
    v_mbcnt_hi_u32_b32 v116, -1, v116
    v_lshl_add_u32 v116, v116, 7, s38
    v_min_u32 v116, L_table-L_pc, v116
    global_load_dword v14, v116, s[74:75]
    s_branch L_itb4x_1
L_sv4x_1:
    s_mov_b32 s14, s90
    s_mov_b32 s29, s89
    s_mov_b32 s32, 0
    s_branch L_itb4x_1
L_sp4x_2:
    s_cmp_eq_u32 s31, 2
    s_cbranch_scc1 L_sv4x_2
    s_mov_b32 s10, s90
    s_mov_b32 s28, s89
    s_mov_b32 s32, 2
    s_branch L_itb4x_2
L_sv4x_2:
    s_mov_b32 s14, s90
    s_mov_b32 s29, s89
    s_mov_b32 s32, 0
    s_branch L_itb4x_2
L_sp4x_3:
    s_cmp_eq_u32 s31, 0
    s_cbranch_scc1 L_e4x_3
    s_cmp_eq_u32 s31, 2
    s_cbranch_scc1 L_sv4x_3
    s_mov_b32 s10, s90
    s_mov_b32 s28, s89
    s_mov_b32 s32, 2
    s_mov_b32 s38, L_e4x_3-L_pc
    s_cmp_eq_u32 s87, 1
    s_cselect_b32 s38, L_e4x_3-L_pc+8192, s38
    s_cmp_eq_u32 s87, 2
    s_cselect_b32 s38, L_e4x_3-L_pc+16384, s38
    s_mov_b32 s39, L_itb3_1-L_pc
    s_cmp_eq_u32 s87, 3
    s_cselect_b32 s38, s39, s38
    v_mbcnt_lo_u32_b32 v116, -1, 0
    v_mbcnt_hi_u32_b32 v116, -1, v116
    v_lshl_add_u32 v116, v116, 7, s38
    v_min_u32 v116, L_table-L_pc, v116
    global_load_dword v14, v116, s[74:75]
    s_branch L_itb4x_3
L_sv4x_3:
    s_mov_b32 s14, s90
    s_mov_b32 s29, s89
    s_mov_b32 s32, 0
    s_branch L_itb4x_3
L_sp4x_0:
    s_cmp_eq_u32 s31, 2
    s_cbranch_scc1 L_sv4x_0
    s_mov_b32 s10, s90
    s_mov_b32 s28, s89
    s_mov_b32 s32, 2
    s_branch L_itb4x_0
L_sv4x_0:
    s_mov_b32 s14, s90
    s_mov_b32 s29, s89
    s_mov_b32 s32, 0
    s_branch L_itb4x_0
.p2align 6
    s_nop 0
L_itb4_1:
    s_barrier
    v_mfma_f32_16x16x32_bf16 v[48:51], a[128:131], a[0:3], v[80:83]
    v_exp_f32 v41, v41
    v_mfma_f32_16x16x32_bf16 v[48:51], a[132:135], a[4:7], v[48:51]
    v_cvt_pk_bf16_f32 v36, v40, v41
    v_mfma_f32_16x16x32_bf16 v[48:51], a[136:139], a[8:11], v[48:51]
    v_exp_f32 v42, v42
    v_mfma_f32_16x16x32_bf16 v[48:51], a[140:143], a[12:15], v[48:51]
    ds_read_b64_tr_b16 a[160:161], v3 offset:17408
    v_mfma_f32_16x16x32_bf16 v[52:55], a[144:147], a[0:3], v[80:83]
    v_exp_f32 v43, v43
    v_mfma_f32_16x16x32_bf16 v[52:55], a[148:151], a[4:7], v[52:55]
    ds_read_b64_tr_b16 a[162:163], v3 offset:17920
    v_cvt_pk_bf16_f32 v37, v42, v43
    v_mfma_f32_16x16x32_bf16 v[52:55], a[152:155], a[8:11], v[52:55]
    v_exp_f32 v44, v44
    v_mfma_f32_16x16x32_bf16 v[52:55], a[156:159], a[12:15], v[52:55]
    ds_read_b64_tr_b16 a[164:165], v3 offset:17440
    v_mfma_f32_16x16x32_bf16 v[56:59], a[128:131], a[16:19], v[84:87]
    v_exp_f32 v45, v45
    v_mfma_f32_16x16x32_bf16 v[56:59], a[132:135], a[20:23], v[56:59]
    ds_read_b64_tr_b16 a[166:167], v3 offset:17952
    v_cvt_pk_bf16_f32 v38, v44, v45
    v_mfma_f32_16x16x32_bf16 v[56:59], a[136:139], a[24:27], v[56:59]
    v_exp_f32 v46, v46
    v_mfma_f32_16x16x32_bf16 v[56:59], a[140:143], a[28:31], v[56:59]
    ds_read_b64_tr_b16 a[168:169], v3 offset:17472
    v_mfma_f32_16x16x32_bf16 v[60:63], a[144:147], a[16:19], v[84:87]
    v_exp_f32 v47, v47
    v_mfma_f32_16x16x32_bf16 v[60:63], a[148:151], a[20:23], v[60:63]
    ds_read_b64_tr_b16 a[170:171], v3 offset:17984
    v_cvt_pk_bf16_f32 v39, v46, v47
    v_mfma_f32_16x16x32_bf16 v[60:63], a[152:155], a[24:27], v[60:63]
    ds_read_b64_tr_b16 a[172:173], v3 offset:17504
    v_mfma_f32_16x16x32_bf16 v[60:63], a[156:159], a[28:31], v[60:63]
    v_exp_f32 v48, v48
    v_mfma_f32_16x16x32_bf16 v[64:67], a[128:131], a[32:35], v[88:91]
    ds_read_b64_tr_b16 a[174:175], v3 offset:18016
    v_mfma_f32_16x16x32_bf16 v[64:67], a[132:135], a[36:39], v[64:67]
    v_exp_f32 v49, v49
    v_mfma_f32_16x16x32_bf16 v[64:67], a[136:139], a[40:43], v[64:67]
    ds_read_b64_tr_b16 a[176:177], v3 offset:17536
    v_cvt_pk_bf16_f32 v48, v48, v49
    v_mfma_f32_16x16x32_bf16 v[64:67], a[140:143], a[44:47], v[64:67]
    v_exp_f32 v50, v50
    v_mfma_f32_16x16x32_bf16 v[68:71], a[144:147], a[32:35], v[88:91]
    ds_read_b64_tr_b16 a[178:179], v3 offset:18048
    v_mfma_f32_16x16x32_bf16 v[68:71], a[148:151], a[36:39], v[68:71]
    v_exp_f32 v51, v51
    v_mfma_f32_16x16x32_bf16 v[68:71], a[152:155], a[40:43], v[68:71]
    ds_read_b64_tr_b16 a[180:181], v3 offset:17568
    v_cvt_pk_bf16_f32 v49, v50, v51
    v_mfma_f32_16x16x32_bf16 v[68:71], a[156:159], a[44:47], v[68:71]
    v_exp_f32 v52, v52
    v_mfma_f32_16x16x32_bf16 v[72:75], a[128:131], a[48:51], v[92:95]
    ds_read_b64_tr_b16 a[182:183], v3 offset:18080
    v_mfma_f32_16x16x32_bf16 v[72:75], a[132:135], a[52:55], v[72:75]
    v_exp_f32 v53, v53
    v_mfma_f32_16x16x32_bf16 v[72:75], a[136:139], a[56:59], v[72:75]
    ds_read_b64_tr_b16 a[184:185], v3 offset:17600
    v_cvt_pk_bf16_f32 v50, v52, v53
    v_mfma_f32_16x16x32_bf16 v[72:75], a[140:143], a[60:63], v[72:75]
    s_add_u32 m0, s30, 0
    v_exp_f32 v54, v54
    v_mfma_f32_16x16x32_bf16 v[76:79], a[144:147], a[48:51], v[92:95]
    ds_read_b64_tr_b16 a[186:187], v3 offset:18112
    v_mfma_f32_16x16x32_bf16 v[76:79], a[148:151], a[52:55], v[76:79]
    v_exp_f32 v55, v55
    v_mfma_f32_16x16x32_bf16 v[76:79], a[152:155], a[56:59], v[76:79]
    ds_read_b64_tr_b16 a[188:189], v3 offset:17632
    v_cvt_pk_bf16_f32 v51, v54, v55
    v_mfma_f32_16x16x32_bf16 v[76:79], a[156:159], a[60:63], v[76:79]
    ds_read_b64_tr_b16 a[190:191], v3 offset:18144
    v_exp_f32 v56, v56
    s_waitcnt lgkmcnt(2)
    v_mfma_f32_16x16x32_bf16 v[128:131], a[160:163], v[16:19], v[128:131]
    buffer_load_dwordx4 v4, s[8:11], s28 offen lds
    v_mfma_f32_16x16x32_bf16 v[132:135], a[164:167], v[16:19], v[132:135]
    v_exp_f32 v57, v57
    v_mfma_f32_16x16x32_bf16 v[136:139], a[168:171], v[16:19], v[136:139]
    s_add_u32 m0, s30, 4224
    v_cvt_pk_bf16_f32 v52, v56, v57
    v_mfma_f32_16x16x32_bf16 v[140:143], a[172:175], v[16:19], v[140:143]
    v_exp_f32 v58, v58
    v_mfma_f32_16x16x32_bf16 v[144:147], a[176:179], v[16:19], v[144:147]
    buffer_load_dwordx4 v5, s[8:11], s28 offen lds
    v_mfma_f32_16x16x32_bf16 v[148:151], a[180:183], v[16:19], v[148:151]
    v_exp_f32 v59, v59
    v_mfma_f32_16x16x32_bf16 v[152:155], a[184:187], v[16:19], v[152:155]
    s_add_u32 m0, s30, 8704
    v_cvt_pk_bf16_f32 v53, v58, v59
    s_waitcnt lgkmcnt(0)
    v_mfma_f32_16x16x32_bf16 v[156:159], a[188:191], v[16:19], v[156:159]
    v_exp_f32 v60, v60
    v_mfma_f32_16x16x32_bf16 v[160:163], a[160:163], v[20:23], v[160:163]
    ds_read_b128 a[128:131], v1 offset:17408
    v_mfma_f32_16x16x32_bf16 v[164:167], a[164:167], v[20:23], v[164:167]
    v_exp_f32 v61, v61
    v_mfma_f32_16x16x32_bf16 v[168:171], a[168:171], v[20:23], v[168:171]
    buffer_load_dwordx4 v6, s[12:15], s29 offen lds
    v_cvt_pk_bf16_f32 v54, v60, v61
    v_mfma_f32_16x16x32_bf16 v[172:175], a[172:175], v[20:23], v[172:175]
    v_exp_f32 v62, v62
    v_mfma_f32_16x16x32_bf16 v[176:179], a[176:179], v[20:23], v[176:179]
    ds_read_b128 a[132:135], v1 offset:17472
    v_mfma_f32_16x16x32_bf16 v[180:183], a[180:183], v[20:23], v[180:183]
    v_exp_f32 v63, v63
    v_mfma_f32_16x16x32_bf16 v[184:187], a[184:187], v[20:23], v[184:187]
    s_add_u32 m0, s30, 12928
    v_cvt_pk_bf16_f32 v55, v62, v63
    v_mfma_f32_16x16x32_bf16 v[188:191], a[188:191], v[20:23], v[188:191]
    ds_read_b128 a[136:139], v2 offset:17408
    v_smfmac_f32_16x16x64_bf16 a[208:211], a[228:231], v[16:23], v15
    buffer_load_dwordx4 v7, s[12:15], s29 offen lds
    v_exp_f32 v64, v64
    v_mfma_f32_16x16x32_bf16 v[192:195], a[160:163], v[32:35], v[192:195]
    ds_read_b128 a[140:143], v2 offset:17472
    v_mfma_f32_16x16x32_bf16 v[196:199], a[164:167], v[32:35], v[196:199]
    v_exp_f32 v65, v65
    v_mfma_f32_16x16x32_bf16 v[200:203], a[168:171], v[32:35], v[200:203]
    ds_read_b128 a[144:147], v1 offset:21632
    v_cvt_pk_bf16_f32 v64, v64, v65
    v_mfma_f32_16x16x32_bf16 v[204:207], a[172:175], v[32:35], v[204:207]
    v_exp_f32 v66, v66
    v_mfma_f32_16x16x32_bf16 v[208:211], a[176:179], v[32:35], v[208:211]
    ds_read_b128 a[148:151], v1 offset:21696
    v_mfma_f32_16x16x32_bf16 v[212:215], a[180:183], v[32:35], v[212:215]
    v_exp_f32 v67, v67
    v_mfma_f32_16x16x32_bf16 v[216:219], a[184:187], v[32:35], v[216:219]
    v_cvt_pk_bf16_f32 v65, v66, v67
    v_mfma_f32_16x16x32_bf16 v[220:223], a[188:191], v[32:35], v[220:223]
    v_exp_f32 v68, v68
    v_mfma_f32_16x16x32_bf16 v[224:227], a[160:163], v[36:39], v[224:227]
    ds_read_b128 a[152:155], v2 offset:21632
    v_mfma_f32_16x16x32_bf16 v[228:231], a[164:167], v[36:39], v[228:231]
    v_exp_f32 v69, v69
    v_mfma_f32_16x16x32_bf16 v[232:235], a[168:171], v[36:39], v[232:235]
    ds_read_b128 a[156:159], v2 offset:21696
    v_cvt_pk_bf16_f32 v66, v68, v69
    v_mfma_f32_16x16x32_bf16 v[236:239], a[172:175], v[36:39], v[236:239]
    s_add_u32 s28, s28, s101
    v_exp_f32 v70, v70
    v_mfma_f32_16x16x32_bf16 v[240:243], a[176:179], v[36:39], v[240:243]
    s_add_u32 s29, s29, s101
    v_mfma_f32_16x16x32_bf16 v[244:247], a[180:183], v[36:39], v[244:247]
    s_sub_u32 s31, s31, 1
    v_exp_f32 v71, v71
    v_mfma_f32_16x16x32_bf16 v[248:251], a[184:187], v[36:39], v[248:251]
    s_cmp_le_u32 s31, s32
    v_cvt_pk_bf16_f32 v67, v70, v71
    v_mfma_f32_16x16x32_bf16 v[252:255], a[188:191], v[36:39], v[252:255]
    s_waitcnt vmcnt(8) lgkmcnt(0)
    v_exp_f32 v72, v72
    v_smfmac_f32_16x16x64_bf16 a[212:215], a[228:231], v[32:39], v15
    s_cbranch_scc1 L_sp4_2
L_itb4_2:
    s_barrier
    v_mfma_f32_16x16x32_bf16 v[16:19], a[128:131], a[0:3], v[80:83]
    v_exp_f32 v73, v73
    v_mfma_f32_16x16x32_bf16 v[16:19], a[132:135], a[4:7], v[16:19]
    v_cvt_pk_bf16_f32 v68, v72, v73
    v_mfma_f32_16x16x32_bf16 v[16:19], a[136:139], a[8:11], v[16:19]
    v_exp_f32 v74, v74
    v_mfma_f32_16x16x32_bf16 v[16:19], a[140:143], a[12:15], v[16:19]
    ds_read_b64_tr_b16 a[160:161], v3 offset:34816
    v_mfma_f32_16x16x32_bf16 v[20:23], a[144:147], a[0:3], v[80:83]
    v_exp_f32 v75, v75
    v_mfma_f32_16x16x32_bf16 v[20:23], a[148:151], a[4:7], v[20:23]
    ds_read_b64_tr_b16 a[162:163], v3 offset:35328
    v_cvt_pk_bf16_f32 v69, v74, v75
    v_mfma_f32_16x16x32_bf16 v[20:23], a[152:155], a[8:11], v[20:23]
    v_exp_f32 v76, v76
    v_mfma_f32_16x16x32_bf16 v[20:23], a[156:159], a[12:15], v[20:23]
    ds_read_b64_tr_b16 a[164:165], v3 offset:34848
    v_mfma_f32_16x16x32_bf16 v[24:27], a[128:131], a[16:19], v[84:87]
    v_exp_f32 v77, v77
    v_mfma_f32_16x16x32_bf16 v[24:27], a[132:135], a[20:23], v[24:27]
    ds_read_b64_tr_b16 a[166:167], v3 offset:35360
    v_cvt_pk_bf16_f32 v70, v76, v77
    v_mfma_f32_16x16x32_bf16 v[24:27], a[136:139], a[24:27], v[24:27]
    v_exp_f32 v78, v78
    v_mfma_f32_16x16x32_bf16 v[24:27], a[140:143], a[28:31], v[24:27]
    ds_read_b64_tr_b16 a[168:169], v3 offset:34880
    v_mfma_f32_16x16x32_bf16 v[28:31], a[144:147], a[16:19], v[84:87]
    v_exp_f32 v79, v79
    v_mfma_f32_16x16x32_bf16 v[28:31], a[148:151], a[20:23], v[28:31]
    ds_read_b64_tr_b16 a[170:171], v3 offset:35392
    v_cvt_pk_bf16_f32 v71, v78, v79
    v_mfma_f32_16x16x32_bf16 v[28:31], a[152:155], a[24:27], v[28:31]
    ds_read_b64_tr_b16 a[172:173], v3 offset:34912
    v_mfma_f32_16x16x32_bf16 v[28:31], a[156:159], a[28:31], v[28:31]
    v_exp_f32 v16, v16
    v_mfma_f32_16x16x32_bf16 v[32:35], a[128:131], a[32:35], v[88:91]
    ds_read_b64_tr_b16 a[174:175], v3 offset:35424
    v_mfma_f32_16x16x32_bf16 v[32:35], a[132:135], a[36:39], v[32:35]
    v_exp_f32 v17, v17
    v_mfma_f32_16x16x32_bf16 v[32:35], a[136:139], a[40:43], v[32:35]
    ds_read_b64_tr_b16 a[176:177], v3 offset:34944
    v_cvt_pk_bf16_f32 v16, v16, v17
    v_mfma_f32_16x16x32_bf16 v[32:35], a[140:143], a[44:47], v[32:35]
    v_exp_f32 v18, v18
    v_mfma_f32_16x16x32_bf16 v[36:39], a[144:147], a[32:35], v[88:91]
    ds_read_b64_tr_b16 a[178:179], v3 offset:35456
    v_mfma_f32_16x16x32_bf16 v[36:39], a[148:151], a[36:39], v[36:39]
    v_exp_f32 v19, v19
    v_mfma_f32_16x16x32_bf16 v[36:39], a[152:155], a[40:43], v[36:39]
    ds_read_b64_tr_b16 a[180:181], v3 offset:34976
    v_cvt_pk_bf16_f32 v17, v18, v19
    v_mfma_f32_16x16x32_bf16 v[36:39], a[156:159], a[44:47], v[36:39]
    v_exp_f32 v20, v20
    v_mfma_f32_16x16x32_bf16 v[40:43], a[128:131], a[48:51], v[92:95]
    ds_read_b64_tr_b16 a[182:183], v3 offset:35488
    v_mfma_f32_16x16x32_bf16 v[40:43], a[132:135], a[52:55], v[40:43]
    v_exp_f32 v21, v21
    v_mfma_f32_16x16x32_bf16 v[40:43], a[136:139], a[56:59], v[40:43]
    ds_read_b64_tr_b16 a[184:185], v3 offset:35008
    v_cvt_pk_bf16_f32 v18, v20, v21
    v_mfma_f32_16x16x32_bf16 v[40:43], a[140:143], a[60:63], v[40:43]
    s_add_u32 m0, s30, 17408
    v_exp_f32 v22, v22
    v_mfma_f32_16x16x32_bf16 v[44:47], a[144:147], a[48:51], v[92:95]
    ds_read_b64_tr_b16 a[186:187], v3 offset:35520
    v_mfma_f32_16x16x32_bf16 v[44:47], a[148:151], a[52:55], v[44:47]
    v_exp_f32 v23, v23
    v_mfma_f32_16x16x32_bf16 v[44:47], a[152:155], a[56:59], v[44:47]
    ds_read_b64_tr_b16 a[188:189], v3 offset:35040
    v_cvt_pk_bf16_f32 v19, v22, v23
    v_mfma_f32_16x16x32_bf16 v[44:47], a[156:159], a[60:63], v[44:47]
    ds_read_b64_tr_b16 a[190:191], v3 offset:35552
    v_exp_f32 v24, v24
    s_waitcnt lgkmcnt(2)
    v_mfma_f32_16x16x32_bf16 v[128:131], a[160:163], v[48:51], v[128:131]
    buffer_load_dwordx4 v4, s[8:11], s28 offen lds
    v_mfma_f32_16x16x32_bf16 v[132:135], a[164:167], v[48:51], v[132:135]
    v_exp_f32 v25, v25
    v_mfma_f32_16x16x32_bf16 v[136:139], a[168:171], v[48:51], v[136:139]
    s_add_u32 m0, s30, 21632
    v_cvt_pk_bf16_f32 v20, v24, v25
    v_mfma_f32_16x16x32_bf16 v[140:143], a[172:175], v[48:51], v[140:143]
    v_exp_f32 v26, v26
    v_mfma_f32_16x16x32_bf16 v[144:147], a[176:179], v[48:51], v[144:147]
    buffer_load_dwordx4 v5, s[8:11], s28 offen lds
    v_mfma_f32_16x16x32_bf16 v[148:151], a[180:183], v[48:51], v[148:151]
    v_exp_f32 v27, v27
    v_mfma_f32_16x16x32_bf16 v[152:155], a[184:187], v[48:51], v[152:155]
    s_add_u32 m0, s30, 26112
    v_cvt_pk_bf16_f32 v21, v26, v27
    s_waitcnt lgkmcnt(0)
    v_mfma_f32_16x16x32_bf16 v[156:159], a[188:191], v[48:51], v[156:159]
    v_exp_f32 v28, v28
    v_mfma_f32_16x16x32_bf16 v[160:163], a[160:163], v[52:55], v[160:163]
    ds_read_b128 a[128:131], v1 offset:34816
    v_mfma_f32_16x16x32_bf16 v[164:167], a[164:167], v[52:55], v[164:167]
    v_exp_f32 v29, v29
    v_mfma_f32_16x16x32_bf16 v[168:171], a[168:171], v[52:55], v[168:171]
    buffer_load_dwordx4 v6, s[12:15], s29 offen lds
    v_cvt_pk_bf16_f32 v22, v28, v29
    v_mfma_f32_16x16x32_bf16 v[172:175], a[172:175], v[52:55], v[172:175]
    v_exp_f32 v30, v30
    v_mfma_f32_16x16x32_bf16 v[176:179], a[176:179], v[52:55], v[176:179]
    ds_read_b128 a[132:135], v1 offset:34880
    v_mfma_f32_16x16x32_bf16 v[180:183], a[180:183], v[52:55], v[180:183]
    v_exp_f32 v31, v31
    v_mfma_f32_16x16x32_bf16 v[184:187], a[184:187], v[52:55], v[184:187]
    s_add_u32 m0, s30, 30336
    v_cvt_pk_bf16_f32 v23, v30, v31
    v_mfma_f32_16x16x32_bf16 v[188:191], a[188:191], v[52:55], v[188:191]
    ds_read_b128 a[136:139], v2 offset:34816
    v_smfmac_f32_16x16x64_bf16 a[208:211], a[228:231], v[48:55], v15
    buffer_load_dwordx4 v7, s[12:15], s29 offen lds
    v_exp_f32 v32, v32
    v_mfma_f32_16x16x32_bf16 v[192:195], a[160:163], v[64:67], v[192:195]
    ds_read_b128 a[140:143], v2 offset:34880
    v_mfma_f32_16x16x32_bf16 v[196:199], a[164:167], v[64:67], v[196:199]
    v_exp_f32 v33, v33
    v_mfma_f32_16x16x32_bf16 v[200:203], a[168:171], v[64:67], v[200:203]
    ds_read_b128 a[144:147], v1 offset:39040
    v_cvt_pk_bf16_f32 v32, v32, v33
    v_mfma_f32_16x16x32_bf16 v[204:207], a[172:175], v[64:67], v[204:207]
    v_exp_f32 v34, v34
    v_mfma_f32_16x16x32_bf16 v[208:211], a[176:179], v[64:67], v[208:211]
    ds_read_b128 a[148:151], v1 offset:39104
    v_mfma_f32_16x16x32_bf16 v[212:215], a[180:183], v[64:67], v[212:215]
    v_exp_f32 v35, v35
    v_mfma_f32_16x16x32_bf16 v[216:219], a[184:187], v[64:67], v[216:219]
    v_cvt_pk_bf16_f32 v33, v34, v35
    v_mfma_f32_16x16x32_bf16 v[220:223], a[188:191], v[64:67], v[220:223]
    v_exp_f32 v36, v36
    v_mfma_f32_16x16x32_bf16 v[224:227], a[160:163], v[68:71], v[224:227]
    ds_read_b128 a[152:155], v2 offset:39040
    v_mfma_f32_16x16x32_bf16 v[228:231], a[164:167], v[68:71], v[228:231]
    v_exp_f32 v37, v37
    v_mfma_f32_16x16x32_bf16 v[232:235], a[168:171], v[68:71], v[232:235]
    ds_read_b128 a[156:159], v2 offset:39104
    v_cvt_pk_bf16_f32 v34, v36, v37
    v_mfma_f32_16x16x32_bf16 v[236:239], a[172:175], v[68:71], v[236:239]
    s_add_u32 s28, s28, s101
    v_exp_f32 v38, v38
    v_mfma_f32_16x16x32_bf16 v[240:243], a[176:179], v[68:71], v[240:243]
    s_add_u32 s29, s29, s101
    v_mfma_f32_16x16x32_bf16 v[244:247], a[180:183], v[68:71], v[244:247]
    s_sub_u32 s31, s31, 1
    v_exp_f32 v39, v39
    v_mfma_f32_16x16x32_bf16 v[248:251], a[184:187], v[68:71], v[248:251]
    s_cmp_le_u32 s31, s32
    v_cvt_pk_bf16_f32 v35, v38, v39
    v_mfma_f32_16x16x32_bf16 v[252:255], a[188:191], v[68:71], v[252:255]
    s_waitcnt vmcnt(8) lgkmcnt(0)
    v_exp_f32 v40, v40
    v_smfmac_f32_16x16x64_bf16 a[212:215], a[228:231], v[64:71], v15
    s_cbranch_scc1 L_sp4_3
L_itb4_3:
    s_barrier
    v_mfma_f32_16x16x32_bf16 v[48:51], a[128:131], a[0:3], v[80:83]
    v_exp_f32 v41, v41
    v_mfma_f32_16x16x32_bf16 v[48:51], a[132:135], a[4:7], v[48:51]
    v_cvt_pk_bf16_f32 v36, v40, v41
    v_mfma_f32_16x16x32_bf16 v[48:51], a[136:139], a[8:11], v[48:51]
    v_exp_f32 v42, v42
    v_mfma_f32_16x16x32_bf16 v[48:51], a[140:143], a[12:15], v[48:51]
    ds_read_b64_tr_b16 a[160:161], v3 offset:52224
    v_mfma_f32_16x16x32_bf16 v[52:55], a[144:147], a[0:3], v[80:83]
    v_exp_f32 v43, v43
    v_mfma_f32_16x16x32_bf16 v[52:55], a[148:151], a[4:7], v[52:55]
    ds_read_b64_tr_b16 a[162:163], v3 offset:52736
    v_cvt_pk_bf16_f32 v37, v42, v43
    v_mfma_f32_16x16x32_bf16 v[52:55], a[152:155], a[8:11], v[52:55]
    v_exp_f32 v44, v44
    v_mfma_f32_16x16x32_bf16 v[52:55], a[156:159], a[12:15], v[52:55]
    ds_read_b64_tr_b16 a[164:165], v3 offset:52256
    v_mfma_f32_16x16x32_bf16 v[56:59], a[128:131], a[16:19], v[84:87]
    v_exp_f32 v45, v45
    v_mfma_f32_16x16x32_bf16 v[56:59], a[132:135], a[20:23], v[56:59]
    ds_read_b64_tr_b16 a[166:167], v3 offset:52768
    v_cvt_pk_bf16_f32 v38, v44, v45
    v_mfma_f32_16x16x32_bf16 v[56:59], a[136:139], a[24:27], v[56:59]
    v_exp_f32 v46, v46
    v_mfma_f32_16x16x32_bf16 v[56:59], a[140:143], a[28:31], v[56:59]
    ds_read_b64_tr_b16 a[168:169], v3 offset:52288
    v_mfma_f32_16x16x32_bf16 v[60:63], a[144:147], a[16:19], v[84:87]
    v_exp_f32 v47, v47
    v_mfma_f32_16x16x32_bf16 v[60:63], a[148:151], a[20:23], v[60:63]
    ds_read_b64_tr_b16 a[170:171], v3 offset:52800
    v_cvt_pk_bf16_f32 v39, v46, v47
    v_mfma_f32_16x16x32_bf16 v[60:63], a[152:155], a[24:27], v[60:63]
    ds_read_b64_tr_b16 a[172:173], v3 offset:52320
    v_mfma_f32_16x16x32_bf16 v[60:63], a[156:159], a[28:31], v[60:63]
    v_exp_f32 v48, v48
    v_mfma_f32_16x16x32_bf16 v[64:67], a[128:131], a[32:35], v[88:91]
    ds_read_b64_tr_b16 a[174:175], v3 offset:52832
    v_mfma_f32_16x16x32_bf16 v[64:67], a[132:135], a[36:39], v[64:67]
    v_exp_f32_e64 v49, v49
    v_mfma_f32_16x16x32_bf16 v[64:67], a[136:139], a[40:43], v[64:67]
    ds_read_b64_tr_b16 a[176:177], v3 offset:52352
    v_cvt_pk_bf16_f32 v48, v48, v49
    v_mfma_f32_16x16x32_bf16 v[64:67], a[140:143], a[44:47], v[64:67]
    v_exp_f32 v50, v50
    v_mfma_f32_16x16x32_bf16 v[68:71], a[144:147], a[32:35], v[88:91]
    ds_read_b64_tr_b16 a[178:179], v3 offset:52864
    v_mfma_f32_16x16x32_bf16 v[68:71], a[148:151], a[36:39], v[68:71]
    v_exp_f32 v51, v51
    v_mfma_f32_16x16x32_bf16 v[68:71], a[152:155], a[40:43], v[68:71]
    ds_read_b64_tr_b16 a[180:181], v3 offset:52384
    v_cvt_pk_bf16_f32 v49, v50, v51
    v_mfma_f32_16x16x32_bf16 v[68:71], a[156:159], a[44:47], v[68:71]
    v_exp_f32 v52, v52
    v_mfma_f32_16x16x32_bf16 v[72:75], a[128:131], a[48:51], v[92:95]
    ds_read_b64_tr_b16 a[182:183], v3 offset:52896
    v_mfma_f32_16x16x32_bf16 v[72:75], a[132:135], a[52:55], v[72:75]
    v_exp_f32 v53, v53
    v_mfma_f32_16x16x32_bf16 v[72:75], a[136:139], a[56:59], v[72:75]
    ds_read_b64_tr_b16 a[184:185], v3 offset:52416
    v_cvt_pk_bf16_f32 v50, v52, v53
    v_mfma_f32_16x16x32_bf16 v[72:75], a[140:143], a[60:63], v[72:75]
    s_add_u32 m0, s30, 34816
    v_exp_f32 v54, v54
    v_mfma_f32_16x16x32_bf16 v[76:79], a[144:147], a[48:51], v[92:95]
    ds_read_b64_tr_b16 a[186:187], v3 offset:52928
    v_mfma_f32_16x16x32_bf16 v[76:79], a[148:151], a[52:55], v[76:79]
    v_exp_f32 v55, v55
    v_mfma_f32_16x16x32_bf16 v[76:79], a[152:155], a[56:59], v[76:79]
    ds_read_b64_tr_b16 a[188:189], v3 offset:52448
    v_cvt_pk_bf16_f32 v51, v54, v55
    v_mfma_f32_16x16x32_bf16 v[76:79], a[156:159], a[60:63], v[76:79]
    ds_read_b64_tr_b16 a[190:191], v3 offset:52960
    v_exp_f32 v56, v56
    s_waitcnt lgkmcnt(2)
    v_mfma_f32_16x16x32_bf16 v[128:131], a[160:163], v[16:19], v[128:131]
    buffer_load_dwordx4 v4, s[8:11], s28 offen lds
    v_mfma_f32_16x16x32_bf16 v[132:135], a[164:167], v[16:19], v[132:135]
    v_exp_f32 v57, v57
    v_mfma_f32_16x16x32_bf16 v[136:139], a[168:171], v[16:19], v[136:139]
    s_add_u32 m0, s30, 39040
    v_cvt_pk_bf16_f32 v52, v56, v57
    v_mfma_f32_16x16x32_bf16 v[140:143], a[172:175], v[16:19], v[140:143]
    v_exp_f32 v58, v58
    v_mfma_f32_16x16x32_bf16 v[144:147], a[176:179], v[16:19], v[144:147]
    buffer_load_dwordx4 v5, s[8:11], s28 offen lds
    v_mfma_f32_16x16x32_bf16 v[148:151], a[180:183], v[16:19], v[148:151]
    v_exp_f32 v59, v59
    v_mfma_f32_16x16x32_bf16 v[152:155], a[184:187], v[16:19], v[152:155]
    s_add_u32 m0, s30, 43520
    v_cvt_pk_bf16_f32 v53, v58, v59
    s_waitcnt lgkmcnt(0)
    v_mfma_f32_16x16x32_bf16 v[156:159], a[188:191], v[16:19], v[156:159]
    v_exp_f32 v60, v60
    v_mfma_f32_16x16x32_bf16 v[160:163], a[160:163], v[20:23], v[160:163]
    ds_read_b128 a[128:131], v1 offset:52224
    v_mfma_f32_16x16x32_bf16 v[164:167], a[164:167], v[20:23], v[164:167]
    v_exp_f32 v61, v61
    v_mfma_f32_16x16x32_bf16 v[168:171], a[168:171], v[20:23], v[168:171]
    buffer_load_dwordx4 v6, s[12:15], s29 offen lds
    v_cvt_pk_bf16_f32 v54, v60, v61
    v_mfma_f32_16x16x32_bf16 v[172:175], a[172:175], v[20:23], v[172:175]
    v_exp_f32 v62, v62
    v_mfma_f32_16x16x32_bf16 v[176:179], a[176:179], v[20:23], v[176:179]
    ds_read_b128 a[132:135], v1 offset:52288
    v_mfma_f32_16x16x32_bf16 v[180:183], a[180:183], v[20:23], v[180:183]
    v_exp_f32 v63, v63
    v_mfma_f32_16x16x32_bf16 v[184:187], a[184:187], v[20:23], v[184:187]
    s_add_u32 m0, s30, 47744
    v_cvt_pk_bf16_f32 v55, v62, v63
    v_mfma_f32_16x16x32_bf16 v[188:191], a[188:191], v[20:23], v[188:191]
    ds_read_b128 a[136:139], v2 offset:52224
    v_smfmac_f32_16x16x64_bf16 a[208:211], a[228:231], v[16:23], v15
    buffer_load_dwordx4 v7, s[12:15], s29 offen lds
    v_exp_f32 v64, v64
    v_mfma_f32_16x16x32_bf16 v[192:195], a[160:163], v[32:35], v[192:195]
    ds_read_b128 a[140:143], v2 offset:52288
    v_mfma_f32_16x16x32_bf16 v[196:199], a[164:167], v[32:35], v[196:199]
    v_exp_f32_e64 v65, v65
    v_mfma_f32_16x16x32_bf16 v[200:203], a[168:171], v[32:35], v[200:203]
    ds_read_b128 a[144:147], v1 offset:56448
    v_cvt_pk_bf16_f32 v64, v64, v65
    v_mfma_f32_16x16x32_bf16 v[204:207], a[172:175], v[32:35], v[204:207]
    v_exp_f32 v66, v66
    v_mfma_f32_16x16x32_bf16 v[208:211], a[176:179], v[32:35], v[208:211]
    ds_read_b128 a[148:151], v1 offset:56512
    v_mfma_f32_16x16x32_bf16 v[212:215], a[180:183], v[32:35], v[212:215]
    v_exp_f32 v67, v67
    v_mfma_f32_16x16x32_bf16 v[216:219], a[184:187], v[32:35], v[216:219]
    v_cvt_pk_bf16_f32 v65, v66, v67
    v_mfma_f32_16x16x32_bf16 v[220:223], a[188:191], v[32:35], v[220:223]
    v_exp_f32 v68, v68
    v_mfma_f32_16x16x32_bf16 v[224:227], a[160:163], v[36:39], v[224:227]
    ds_read_b128 a[152:155], v2 offset:56448
    v_mfma_f32_16x16x32_bf16 v[228:231], a[164:167], v[36:39], v[228:231]
    v_exp_f32 v69, v69
    v_mfma_f32_16x16x32_bf16 v[232:235], a[168:171], v[36:39], v[232:235]
    ds_read_b128 a[156:159], v2 offset:56512
    v_cvt_pk_bf16_f32 v66, v68, v69
    v_mfma_f32_16x16x32_bf16 v[236:239], a[172:175], v[36:39], v[236:239]
    s_add_u32 s28, s28, s101
    v_exp_f32 v70, v70
    v_mfma_f32_16x16x32_bf16 v[240:243], a[176:179], v[36:39], v[240:243]
    s_add_u32 s29, s29, s101
    v_mfma_f32_16x16x32_bf16 v[244:247], a[180:183], v[36:39], v[244:247]
    s_sub_u32 s31, s31, 1
    v_exp_f32 v71, v71
    v_mfma_f32_16x16x32_bf16 v[248:251], a[184:187], v[36:39], v[248:251]
    s_cmp_le_u32 s31, s32
    v_cvt_pk_bf16_f32 v67, v70, v71
    v_mfma_f32_16x16x32_bf16 v[252:255], a[188:191], v[36:39], v[252:255]
    s_waitcnt vmcnt(8) lgkmcnt(0)
    v_exp_f32 v72, v72
    v_smfmac_f32_16x16x64_bf16 a[212:215], a[228:231], v[32:39], v15
    s_cbranch_scc1 L_sp4_0
L_itb4_0:
    s_barrier
    v_mfma_f32_16x16x32_bf16 v[16:19], a[128:131], a[0:3], v[80:83]
    v_exp_f32 v73, v73
    v_mfma_f32_16x16x32_bf16 v[16:19], a[132:135], a[4:7], v[16:19]
    v_cvt_pk_bf16_f32 v68, v72, v73
    v_mfma_f32_16x16x32_bf16 v[16:19], a[136:139], a[8:11], v[16:19]
    v_exp_f32 v74, v74
    v_mfma_f32_16x16x32_bf16 v[16:19], a[140:143], a[12:15], v[16:19]
    ds_read_b64_tr_b16 a[160:161], v3 offset:0
    v_mfma_f32_16x16x32_bf16 v[20:23], a[144:147], a[0:3], v[80:83]
    v_exp_f32 v75, v75
    v_mfma_f32_16x16x32_bf16 v[20:23], a[148:151], a[4:7], v[20:23]
    ds_read_b64_tr_b16 a[162:163], v3 offset:512
    v_cvt_pk_bf16_f32 v69, v74, v75
    v_mfma_f32_16x16x32_bf16 v[20:23], a[152:155], a[8:11], v[20:23]
    v_exp_f32 v76, v76
    v_mfma_f32_16x16x32_bf16 v[20:23], a[156:159], a[12:15], v[20:23]
    ds_read_b64_tr_b16 a[164:165], v3 offset:32
    v_mfma_f32_16x16x32_bf16 v[24:27], a[128:131], a[16:19], v[84:87]
    v_exp_f32 v77, v77
    v_mfma_f32_16x16x32_bf16 v[24:27], a[132:135], a[20:23], v[24:27]
    ds_read_b64_tr_b16 a[166:167], v3 offset:544
    v_cvt_pk_bf16_f32 v70, v76, v77
    v_mfma_f32_16x16x32_bf16 v[24:27], a[136:139], a[24:27], v[24:27]
    v_exp_f32 v78, v78
    v_mfma_f32_16x16x32_bf16 v[24:27], a[140:143], a[28:31], v[24:27]
    ds_read_b64_tr_b16 a[168:169], v3 offset:64
    v_mfma_f32_16x16x32_bf16 v[28:31], a[144:147], a[16:19], v[84:87]
    v_exp_f32 v79, v79
    v_mfma_f32_16x16x32_bf16 v[28:31], a[148:151], a[20:23], v[28:31]
    ds_read_b64_tr_b16 a[170:171], v3 offset:576
    v_cvt_pk_bf16_f32 v71, v78, v79
    v_mfma_f32_16x16x32_bf16 v[28:31], a[152:155], a[24:27], v[28:31]
    ds_read_b64_tr_b16 a[172:173], v3 offset:96
    v_mfma_f32_16x16x32_bf16 v[28:31], a[156:159], a[28:31], v[28:31]
    v_exp_f32 v16, v16
    v_mfma_f32_16x16x32_bf16 v[32:35], a[128:131], a[32:35], v[88:91]
    ds_read_b64_tr_b16 a[174:175], v3 offset:608
    v_mfma_f32_16x16x32_bf16 v[32:35], a[132:135], a[36:39], v[32:35]
    v_exp_f32 v17, v17
    v_mfma_f32_16x16x32_bf16 v[32:35], a[136:139], a[40:43], v[32:35]
    ds_read_b64_tr_b16 a[176:177], v3 offset:128
    v_cvt_pk_bf16_f32 v16, v16, v17
    v_mfma_f32_16x16x32_bf16 v[32:35], a[140:143], a[44:47], v[32:35]
    v_exp_f32 v18, v18
    v_mfma_f32_16x16x32_bf16 v[36:39], a[144:147], a[32:35], v[88:91]
    ds_read_b64_tr_b16 a[178:179], v3 offset:640
    v_mfma_f32_16x16x32_bf16 v[36:39], a[148:151], a[36:39], v[36:39]
    v_exp_f32 v19, v19
    v_mfma_f32_16x16x32_bf16 v[36:39], a[152:155], a[40:43], v[36:39]
    ds_read_b64_tr_b16 a[180:181], v3 offset:160
    v_cvt_pk_bf16_f32 v17, v18, v19
    v_mfma_f32_16x16x32_bf16 v[36:39], a[156:159], a[44:47], v[36:39]
    v_exp_f32 v20, v20
    v_mfma_f32_16x16x32_bf16 v[40:43], a[128:131], a[48:51], v[92:95]
    ds_read_b64_tr_b16 a[182:183], v3 offset:672
    v_mfma_f32_16x16x32_bf16 v[40:43], a[132:135], a[52:55], v[40:43]
    v_exp_f32 v21, v21
    v_mfma_f32_16x16x32_bf16 v[40:43], a[136:139], a[56:59], v[40:43]
    ds_read_b64_tr_b16 a[184:185], v3 offset:192
    v_cvt_pk_bf16_f32 v18, v20, v21
    v_mfma_f32_16x16x32_bf16 v[40:43], a[140:143], a[60:63], v[40:43]
    s_add_u32 m0, s30, 52224
    v_exp_f32 v22, v22
    v_mfma_f32_16x16x32_bf16 v[44:47], a[144:147], a[48:51], v[92:95]
    ds_read_b64_tr_b16 a[186:187], v3 offset:704
    v_mfma_f32_16x16x32_bf16 v[44:47], a[148:151], a[52:55], v[44:47]
    v_exp_f32 v23, v23
    v_mfma_f32_16x16x32_bf16 v[44:47], a[152:155], a[56:59], v[44:47]
    ds_read_b64_tr_b16 a[188:189], v3 offset:224
    v_cvt_pk_bf16_f32 v19, v22, v23
    v_mfma_f32_16x16x32_bf16 v[44:47], a[156:159], a[60:63], v[44:47]
    ds_read_b64_tr_b16 a[190:191], v3 offset:736
    v_exp_f32 v24, v24
    s_waitcnt lgkmcnt(2)
    v_mfma_f32_16x16x32_bf16 v[128:131], a[160:163], v[48:51], v[128:131]
    buffer_load_dwordx4 v4, s[8:11], s28 offen lds
    v_mfma_f32_16x16x32_bf16 v[132:135], a[164:167], v[48:51], v[132:135]
    v_exp_f32 v25, v25
    v_mfma_f32_16x16x32_bf16 v[136:139], a[168:171], v[48:51], v[136:139]
    s_add_u32 m0, s30, 56448
    v_cvt_pk_bf16_f32 v20, v24, v25
    v_mfma_f32_16x16x32_bf16 v[140:143], a[172:175], v[48:51], v[140:143]
    v_exp_f32 v26, v26
    v_mfma_f32_16x16x32_bf16 v[144:147], a[176:179], v[48:51], v[144:147]
    buffer_load_dwordx4 v5, s[8:11], s28 offen lds
    v_mfma_f32_16x16x32_bf16 v[148:151], a[180:183], v[48:51], v[148:151]
    v_exp_f32 v27, v27
    v_mfma_f32_16x16x32_bf16 v[152:155], a[184:187], v[48:51], v[152:155]
    s_add_u32 m0, s30, 60928
    v_cvt_pk_bf16_f32 v21, v26, v27
    s_waitcnt lgkmcnt(0)
    v_mfma_f32_16x16x32_bf16 v[156:159], a[188:191], v[48:51], v[156:159]
    v_exp_f32 v28, v28
    v_mfma_f32_16x16x32_bf16 v[160:163], a[160:163], v[52:55], v[160:163]
    ds_read_b128 a[128:131], v1 offset:0
    v_mfma_f32_16x16x32_bf16 v[164:167], a[164:167], v[52:55], v[164:167]
    v_exp_f32 v29, v29
    v_mfma_f32_16x16x32_bf16 v[168:171], a[168:171], v[52:55], v[168:171]
    buffer_load_dwordx4 v6, s[12:15], s29 offen lds
    v_cvt_pk_bf16_f32 v22, v28, v29
    v_mfma_f32_16x16x32_bf16 v[172:175], a[172:175], v[52:55], v[172:175]
    v_exp_f32 v30, v30
    v_mfma_f32_16x16x32_bf16 v[176:179], a[176:179], v[52:55], v[176:179]
    ds_read_b128 a[132:135], v1 offset:64
    v_mfma_f32_16x16x32_bf16 v[180:183], a[180:183], v[52:55], v[180:183]
    v_exp_f32 v31, v31
    v_mfma_f32_16x16x32_bf16 v[184:187], a[184:187], v[52:55], v[184:187]
    s_add_u32 m0, s30, 65152
    v_cvt_pk_bf16_f32 v23, v30, v31
    v_mfma_f32_16x16x32_bf16 v[188:191], a[188:191], v[52:55], v[188:191]
    ds_read_b128 a[136:139], v2 offset:0
    v_smfmac_f32_16x16x64_bf16 a[208:211], a[228:231], v[48:55], v15
    buffer_load_dwordx4 v7, s[12:15], s29 offen lds
    v_exp_f32 v32, v32
    v_mfma_f32_16x16x32_bf16 v[192:195], a[160:163], v[64:67], v[192:195]
    ds_read_b128 a[140:143], v2 offset:64
    v_mfma_f32_16x16x32_bf16 v[196:199], a[164:167], v[64:67], v[196:199]
    v_exp_f32 v33, v33
    v_mfma_f32_16x16x32_bf16 v[200:203], a[168:171], v[64:67], v[200:203]
    ds_read_b128 a[144:147], v1 offset:4224
    v_cvt_pk_bf16_f32 v32, v32, v33
    v_mfma_f32_16x16x32_bf16 v[204:207], a[172:175], v[64:67], v[204:207]
    v_exp_f32 v34, v34
    v_mfma_f32_16x16x32_bf16 v[208:211], a[176:179], v[64:67], v[208:211]
    ds_read_b128 a[148:151], v1 offset:4288
    v_mfma_f32_16x16x32_bf16 v[212:215], a[180:183], v[64:67], v[212:215]
    v_exp_f32 v35, v35
    v_mfma_f32_16x16x32_bf16 v[216:219], a[184:187], v[64:67], v[216:219]
    v_cvt_pk_bf16_f32 v33, v34, v35
    v_mfma_f32_16x16x32_bf16 v[220:223], a[188:191], v[64:67], v[220:223]
    v_exp_f32 v36, v36
    v_mfma_f32_16x16x32_bf16 v[224:227], a[160:163], v[68:71], v[224:227]
    ds_read_b128 a[152:155], v2 offset:4224
    v_mfma_f32_16x16x32_bf16 v[228:231], a[164:167], v[68:71], v[228:231]
    v_exp_f32 v37, v37
    v_mfma_f32_16x16x32_bf16 v[232:235], a[168:171], v[68:71], v[232:235]
    ds_read_b128 a[156:159], v2 offset:4288
    v_cvt_pk_bf16_f32 v34, v36, v37
    v_mfma_f32_16x16x32_bf16 v[236:239], a[172:175], v[68:71], v[236:239]
    s_add_u32 s28, s28, s101
    v_exp_f32 v38, v38
    v_mfma_f32_16x16x32_bf16 v[240:243], a[176:179], v[68:71], v[240:243]
    s_add_u32 s29, s29, s101
    v_mfma_f32_16x16x32_bf16 v[244:247], a[180:183], v[68:71], v[244:247]
    s_sub_u32 s31, s31, 1
    v_exp_f32 v39, v39
    v_mfma_f32_16x16x32_bf16 v[248:251], a[184:187], v[68:71], v[248:251]
    s_cmp_le_u32 s31, s32
    v_cvt_pk_bf16_f32 v35, v38, v39
    v_mfma_f32_16x16x32_bf16 v[252:255], a[188:191], v[68:71], v[252:255]
    s_waitcnt vmcnt(8) lgkmcnt(0)
    v_exp_f32 v40, v40
    v_smfmac_f32_16x16x64_bf16 a[212:215], a[228:231], v[64:71], v15
    s_cbranch_scc0 L_itb4_1
L_sp4_1:
    s_mov_b32 s32, 0
    s_branch L_itb4_1
L_sp4_2:
    s_cmp_eq_u32 s31, 0
    s_cbranch_scc1 L_e4_2
    s_mov_b32 s32, 0
    s_mov_b32 s38, L_e4_2-L_pc
    v_mbcnt_lo_u32_b32 v116, -1, 0
    v_mbcnt_hi_u32_b32 v116, -1, v116
    v_lshl_add_u32 v116, v116, 7, s38
    v_min_u32 v116, L_table-L_pc, v116
    global_load_dword v14, v116, s[74:75]
    s_branch L_itb4_2
L_sp4_3:
    s_cmp_eq_u32 s31, 0
    s_cbranch_scc1 L_e4_3
    s_mov_b32 s32, 0
    s_mov_b32 s38, L_e4_3-L_pc
    v_mbcnt_lo_u32_b32 v116, -1, 0
    v_mbcnt_hi_u32_b32 v116, -1, v116
    v_lshl_add_u32 v116, v116, 7, s38
    v_min_u32 v116, L_table-L_pc, v116
    global_load_dword v14, v116, s[74:75]
    s_branch L_itb4_3
L_sp4_0:
    s_mov_b32 s32, 0
    s_branch L_itb4_0
.p2align 6
    s_nop 0
L_itb3x_1:
    s_barrier
    v_mfma_f32_16x16x32_bf16 v[48:51], a[128:131], a[0:3], v[80:83]
    v_exp_f32 v27, v27
    v_mfma_f32_16x16x32_bf16 v[48:51], a[132:135], a[4:7], v[48:51]
    ds_read_b64_tr_b16 a[160:161], v3 offset:17408
    v_cvt_pk_bf16_f32 v21, v26, v27
    v_mfma_f32_16x16x32_bf16 v[48:51], a[136:139], a[8:11], v[48:51]
    ds_read_b64_tr_b16 a[162:163], v3 offset:17920
    v_mfma_f32_16x16x32_bf16 v[48:51], a[140:143], a[12:15], v[48:51]
    v_exp_f32 v28, v28
    v_mfma_f32_16x16x32_bf16 v[52:55], a[144:147], a[0:3], v[80:83]
    ds_read_b64_tr_b16 a[164:165], v3 offset:17440
    v_mfma_f32_16x16x32_bf16 v[52:55], a[148:151], a[4:7], v[52:55]
    v_exp_f32 v29, v29
    v_mfma_f32_16x16x32_bf16 v[52:55], a[152:155], a[8:11], v[52:55]
    ds_read_b64_tr_b16 a[166:167], v3 offset:17952
    v_cvt_pk_bf16_f32 v22, v28, v29
    v_mfma_f32_16x16x32_bf16 v[52:55], a[156:159], a[12:15], v[52:55]
    s_mov_b32 m0, s99
    v_exp_f32 v30, v30
    v_mfma_f32_16x16x32_bf16 v[56:59], a[128:131], a[16:19], v[84:87]
    ds_read_b64_tr_b16 a[168:169], v3 offset:17472
    buffer_load_dwordx4 v4, s[4:7], s86 offen lds
    v_mfma_f32_16x16x32_bf16 v[56:59], a[132:135], a[20:23], v[56:59]
    s_add_u32 m0, s30, 0
    v_exp_f32 v31, v31
    v_mfma_f32_16x16x32_bf16 v[56:59], a[136:139], a[24:27], v[56:59]
    ds_read_b64_tr_b16 a[170:171], v3 offset:17984
    v_cvt_pk_bf16_f32 v23, v30, v31
    v_mfma_f32_16x16x32_bf16 v[56:59], a[140:143], a[28:31], v[56:59]
    ds_read_b64_tr_b16 a[172:173], v3 offset:17504
    v_exp_f32 v32, v32
    v_mfma_f32_16x16x32_bf16 v[60:63], a[144:147], a[16:19], v[84:87]
    ds_read_b64_tr_b16 a[174:175], v3 offset:18016
    buffer_load_dwordx4 v4, s[8:11], s28 offen lds
    v_mfma_f32_16x16x32_bf16 v[60:63], a[148:151], a[20:23], v[60:63]
    s_add_u32 m0, s30, 4224
    s_add_u32 s99, s99, 1056
    v_exp_f32 v33, v33
    v_mfma_f32_16x16x32_bf16 v[60:63], a[152:155], a[24:27], v[60:63]
    ds_read_b64_tr_b16 a[176:177], v3 offset:17536
    v_cvt_pk_bf16_f32 v32, v32, v33
    v_mfma_f32_16x16x32_bf16 v[60:63], a[156:159], a[28:31], v[60:63]
    buffer_load_dwordx4 v5, s[8:11], s28 offen lds
    v_exp_f32 v34, v34
    v_mfma_f32_16x16x32_bf16 v[64:67], a[128:131], a[32:35], v[88:91]
    ds_read_b64_tr_b16 a[178:179], v3 offset:18048
    s_add_u32 m0, s30, 8704
    v_mfma_f32_16x16x32_bf16 v[64:67], a[132:135], a[36:39], v[64:67]
    buffer_load_dwordx4 v6, s[12:15], s29 offen lds
    v_exp_f32 v35, v35
    v_mfma_f32_16x16x32_bf16 v[64:67], a[136:139], a[40:43], v[64:67]
    ds_read_b64_tr_b16 a[180:181], v3 offset:17568
    v_cvt_pk_bf16_f32 v33, v34, v35
    v_mfma_f32_16x16x32_bf16 v[64:67], a[140:143], a[44:47], v[64:67]
    s_add_u32 m0, s30, 12928
    v_exp_f32 v36, v36
    v_mfma_f32_16x16x32_bf16 v[68:71], a[144:147], a[32:35], v[88:91]
    ds_read_b64_tr_b16 a[182:183], v3 offset:18080
    buffer_load_dwordx4 v7, s[12:15], s29 offen lds
    v_mfma_f32_16x16x32_bf16 v[68:71], a[148:151], a[36:39], v[68:71]
    s_min_u32 s99, s99, s100
    v_exp_f32 v37, v37
    v_mfma_f32_16x16x32_bf16 v[68:71], a[152:155], a[40:43], v[68:71]
    ds_read_b64_tr_b16 a[184:185], v3 offset:17600
    v_cvt_pk_bf16_f32 v34, v36, v37
    v_mfma_f32_16x16x32_bf16 v[68:71], a[156:159], a[44:47], v[68:71]
    ds_read_b64_tr_b16 a[186:187], v3 offset:18112
    v_exp_f32 v38, v38
    s_waitcnt lgkmcnt(2)
    v_mfma_f32_16x16x32_bf16 v[128:131], a[160:163], v[16:19], v[128:131]
    ds_read_b64_tr_b16 a[188:189], v3 offset:17632
    v_mfma_f32_16x16x32_bf16 v[132:135], a[164:167], v[16:19], v[132:135]
    v_exp_f32 v39, v39
    v_mfma_f32_16x16x32_bf16 v[136:139], a[168:171], v[16:19], v[136:139]
    ds_read_b64_tr_b16 a[190:191], v3 offset:18144
    v_cvt_pk_bf16_f32 v35, v38, v39
    v_mfma_f32_16x16x32_bf16 v[140:143], a[172:175], v[16:19], v[140:143]
    ds_read_b128 a[128:131], v1 offset:17408
    v_mfma_f32_16x16x32_bf16 v[144:147], a[176:179], v[16:19], v[144:147]
    v_exp_f32 v48, v48
    v_mfma_f32_16x16x32_bf16 v[148:151], a[180:183], v[16:19], v[148:151]
    ds_read_b128 a[132:135], v1 offset:17472
    s_waitcnt lgkmcnt(2)
    v_mfma_f32_16x16x32_bf16 v[152:155], a[184:187], v[16:19], v[152:155]
    s_add_u32 s86, s86, 16384
    v_exp_f32 v49, v49
    v_mfma_f32_16x16x32_bf16 v[156:159], a[188:191], v[16:19], v[156:159]
    ds_read_b128 a[136:139], v2 offset:17408
    v_cvt_pk_bf16_f32 v48, v48, v49
    v_mfma_f32_16x16x32_bf16 v[160:163], a[160:163], v[20:23], v[160:163]
    v_exp_f32 v50, v50
    v_mfma_f32_16x16x32_bf16 v[164:167], a[164:167], v[20:23], v[164:167]
    ds_read_b128 a[140:143], v2 offset:17472
    v_mfma_f32_16x16x32_bf16 v[168:171], a[168:171], v[20:23], v[168:171]
    v_exp_f32 v51, v51
    v_mfma_f32_16x16x32_bf16 v[172:175], a[172:175], v[20:23], v[172:175]
    ds_read_b128 a[144:147], v1 offset:21632
    v_cvt_pk_bf16_f32 v49, v50, v51
    v_mfma_f32_16x16x32_bf16 v[176:179], a[176:179], v[20:23], v[176:179]
    v_exp_f32 v52, v52
    v_mfma_f32_16x16x32_bf16 v[180:183], a[180:183], v[20:23], v[180:183]
    ds_read_b128 a[148:151], v1 offset:21696
    v_mfma_f32_16x16x32_bf16 v[184:187], a[184:187], v[20:23], v[184:187]
    s_min_u32 s86, s86, s96
    v_exp_f32 v53, v53
    v_mfma_f32_16x16x32_bf16 v[188:191], a[188:191], v[20:23], v[188:191]
    ds_read_b128 a[152:155], v2 offset:21632
    v_cvt_pk_bf16_f32 v50, v52, v53
    v_smfmac_f32_16x16x64_bf16 a[208:211], a[228:231], v[16:23], v15
    v_exp_f32 v54, v54
    v_mfma_f32_16x16x32_bf16 v[192:195], a[160:163], v[32:35], v[192:195]
    ds_read_b128 a[156:159], v2 offset:21696
    v_mfma_f32_16x16x32_bf16 v[196:199], a[164:167], v[32:35], v[196:199]
    v_exp_f32 v55, v55
    v_mfma_f32_16x16x32_bf16 v[200:203], a[168:171], v[32:35], v[200:203]
    s_add_u32 s28, s28, s101
    v_cvt_pk_bf16_f32 v51, v54, v55
    v_mfma_f32_16x16x32_bf16 v[204:207], a[172:175], v[32:35], v[204:207]
    v_exp_f32 v56, v56
    v_mfma_f32_16x16x32_bf16 v[208:211], a[176:179], v[32:35], v[208:211]
    s_add_u32 s29, s29, s101
    s_sub_u32 s31, s31, 1
    v_mfma_f32_16x16x32_bf16 v[212:215], a[180:183], v[32:35], v[212:215]
    v_exp_f32 v57, v57
    v_mfma_f32_16x16x32_bf16 v[216:219], a[184:187], v[32:35], v[216:219]
    s_cmp_le_u32 s31, s32
    s_waitcnt vmcnt(10) lgkmcnt(0)
    v_cvt_pk_bf16_f32 v52, v56, v57
    v_mfma_f32_16x16x32_bf16 v[220:223], a[188:191], v[32:35], v[220:223]
    v_exp_f32 v58, v58
    v_mfma_f32_16x16x32_bf16 a[212:215], a[224:227], v[32:35], a[212:215]
    s_cbranch_scc1 L_sp3x_2
L_itb3x_2:
    s_barrier
    v_mfma_f32_16x16x32_bf16 v[16:19], a[128:131], a[0:3], v[80:83]
    v_exp_f32 v59, v59
    v_mfma_f32_16x16x32_bf16 v[16:19], a[132:135], a[4:7], v[16:19]
    ds_read_b64_tr_b16 a[160:161], v3 offset:34816
    v_cvt_pk_bf16_f32 v53, v58, v59
    v_mfma_f32_16x16x32_bf16 v[16:19], a[136:139], a[8:11], v[16:19]
    ds_read_b64_tr_b16 a[162:163], v3 offset:35328
    v_mfma_f32_16x16x32_bf16 v[16:19], a[140:143], a[12:15], v[16:19]
    v_exp_f32 v60, v60
    v_mfma_f32_16x16x32_bf16 v[20:23], a[144:147], a[0:3], v[80:83]
    ds_read_b64_tr_b16 a[164:165], v3 offset:34848
    v_mfma_f32_16x16x32_bf16 v[20:23], a[148:151], a[4:7], v[20:23]
    v_exp_f32 v61, v61
    v_mfma_f32_16x16x32_bf16 v[20:23], a[152:155], a[8:11], v[20:23]
    ds_read_b64_tr_b16 a[166:167], v3 offset:35360
    v_cvt_pk_bf16_f32 v54, v60, v61
    v_mfma_f32_16x16x32_bf16 v[20:23], a[156:159], a[12:15], v[20:23]
    s_mov_b32 m0, s99
    v_exp_f32 v62, v62
    v_mfma_f32_16x16x32_bf16 v[24:27], a[128:131], a[16:19], v[84:87]
    ds_read_b64_tr_b16 a[168:169], v3 offset:34880
    buffer_load_dwordx4 v4, s[4:7], s86 offen lds
    v_mfma_f32_16x16x32_bf16 v[24:27], a[132:135], a[20:23], v[24:27]
    s_add_u32 m0, s30, 17408
    v_exp_f32 v63, v63
    v_mfma_f32_16x16x32_bf16 v[24:27], a[136:139], a[24:27], v[24:27]
    ds_read_b64_tr_b16 a[170:171], v3 offset:35392
    v_cvt_pk_bf16_f32 v55, v62, v63
    v_mfma_f32_16x16x32_bf16 v[24:27], a[140:143], a[28:31], v[24:27]
    ds_read_b64_tr_b16 a[172:173], v3 offset:34912
    v_exp_f32 v64, v64
    v_mfma_f32_16x16x32_bf16 v[28:31], a[144:147], a[16:19], v[84:87]
    ds_read_b64_tr_b16 a[174:175], v3 offset:35424
    buffer_load_dwordx4 v4, s[8:11], s28 offen lds
    v_mfma_f32_16x16x32_bf16 v[28:31], a[148:151], a[20:23], v[28:31]
    s_add_u32 m0, s30, 21632
    s_add_u32 s99, s99, 1056
    v_exp_f32 v65, v65
    v_mfma_f32_16x16x32_bf16 v[28:31], a[152:155], a[24:27], v[28:31]
    ds_read_b64_tr_b16 a[176:177], v3 offset:34944
    v_cvt_pk_bf16_f32 v64, v64, v65
    v_mfma_f32_16x16x32_bf16 v[28:31], a[156:159], a[28:31], v[28:31]
    buffer_load_dwordx4 v5, s[8:11], s28 offen lds
    v_exp_f32 v66, v66
    v_mfma_f32_16x16x32_bf16 v[32:35], a[128:131], a[32:35], v[88:91]
    ds_read_b64_tr_b16 a[178:179], v3 offset:35456
    s_add_u32 m0, s30, 26112
    v_mfma_f32_16x16x32_bf16 v[32:35], a[132:135], a[36:39], v[32:35]
    buffer_load_dwordx4 v6, s[12:15], s29 offen lds
    v_exp_f32 v67, v67
    v_mfma_f32_16x16x32_bf16 v[32:35], a[136:139], a[40:43], v[32:35]
    ds_read_b64_tr_b16 a[180:181], v3 offset:34976
    v_cvt_pk_bf16_f32 v65, v66, v67
    v_mfma_f32_16x16x32_bf16 v[32:35], a[140:143], a[44:47], v[32:35]
    s_add_u32 m0, s30, 30336
    v_exp_f32 v68, v68
    v_mfma_f32_16x16x32_bf16 v[36:39], a[144:147], a[32:35], v[88:91]
    ds_read_b64_tr_b16 a[182:183], v3 offset:35488
    buffer_load_dwordx4 v7, s[12:15], s29 offen lds
    v_mfma_f32_16x16x32_bf16 v[36:39], a[148:151], a[36:39], v[36:39]
    s_min_u32 s99, s99, s100
    v_exp_f32 v69, v69
    v_mfma_f32_16x16x32_bf16 v[36:39], a[152:155], a[40:43], v[36:39]
    ds_read_b64_tr_b16 a[184:185], v3 offset:35008
    v_cvt_pk_bf16_f32 v66, v68, v69
    v_mfma_f32_16x16x32_bf16 v[36:39], a[156:159], a[44:47], v[36:39]
    ds_read_b64_tr_b16 a[186:187], v3 offset:35520
    v_exp_f32 v70, v70
    s_waitcnt lgkmcnt(2)
    v_mfma_f32_16x16x32_bf16 v[128:131], a[160:163], v[48:51], v[128:131]
    ds_read_b64_tr_b16 a[188:189], v3 offset:35040
    v_mfma_f32_16x16x32_bf16 v[132:135], a[164:167], v[48:51], v[132:135]
    v_exp_f32 v71, v71
    v_mfma_f32_16x16x32_bf16 v[136:139], a[168:171], v[48:51], v[136:139]
    ds_read_b64_tr_b16 a[190:191], v3 offset:35552
    v_cvt_pk_bf16_f32 v67, v70, v71
    v_mfma_f32_16x16x32_bf16 v[140:143], a[172:175], v[48:51], v[140:143]
    ds_read_b128 a[128:131], v1 offset:34816
    v_mfma_f32_16x16x32_bf16 v[144:147], a[176:179], v[48:51], v[144:147]
    v_exp_f32 v16, v16
    v_mfma_f32_16x16x32_bf16 v[148:151], a[180:183], v[48:51], v[148:151]
    ds_read_b128 a[132:135], v1 offset:34880
    s_waitcnt lgkmcnt(2)
    v_mfma_f32_16x16x32_bf16 v[152:155], a[184:187], v[48:51], v[152:155]
    s_add_u32 s86, s86, 16384
    v_exp_f32 v17, v17
    v_mfma_f32_16x16x32_bf16 v[156:159], a[188:191], v[48:51], v[156:159]
    ds_read_b128 a[136:139], v2 offset:34816
    v_cvt_pk_bf16_f32 v16, v16, v17
    v_mfma_f32_16x16x32_bf16 v[160:163], a[160:163], v[52:55], v[160:163]
    v_exp_f32 v18, v18
    v_mfma_f32_16x16x32_bf16 v[164:167], a[164:167], v[52:55], v[164:167]
    ds_read_b128 a[140:143], v2 offset:34880
    v_mfma_f32_16x16x32_bf16 v[168:171], a[168:171], v[52:55], v[168:171]
    v_exp_f32 v19, v19
    v_mfma_f32_16x16x32_bf16 v[172:175], a[172:175], v[52:55], v[172:175]
    ds_read_b128 a[144:147], v1 offset:39040
    v_cvt_pk_bf16_f32 v17, v18, v19
    v_mfma_f32_16x16x32_bf16 v[176:179], a[176:179], v[52:55], v[176:179]
    v_exp_f32 v20, v20
    v_mfma_f32_16x16x32_bf16 v[180:183], a[180:183], v[52:55], v[180:183]
    ds_read_b128 a[148:151], v1 offset:39104
    v_mfma_f32_16x16x32_bf16 v[184:187], a[184:187], v[52:55], v[184:187]
    s_min_u32 s86, s86, s96
    v_exp_f32 v21, v21
    v_mfma_f32_16x16x32_bf16 v[188:191], a[188:191], v[52:55], v[188:191]
    ds_read_b128 a[152:155], v2 offset:39040
    v_cvt_pk_bf16_f32 v18, v20, v21
    v_smfmac_f32_16x16x64_bf16 a[208:211], a[228:231], v[48:55], v15
    v_exp_f32 v22, v22
    v_mfma_f32_16x16x32_bf16 v[192:195], a[160:163], v[64:67], v[192:195]
    ds_read_b128 a[156:159], v2 offset:39104
    v_mfma_f32_16x16x32_bf16 v[196:199], a[164:167], v[64:67], v[196:199]
    v_exp_f32 v23, v23
    v_mfma_f32_16x16x32_bf16 v[200:203], a[168:171], v[64:67], v[200:203]
    s_add_u32 s28, s28, s101
    v_cvt_pk_bf16_f32 v19, v22, v23
    v_mfma_f32_16x16x32_bf16 v[204:207], a[172:175], v[64:67], v[204:207]
    v_exp_f32 v24, v24
    v_mfma_f32_16x16x32_bf16 v[208:211], a[176:179], v[64:67], v[208:211]
    s_add_u32 s29, s29, s101
    s_sub_u32 s31, s31, 1
    v_mfma_f32_16x16x32_bf16 v[212:215], a[180:183], v[64:67], v[212:215]
    v_exp_f32 v25, v25
    v_mfma_f32_16x16x32_bf16 v[216:219], a[184:187], v[64:67], v[216:219]
    s_cmp_le_u32 s31, s32
    s_waitcnt vmcnt(10) lgkmcnt(0)
    v_cvt_pk_bf16_f32 v20, v24, v25
    v_mfma_f32_16x16x32_bf16 v[220:223], a[188:191], v[64:67], v[220:223]
    v_exp_f32 v26, v26
    v_mfma_f32_16x16x32_bf16 a[212:215], a[224:227], v[64:67], a[212:215]
    s_cbranch_scc1 L_sp3x_3
L_itb3x_3:
    s_barrier
    v_mfma_f32_16x16x32_bf16 v[48:51], a[128:131], a[0:3], v[80:83]
    v_exp_f32 v27, v27
    v_mfma_f32_16x16x32_bf16 v[48:51], a[132:135], a[4:7], v[48:51]
    ds_read_b64_tr_b16 a[160:161], v3 offset:52224
    v_cvt_pk_bf16_f32 v21, v26, v27
    v_mfma_f32_16x16x32_bf16 v[48:51], a[136:139], a[8:11], v[48:51]
    ds_read_b64_tr_b16 a[162:163], v3 offset:52736
    v_mfma_f32_16x16x32_bf16 v[48:51], a[140:143], a[12:15], v[48:51]
    v_exp_f32 v28, v28
    v_mfma_f32_16x16x32_bf16 v[52:55], a[144:147], a[0:3], v[80:83]
    ds_read_b64_tr_b16 a[164:165], v3 offset:52256
    v_mfma_f32_16x16x32_bf16 v[52:55], a[148:151], a[4:7], v[52:55]
    v_exp_f32 v29, v29
    v_mfma_f32_16x16x32_bf16 v[52:55], a[152:155], a[8:11], v[52:55]
    ds_read_b64_tr_b16 a[166:167], v3 offset:52768
    v_cvt_pk_bf16_f32 v22, v28, v29
    v_mfma_f32_16x16x32_bf16 v[52:55], a[156:159], a[12:15], v[52:55]
    s_mov_b32 m0, s99
    v_exp_f32 v30, v30
    v_mfma_f32_16x16x32_bf16 v[56:59], a[128:131], a[16:19], v[84:87]
    ds_read_b64_tr_b16 a[168:169], v3 offset:52288
    buffer_load_dwordx4 v4, s[4:7], s86 offen lds
    v_mfma_f32_16x16x32_bf16 v[56:59], a[132:135], a[20:23], v[56:59]
    s_add_u32 m0, s30, 34816
    v_exp_f32 v31, v31
    v_mfma_f32_16x16x32_bf16 v[56:59], a[136:139], a[24:27], v[56:59]
    ds_read_b64_tr_b16 a[170:171], v3 offset:52800
    v_cvt_pk_bf16_f32 v23, v30, v31
    v_mfma_f32_16x16x32_bf16 v[56:59], a[140:143], a[28:31], v[56:59]
    ds_read_b64_tr_b16 a[172:173], v3 offset:52320
    v_exp_f32 v32, v32
    v_mfma_f32_16x16x32_bf16 v[60:63], a[144:147], a[16:19], v[84:87]
    ds_read_b64_tr_b16 a[174:175], v3 offset:52832
    buffer_load_dwordx4 v4, s[8:11], s28 offen lds
    v_mfma_f32_16x16x32_bf16 v[60:63], a[148:151], a[20:23], v[60:63]
    s_add_u32 m0, s30, 39040
    s_add_u32 s99, s99, 1056
    v_exp_f32 v33, v33
    v_mfma_f32_16x16x32_bf16 v[60:63], a[152:155], a[24:27], v[60:63]
    ds_read_b64_tr_b16 a[176:177], v3 offset:52352
    v_cvt_pk_bf16_f32 v32, v32, v33
    v_mfma_f32_16x16x32_bf16 v[60:63], a[156:159], a[28:31], v[60:63]
    buffer_load_dwordx4 v5, s[8:11], s28 offen lds
    v_exp_f32 v34, v34
    v_mfma_f32_16x16x32_bf16 v[64:67], a[128:131], a[32:35], v[88:91]
    ds_read_b64_tr_b16 a[178:179], v3 offset:52864
    s_add_u32 m0, s30, 43520
    v_mfma_f32_16x16x32_bf16 v[64:67], a[132:135], a[36:39], v[64:67]
    buffer_load_dwordx4 v6, s[12:15], s29 offen lds
    v_exp_f32 v35, v35
    v_mfma_f32_16x16x32_bf16 v[64:67], a[136:139], a[40:43], v[64:67]
    ds_read_b64_tr_b16 a[180:181], v3 offset:52384
    v_cvt_pk_bf16_f32 v33, v34, v35
    v_mfma_f32_16x16x32_bf16 v[64:67], a[140:143], a[44:47], v[64:67]
    s_add_u32 m0, s30, 47744
    v_exp_f32 v36, v36
    v_mfma_f32_16x16x32_bf16 v[68:71], a[144:147], a[32:35], v[88:91]
    ds_read_b64_tr_b16 a[182:183], v3 offset:52896
    buffer_load_dwordx4 v7, s[12:15], s29 offen lds
    v_mfma_f32_16x16x32_bf16 v[68:71], a[148:151], a[36:39], v[68:71]
    s_min_u32 s99, s99, s100
    v_exp_f32 v37, v37
    v_mfma_f32_16x16x32_bf16 v[68:71], a[152:155], a[40:43], v[68:71]
    ds_read_b64_tr_b16 a[184:185], v3 offset:52416
    v_cvt_pk_bf16_f32 v34, v36, v37
    v_mfma_f32_16x16x32_bf16 v[68:71], a[156:159], a[44:47], v[68:71]
    ds_read_b64_tr_b16 a[186:187], v3 offset:52928
    v_exp_f32 v38, v38
    s_waitcnt lgkmcnt(2)
    v_mfma_f32_16x16x32_bf16 v[128:131], a[160:163], v[16:19], v[128:131]
    ds_read_b64_tr_b16 a[188:189], v3 offset:52448
    v_mfma_f32_16x16x32_bf16 v[132:135], a[164:167], v[16:19], v[132:135]
    v_exp_f32 v39, v39
    v_mfma_f32_16x16x32_bf16 v[136:139], a[168:171], v[16:19], v[136:139]
    ds_read_b64_tr_b16 a[190:191], v3 offset:52960
    v_cvt_pk_bf16_f32 v35, v38, v39
    v_mfma_f32_16x16x32_bf16 v[140:143], a[172:175], v[16:19], v[140:143]
    ds_read_b128 a[128:131], v1 offset:52224
    v_mfma_f32_16x16x32_bf16 v[144:147], a[176:179], v[16:19], v[144:147]
    v_exp_f32 v48, v48
    v_mfma_f32_16x16x32_bf16 v[148:151], a[180:183], v[16:19], v[148:151]
    ds_read_b128 a[132:135], v1 offset:52288
    s_waitcnt lgkmcnt(2)
    v_mfma_f32_16x16x32_bf16 v[152:155], a[184:187], v[16:19], v[152:155]
    s_add_u32 s86, s86, 16384
    v_exp_f32 v49, v49
    v_mfma_f32_16x16x32_bf16 v[156:159], a[188:191], v[16:19], v[156:159]
    ds_read_b128 a[136:139], v2 offset:52224
    v_cvt_pk_bf16_f32 v48, v48, v49
    v_mfma_f32_16x16x32_bf16 v[160:163], a[160:163], v[20:23], v[160:163]
    v_exp_f32 v50, v50
    v_mfma_f32_16x16x32_bf16 v[164:167], a[164:167], v[20:23], v[164:167]
    ds_read_b128 a[140:143], v2 offset:52288
    v_mfma_f32_16x16x32_bf16 v[168:171], a[168:171], v[20:23], v[168:171]
    v_exp_f32 v51, v51
    v_mfma_f32_16x16x32_bf16 v[172:175], a[172:175], v[20:23], v[172:175]
    ds_read_b128 a[144:147], v1 offset:56448
    v_cvt_pk_bf16_f32 v49, v50, v51
    v_mfma_f32_16x16x32_bf16 v[176:179], a[176:179], v[20:23], v[176:179]
    v_exp_f32 v52, v52
    v_mfma_f32_16x16x32_bf16 v[180:183], a[180:183], v[20:23], v[180:183]
    ds_read_b128 a[148:151], v1 offset:56512
    v_mfma_f32_16x16x32_bf16 v[184:187], a[184:187], v[20:23], v[184:187]
    s_min_u32 s86, s86, s96
    v_exp_f32 v53, v53
    v_mfma_f32_16x16x32_bf16 v[188:191], a[188:191], v[20:23], v[188:191]
    ds_read_b128 a[152:155], v2 offset:56448
    v_cvt_pk_bf16_f32 v50, v52, v53
    v_smfmac_f32_16x16x64_bf16 a[208:211], a[228:231], v[16:23], v15
    v_exp_f32 v54, v54
    v_mfma_f32_16x16x32_bf16 v[192:195], a[160:163], v[32:35], v[192:195]
    ds_read_b128 a[156:159], v2 offset:56512
    v_mfma_f32_16x16x32_bf16 v[196:199], a[164:167], v[32:35], v[196:199]
    v_exp_f32 v55, v55
    v_mfma_f32_16x16x32_bf16 v[200:203], a[168:171], v[32:35], v[200:203]
    s_add_u32 s28, s28, s101
    v_cvt_pk_bf16_f32 v51, v54, v55
    v_mfma_f32_16x16x32_bf16 v[204:207], a[172:175], v[32:35], v[204:207]
    v_exp_f32 v56, v56
    v_mfma_f32_16x16x32_bf16 v[208:211], a[176:179], v[32:35], v[208:211]
    s_add_u32 s29, s29, s101
    s_sub_u32 s31, s31, 1
    v_mfma_f32_16x16x32_bf16 v[212:215], a[180:183], v[32:35], v[212:215]
    v_exp_f32 v57, v57
    v_mfma_f32_16x16x32_bf16 v[216:219], a[184:187], v[32:35], v[216:219]
    s_cmp_le_u32 s31, s32
    s_waitcnt vmcnt(10) lgkmcnt(0)
    v_cvt_pk_bf16_f32 v52, v56, v57
    v_mfma_f32_16x16x32_bf16 v[220:223], a[188:191], v[32:35], v[220:223]
    v_exp_f32 v58, v58
    v_mfma_f32_16x16x32_bf16 a[212:215], a[224:227], v[32:35], a[212:215]
    s_cbranch_scc1 L_sp3x_0
L_itb3x_0:
    s_barrier
    v_mfma_f32_16x16x32_bf16 v[16:19], a[128:131], a[0:3], v[80:83]
    v_exp_f32 v59, v59
    v_mfma_f32_16x16x32_bf16 v[16:19], a[132:135], a[4:7], v[16:19]
    ds_read_b64_tr_b16 a[160:161], v3 offset:0
    v_cvt_pk_bf16_f32 v53, v58, v59
    v_mfma_f32_16x16x32_bf16 v[16:19], a[136:139], a[8:11], v[16:19]
    ds_read_b64_tr_b16 a[162:163], v3 offset:512
    v_mfma_f32_16x16x32_bf16 v[16:19], a[140:143], a[12:15], v[16:19]
    v_exp_f32 v60, v60
    v_mfma_f32_16x16x32_bf16 v[20:23], a[144:147], a[0:3], v[80:83]
    ds_read_b64_tr_b16 a[164:165], v3 offset:32
    v_mfma_f32_16x16x32_bf16 v[20:23], a[148:151], a[4:7], v[20:23]
    v_exp_f32 v61, v61
    v_mfma_f32_16x16x32_bf16 v[20:23], a[152:155], a[8:11], v[20:23]
    ds_read_b64_tr_b16 a[166:167], v3 offset:544
    v_cvt_pk_bf16_f32 v54, v60, v61
    v_mfma_f32_16x16x32_bf16 v[20:23], a[156:159], a[12:15], v[20:23]
    s_mov_b32 m0, s99
    v_exp_f32 v62, v62
    v_mfma_f32_16x16x32_bf16 v[24:27], a[128:131], a[16:19], v[84:87]
    ds_read_b64_tr_b16 a[168:169], v3 offset:64
    buffer_load_dwordx4 v4, s[4:7], s86 offen lds
    v_mfma_f32_16x16x32_bf16 v[24:27], a[132:135], a[20:23], v[24:27]
    s_add_u32 m0, s30, 52224
    v_exp_f32 v63, v63
    v_mfma_f32_16x16x32_bf16 v[24:27], a[136:139], a[24:27], v[24:27]
    ds_read_b64_tr_b16 a[170:171], v3 offset:576
    v_cvt_pk_bf16_f32 v55, v62, v63
    v_mfma_f32_16x16x32_bf16 v[24:27], a[140:143], a[28:31], v[24:27]
    ds_read_b64_tr_b16 a[172:173], v3 offset:96
    v_exp_f32 v64, v64
    v_mfma_f32_16x16x32_bf16 v[28:31], a[144:147], a[16:19], v[84:87]
    ds_read_b64_tr_b16 a[174:175], v3 offset:608
    buffer_load_dwordx4 v4, s[8:11], s28 offen lds
    v_mfma_f32_16x16x32_bf16 v[28:31], a[148:151], a[20:23], v[28:31]
    s_add_u32 m0, s30, 56448
    s_add_u32 s99, s99, 1056
    v_exp_f32 v65, v65
    v_mfma_f32_16x16x32_bf16 v[28:31], a[152:155], a[24:27], v[28:31]
    ds_read_b64_tr_b16 a[176:177], v3 offset:128
    v_cvt_pk_bf16_f32 v64, v64, v65
    v_mfma_f32_16x16x32_bf16 v[28:31], a[156:159], a[28:31], v[28:31]
    buffer_load_dwordx4 v5, s[8:11], s28 offen lds
    v_exp_f32 v66, v66
    v_mfma_f32_16x16x32_bf16 v[32:35], a[128:131], a[32:35], v[88:91]
    ds_read_b64_tr_b16 a[178:179], v3 offset:640
    s_add_u32 m0, s30, 60928
    v_mfma_f32_16x16x32_bf16 v[32:35], a[132:135], a[36:39], v[32:35]
    buffer_load_dwordx4 v6, s[12:15], s29 offen lds
    v_exp_f32 v67, v67
    v_mfma_f32_16x16x32_bf16 v[32:35], a[136:139], a[40:43], v[32:35]
    ds_read_b64_tr_b16 a[180:181], v3 offset:160
    v_cvt_pk_bf16_f32 v65, v66, v67
    v_mfma_f32_16x16x32_bf16 v[32:35], a[140:143], a[44:47], v[32:35]
    s_add_u32 m0, s30, 65152
    v_exp_f32 v68, v68
    v_mfma_f32_16x16x32_bf16 v[36:39], a[144:147], a[32:35], v[88:91]
    ds_read_b64_tr_b16 a[182:183], v3 offset:672
    buffer_load_dwordx4 v7, s[12:15], s29 offen lds
    v_mfma_f32_16x16x32_bf16 v[36:39], a[148:151], a[36:39], v[36:39]
    s_min_u32 s99, s99, s100
    v_exp_f32 v69, v69
    v_mfma_f32_16x16x32_bf16 v[36:39], a[152:155], a[40:43], v[36:39]
    ds_read_b64_tr_b16 a[184:185], v3 offset:192
    v_cvt_pk_bf16_f32 v66, v68, v69
    v_mfma_f32_16x16x32_bf16 v[36:39], a[156:159], a[44:47], v[36:39]
    ds_read_b64_tr_b16 a[186:187], v3 offset:704
    v_exp_f32 v70, v70
    s_waitcnt lgkmcnt(2)
    v_mfma_f32_16x16x32_bf16 v[128:131], a[160:163], v[48:51], v[128:131]
    ds_read_b64_tr_b16 a[188:189], v3 offset:224
    v_mfma_f32_16x16x32_bf16 v[132:135], a[164:167], v[48:51], v[132:135]
    v_exp_f32_e64 v71, v71
    v_mfma_f32_16x16x32_bf16 v[136:139], a[168:171], v[48:51], v[136:139]
    ds_read_b64_tr_b16 a[190:191], v3 offset:736
    v_cvt_pk_bf16_f32 v67, v70, v71
    v_mfma_f32_16x16x32_bf16 v[140:143], a[172:175], v[48:51], v[140:143]
    ds_read_b128 a[128:131], v1 offset:0
    v_mfma_f32_16x16x32_bf16 v[144:147], a[176:179], v[48:51], v[144:147]
    v_exp_f32 v16, v16
    v_mfma_f32_16x16x32_bf16 v[148:151], a[180:183], v[48:51], v[148:151]
    ds_read_b128 a[132:135], v1 offset:64
    s_waitcnt lgkmcnt(2)
    v_mfma_f32_16x16x32_bf16 v[152:155], a[184:187], v[48:51], v[152:155]
    s_add_u32 s86, s86, 16384
    v_exp_f32 v17, v17
    v_mfma_f32_16x16x32_bf16 v[156:159], a[188:191], v[48:51], v[156:159]
    ds_read_b128 a[136:139], v2 offset:0
    v_cvt_pk_bf16_f32 v16, v16, v17
    v_mfma_f32_16x16x32_bf16 v[160:163], a[160:163], v[52:55], v[160:163]
    v_exp_f32 v18, v18
    v_mfma_f32_16x16x32_bf16 v[164:167], a[164:167], v[52:55], v[164:167]
    ds_read_b128 a[140:143], v2 offset:64
    v_mfma_f32_16x16x32_bf16 v[168:171], a[168:171], v[52:55], v[168:171]
    v_exp_f32 v19, v19
    v_mfma_f32_16x16x32_bf16 v[172:175], a[172:175], v[52:55], v[172:175]
    ds_read_b128 a[144:147], v1 offset:4224
    v_cvt_pk_bf16_f32 v17, v18, v19
    v_mfma_f32_16x16x32_bf16 v[176:179], a[176:179], v[52:55], v[176:179]
    v_exp_f32 v20, v20
    v_mfma_f32_16x16x32_bf16 v[180:183], a[180:183], v[52:55], v[180:183]
    ds_read_b128 a[148:151], v1 offset:4288
    v_mfma_f32_16x16x32_bf16 v[184:187], a[184:187], v[52:55], v[184:187]
    s_min_u32 s86, s86, s96
    v_exp_f32 v21, v21
    v_mfma_f32_16x16x32_bf16 v[188:191], a[188:191], v[52:55], v[188:191]
    ds_read_b128 a[152:155], v2 offset:4224
    v_cvt_pk_bf16_f32 v18, v20, v21
    v_smfmac_f32_16x16x64_bf16 a[208:211], a[228:231], v[48:55], v15
    v_exp_f32 v22, v22
    v_mfma_f32_16x16x32_bf16 v[192:195], a[160:163], v[64:67], v[192:195]
    ds_read_b128 a[156:159], v2 offset:4288
    v_mfma_f32_16x16x32_bf16 v[196:199], a[164:167], v[64:67], v[196:199]
    v_exp_f32 v23, v23
    v_mfma_f32_16x16x32_bf16 v[200:203], a[168:171], v[64:67], v[200:203]
    s_add_u32 s28, s28, s101
    v_cvt_pk_bf16_f32 v19, v22, v23
    v_mfma_f32_16x16x32_bf16 v[204:207], a[172:175], v[64:67], v[204:207]
    v_exp_f32 v24, v24
    v_mfma_f32_16x16x32_bf16 v[208:211], a[176:179], v[64:67], v[208:211]
    s_add_u32 s29, s29, s101
    s_sub_u32 s31, s31, 1
    v_mfma_f32_16x16x32_bf16 v[212:215], a[180:183], v[64:67], v[212:215]
    v_exp_f32 v25, v25
    v_mfma_f32_16x16x32_bf16 v[216:219], a[184:187], v[64:67], v[216:219]
    s_cmp_le_u32 s31, s32
    s_waitcnt vmcnt(10) lgkmcnt(0)
    v_cvt_pk_bf16_f32 v20, v24, v25
    v_mfma_f32_16x16x32_bf16 v[220:223], a[188:191], v[64:67], v[220:223]
    v_exp_f32 v26, v26
    v_mfma_f32_16x16x32_bf16 a[212:215], a[224:227], v[64:67], a[212:215]
    s_cbranch_scc0 L_itb3x_1
L_sp3x_1:
    s_cmp_eq_u32 s31, 0
    s_cbranch_scc1 L_e3x_1
    s_cmp_eq_u32 s31, 2
    s_cbranch_scc1 L_sv3x_1
    s_mov_b32 s10, s90
    s_mov_b32 s28, s89
    s_mov_b32 s32, 2
    s_mov_b32 s38, L_e3x_1-L_pc
    s_cmp_eq_u32 s87, 1
    s_cselect_b32 s38, L_e3x_1-L_pc+8192, s38
    s_cmp_eq_u32 s87, 2
    s_cselect_b32 s38, L_e3x_1-L_pc+16384, s38
    s_mov_b32 s39, L_itb2_1-L_pc
    s_cmp_eq_u32 s87, 3
    s_cselect_b32 s38, s39, s38
    v_mbcnt_lo_u32_b32 v116, -1, 0
    v_mbcnt_hi_u32_b32 v116, -1, v116
    v_lshl_add_u32 v116, v116, 7, s38
    v_min_u32 v116, L_table-L_pc, v116
    global_load_dword v14, v116, s[74:75]
    s_branch L_itb3x_1
L_sv3x_1:
    s_mov_b32 s14, s90
    s_mov_b32 s29, s89
    s_mov_b32 s32, 0
    s_branch L_itb3x_1
L_sp3x_2:
    s_cmp_eq_u32 s31, 0
    s_cbranch_scc1 L_e3x_2
    s_cmp_eq_u32 s31, 2
    s_cbranch_scc1 L_sv3x_2
    s_mov_b32 s10, s90
    s_mov_b32 s28, s89
    s_mov_b32 s32, 2
    s_mov_b32 s38, L_e3x_2-L_pc
    s_cmp_eq_u32 s87, 1
    s_cselect_b32 s38, L_e3x_2-L_pc+8192, s38
    s_cmp_eq_u32 s87, 2
    s_cselect_b32 s38, L_e3x_2-L_pc+16384, s38
    s_mov_b32 s39, L_itb3_1-L_pc
    s_cmp_eq_u32 s87, 3
    s_cselect_b32 s38, s39, s38
    v_mbcnt_lo_u32_b32 v116, -1, 0
    v_mbcnt_hi_u32_b32 v116, -1, v116
    v_lshl_add_u32 v116, v116, 7, s38
    v_min_u32 v116, L_table-L_pc, v116
    global_load_dword v14, v116, s[74:75]
    s_branch L_itb3x_2
L_sv3x_2:
    s_mov_b32 s14, s90
    s_mov_b32 s29, s89
    s_mov_b32 s32, 0
    s_branch L_itb3x_2
L_sp3x_3:
    s_cmp_eq_u32 s31, 0
    s_cbranch_scc1 L_e3x_3
    s_cmp_eq_u32 s31, 2
    s_cbranch_scc1 L_sv3x_3
    s_mov_b32 s10, s90
    s_mov_b32 s28, s89
    s_mov_b32 s32, 2
    s_mov_b32 s38, L_e3x_3-L_pc
    s_cmp_eq_u32 s87, 1
    s_cselect_b32 s38, L_e3x_3-L_pc+8192, s38
    s_cmp_eq_u32 s87, 2
    s_cselect_b32 s38, L_e3x_3-L_pc+16384, s38
    s_mov_b32 s39, L_itb3_1-L_pc
    s_cmp_eq_u32 s87, 3
    s_cselect_b32 s38, s39, s38
    v_mbcnt_lo_u32_b32 v116, -1, 0
    v_mbcnt_hi_u32_b32 v116, -1, v116
    v_lshl_add_u32 v116, v116, 7, s38
    v_min_u32 v116, L_table-L_pc, v116
    global_load_dword v14, v116, s[74:75]
    s_branch L_itb3x_3
L_sv3x_3:
    s_mov_b32 s14, s90
    s_mov_b32 s29, s89
    s_mov_b32 s32, 0
    s_branch L_itb3x_3
L_sp3x_0:
    s_cmp_eq_u32 s31, 0
    s_cbranch_scc1 L_e3x_0
    s_cmp_eq_u32 s31, 2
    s_cbranch_scc1 L_sv3x_0
    s_mov_b32 s10, s90
    s_mov_b32 s28, s89
    s_mov_b32 s32, 2
    s_mov_b32 s38, L_e3x_0-L_pc
    s_cmp_eq_u32 s87, 1
    s_cselect_b32 s38, L_e3x_0-L_pc+8192, s38
    s_cmp_eq_u32 s87, 2
    s_cselect_b32 s38, L_e3x_0-L_pc+16384, s38
    s_mov_b32 s39, L_itb2_1-L_pc
    s_cmp_eq_u32 s93, 3
    s_cselect_b32 s39, L_itb3_1-L_pc, s39
    s_cmp_eq_u32 s87, 3
    s_cselect_b32 s38, s39, s38
    v_mbcnt_lo_u32_b32 v116, -1, 0
    v_mbcnt_hi_u32_b32 v116, -1, v116
    v_lshl_add_u32 v116, v116, 7, s38
    v_min_u32 v116, L_table-L_pc, v116
    global_load_dword v14, v116, s[74:75]
    s_branch L_itb3x_0
L_sv3x_0:
    s_mov_b32 s14, s90
    s_mov_b32 s29, s89
    s_mov_b32 s32, 0
    s_branch L_itb3x_0
.p2align 6
    s_nop 0
L_itb3_1:
    s_barrier
    v_mfma_f32_16x16x32_bf16 v[48:51], a[128:131], a[0:3], v[80:83]
    v_exp_f32 v27, v27
    v_mfma_f32_16x16x32_bf16 v[48:51], a[132:135], a[4:7], v[48:51]
    ds_read_b64_tr_b16 a[160:161], v3 offset:17408
    v_cvt_pk_bf16_f32 v21, v26, v27
    v_mfma_f32_16x16x32_bf16 v[48:51], a[136:139], a[8:11], v[48:51]
    ds_read_b64_tr_b16 a[162:163], v3 offset:17920
    v_mfma_f32_16x16x32_bf16 v[48:51], a[140:143], a[12:15], v[48:51]
    v_exp_f32 v28, v28
    v_mfma_f32_16x16x32_bf16 v[52:55], a[144:147], a[0:3], v[80:83]
    ds_read_b64_tr_b16 a[164:165], v3 offset:17440
    v_mfma_f32_16x16x32_bf16 v[52:55], a[148:151], a[4:7], v[52:55]
    v_exp_f32 v29, v29
    v_mfma_f32_16x16x32_bf16 v[52:55], a[152:155], a[8:11], v[52:55]
    ds_read_b64_tr_b16 a[166:167], v3 offset:17952
    v_cvt_pk_bf16_f32 v22, v28, v29
    v_mfma_f32_16x16x32_bf16 v[52:55], a[156:159], a[12:15], v[52:55]
    s_add_u32 m0, s30, 0
    v_exp_f32 v30, v30
    v_mfma_f32_16x16x32_bf16 v[56:59], a[128:131], a[16:19], v[84:87]
    ds_read_b64_tr_b16 a[168:169], v3 offset:17472
    buffer_load_dwordx4 v4, s[8:11], s28 offen lds
    v_mfma_f32_16x16x32_bf16 v[56:59], a[132:135], a[20:23], v[56:59]
    s_add_u32 m0, s30, 4224
    v_exp_f32 v31, v31
    v_mfma_f32_16x16x32_bf16 v[56:59], a[136:139], a[24:27], v[56:59]
    ds_read_b64_tr_b16 a[170:171], v3 offset:17984
    v_cvt_pk_bf16_f32 v23, v30, v31
    v_mfma_f32_16x16x32_bf16 v[56:59], a[140:143], a[28:31], v[56:59]
    ds_read_b64_tr_b16 a[172:173], v3 offset:17504
    v_exp_f32 v32, v32
    v_mfma_f32_16x16x32_bf16 v[60:63], a[144:147], a[16:19], v[84:87]
    ds_read_b64_tr_b16 a[174:175], v3 offset:18016
    buffer_load_dwordx4 v5, s[8:11], s28 offen lds
    v_mfma_f32_16x16x32_bf16 v[60:63], a[148:151], a[20:23], v[60:63]
    s_add_u32 m0, s30, 8704
    v_exp_f32 v33, v33
    v_mfma_f32_16x16x32_bf16 v[60:63], a[152:155], a[24:27], v[60:63]
    ds_read_b64_tr_b16 a[176:177], v3 offset:17536
    v_cvt_pk_bf16_f32 v32, v32, v33
    v_mfma_f32_16x16x32_bf16 v[60:63], a[156:159], a[28:31], v[60:63]
    v_exp_f32 v34, v34
    v_mfma_f32_16x16x32_bf16 v[64:67], a[128:131], a[32:35], v[88:91]
    ds_read_b64_tr_b16 a[178:179], v3 offset:18048
    buffer_load_dwordx4 v6, s[12:15], s29 offen lds
    v_mfma_f32_16x16x32_bf16 v[64:67], a[132:135], a[36:39], v[64:67]
    s_add_u32 m0, s30, 12928
    v_exp_f32 v35, v35
    v_mfma_f32_16x16x32_bf16 v[64:67], a[136:139], a[40:43], v[64:67]
    ds_read_b64_tr_b16 a[180:181], v3 offset:17568
    v_cvt_pk_bf16_f32 v33, v34, v35
    v_mfma_f32_16x16x32_bf16 v[64:67], a[140:143], a[44:47], v[64:67]
    v_exp_f32 v36, v36
    v_mfma_f32_16x16x32_bf16 v[68:71], a[144:147], a[32:35], v[88:91]
    ds_read_b64_tr_b16 a[182:183], v3 offset:18080
    buffer_load_dwordx4 v7, s[12:15], s29 offen lds
    v_mfma_f32_16x16x32_bf16 v[68:71], a[148:151], a[36:39], v[68:71]
    v_exp_f32 v37, v37
    v_mfma_f32_16x16x32_bf16 v[68:71], a[152:155], a[40:43], v[68:71]
    ds_read_b64_tr_b16 a[184:185], v3 offset:17600
    v_cvt_pk_bf16_f32 v34, v36, v37
    v_mfma_f32_16x16x32_bf16 v[68:71], a[156:159], a[44:47], v[68:71]
    ds_read_b64_tr_b16 a[186:187], v3 offset:18112
    v_exp_f32 v38, v38
    s_waitcnt lgkmcnt(2)
    v_mfma_f32_16x16x32_bf16 v[128:131], a[160:163], v[16:19], v[128:131]
    ds_read_b64_tr_b16 a[188:189], v3 offset:17632
    v_mfma_f32_16x16x32_bf16 v[132:135], a[164:167], v[16:19], v[132:135]
    v_exp_f32 v39, v39
    v_mfma_f32_16x16x32_bf16 v[136:139], a[168:171], v[16:19], v[136:139]
    ds_read_b64_tr_b16 a[190:191], v3 offset:18144
    v_cvt_pk_bf16_f32 v35, v38, v39
    v_mfma_f32_16x16x32_bf16 v[140:143], a[172:175], v[16:19], v[140:143]
    ds_read_b128 a[128:131], v1 offset:17408
    v_mfma_f32_16x16x32_bf16 v[144:147], a[176:179], v[16:19], v[144:147]
    v_exp_f32 v48, v48
    v_mfma_f32_16x16x32_bf16 v[148:151], a[180:183], v[16:19], v[148:151]
    ds_read_b128 a[132:135], v1 offset:17472
    s_waitcnt lgkmcnt(2)
    v_mfma_f32_16x16x32_bf16 v[152:155], a[184:187], v[16:19], v[152:155]
    v_exp_f32 v49, v49
    v_mfma_f32_16x16x32_bf16 v[156:159], a[188:191], v[16:19], v[156:159]
    ds_read_b128 a[136:139], v2 offset:17408
    v_cvt_pk_bf16_f32 v48, v48, v49
    v_mfma_f32_16x16x32_bf16 v[160:163], a[160:163], v[20:23], v[160:163]
    v_exp_f32 v50, v50
    v_mfma_f32_16x16x32_bf16 v[164:167], a[164:167], v[20:23], v[164:167]
    ds_read_b128 a[140:143], v2 offset:17472
    v_mfma_f32_16x16x32_bf16 v[168:171], a[168:171], v[20:23], v[168:171]
    v_exp_f32 v51, v51
    v_mfma_f32_16x16x32_bf16 v[172:175], a[172:175], v[20:23], v[172:175]
    ds_read_b128 a[144:147], v1 offset:21632
    v_cvt_pk_bf16_f32 v49, v50, v51
    v_mfma_f32_16x16x32_bf16 v[176:179], a[176:179], v[20:23], v[176:179]
    v_exp_f32 v52, v52
    v_mfma_f32_16x16x32_bf16 v[180:183], a[180:183], v[20:23], v[180:183]
    ds_read_b128 a[148:151], v1 offset:21696
    v_mfma_f32_16x16x32_bf16 v[184:187], a[184:187], v[20:23], v[184:187]
    v_exp_f32 v53, v53
    v_mfma_f32_16x16x32_bf16 v[188:191], a[188:191], v[20:23], v[188:191]
    ds_read_b128 a[152:155], v2 offset:21632
    v_cvt_pk_bf16_f32 v50, v52, v53
    v_smfmac_f32_16x16x64_bf16 a[208:211], a[228:231], v[16:23], v15
    v_exp_f32 v54, v54
    v_mfma_f32_16x16x32_bf16 v[192:195], a[160:163], v[32:35], v[192:195]
    ds_read_b128 a[156:159], v2 offset:21696
    v_mfma_f32_16x16x32_bf16 v[196:199], a[164:167], v[32:35], v[196:199]
    v_exp_f32 v55, v55
    v_mfma_f32_16x16x32_bf16 v[200:203], a[168:171], v[32:35], v[200:203]
    s_add_u32 s28, s28, s101
    v_cvt_pk_bf16_f32 v51, v54, v55
    v_mfma_f32_16x16x32_bf16 v[204:207], a[172:175], v[32:35], v[204:207]
    v_exp_f32 v56, v56
    v_mfma_f32_16x16x32_bf16 v[208:211], a[176:179], v[32:35], v[208:211]
    s_add_u32 s29, s29, s101
    s_sub_u32 s31, s31, 1
    v_mfma_f32_16x16x32_bf16 v[212:215], a[180:183], v[32:35], v[212:215]
    v_exp_f32 v57, v57
    v_mfma_f32_16x16x32_bf16 v[216:219], a[184:187], v[32:35], v[216:219]
    s_cmp_le_u32 s31, s32
    s_waitcnt vmcnt(8) lgkmcnt(0)
    v_cvt_pk_bf16_f32 v52, v56, v57
    v_mfma_f32_16x16x32_bf16 v[220:223], a[188:191], v[32:35], v[220:223]
    v_exp_f32 v58, v58
    v_mfma_f32_16x16x32_bf16 a[212:215], a[224:227], v[32:35], a[212:215]
    s_cbranch_scc1 L_sp3_2
L_itb3_2:
    s_barrier
    v_mfma_f32_16x16x32_bf16 v[16:19], a[128:131], a[0:3], v[80:83]
    v_exp_f32 v59, v59
    v_mfma_f32_16x16x32_bf16 v[16:19], a[132:135], a[4:7], v[16:19]
    ds_read_b64_tr_b16 a[160:161], v3 offset:34816
    v_cvt_pk_bf16_f32 v53, v58, v59
    v_mfma_f32_16x16x32_bf16 v[16:19], a[136:139], a[8:11], v[16:19]
    ds_read_b64_tr_b16 a[162:163], v3 offset:35328
    v_mfma_f32_16x16x32_bf16 v[16:19], a[140:143], a[12:15], v[16:19]
    v_exp_f32 v60, v60
    v_mfma_f32_16x16x32_bf16 v[20:23], a[144:147], a[0:3], v[80:83]
    ds_read_b64_tr_b16 a[164:165], v3 offset:34848
    v_mfma_f32_16x16x32_bf16 v[20:23], a[148:151], a[4:7], v[20:23]
    v_exp_f32 v61, v61
    v_mfma_f32_16x16x32_bf16 v[20:23], a[152:155], a[8:11], v[20:23]
    ds_read_b64_tr_b16 a[166:167], v3 offset:35360
    v_cvt_pk_bf16_f32 v54, v60, v61
    v_mfma_f32_16x16x32_bf16 v[20:23], a[156:159], a[12:15], v[20:23]
    s_add_u32 m0, s30, 17408
    v_exp_f32 v62, v62
    v_mfma_f32_16x16x32_bf16 v[24:27], a[128:131], a[16:19], v[84:87]
    ds_read_b64_tr_b16 a[168:169], v3 offset:34880
    buffer_load_dwordx4 v4, s[8:11], s28 offen lds
    v_mfma_f32_16x16x32_bf16 v[24:27], a[132:135], a[20:23], v[24:27]
    s_add_u32 m0, s30, 21632
    v_exp_f32 v63, v63
    v_mfma_f32_16x16x32_bf16 v[24:27], a[136:139], a[24:27], v[24:27]
    ds_read_b64_tr_b16 a[170:171], v3 offset:35392
    v_cvt_pk_bf16_f32 v55, v62, v63
    v_mfma_f32_16x16x32_bf16 v[24:27], a[140:143], a[28:31], v[24:27]
    ds_read_b64_tr_b16 a[172:173], v3 offset:34912
    v_exp_f32 v64, v64
    v_mfma_f32_16x16x32_bf16 v[28:31], a[144:147], a[16:19], v[84:87]
    ds_read_b64_tr_b16 a[174:175], v3 offset:35424
    buffer_load_dwordx4 v5, s[8:11], s28 offen lds
    v_mfma_f32_16x16x32_bf16 v[28:31], a[148:151], a[20:23], v[28:31]
    s_add_u32 m0, s30, 26112
    v_exp_f32 v65, v65
    v_mfma_f32_16x16x32_bf16 v[28:31], a[152:155], a[24:27], v[28:31]
    ds_read_b64_tr_b16 a[176:177], v3 offset:34944
    v_cvt_pk_bf16_f32 v64, v64, v65
    v_mfma_f32_16x16x32_bf16 v[28:31], a[156:159], a[28:31], v[28:31]
    v_exp_f32 v66, v66
    v_mfma_f32_16x16x32_bf16 v[32:35], a[128:131], a[32:35], v[88:91]
    ds_read_b64_tr_b16 a[178:179], v3 offset:35456
    buffer_load_dwordx4 v6, s[12:15], s29 offen lds
    v_mfma_f32_16x16x32_bf16 v[32:35], a[132:135], a[36:39], v[32:35]
    s_add_u32 m0, s30, 30336
    v_exp_f32 v67, v67
    v_mfma_f32_16x16x32_bf16 v[32:35], a[136:139], a[40:43], v[32:35]
    ds_read_b64_tr_b16 a[180:181], v3 offset:34976
    v_cvt_pk_bf16_f32 v65, v66, v67
    v_mfma_f32_16x16x32_bf16 v[32:35], a[140:143], a[44:47], v[32:35]
    v_exp_f32 v68, v68
    v_mfma_f32_16x16x32_bf16 v[36:39], a[144:147], a[32:35], v[88:91]
    ds_read_b64_tr_b16 a[182:183], v3 offset:35488
    buffer_load_dwordx4 v7, s[12:15], s29 offen lds
    v_mfma_f32_16x16x32_bf16 v[36:39], a[148:151], a[36:39], v[36:39]
    v_exp_f32 v69, v69
    v_mfma_f32_16x16x32_bf16 v[36:39], a[152:155], a[40:43], v[36:39]
    ds_read_b64_tr_b16 a[184:185], v3 offset:35008
    v_cvt_pk_bf16_f32 v66, v68, v69
    v_mfma_f32_16x16x32_bf16 v[36:39], a[156:159], a[44:47], v[36:39]
    ds_read_b64_tr_b16 a[186:187], v3 offset:35520
    v_exp_f32 v70, v70
    s_waitcnt lgkmcnt(2)
    v_mfma_f32_16x16x32_bf16 v[128:131], a[160:163], v[48:51], v[128:131]
    ds_read_b64_tr_b16 a[188:189], v3 offset:35040
    v_mfma_f32_16x16x32_bf16 v[132:135], a[164:167], v[48:51], v[132:135]
    v_exp_f32 v71, v71
    v_mfma_f32_16x16x32_bf16 v[136:139], a[168:171], v[48:51], v[136:139]
    ds_read_b64_tr_b16 a[190:191], v3 offset:35552
    v_cvt_pk_bf16_f32 v67, v70, v71
    v_mfma_f32_16x16x32_bf16 v[140:143], a[172:175], v[48:51], v[140:143]
    ds_read_b128 a[128:131], v1 offset:34816
    v_mfma_f32_16x16x32_bf16 v[144:147], a[176:179], v[48:51], v[144:147]
    v_exp_f32 v16, v16
    v_mfma_f32_16x16x32_bf16 v[148:151], a[180:183], v[48:51], v[148:151]
    ds_read_b128 a[132:135], v1 offset:34880
    s_waitcnt lgkmcnt(2)
    v_mfma_f32_16x16x32_bf16 v[152:155], a[184:187], v[48:51], v[152:155]
    v_exp_f32 v17, v17
    v_mfma_f32_16x16x32_bf16 v[156:159], a[188:191], v[48:51], v[156:159]
    ds_read_b128 a[136:139], v2 offset:34816
    v_cvt_pk_bf16_f32 v16, v16, v17
    v_mfma_f32_16x16x32_bf16 v[160:163], a[160:163], v[52:55], v[160:163]
    v_exp_f32 v18, v18
    v_mfma_f32_16x16x32_bf16 v[164:167], a[164:167], v[52:55], v[164:167]
    ds_read_b128 a[140:143], v2 offset:34880
    v_mfma_f32_16x16x32_bf16 v[168:171], a[168:171], v[52:55], v[168:171]
    v_exp_f32 v19, v19
    v_mfma_f32_16x16x32_bf16 v[172:175], a[172:175], v[52:55], v[172:175]
    ds_read_b128 a[144:147], v1 offset:39040
    v_cvt_pk_bf16_f32 v17, v18, v19
    v_mfma_f32_16x16x32_bf16 v[176:179], a[176:179], v[52:55], v[176:179]
    v_exp_f32 v20, v20
    v_mfma_f32_16x16x32_bf16 v[180:183], a[180:183], v[52:55], v[180:183]
    ds_read_b128 a[148:151], v1 offset:39104
    v_mfma_f32_16x16x32_bf16 v[184:187], a[184:187], v[52:55], v[184:187]
    v_exp_f32 v21, v21
    v_mfma_f32_16x16x32_bf16 v[188:191], a[188:191], v[52:55], v[188:191]
    ds_read_b128 a[152:155], v2 offset:39040
    v_cvt_pk_bf16_f32 v18, v20, v21
    v_smfmac_f32_16x16x64_bf16 a[208:211], a[228:231], v[48:55], v15
    v_exp_f32 v22, v22
    v_mfma_f32_16x16x32_bf16 v[192:195], a[160:163], v[64:67], v[192:195]
    ds_read_b128 a[156:159], v2 offset:39104
    v_mfma_f32_16x16x32_bf16 v[196:199], a[164:167], v[64:67], v[196:199]
    v_exp_f32 v23, v23
    v_mfma_f32_16x16x32_bf16 v[200:203], a[168:171], v[64:67], v[200:203]
    s_add_u32 s28, s28, s101
    v_cvt_pk_bf16_f32 v19, v22, v23
    v_mfma_f32_16x16x32_bf16 v[204:207], a[172:175], v[64:67], v[204:207]
    v_exp_f32 v24, v24
    v_mfma_f32_16x16x32_bf16 v[208:211], a[176:179], v[64:67], v[208:211]
    s_add_u32 s29, s29, s101
    s_sub_u32 s31, s31, 1
    v_mfma_f32_16x16x32_bf16 v[212:215], a[180:183], v[64:67], v[212:215]
    v_exp_f32 v25, v25
    v_mfma_f32_16x16x32_bf16 v[216:219], a[184:187], v[64:67], v[216:219]
    s_cmp_le_u32 s31, s32
    s_waitcnt vmcnt(8) lgkmcnt(0)
    v_cvt_pk_bf16_f32 v20, v24, v25
    v_mfma_f32_16x16x32_bf16 v[220:223], a[188:191], v[64:67], v[220:223]
    v_exp_f32 v26, v26
    v_mfma_f32_16x16x32_bf16 a[212:215], a[224:227], v[64:67], a[212:215]
    s_cbranch_scc1 L_sp3_3
L_itb3_3:
    s_barrier
    v_mfma_f32_16x16x32_bf16 v[48:51], a[128:131], a[0:3], v[80:83]
    v_exp_f32 v27, v27
    v_mfma_f32_16x16x32_bf16 v[48:51], a[132:135], a[4:7], v[48:51]
    ds_read_b64_tr_b16 a[160:161], v3 offset:52224
    v_cvt_pk_bf16_f32 v21, v26, v27
    v_mfma_f32_16x16x32_bf16 v[48:51], a[136:139], a[8:11], v[48:51]
    ds_read_b64_tr_b16 a[162:163], v3 offset:52736
    v_mfma_f32_16x16x32_bf16 v[48:51], a[140:143], a[12:15], v[48:51]
    v_exp_f32 v28, v28
    v_mfma_f32_16x16x32_bf16 v[52:55], a[144:147], a[0:3], v[80:83]
    ds_read_b64_tr_b16 a[164:165], v3 offset:52256
    v_mfma_f32_16x16x32_bf16 v[52:55], a[148:151], a[4:7], v[52:55]
    v_exp_f32 v29, v29
    v_mfma_f32_16x16x32_bf16 v[52:55], a[152:155], a[8:11], v[52:55]
    ds_read_b64_tr_b16 a[166:167], v3 offset:52768
    v_cvt_pk_bf16_f32 v22, v28, v29
    v_mfma_f32_16x16x32_bf16 v[52:55], a[156:159], a[12:15], v[52:55]
    s_add_u32 m0, s30, 34816
    v_exp_f32 v30, v30
    v_mfma_f32_16x16x32_bf16 v[56:59], a[128:131], a[16:19], v[84:87]
    ds_read_b64_tr_b16 a[168:169], v3 offset:52288
    buffer_load_dwordx4 v4, s[8:11], s28 offen lds
    v_mfma_f32_16x16x32_bf16 v[56:59], a[132:135], a[20:23], v[56:59]
    s_add_u32 m0, s30, 39040
    v_exp_f32 v31, v31
    v_mfma_f32_16x16x32_bf16 v[56:59], a[136:139], a[24:27], v[56:59]
    ds_read_b64_tr_b16 a[170:171], v3 offset:52800
    v_cvt_pk_bf16_f32 v23, v30, v31
    v_mfma_f32_16x16x32_bf16 v[56:59], a[140:143], a[28:31], v[56:59]
    ds_read_b64_tr_b16 a[172:173], v3 offset:52320
    v_exp_f32 v32, v32
    v_mfma_f32_16x16x32_bf16 v[60:63], a[144:147], a[16:19], v[84:87]
    ds_read_b64_tr_b16 a[174:175], v3 offset:52832
    buffer_load_dwordx4 v5, s[8:11], s28 offen lds
    v_mfma_f32_16x16x32_bf16 v[60:63], a[148:151], a[20:23], v[60:63]
    s_add_u32 m0, s30, 43520
    v_exp_f32_e64 v33, v33
    v_mfma_f32_16x16x32_bf16 v[60:63], a[152:155], a[24:27], v[60:63]
    ds_read_b64_tr_b16 a[176:177], v3 offset:52352
    v_cvt_pk_bf16_f32 v32, v32, v33
    v_mfma_f32_16x16x32_bf16 v[60:63], a[156:159], a[28:31], v[60:63]
    v_exp_f32 v34, v34
    v_mfma_f32_16x16x32_bf16 v[64:67], a[128:131], a[32:35], v[88:91]
    ds_read_b64_tr_b16 a[178:179], v3 offset:52864
    buffer_load_dwordx4 v6, s[12:15], s29 offen lds
    v_mfma_f32_16x16x32_bf16 v[64:67], a[132:135], a[36:39], v[64:67]
    s_add_u32 m0, s30, 47744
    v_exp_f32 v35, v35
    v_mfma_f32_16x16x32_bf16 v[64:67], a[136:139], a[40:43], v[64:67]
    ds_read_b64_tr_b16 a[180:181], v3 offset:52384
    v_cvt_pk_bf16_f32 v33, v34, v35
    v_mfma_f32_16x16x32_bf16 v[64:67], a[140:143], a[44:47], v[64:67]
    v_exp_f32 v36, v36
    v_mfma_f32_16x16x32_bf16 v[68:71], a[144:147], a[32:35], v[88:91]
    ds_read_b64_tr_b16 a[182:183], v3 offset:52896
    buffer_load_dwordx4 v7, s[12:15], s29 offen lds
    v_mfma_f32_16x16x32_bf16 v[68:71], a[148:151], a[36:39], v[68:71]
    v_exp_f32 v37, v37
    v_mfma_f32_16x16x32_bf16 v[68:71], a[152:155], a[40:43], v[68:71]
    ds_read_b64_tr_b16 a[184:185], v3 offset:52416
    v_cvt_pk_bf16_f32 v34, v36, v37
    v_mfma_f32_16x16x32_bf16 v[68:71], a[156:159], a[44:47], v[68:71]
    ds_read_b64_tr_b16 a[186:187], v3 offset:52928
    v_exp_f32 v38, v38
    s_waitcnt lgkmcnt(2)
    v_mfma_f32_16x16x32_bf16 v[128:131], a[160:163], v[16:19], v[128:131]
    ds_read_b64_tr_b16 a[188:189], v3 offset:52448
    v_mfma_f32_16x16x32_bf16 v[132:135], a[164:167], v[16:19], v[132:135]
    v_exp_f32 v39, v39
    v_mfma_f32_16x16x32_bf16 v[136:139], a[168:171], v[16:19], v[136:139]
    ds_read_b64_tr_b16 a[190:191], v3 offset:52960
    v_cvt_pk_bf16_f32 v35, v38, v39
    v_mfma_f32_16x16x32_bf16 v[140:143], a[172:175], v[16:19], v[140:143]
    ds_read_b128 a[128:131], v1 offset:52224
    v_mfma_f32_16x16x32_bf16 v[144:147], a[176:179], v[16:19], v[144:147]
    v_exp_f32 v48, v48
    v_mfma_f32_16x16x32_bf16 v[148:151], a[180:183], v[16:19], v[148:151]
    ds_read_b128 a[132:135], v1 offset:52288
    s_waitcnt lgkmcnt(2)
    v_mfma_f32_16x16x32_bf16 v[152:155], a[184:187], v[16:19], v[152:155]
    v_exp_f32 v49, v49
    v_mfma_f32_16x16x32_bf16 v[156:159], a[188:191], v[16:19], v[156:159]
    ds_read_b128 a[136:139], v2 offset:52224
    v_cvt_pk_bf16_f32 v48, v48, v49
    v_mfma_f32_16x16x32_bf16 v[160:163], a[160:163], v[20:23], v[160:163]
    v_exp_f32 v50, v50
    v_mfma_f32_16x16x32_bf16 v[164:167], a[164:167], v[20:23], v[164:167]
    ds_read_b128 a[140:143], v2 offset:52288
    v_mfma_f32_16x16x32_bf16 v[168:171], a[168:171], v[20:23], v[168:171]
    v_exp_f32 v51, v51
    v_mfma_f32_16x16x32_bf16 v[172:175], a[172:175], v[20:23], v[172:175]
    ds_read_b128 a[144:147], v1 offset:56448
    v_cvt_pk_bf16_f32 v49, v50, v51
    v_mfma_f32_16x16x32_bf16 v[176:179], a[176:179], v[20:23], v[176:179]
    v_exp_f32 v52, v52
    v_mfma_f32_16x16x32_bf16 v[180:183], a[180:183], v[20:23], v[180:183]
    ds_read_b128 a[148:151], v1 offset:56512
    v_mfma_f32_16x16x32_bf16 v[184:187], a[184:187], v[20:23], v[184:187]
    v_exp_f32_e64 v53, v53
    v_mfma_f32_16x16x32_bf16 v[188:191], a[188:191], v[20:23], v[188:191]
    ds_read_b128 a[152:155], v2 offset:56448
    v_cvt_pk_bf16_f32 v50, v52, v53
    v_smfmac_f32_16x16x64_bf16 a[208:211], a[228:231], v[16:23], v15
    v_exp_f32 v54, v54
    v_mfma_f32_16x16x32_bf16 v[192:195], a[160:163], v[32:35], v[192:195]
    ds_read_b128 a[156:159], v2 offset:56512
    v_mfma_f32_16x16x32_bf16 v[196:199], a[164:167], v[32:35], v[196:199]
    v_exp_f32 v55, v55
    v_mfma_f32_16x16x32_bf16 v[200:203], a[168:171], v[32:35], v[200:203]
    s_add_u32 s28, s28, s101
    v_cvt_pk_bf16_f32 v51, v54, v55
    v_mfma_f32_16x16x32_bf16 v[204:207], a[172:175], v[32:35], v[204:207]
    v_exp_f32 v56, v56
    v_mfma_f32_16x16x32_bf16 v[208:211], a[176:179], v[32:35], v[208:211]
    s_add_u32 s29, s29, s101
    s_sub_u32 s31, s31, 1
    v_mfma_f32_16x16x32_bf16 v[212:215], a[180:183], v[32:35], v[212:215]
    v_exp_f32 v57, v57
    v_mfma_f32_16x16x32_bf16 v[216:219], a[184:187], v[32:35], v[216:219]
    s_cmp_le_u32 s31, s32
    s_waitcnt vmcnt(8) lgkmcnt(0)
    v_cvt_pk_bf16_f32 v52, v56, v57
    v_mfma_f32_16x16x32_bf16 v[220:223], a[188:191], v[32:35], v[220:223]
    v_exp_f32 v58, v58
    v_mfma_f32_16x16x32_bf16 a[212:215], a[224:227], v[32:35], a[212:215]
    s_cbranch_scc1 L_sp3_0
L_itb3_0:
    s_barrier
    v_mfma_f32_16x16x32_bf16 v[16:19], a[128:131], a[0:3], v[80:83]
    v_exp_f32 v59, v59
    v_mfma_f32_16x16x32_bf16 v[16:19], a[132:135], a[4:7], v[16:19]
    ds_read_b64_tr_b16 a[160:161], v3 offset:0
    v_cvt_pk_bf16_f32 v53, v58, v59
    v_mfma_f32_16x16x32_bf16 v[16:19], a[136:139], a[8:11], v[16:19]
    ds_read_b64_tr_b16 a[162:163], v3 offset:512
    v_mfma_f32_16x16x32_bf16 v[16:19], a[140:143], a[12:15], v[16:19]
    v_exp_f32 v60, v60
    v_mfma_f32_16x16x32_bf16 v[20:23], a[144:147], a[0:3], v[80:83]
    ds_read_b64_tr_b16 a[164:165], v3 offset:32
    v_mfma_f32_16x16x32_bf16 v[20:23], a[148:151], a[4:7], v[20:23]
    v_exp_f32 v61, v61
    v_mfma_f32_16x16x32_bf16 v[20:23], a[152:155], a[8:11], v[20:23]
    ds_read_b64_tr_b16 a[166:167], v3 offset:544
    v_cvt_pk_bf16_f32 v54, v60, v61
    v_mfma_f32_16x16x32_bf16 v[20:23], a[156:159], a[12:15], v[20:23]
    s_add_u32 m0, s30, 52224
    v_exp_f32 v62, v62
    v_mfma_f32_16x16x32_bf16 v[24:27], a[128:131], a[16:19], v[84:87]
    ds_read_b64_tr_b16 a[168:169], v3 offset:64
    buffer_load_dwordx4 v4, s[8:11], s28 offen lds
    v_mfma_f32_16x16x32_bf16 v[24:27], a[132:135], a[20:23], v[24:27]
    s_add_u32 m0, s30, 56448
    v_exp_f32 v63, v63
    v_mfma_f32_16x16x32_bf16 v[24:27], a[136:139], a[24:27], v[24:27]
    ds_read_b64_tr_b16 a[170:171], v3 offset:576
    v_cvt_pk_bf16_f32 v55, v62, v63
    v_mfma_f32_16x16x32_bf16 v[24:27], a[140:143], a[28:31], v[24:27]
    ds_read_b64_tr_b16 a[172:173], v3 offset:96
    v_exp_f32 v64, v64
    v_mfma_f32_16x16x32_bf16 v[28:31], a[144:147], a[16:19], v[84:87]
    ds_read_b64_tr_b16 a[174:175], v3 offset:608
    buffer_load_dwordx4 v5, s[8:11], s28 offen lds
    v_mfma_f32_16x16x32_bf16 v[28:31], a[148:151], a[20:23], v[28:31]
    s_add_u32 m0, s30, 60928
    v_exp_f32 v65, v65
    v_mfma_f32_16x16x32_bf16 v[28:31], a[152:155], a[24:27], v[28:31]
    ds_read_b64_tr_b16 a[176:177], v3 offset:128
    v_cvt_pk_bf16_f32 v64, v64, v65
    v_mfma_f32_16x16x32_bf16 v[28:31], a[156:159], a[28:31], v[28:31]
    v_exp_f32 v66, v66
    v_mfma_f32_16x16x32_bf16 v[32:35], a[128:131], a[32:35], v[88:91]
    ds_read_b64_tr_b16 a[178:179], v3 offset:640
    buffer_load_dwordx4 v6, s[12:15], s29 offen lds
    v_mfma_f32_16x16x32_bf16 v[32:35], a[132:135], a[36:39], v[32:35]
    s_add_u32 m0, s30, 65152
    v_exp_f32 v67, v67
    v_mfma_f32_16x16x32_bf16 v[32:35], a[136:139], a[40:43], v[32:35]
    ds_read_b64_tr_b16 a[180:181], v3 offset:160
    v_cvt_pk_bf16_f32 v65, v66, v67
    v_mfma_f32_16x16x32_bf16 v[32:35], a[140:143], a[44:47], v[32:35]
    v_exp_f32 v68, v68
    v_mfma_f32_16x16x32_bf16 v[36:39], a[144:147], a[32:35], v[88:91]
    ds_read_b64_tr_b16 a[182:183], v3 offset:672
    buffer_load_dwordx4 v7, s[12:15], s29 offen lds
    v_mfma_f32_16x16x32_bf16 v[36:39], a[148:151], a[36:39], v[36:39]
    v_exp_f32 v69, v69
    v_mfma_f32_16x16x32_bf16 v[36:39], a[152:155], a[40:43], v[36:39]
    ds_read_b64_tr_b16 a[184:185], v3 offset:192
    v_cvt_pk_bf16_f32 v66, v68, v69
    v_mfma_f32_16x16x32_bf16 v[36:39], a[156:159], a[44:47], v[36:39]
    ds_read_b64_tr_b16 a[186:187], v3 offset:704
    v_exp_f32 v70, v70
    s_waitcnt lgkmcnt(2)
    v_mfma_f32_16x16x32_bf16 v[128:131], a[160:163], v[48:51], v[128:131]
    ds_read_b64_tr_b16 a[188:189], v3 offset:224
    v_mfma_f32_16x16x32_bf16 v[132:135], a[164:167], v[48:51], v[132:135]
    v_exp_f32 v71, v71
    v_mfma_f32_16x16x32_bf16 v[136:139], a[168:171], v[48:51], v[136:139]
    ds_read_b64_tr_b16 a[190:191], v3 offset:736
    v_cvt_pk_bf16_f32 v67, v70, v71
    v_mfma_f32_16x16x32_bf16 v[140:143], a[172:175], v[48:51], v[140:143]
    ds_read_b128 a[128:131], v1 offset:0
    v_mfma_f32_16x16x32_bf16 v[144:147], a[176:179], v[48:51], v[144:147]
    v_exp_f32 v16, v16
    v_mfma_f32_16x16x32_bf16 v[148:151], a[180:183], v[48:51], v[148:151]
    ds_read_b128 a[132:135], v1 offset:64
    s_waitcnt lgkmcnt(2)
    v_mfma_f32_16x16x32_bf16 v[152:155], a[184:187], v[48:51], v[152:155]
    v_exp_f32 v17, v17
    v_mfma_f32_16x16x32_bf16 v[156:159], a[188:191], v[48:51], v[156:159]
    ds_read_b128 a[136:139], v2 offset:0
    v_cvt_pk_bf16_f32 v16, v16, v17
    v_mfma_f32_16x16x32_bf16 v[160:163], a[160:163], v[52:55], v[160:163]
    v_exp_f32 v18, v18
    v_mfma_f32_16x16x32_bf16 v[164:167], a[164:167], v[52:55], v[164:167]
    ds_read_b128 a[140:143], v2 offset:64
    v_mfma_f32_16x16x32_bf16 v[168:171], a[168:171], v[52:55], v[168:171]
    v_exp_f32 v19, v19
    v_mfma_f32_16x16x32_bf16 v[172:175], a[172:175], v[52:55], v[172:175]
    ds_read_b128 a[144:147], v1 offset:4224
    v_cvt_pk_bf16_f32 v17, v18, v19
    v_mfma_f32_16x16x32_bf16 v[176:179], a[176:179], v[52:55], v[176:179]
    v_exp_f32 v20, v20
    v_mfma_f32_16x16x32_bf16 v[180:183], a[180:183], v[52:55], v[180:183]
    ds_read_b128 a[148:151], v1 offset:4288
    v_mfma_f32_16x16x32_bf16 v[184:187], a[184:187], v[52:55], v[184:187]
    v_exp_f32 v21, v21
    v_mfma_f32_16x16x32_bf16 v[188:191], a[188:191], v[52:55], v[188:191]
    ds_read_b128 a[152:155], v2 offset:4224
    v_cvt_pk_bf16_f32 v18, v20, v21
    v_smfmac_f32_16x16x64_bf16 a[208:211], a[228:231], v[48:55], v15
    v_exp_f32 v22, v22
    v_mfma_f32_16x16x32_bf16 v[192:195], a[160:163], v[64:67], v[192:195]
    ds_read_b128 a[156:159], v2 offset:4288
    v_mfma_f32_16x16x32_bf16 v[196:199], a[164:167], v[64:67], v[196:199]
    v_exp_f32 v23, v23
    v_mfma_f32_16x16x32_bf16 v[200:203], a[168:171], v[64:67], v[200:203]
    s_add_u32 s28, s28, s101
    v_cvt_pk_bf16_f32 v19, v22, v23
    v_mfma_f32_16x16x32_bf16 v[204:207], a[172:175], v[64:67], v[204:207]
    v_exp_f32 v24, v24
    v_mfma_f32_16x16x32_bf16 v[208:211], a[176:179], v[64:67], v[208:211]
    s_add_u32 s29, s29, s101
    s_sub_u32 s31, s31, 1
    v_mfma_f32_16x16x32_bf16 v[212:215], a[180:183], v[64:67], v[212:215]
    v_exp_f32 v25, v25
    v_mfma_f32_16x16x32_bf16 v[216:219], a[184:187], v[64:67], v[216:219]
    s_cmp_le_u32 s31, s32
    s_waitcnt vmcnt(8) lgkmcnt(0)
    v_cvt_pk_bf16_f32 v20, v24, v25
    v_mfma_f32_16x16x32_bf16 v[220:223], a[188:191], v[64:67], v[220:223]
    v_exp_f32 v26, v26
    v_mfma_f32_16x16x32_bf16 a[212:215], a[224:227], v[64:67], a[212:215]
    s_cbranch_scc0 L_itb3_1
L_sp3_1:
    s_mov_b32 s32, 0
    s_branch L_itb3_1
L_sp3_2:
    s_cmp_eq_u32 s31, 0
    s_cbranch_scc1 L_e3_2
    s_mov_b32 s32, 0
    s_mov_b32 s38, L_e3_2-L_pc
    v_mbcnt_lo_u32_b32 v116, -1, 0
    v_mbcnt_hi_u32_b32 v116, -1, v116
    v_lshl_add_u32 v116, v116, 7, s38
    v_min_u32 v116, L_table-L_pc, v116
    global_load_dword v14, v116, s[74:75]
    s_branch L_itb3_2
L_sp3_3:
    s_cmp_eq_u32 s31, 0
    s_cbranch_scc1 L_e3_3
    s_mov_b32 s32, 0
    s_mov_b32 s38, L_e3_3-L_pc
    v_mbcnt_lo_u32_b32 v116, -1, 0
    v_mbcnt_hi_u32_b32 v116, -1, v116
    v_lshl_add_u32 v116, v116, 7, s38
    v_min_u32 v116, L_table-L_pc, v116
    global_load_dword v14, v116, s[74:75]
    s_branch L_itb3_3
L_sp3_0:
    s_cmp_eq_u32 s31, 0
    s_cbranch_scc1 L_e3_0
    s_mov_b32 s32, 0
    s_mov_b32 s38, L_e3_0-L_pc
    v_mbcnt_lo_u32_b32 v116, -1, 0
    v_mbcnt_hi_u32_b32 v116, -1, v116
    v_lshl_add_u32 v116, v116, 7, s38
    v_min_u32 v116, L_table-L_pc, v116
    global_load_dword v14, v116, s[74:75]
    s_branch L_itb3_0
.p2align 6
    s_nop 0
L_itb2_1:
    s_barrier
    v_mfma_f32_16x16x32_bf16 v[48:51], a[128:131], a[0:3], v[80:83]
    v_exp_f32 v23, v23
    v_mfma_f32_16x16x32_bf16 v[48:51], a[132:135], a[4:7], v[48:51]
    ds_read_b64_tr_b16 a[160:161], v3 offset:17408
    v_cvt_pk_bf16_f32 v19, v22, v23
    v_mfma_f32_16x16x32_bf16 v[48:51], a[136:139], a[8:11], v[48:51]
    ds_read_b64_tr_b16 a[162:163], v3 offset:17920
    v_exp_f32 v24, v24
    v_mfma_f32_16x16x32_bf16 v[48:51], a[140:143], a[12:15], v[48:51]
    ds_read_b64_tr_b16 a[164:165], v3 offset:17440
    ds_read_b64_tr_b16 a[166:167], v3 offset:17952
    v_mfma_f32_16x16x32_bf16 v[52:55], a[144:147], a[0:3], v[80:83]
    v_exp_f32 v25, v25
    v_mfma_f32_16x16x32_bf16 v[52:55], a[148:151], a[4:7], v[52:55]
    ds_read_b64_tr_b16 a[168:169], v3 offset:17472
    v_cvt_pk_bf16_f32 v20, v24, v25
    v_mfma_f32_16x16x32_bf16 v[52:55], a[152:155], a[8:11], v[52:55]
    ds_read_b64_tr_b16 a[170:171], v3 offset:17984
    v_exp_f32 v26, v26
    v_mfma_f32_16x16x32_bf16 v[52:55], a[156:159], a[12:15], v[52:55]
    ds_read_b64_tr_b16 a[172:173], v3 offset:17504
    ds_read_b64_tr_b16 a[174:175], v3 offset:18016
    v_mfma_f32_16x16x32_bf16 v[56:59], a[128:131], a[16:19], v[84:87]
    v_exp_f32 v27, v27
    v_mfma_f32_16x16x32_bf16 v[56:59], a[132:135], a[20:23], v[56:59]
    ds_read_b64_tr_b16 a[176:177], v3 offset:17536
    v_cvt_pk_bf16_f32 v21, v26, v27
    v_mfma_f32_16x16x32_bf16 v[56:59], a[136:139], a[24:27], v[56:59]
    v_exp_f32 v28, v28
    v_mfma_f32_16x16x32_bf16 v[56:59], a[140:143], a[28:31], v[56:59]
    ds_read_b64_tr_b16 a[178:179], v3 offset:18048
    ds_read_b64_tr_b16 a[180:181], v3 offset:17568
    v_mfma_f32_16x16x32_bf16 v[60:63], a[144:147], a[16:19], v[84:87]
    s_add_u32 m0, s30, 0
    v_exp_f32 v29, v29
    v_mfma_f32_16x16x32_bf16 v[60:63], a[148:151], a[20:23], v[60:63]
    ds_read_b64_tr_b16 a[182:183], v3 offset:18080
    buffer_load_dwordx4 v4, s[8:11], s28 offen lds
    v_cvt_pk_bf16_f32 v22, v28, v29
    v_mfma_f32_16x16x32_bf16 v[60:63], a[152:155], a[24:27], v[60:63]
    ds_read_b64_tr_b16 a[184:185], v3 offset:17600
    s_add_u32 m0, s30, 4224
    v_exp_f32 v30, v30
    v_mfma_f32_16x16x32_bf16 v[60:63], a[156:159], a[28:31], v[60:63]
    ds_read_b64_tr_b16 a[186:187], v3 offset:18112
    ds_read_b64_tr_b16 a[188:189], v3 offset:17632
    s_waitcnt lgkmcnt(5)
    v_mfma_f32_16x16x32_bf16 v[128:131], a[160:163], v[16:19], v[128:131]
    ds_read_b64_tr_b16 a[190:191], v3 offset:18144
    v_exp_f32 v31, v31
    v_mfma_f32_16x16x32_bf16 v[132:135], a[164:167], v[16:19], v[132:135]
    ds_read_b128 a[128:131], v1 offset:17408
    v_cvt_pk_bf16_f32 v23, v30, v31
    v_mfma_f32_16x16x32_bf16 v[136:139], a[168:171], v[16:19], v[136:139]
    ds_read_b128 a[132:135], v1 offset:17472
    buffer_load_dwordx4 v5, s[8:11], s28 offen lds
    v_mfma_f32_16x16x32_bf16 v[140:143], a[172:175], v[16:19], v[140:143]
    s_add_u32 m0, s30, 8704
    v_exp_f32 v48, v48
    v_mfma_f32_16x16x32_bf16 v[144:147], a[176:179], v[16:19], v[144:147]
    ds_read_b128 a[136:139], v2 offset:17408
    s_waitcnt lgkmcnt(3)
    v_mfma_f32_16x16x32_bf16 v[148:151], a[180:183], v[16:19], v[148:151]
    buffer_load_dwordx4 v6, s[12:15], s29 offen lds
    v_exp_f32 v49, v49
    v_mfma_f32_16x16x32_bf16 v[152:155], a[184:187], v[16:19], v[152:155]
    ds_read_b128 a[140:143], v2 offset:17472
    v_cvt_pk_bf16_f32 v48, v48, v49
    v_mfma_f32_16x16x32_bf16 v[156:159], a[188:191], v[16:19], v[156:159]
    s_add_u32 m0, s30, 12928
    v_exp_f32 v50, v50
    v_mfma_f32_16x16x32_bf16 v[160:163], a[160:163], v[20:23], v[160:163]
    ds_read_b128 a[144:147], v1 offset:21632
    buffer_load_dwordx4 v7, s[12:15], s29 offen lds
    v_mfma_f32_16x16x32_bf16 v[164:167], a[164:167], v[20:23], v[164:167]
    ds_read_b128 a[148:151], v1 offset:21696
    v_exp_f32 v51, v51
    v_mfma_f32_16x16x32_bf16 v[168:171], a[168:171], v[20:23], v[168:171]
    ds_read_b128 a[152:155], v2 offset:21632
    v_cvt_pk_bf16_f32 v49, v50, v51
    v_mfma_f32_16x16x32_bf16 v[172:175], a[172:175], v[20:23], v[172:175]
    s_add_u32 s28, s28, s101
    v_exp_f32 v52, v52
    v_mfma_f32_16x16x32_bf16 v[176:179], a[176:179], v[20:23], v[176:179]
    ds_read_b128 a[156:159], v2 offset:21696
    s_add_u32 s29, s29, s101
    v_mfma_f32_16x16x32_bf16 v[180:183], a[180:183], v[20:23], v[180:183]
    s_sub_u32 s31, s31, 1
    v_exp_f32 v53, v53
    v_mfma_f32_16x16x32_bf16 v[184:187], a[184:187], v[20:23], v[184:187]
    s_cmp_le_u32 s31, s32
    v_cvt_pk_bf16_f32 v50, v52, v53
    v_mfma_f32_16x16x32_bf16 v[188:191], a[188:191], v[20:23], v[188:191]
    s_waitcnt vmcnt(8) lgkmcnt(0)
    v_exp_f32 v54, v54
    v_smfmac_f32_16x16x64_bf16 a[208:211], a[228:231], v[16:23], v15
    s_cbranch_scc1 L_sp2_2
L_itb2_2:
    s_barrier
    v_mfma_f32_16x16x32_bf16 v[16:19], a[128:131], a[0:3], v[80:83]
    v_exp_f32 v55, v55
    v_mfma_f32_16x16x32_bf16 v[16:19], a[132:135], a[4:7], v[16:19]
    ds_read_b64_tr_b16 a[160:161], v3 offset:34816
    v_cvt_pk_bf16_f32 v51, v54, v55
    v_mfma_f32_16x16x32_bf16 v[16:19], a[136:139], a[8:11], v[16:19]
    ds_read_b64_tr_b16 a[162:163], v3 offset:35328
    v_exp_f32 v56, v56
    v_mfma_f32_16x16x32_bf16 v[16:19], a[140:143], a[12:15], v[16:19]
    ds_read_b64_tr_b16 a[164:165], v3 offset:34848
    ds_read_b64_tr_b16 a[166:167], v3 offset:35360
    v_mfma_f32_16x16x32_bf16 v[20:23], a[144:147], a[0:3], v[80:83]
    v_exp_f32 v57, v57
    v_mfma_f32_16x16x32_bf16 v[20:23], a[148:151], a[4:7], v[20:23]
    ds_read_b64_tr_b16 a[168:169], v3 offset:34880
    v_cvt_pk_bf16_f32 v52, v56, v57
    v_mfma_f32_16x16x32_bf16 v[20:23], a[152:155], a[8:11], v[20:23]
    ds_read_b64_tr_b16 a[170:171], v3 offset:35392
    v_exp_f32 v58, v58
    v_mfma_f32_16x16x32_bf16 v[20:23], a[156:159], a[12:15], v[20:23]
    ds_read_b64_tr_b16 a[172:173], v3 offset:34912
    ds_read_b64_tr_b16 a[174:175], v3 offset:35424
    v_mfma_f32_16x16x32_bf16 v[24:27], a[128:131], a[16:19], v[84:87]
    v_exp_f32 v59, v59
    v_mfma_f32_16x16x32_bf16 v[24:27], a[132:135], a[20:23], v[24:27]
    ds_read_b64_tr_b16 a[176:177], v3 offset:34944
    v_cvt_pk_bf16_f32 v53, v58, v59
    v_mfma_f32_16x16x32_bf16 v[24:27], a[136:139], a[24:27], v[24:27]
    v_exp_f32 v60, v60
    v_mfma_f32_16x16x32_bf16 v[24:27], a[140:143], a[28:31], v[24:27]
    ds_read_b64_tr_b16 a[178:179], v3 offset:35456
    ds_read_b64_tr_b16 a[180:181], v3 offset:34976
    v_mfma_f32_16x16x32_bf16 v[28:31], a[144:147], a[16:19], v[84:87]
    s_add_u32 m0, s30, 17408
    v_exp_f32 v61, v61
    v_mfma_f32_16x16x32_bf16 v[28:31], a[148:151], a[20:23], v[28:31]
    ds_read_b64_tr_b16 a[182:183], v3 offset:35488
    buffer_load_dwordx4 v4, s[8:11], s28 offen lds
    v_cvt_pk_bf16_f32 v54, v60, v61
    v_mfma_f32_16x16x32_bf16 v[28:31], a[152:155], a[24:27], v[28:31]
    ds_read_b64_tr_b16 a[184:185], v3 offset:35008
    s_add_u32 m0, s30, 21632
    v_exp_f32 v62, v62
    v_mfma_f32_16x16x32_bf16 v[28:31], a[156:159], a[28:31], v[28:31]
    ds_read_b64_tr_b16 a[186:187], v3 offset:35520
    ds_read_b64_tr_b16 a[188:189], v3 offset:35040
    s_waitcnt lgkmcnt(5)
    v_mfma_f32_16x16x32_bf16 v[128:131], a[160:163], v[48:51], v[128:131]
    ds_read_b64_tr_b16 a[190:191], v3 offset:35552
    v_exp_f32 v63, v63
    v_mfma_f32_16x16x32_bf16 v[132:135], a[164:167], v[48:51], v[132:135]
    ds_read_b128 a[128:131], v1 offset:34816
    v_cvt_pk_bf16_f32 v55, v62, v63
    v_mfma_f32_16x16x32_bf16 v[136:139], a[168:171], v[48:51], v[136:139]
    ds_read_b128 a[132:135], v1 offset:34880
    buffer_load_dwordx4 v5, s[8:11], s28 offen lds
    v_mfma_f32_16x16x32_bf16 v[140:143], a[172:175], v[48:51], v[140:143]
    s_add_u32 m0, s30, 26112
    v_exp_f32 v16, v16
    v_mfma_f32_16x16x32_bf16 v[144:147], a[176:179], v[48:51], v[144:147]
    ds_read_b128 a[136:139], v2 offset:34816
    s_waitcnt lgkmcnt(3)
    v_mfma_f32_16x16x32_bf16 v[148:151], a[180:183], v[48:51], v[148:151]
    buffer_load_dwordx4 v6, s[12:15], s29 offen lds
    v_exp_f32 v17, v17
    v_mfma_f32_16x16x32_bf16 v[152:155], a[184:187], v[48:51], v[152:155]
    ds_read_b128 a[140:143], v2 offset:34880
    v_cvt_pk_bf16_f32 v16, v16, v17
    v_mfma_f32_16x16x32_bf16 v[156:159], a[188:191], v[48:51], v[156:159]
    s_add_u32 m0, s30, 30336
    v_exp_f32 v18, v18
    v_mfma_f32_16x16x32_bf16 v[160:163], a[160:163], v[52:55], v[160:163]
    ds_read_b128 a[144:147], v1 offset:39040
    buffer_load_dwordx4 v7, s[12:15], s29 offen lds
    v_mfma_f32_16x16x32_bf16 v[164:167], a[164:167], v[52:55], v[164:167]
    ds_read_b128 a[148:151], v1 offset:39104
    v_exp_f32 v19, v19
    v_mfma_f32_16x16x32_bf16 v[168:171], a[168:171], v[52:55], v[168:171]
    ds_read_b128 a[152:155], v2 offset:39040
    v_cvt_pk_bf16_f32 v17, v18, v19
    v_mfma_f32_16x16x32_bf16 v[172:175], a[172:175], v[52:55], v[172:175]
    s_add_u32 s28, s28, s101
    v_exp_f32 v20, v20
    v_mfma_f32_16x16x32_bf16 v[176:179], a[176:179], v[52:55], v[176:179]
    ds_read_b128 a[156:159], v2 offset:39104
    s_add_u32 s29, s29, s101
    v_mfma_f32_16x16x32_bf16 v[180:183], a[180:183], v[52:55], v[180:183]
    s_sub_u32 s31, s31, 1
    v_exp_f32 v21, v21
    v_mfma_f32_16x16x32_bf16 v[184:187], a[184:187], v[52:55], v[184:187]
    s_cmp_le_u32 s31, s32
    v_cvt_pk_bf16_f32 v18, v20, v21
    v_mfma_f32_16x16x32_bf16 v[188:191], a[188:191], v[52:55], v[188:191]
    s_waitcnt vmcnt(8) lgkmcnt(0)
    v_exp_f32 v22, v22
    v_smfmac_f32_16x16x64_bf16 a[208:211], a[228:231], v[48:55], v15
    s_cbranch_scc1 L_sp2_3
L_itb2_3:
    s_barrier
    v_mfma_f32_16x16x32_bf16 v[48:51], a[128:131], a[0:3], v[80:83]
    v_exp_f32 v23, v23
    v_mfma_f32_16x16x32_bf16 v[48:51], a[132:135], a[4:7], v[48:51]
    ds_read_b64_tr_b16 a[160:161], v3 offset:52224
    v_cvt_pk_bf16_f32 v19, v22, v23
    v_mfma_f32_16x16x32_bf16 v[48:51], a[136:139], a[8:11], v[48:51]
    ds_read_b64_tr_b16 a[162:163], v3 offset:52736
    v_exp_f32 v24, v24
    v_mfma_f32_16x16x32_bf16 v[48:51], a[140:143], a[12:15], v[48:51]
    ds_read_b64_tr_b16 a[164:165], v3 offset:52256
    ds_read_b64_tr_b16 a[166:167], v3 offset:52768
    v_mfma_f32_16x16x32_bf16 v[52:55], a[144:147], a[0:3], v[80:83]
    v_exp_f32 v25, v25
    v_mfma_f32_16x16x32_bf16 v[52:55], a[148:151], a[4:7], v[52:55]
    ds_read_b64_tr_b16 a[168:169], v3 offset:52288
    v_cvt_pk_bf16_f32 v20, v24, v25
    v_mfma_f32_16x16x32_bf16 v[52:55], a[152:155], a[8:11], v[52:55]
    ds_read_b64_tr_b16 a[170:171], v3 offset:52800
    v_exp_f32 v26, v26
    v_mfma_f32_16x16x32_bf16 v[52:55], a[156:159], a[12:15], v[52:55]
    ds_read_b64_tr_b16 a[172:173], v3 offset:52320
    ds_read_b64_tr_b16 a[174:175], v3 offset:52832
    v_mfma_f32_16x16x32_bf16 v[56:59], a[128:131], a[16:19], v[84:87]
    v_exp_f32 v27, v27
    v_mfma_f32_16x16x32_bf16 v[56:59], a[132:135], a[20:23], v[56:59]
    ds_read_b64_tr_b16 a[176:177], v3 offset:52352
    v_cvt_pk_bf16_f32 v21, v26, v27
    v_mfma_f32_16x16x32_bf16 v[56:59], a[136:139], a[24:27], v[56:59]
    v_exp_f32 v28, v28
    v_mfma_f32_16x16x32_bf16 v[56:59], a[140:143], a[28:31], v[56:59]
    ds_read_b64_tr_b16 a[178:179], v3 offset:52864
    ds_read_b64_tr_b16 a[180:181], v3 offset:52384
    v_mfma_f32_16x16x32_bf16 v[60:63], a[144:147], a[16:19], v[84:87]
    s_add_u32 m0, s30, 34816
    v_exp_f32 v29, v29
    v_mfma_f32_16x16x32_bf16 v[60:63], a[148:151], a[20:23], v[60:63]
    ds_read_b64_tr_b16 a[182:183], v3 offset:52896
    buffer_load_dwordx4 v4, s[8:11], s28 offen lds
    v_cvt_pk_bf16_f32 v22, v28, v29
    v_mfma_f32_16x16x32_bf16 v[60:63], a[152:155], a[24:27], v[60:63]
    ds_read_b64_tr_b16 a[184:185], v3 offset:52416
    s_add_u32 m0, s30, 39040
    v_exp_f32 v30, v30
    v_mfma_f32_16x16x32_bf16 v[60:63], a[156:159], a[28:31], v[60:63]
    ds_read_b64_tr_b16 a[186:187], v3 offset:52928
    ds_read_b64_tr_b16 a[188:189], v3 offset:52448
    s_waitcnt lgkmcnt(5)
    v_mfma_f32_16x16x32_bf16 v[128:131], a[160:163], v[16:19], v[128:131]
    ds_read_b64_tr_b16 a[190:191], v3 offset:52960
    v_exp_f32 v31, v31
    v_mfma_f32_16x16x32_bf16 v[132:135], a[164:167], v[16:19], v[132:135]
    ds_read_b128 a[128:131], v1 offset:52224
    v_cvt_pk_bf16_f32 v23, v30, v31
    v_mfma_f32_16x16x32_bf16 v[136:139], a[168:171], v[16:19], v[136:139]
    ds_read_b128 a[132:135], v1 offset:52288
    buffer_load_dwordx4 v5, s[8:11], s28 offen lds
    v_mfma_f32_16x16x32_bf16 v[140:143], a[172:175], v[16:19], v[140:143]
    s_add_u32 m0, s30, 43520
    v_exp_f32 v48, v48
    v_mfma_f32_16x16x32_bf16 v[144:147], a[176:179], v[16:19], v[144:147]
    ds_read_b128 a[136:139], v2 offset:52224
    s_waitcnt lgkmcnt(3)
    v_mfma_f32_16x16x32_bf16 v[148:151], a[180:183], v[16:19], v[148:151]
    buffer_load_dwordx4 v6, s[12:15], s29 offen lds
    v_exp_f32 v49, v49
    v_mfma_f32_16x16x32_bf16 v[152:155], a[184:187], v[16:19], v[152:155]
    ds_read_b128 a[140:143], v2 offset:52288
    v_cvt_pk_bf16_f32 v48, v48, v49
    v_mfma_f32_16x16x32_bf16 v[156:159], a[188:191], v[16:19], v[156:159]
    s_add_u32 m0, s30, 47744
    v_exp_f32 v50, v50
    v_mfma_f32_16x16x32_bf16 v[160:163], a[160:163], v[20:23], v[160:163]
    ds_read_b128 a[144:147], v1 offset:56448
    buffer_load_dwordx4 v7, s[12:15], s29 offen lds
    v_mfma_f32_16x16x32_bf16 v[164:167], a[164:167], v[20:23], v[164:167]
    ds_read_b128 a[148:151], v1 offset:56512
    v_exp_f32 v51, v51
    v_mfma_f32_16x16x32_bf16 v[168:171], a[168:171], v[20:23], v[168:171]
    ds_read_b128 a[152:155], v2 offset:56448
    v_cvt_pk_bf16_f32 v49, v50, v51
    v_mfma_f32_16x16x32_bf16 v[172:175], a[172:175], v[20:23], v[172:175]
    s_add_u32 s28, s28, s101
    v_exp_f32 v52, v52
    v_mfma_f32_16x16x32_bf16 v[176:179], a[176:179], v[20:23], v[176:179]
    ds_read_b128 a[156:159], v2 offset:56512
    s_add_u32 s29, s29, s101
    v_mfma_f32_16x16x32_bf16 v[180:183], a[180:183], v[20:23], v[180:183]
    s_sub_u32 s31, s31, 1
    v_exp_f32 v53, v53
    v_mfma_f32_16x16x32_bf16 v[184:187], a[184:187], v[20:23], v[184:187]
    s_cmp_le_u32 s31, s32
    v_cvt_pk_bf16_f32 v50, v52, v53
    v_mfma_f32_16x16x32_bf16 v[188:191], a[188:191], v[20:23], v[188:191]
    s_waitcnt vmcnt(8) lgkmcnt(0)
    v_exp_f32 v54, v54
    v_smfmac_f32_16x16x64_bf16 a[208:211], a[228:231], v[16:23], v15
    s_cbranch_scc1 L_sp2_0
L_itb2_0:
    s_barrier
    v_mfma_f32_16x16x32_bf16 v[16:19], a[128:131], a[0:3], v[80:83]
    v_exp_f32 v55, v55
    v_mfma_f32_16x16x32_bf16 v[16:19], a[132:135], a[4:7], v[16:19]
    ds_read_b64_tr_b16 a[160:161], v3 offset:0
    v_cvt_pk_bf16_f32 v51, v54, v55
    v_mfma_f32_16x16x32_bf16 v[16:19], a[136:139], a[8:11], v[16:19]
    ds_read_b64_tr_b16 a[162:163], v3 offset:512
    v_exp_f32 v56, v56
    v_mfma_f32_16x16x32_bf16 v[16:19], a[140:143], a[12:15], v[16:19]
    ds_read_b64_tr_b16 a[164:165], v3 offset:32
    ds_read_b64_tr_b16 a[166:167], v3 offset:544
    v_mfma_f32_16x16x32_bf16 v[20:23], a[144:147], a[0:3], v[80:83]
    v_exp_f32 v57, v57
    v_mfma_f32_16x16x32_bf16 v[20:23], a[148:151], a[4:7], v[20:23]
    ds_read_b64_tr_b16 a[168:169], v3 offset:64
    v_cvt_pk_bf16_f32 v52, v56, v57
    v_mfma_f32_16x16x32_bf16 v[20:23], a[152:155], a[8:11], v[20:23]
    ds_read_b64_tr_b16 a[170:171], v3 offset:576
    v_exp_f32 v58, v58
    v_mfma_f32_16x16x32_bf16 v[20:23], a[156:159], a[12:15], v[20:23]
    ds_read_b64_tr_b16 a[172:173], v3 offset:96
    ds_read_b64_tr_b16 a[174:175], v3 offset:608
    v_mfma_f32_16x16x32_bf16 v[24:27], a[128:131], a[16:19], v[84:87]
    v_exp_f32 v59, v59
    v_mfma_f32_16x16x32_bf16 v[24:27], a[132:135], a[20:23], v[24:27]
    ds_read_b64_tr_b16 a[176:177], v3 offset:128
    v_cvt_pk_bf16_f32 v53, v58, v59
    v_mfma_f32_16x16x32_bf16 v[24:27], a[136:139], a[24:27], v[24:27]
    v_exp_f32 v60, v60
    v_mfma_f32_16x16x32_bf16 v[24:27], a[140:143], a[28:31], v[24:27]
    ds_read_b64_tr_b16 a[178:179], v3 offset:640
    ds_read_b64_tr_b16 a[180:181], v3 offset:160
    v_mfma_f32_16x16x32_bf16 v[28:31], a[144:147], a[16:19], v[84:87]
    s_add_u32 m0, s30, 52224
    v_exp_f32 v61, v61
    v_mfma_f32_16x16x32_bf16 v[28:31], a[148:151], a[20:23], v[28:31]
    ds_read_b64_tr_b16 a[182:183], v3 offset:672
    buffer_load_dwordx4 v4, s[8:11], s28 offen lds
    v_cvt_pk_bf16_f32 v54, v60, v61
    v_mfma_f32_16x16x32_bf16 v[28:31], a[152:155], a[24:27], v[28:31]
    ds_read_b64_tr_b16 a[184:185], v3 offset:192
    s_add_u32 m0, s30, 56448
    v_exp_f32 v62, v62
    v_mfma_f32_16x16x32_bf16 v[28:31], a[156:159], a[28:31], v[28:31]
    ds_read_b64_tr_b16 a[186:187], v3 offset:704
    ds_read_b64_tr_b16 a[188:189], v3 offset:224
    s_waitcnt lgkmcnt(5)
    v_mfma_f32_16x16x32_bf16 v[128:131], a[160:163], v[48:51], v[128:131]
    ds_read_b64_tr_b16 a[190:191], v3 offset:736
    v_exp_f32 v63, v63
    v_mfma_f32_16x16x32_bf16 v[132:135], a[164:167], v[48:51], v[132:135]
    ds_read_b128 a[128:131], v1 offset:0
    v_cvt_pk_bf16_f32 v55, v62, v63
    v_mfma_f32_16x16x32_bf16 v[136:139], a[168:171], v[48:51], v[136:139]
    ds_read_b128 a[132:135], v1 offset:64
    buffer_load_dwordx4 v5, s[8:11], s28 offen lds
    v_mfma_f32_16x16x32_bf16 v[140:143], a[172:175], v[48:51], v[140:143]
    s_add_u32 m0, s30, 60928
    v_exp_f32 v16, v16
    v_mfma_f32_16x16x32_bf16 v[144:147], a[176:179], v[48:51], v[144:147]
    ds_read_b128 a[136:139], v2 offset:0
    s_waitcnt lgkmcnt(3)
    v_mfma_f32_16x16x32_bf16 v[148:151], a[180:183], v[48:51], v[148:151]
    buffer_load_dwordx4 v6, s[12:15], s29 offen lds
    v_exp_f32 v17, v17
    v_mfma_f32_16x16x32_bf16 v[152:155], a[184:187], v[48:51], v[152:155]
    ds_read_b128 a[140:143], v2 offset:64
    v_cvt_pk_bf16_f32 v16, v16, v17
    v_mfma_f32_16x16x32_bf16 v[156:159], a[188:191], v[48:51], v[156:159]
    s_add_u32 m0, s30, 65152
    v_exp_f32 v18, v18
    v_mfma_f32_16x16x32_bf16 v[160:163], a[160:163], v[52:55], v[160:163]
    ds_read_b128 a[144:147], v1 offset:4224
    buffer_load_dwordx4 v7, s[12:15], s29 offen lds
    v_mfma_f32_16x16x32_bf16 v[164:167], a[164:167], v[52:55], v[164:167]
    ds_read_b128 a[148:151], v1 offset:4288
    v_exp_f32 v19, v19
    v_mfma_f32_16x16x32_bf16 v[168:171], a[168:171], v[52:55], v[168:171]
    ds_read_b128 a[152:155], v2 offset:4224
    v_cvt_pk_bf16_f32 v17, v18, v19
    v_mfma_f32_16x16x32_bf16 v[172:175], a[172:175], v[52:55], v[172:175]
    s_add_u32 s28, s28, s101
    v_exp_f32 v20, v20
    v_mfma_f32_16x16x32_bf16 v[176:179], a[176:179], v[52:55], v[176:179]
    ds_read_b128 a[156:159], v2 offset:4288
    s_add_u32 s29, s29, s101
    v_mfma_f32_16x16x32_bf16 v[180:183], a[180:183], v[52:55], v[180:183]
    s_sub_u32 s31, s31, 1
    v_exp_f32 v21, v21
    v_mfma_f32_16x16x32_bf16 v[184:187], a[184:187], v[52:55], v[184:187]
    s_cmp_le_u32 s31, s32
    v_cvt_pk_bf16_f32 v18, v20, v21
    v_mfma_f32_16x16x32_bf16 v[188:191], a[188:191], v[52:55], v[188:191]
    s_waitcnt vmcnt(8) lgkmcnt(0)
    v_exp_f32 v22, v22
    v_smfmac_f32_16x16x64_bf16 a[208:211], a[228:231], v[48:55], v15
    s_cbranch_scc0 L_itb2_1
L_sp2_1:
    s_cmp_eq_u32 s31, 0
    s_cbranch_scc1 L_e2_1
    s_mov_b32 s32, 0
    s_mov_b32 s38, L_e2_1-L_pc
    v_mbcnt_lo_u32_b32 v116, -1, 0
    v_mbcnt_hi_u32_b32 v116, -1, v116
    v_lshl_add_u32 v116, v116, 7, s38
    v_min_u32 v116, L_table-L_pc, v116
    global_load_dword v14, v116, s[74:75]
    s_branch L_itb2_1
L_sp2_2:
    s_mov_b32 s32, 0
    s_branch L_itb2_2
L_sp2_3:
    s_mov_b32 s32, 0
    s_branch L_itb2_3
L_sp2_0:
    s_cmp_eq_u32 s31, 0
    s_cbranch_scc1 L_e2_0
    s_mov_b32 s32, 0
    s_mov_b32 s38, L_e2_0-L_pc
    v_mbcnt_lo_u32_b32 v116, -1, 0
    v_mbcnt_hi_u32_b32 v116, -1, v116
    v_lshl_add_u32 v116, v116, 7, s38
    v_min_u32 v116, L_table-L_pc, v116
    global_load_dword v14, v116, s[74:75]
    s_branch L_itb2_0
.p2align 6
    s_nop 0
L_itb1_1:
    s_barrier
    v_mfma_f32_16x16x32_bf16 v[48:51], a[128:131], a[0:3], v[80:83]
    ds_read_b64_tr_b16 a[160:161], v3 offset:17408
    s_add_u32 m0, s30, 0
    v_exp_f32 v20, v20
    v_mfma_f32_16x16x32_bf16 v[48:51], a[132:135], a[4:7], v[48:51]
    ds_read_b64_tr_b16 a[162:163], v3 offset:17920
    buffer_load_dwordx4 v4, s[8:11], s28 offen lds
    v_exp_f32 v21, v21
    v_mfma_f32_16x16x32_bf16 v[48:51], a[136:139], a[8:11], v[48:51]
    ds_read_b64_tr_b16 a[164:165], v3 offset:17440
    ds_read_b64_tr_b16 a[166:167], v3 offset:17952
    s_add_u32 m0, s30, 4224
    v_cvt_pk_bf16_f32 v18, v20, v21
    v_mfma_f32_16x16x32_bf16 v[48:51], a[140:143], a[12:15], v[48:51]
    ds_read_b64_tr_b16 a[168:169], v3 offset:17472
    ds_read_b64_tr_b16 a[170:171], v3 offset:17984
    v_exp_f32 v22, v22
    v_mfma_f32_16x16x32_bf16 v[52:55], a[144:147], a[0:3], v[80:83]
    ds_read_b64_tr_b16 a[172:173], v3 offset:17504
    ds_read_b64_tr_b16 a[174:175], v3 offset:18016
    v_exp_f32 v23, v23
    v_mfma_f32_16x16x32_bf16 v[52:55], a[148:151], a[4:7], v[52:55]
    ds_read_b64_tr_b16 a[176:177], v3 offset:17536
    ds_read_b64_tr_b16 a[178:179], v3 offset:18048
    buffer_load_dwordx4 v5, s[8:11], s28 offen lds
    v_cvt_pk_bf16_f32 v19, v22, v23
    v_mfma_f32_16x16x32_bf16 v[52:55], a[152:155], a[8:11], v[52:55]
    ds_read_b64_tr_b16 a[180:181], v3 offset:17568
    ds_read_b64_tr_b16 a[182:183], v3 offset:18080
    s_add_u32 m0, s30, 8704
    v_mfma_f32_16x16x32_bf16 v[52:55], a[156:159], a[12:15], v[52:55]
    ds_read_b64_tr_b16 a[184:185], v3 offset:17600
    ds_read_b64_tr_b16 a[186:187], v3 offset:18112
    ds_read_b64_tr_b16 a[188:189], v3 offset:17632
    ds_read_b64_tr_b16 a[190:191], v3 offset:18144
    buffer_load_dwordx4 v6, s[12:15], s29 offen lds
    s_waitcnt lgkmcnt(8)
    v_mfma_f32_16x16x32_bf16 v[128:131], a[160:163], v[16:19], v[128:131]
    ds_read_b128 a[128:131], v1 offset:17408
    s_add_u32 m0, s30, 12928
    v_mfma_f32_16x16x32_bf16 v[132:135], a[164:167], v[16:19], v[132:135]
    ds_read_b128 a[132:135], v1 offset:17472
    buffer_load_dwordx4 v7, s[12:15], s29 offen lds
    v_mfma_f32_16x16x32_bf16 v[136:139], a[168:171], v[16:19], v[136:139]
    ds_read_b128 a[136:139], v2 offset:17408
    v_mfma_f32_16x16x32_bf16 v[140:143], a[172:175], v[16:19], v[140:143]
    ds_read_b128 a[140:143], v2 offset:17472
    s_add_u32 s28, s28, s101
    v_exp_f32 v48, v48
    s_waitcnt lgkmcnt(4)
    v_mfma_f32_16x16x32_bf16 v[144:147], a[176:179], v[16:19], v[144:147]
    ds_read_b128 a[144:147], v1 offset:21632
    s_add_u32 s29, s29, s101
    v_exp_f32 v49, v49
    v_mfma_f32_16x16x32_bf16 v[148:151], a[180:183], v[16:19], v[148:151]
    ds_read_b128 a[148:151], v1 offset:21696
    ds_read_b128 a[152:155], v2 offset:21632
    ds_read_b128 a[156:159], v2 offset:21696
    s_sub_u32 s31, s31, 1
    v_cvt_pk_bf16_f32 v48, v48, v49
    v_mfma_f32_16x16x32_bf16 v[152:155], a[184:187], v[16:19], v[152:155]
    s_cmp_le_u32 s31, s32
    v_exp_f32 v50, v50
    v_mfma_f32_16x16x32_bf16 v[156:159], a[188:191], v[16:19], v[156:159]
    s_waitcnt vmcnt(8) lgkmcnt(0)
    v_exp_f32 v51, v51
    v_mfma_f32_16x16x32_bf16 a[208:211], a[224:227], v[16:19], a[208:211]
    v_cvt_pk_bf16_f32 v49, v50, v51
    s_cbranch_scc1 L_sp1_2
L_itb1_2:
    s_barrier
    v_mfma_f32_16x16x32_bf16 v[16:19], a[128:131], a[0:3], v[80:83]
    ds_read_b64_tr_b16 a[160:161], v3 offset:34816
    s_add_u32 m0, s30, 17408
    v_exp_f32 v52, v52
    v_mfma_f32_16x16x32_bf16 v[16:19], a[132:135], a[4:7], v[16:19]
    ds_read_b64_tr_b16 a[162:163], v3 offset:35328
    buffer_load_dwordx4 v4, s[8:11], s28 offen lds
    v_exp_f32 v53, v53
    v_mfma_f32_16x16x32_bf16 v[16:19], a[136:139], a[8:11], v[16:19]
    ds_read_b64_tr_b16 a[164:165], v3 offset:34848
    ds_read_b64_tr_b16 a[166:167], v3 offset:35360
    s_add_u32 m0, s30, 21632
    v_cvt_pk_bf16_f32 v50, v52, v53
    v_mfma_f32_16x16x32_bf16 v[16:19], a[140:143], a[12:15], v[16:19]
    ds_read_b64_tr_b16 a[168:169], v3 offset:34880
    ds_read_b64_tr_b16 a[170:171], v3 offset:35392
    v_exp_f32 v54, v54
    v_mfma_f32_16x16x32_bf16 v[20:23], a[144:147], a[0:3], v[80:83]
    ds_read_b64_tr_b16 a[172:173], v3 offset:34912
    ds_read_b64_tr_b16 a[174:175], v3 offset:35424
    v_exp_f32 v55, v55
    v_mfma_f32_16x16x32_bf16 v[20:23], a[148:151], a[4:7], v[20:23]
    ds_read_b64_tr_b16 a[176:177], v3 offset:34944
    ds_read_b64_tr_b16 a[178:179], v3 offset:35456
    buffer_load_dwordx4 v5, s[8:11], s28 offen lds
    v_cvt_pk_bf16_f32 v51, v54, v55
    v_mfma_f32_16x16x32_bf16 v[20:23], a[152:155], a[8:11], v[20:23]
    ds_read_b64_tr_b16 a[180:181], v3 offset:34976
    ds_read_b64_tr_b16 a[182:183], v3 offset:35488
    s_add_u32 m0, s30, 26112
    v_mfma_f32_16x16x32_bf16 v[20:23], a[156:159], a[12:15], v[20:23]
    ds_read_b64_tr_b16 a[184:185], v3 offset:35008
    ds_read_b64_tr_b16 a[186:187], v3 offset:35520
    ds_read_b64_tr_b16 a[188:189], v3 offset:35040
    ds_read_b64_tr_b16 a[190:191], v3 offset:35552
    buffer_load_dwordx4 v6, s[12:15], s29 offen lds
    s_waitcnt lgkmcnt(8)
    v_mfma_f32_16x16x32_bf16 v[128:131], a[160:163], v[48:51], v[128:131]
    ds_read_b128 a[128:131], v1 offset:34816
    s_add_u32 m0, s30, 30336
    v_mfma_f32_16x16x32_bf16 v[132:135], a[164:167], v[48:51], v[132:135]
    ds_read_b128 a[132:135], v1 offset:34880
    buffer_load_dwordx4 v7, s[12:15], s29 offen lds
    v_mfma_f32_16x16x32_bf16 v[136:139], a[168:171], v[48:51], v[136:139]
    ds_read_b128 a[136:139], v2 offset:34816
    v_mfma_f32_16x16x32_bf16 v[140:143], a[172:175], v[48:51], v[140:143]
    ds_read_b128 a[140:143], v2 offset:34880
    s_add_u32 s28, s28, s101
    v_exp_f32 v16, v16
    s_waitcnt lgkmcnt(4)
    v_mfma_f32_16x16x32_bf16 v[144:147], a[176:179], v[48:51], v[144:147]
    ds_read_b128 a[144:147], v1 offset:39040
    s_add_u32 s29, s29, s101
    v_exp_f32 v17, v17
    v_mfma_f32_16x16x32_bf16 v[148:151], a[180:183], v[48:51], v[148:151]
    ds_read_b128 a[148:151], v1 offset:39104
    ds_read_b128 a[152:155], v2 offset:39040
    ds_read_b128 a[156:159], v2 offset:39104
    s_sub_u32 s31, s31, 1
    v_cvt_pk_bf16_f32 v16, v16, v17
    v_mfma_f32_16x16x32_bf16 v[152:155], a[184:187], v[48:51], v[152:155]
    s_cmp_le_u32 s31, s32
    v_exp_f32 v18, v18
    v_mfma_f32_16x16x32_bf16 v[156:159], a[188:191], v[48:51], v[156:159]
    s_waitcnt vmcnt(8) lgkmcnt(0)
    v_exp_f32 v19, v19
    v_mfma_f32_16x16x32_bf16 a[208:211], a[224:227], v[48:51], a[208:211]
    v_cvt_pk_bf16_f32 v17, v18, v19
    s_cbranch_scc1 L_sp1_3
L_itb1_3:
    s_barrier
    v_mfma_f32_16x16x32_bf16 v[48:51], a[128:131], a[0:3], v[80:83]
    ds_read_b64_tr_b16 a[160:161], v3 offset:52224
    s_add_u32 m0, s30, 34816
    v_exp_f32 v20, v20
    v_mfma_f32_16x16x32_bf16 v[48:51], a[132:135], a[4:7], v[48:51]
    ds_read_b64_tr_b16 a[162:163], v3 offset:52736
    buffer_load_dwordx4 v4, s[8:11], s28 offen lds
    v_exp_f32 v21, v21
    v_mfma_f32_16x16x32_bf16 v[48:51], a[136:139], a[8:11], v[48:51]
    ds_read_b64_tr_b16 a[164:165], v3 offset:52256
    ds_read_b64_tr_b16 a[166:167], v3 offset:52768
    s_add_u32 m0, s30, 39040
    v_cvt_pk_bf16_f32 v18, v20, v21
    v_mfma_f32_16x16x32_bf16 v[48:51], a[140:143], a[12:15], v[48:51]
    ds_read_b64_tr_b16 a[168:169], v3 offset:52288
    ds_read_b64_tr_b16 a[170:171], v3 offset:52800
    v_exp_f32 v22, v22
    v_mfma_f32_16x16x32_bf16 v[52:55], a[144:147], a[0:3], v[80:83]
    ds_read_b64_tr_b16 a[172:173], v3 offset:52320
    ds_read_b64_tr_b16 a[174:175], v3 offset:52832
    v_exp_f32 v23, v23
    v_mfma_f32_16x16x32_bf16 v[52:55], a[148:151], a[4:7], v[52:55]
    ds_read_b64_tr_b16 a[176:177], v3 offset:52352
    ds_read_b64_tr_b16 a[178:179], v3 offset:52864
    buffer_load_dwordx4 v5, s[8:11], s28 offen lds
    v_cvt_pk_bf16_f32 v19, v22, v23
    v_mfma_f32_16x16x32_bf16 v[52:55], a[152:155], a[8:11], v[52:55]
    ds_read_b64_tr_b16 a[180:181], v3 offset:52384
    ds_read_b64_tr_b16 a[182:183], v3 offset:52896
    s_add_u32 m0, s30, 43520
    v_mfma_f32_16x16x32_bf16 v[52:55], a[156:159], a[12:15], v[52:55]
    ds_read_b64_tr_b16 a[184:185], v3 offset:52416
    ds_read_b64_tr_b16 a[186:187], v3 offset:52928
    ds_read_b64_tr_b16 a[188:189], v3 offset:52448
    ds_read_b64_tr_b16 a[190:191], v3 offset:52960
    buffer_load_dwordx4 v6, s[12:15], s29 offen lds
    s_waitcnt lgkmcnt(8)
    v_mfma_f32_16x16x32_bf16 v[128:131], a[160:163], v[16:19], v[128:131]
    ds_read_b128 a[128:131], v1 offset:52224
    s_add_u32 m0, s30, 47744
    v_mfma_f32_16x16x32_bf16 v[132:135], a[164:167], v[16:19], v[132:135]
    ds_read_b128 a[132:135], v1 offset:52288
    buffer_load_dwordx4 v7, s[12:15], s29 offen lds
    v_mfma_f32_16x16x32_bf16 v[136:139], a[168:171], v[16:19], v[136:139]
    ds_read_b128 a[136:139], v2 offset:52224
    v_mfma_f32_16x16x32_bf16 v[140:143], a[172:175], v[16:19], v[140:143]
    ds_read_b128 a[140:143], v2 offset:52288
    s_add_u32 s28, s28, s101
    v_exp_f32 v48, v48
    s_waitcnt lgkmcnt(4)
    v_mfma_f32_16x16x32_bf16 v[144:147], a[176:179], v[16:19], v[144:147]
    ds_read_b128 a[144:147], v1 offset:56448
    s_add_u32 s29, s29, s101
    v_exp_f32 v49, v49
    v_mfma_f32_16x16x32_bf16 v[148:151], a[180:183], v[16:19], v[148:151]
    ds_read_b128 a[148:151], v1 offset:56512
    ds_read_b128 a[152:155], v2 offset:56448
    ds_read_b128 a[156:159], v2 offset:56512
    s_sub_u32 s31, s31, 1
    v_cvt_pk_bf16_f32 v48, v48, v49
    v_mfma_f32_16x16x32_bf16 v[152:155], a[184:187], v[16:19], v[152:155]
    s_cmp_le_u32 s31, s32
    v_exp_f32 v50, v50
    v_mfma_f32_16x16x32_bf16 v[156:159], a[188:191], v[16:19], v[156:159]
    s_waitcnt vmcnt(8) lgkmcnt(0)
    v_exp_f32 v51, v51
    v_mfma_f32_16x16x32_bf16 a[208:211], a[224:227], v[16:19], a[208:211]
    v_cvt_pk_bf16_f32 v49, v50, v51
    s_cbranch_scc1 L_sp1_0
L_itb1_0:
    s_barrier
    v_mfma_f32_16x16x32_bf16 v[16:19], a[128:131], a[0:3], v[80:83]
    ds_read_b64_tr_b16 a[160:161], v3 offset:0
    s_add_u32 m0, s30, 52224
    v_exp_f32 v52, v52
    v_mfma_f32_16x16x32_bf16 v[16:19], a[132:135], a[4:7], v[16:19]
    ds_read_b64_tr_b16 a[162:163], v3 offset:512
    buffer_load_dwordx4 v4, s[8:11], s28 offen lds
    v_exp_f32 v53, v53
    v_mfma_f32_16x16x32_bf16 v[16:19], a[136:139], a[8:11], v[16:19]
    ds_read_b64_tr_b16 a[164:165], v3 offset:32
    ds_read_b64_tr_b16 a[166:167], v3 offset:544
    s_add_u32 m0, s30, 56448
    v_cvt_pk_bf16_f32 v50, v52, v53
    v_mfma_f32_16x16x32_bf16 v[16:19], a[140:143], a[12:15], v[16:19]
    ds_read_b64_tr_b16 a[168:169], v3 offset:64
    ds_read_b64_tr_b16 a[170:171], v3 offset:576
    v_exp_f32 v54, v54
    v_mfma_f32_16x16x32_bf16 v[20:23], a[144:147], a[0:3], v[80:83]
    ds_read_b64_tr_b16 a[172:173], v3 offset:96
    ds_read_b64_tr_b16 a[174:175], v3 offset:608
    v_exp_f32 v55, v55
    v_mfma_f32_16x16x32_bf16 v[20:23], a[148:151], a[4:7], v[20:23]
    ds_read_b64_tr_b16 a[176:177], v3 offset:128
    ds_read_b64_tr_b16 a[178:179], v3 offset:640
    buffer_load_dwordx4 v5, s[8:11], s28 offen lds
    v_cvt_pk_bf16_f32 v51, v54, v55
    v_mfma_f32_16x16x32_bf16 v[20:23], a[152:155], a[8:11], v[20:23]
    ds_read_b64_tr_b16 a[180:181], v3 offset:160
    ds_read_b64_tr_b16 a[182:183], v3 offset:672
    s_add_u32 m0, s30, 60928
    v_mfma_f32_16x16x32_bf16 v[20:23], a[156:159], a[12:15], v[20:23]
    ds_read_b64_tr_b16 a[184:185], v3 offset:192
    ds_read_b64_tr_b16 a[186:187], v3 offset:704
    ds_read_b64_tr_b16 a[188:189], v3 offset:224
    ds_read_b64_tr_b16 a[190:191], v3 offset:736
    buffer_load_dwordx4 v6, s[12:15], s29 offen lds
    s_waitcnt lgkmcnt(8)
    v_mfma_f32_16x16x32_bf16 v[128:131], a[160:163], v[48:51], v[128:131]
    ds_read_b128 a[128:131], v1 offset:0
    s_add_u32 m0, s30, 65152
    v_mfma_f32_16x16x32_bf16 v[132:135], a[164:167], v[48:51], v[132:135]
    ds_read_b128 a[132:135], v1 offset:64
    buffer_load_dwordx4 v7, s[12:15], s29 offen lds
    v_mfma_f32_16x16x32_bf16 v[136:139], a[168:171], v[48:51], v[136:139]
    ds_read_b128 a[136:139], v2 offset:0
    v_mfma_f32_16x16x32_bf16 v[140:143], a[172:175], v[48:51], v[140:143]
    ds_read_b128 a[140:143], v2 offset:64
    s_add_u32 s28, s28, s101
    v_exp_f32 v16, v16
    s_waitcnt lgkmcnt(4)
    v_mfma_f32_16x16x32_bf16 v[144:147], a[176:179], v[48:51], v[144:147]
    ds_read_b128 a[144:147], v1 offset:4224
    s_add_u32 s29, s29, s101
    v_exp_f32 v17, v17
    v_mfma_f32_16x16x32_bf16 v[148:151], a[180:183], v[48:51], v[148:151]
    ds_read_b128 a[148:151], v1 offset:4288
    ds_read_b128 a[152:155], v2 offset:4224
    ds_read_b128 a[156:159], v2 offset:4288
    s_sub_u32 s31, s31, 1
    v_cvt_pk_bf16_f32 v16, v16, v17
    v_mfma_f32_16x16x32_bf16 v[152:155], a[184:187], v[48:51], v[152:155]
    s_cmp_le_u32 s31, s32
    v_exp_f32 v18, v18
    v_mfma_f32_16x16x32_bf16 v[156:159], a[188:191], v[48:51], v[156:159]
    s_waitcnt vmcnt(8) lgkmcnt(0)
    v_exp_f32 v19, v19
    v_mfma_f32_16x16x32_bf16 a[208:211], a[224:227], v[48:51], a[208:211]
    v_cvt_pk_bf16_f32 v17, v18, v19
    s_cbranch_scc0 L_itb1_1
L_sp1_1:
    s_mov_b32 s32, 0
    s_branch L_itb1_1
L_sp1_2:
    s_mov_b32 s32, 0
    s_branch L_itb1_2
L_sp1_3:
    s_cmp_eq_u32 s31, 0
    s_cbranch_scc1 L_e1_3
    s_mov_b32 s32, 0
    s_mov_b32 s38, L_e1_3-L_pc
    v_mbcnt_lo_u32_b32 v116, -1, 0
    v_mbcnt_hi_u32_b32 v116, -1, v116
    v_lshl_add_u32 v116, v116, 7, s38
    v_min_u32 v116, L_table-L_pc, v116
    global_load_dword v14, v116, s[74:75]
    s_branch L_itb1_3
L_sp1_0:
    s_mov_b32 s32, 0
    s_branch L_itb1_0
L_late:
L_e4x_1:
    s_mov_b32 s44, 1
    s_barrier
L_e4_1_1:
    v_smfmac_f32_16x16x64_bf16 a[208:211], a[236:239], v[16:23], v15
    ds_read_b64_tr_b16 a[160:161], v3 offset:17408
    v_exp_f32 v41, v41
    ds_read_b64_tr_b16 a[162:163], v3 offset:17920
    v_exp_f32 v42, v42
    ds_read_b64_tr_b16 a[164:165], v3 offset:17440
    v_cvt_pk_bf16_f32 v36, v40, v41
    ds_read_b64_tr_b16 a[166:167], v3 offset:17952
    v_exp_f32 v43, v43
    ds_read_b64_tr_b16 a[168:169], v3 offset:17472
    v_exp_f32 v44, v44
    ds_read_b64_tr_b16 a[170:171], v3 offset:17984
    v_cvt_pk_bf16_f32 v37, v42, v43
    ds_read_b64_tr_b16 a[172:173], v3 offset:17504
    v_exp_f32 v45, v45
    ds_read_b64_tr_b16 a[174:175], v3 offset:18016
    v_exp_f32 v46, v46
    ds_read_b64_tr_b16 a[176:177], v3 offset:17536
    v_cvt_pk_bf16_f32 v38, v44, v45
    ds_read_b64_tr_b16 a[178:179], v3 offset:18048
    v_exp_f32 v47, v47
    ds_read_b64_tr_b16 a[180:181], v3 offset:17568
    s_nop 0
    ds_read_b64_tr_b16 a[182:183], v3 offset:18080
    v_cvt_pk_bf16_f32 v39, v46, v47
    ds_read_b64_tr_b16 a[184:185], v3 offset:17600
    ds_read_b64_tr_b16 a[186:187], v3 offset:18112
    ds_read_b64_tr_b16 a[188:189], v3 offset:17632
    ds_read_b64_tr_b16 a[190:191], v3 offset:18144
    s_nop 1
    v_smfmac_f32_16x16x64_bf16 a[212:215], a[236:239], v[32:39], v15
    s_waitcnt lgkmcnt(8)
    v_mfma_f32_16x16x32_bf16 v[128:131], a[160:163], v[16:19], v[128:131]
    s_add_u32 m0, s30, 0
    v_mfma_f32_16x16x32_bf16 v[132:135], a[164:167], v[16:19], v[132:135]
    buffer_load_dwordx4 v4, s[8:11], s28 offen lds
    v_mfma_f32_16x16x32_bf16 v[136:139], a[168:171], v[16:19], v[136:139]
    s_add_u32 m0, s30, 4224
    v_mfma_f32_16x16x32_bf16 v[140:143], a[172:175], v[16:19], v[140:143]
    buffer_load_dwordx4 v5, s[8:11], s28 offen lds
    s_waitcnt lgkmcnt(0)
    v_mfma_f32_16x16x32_bf16 v[144:147], a[176:179], v[16:19], v[144:147]
    s_add_u32 m0, s30, 8704
    ds_read_b128 a[64:67], v9 offset:0
    v_mfma_f32_16x16x32_bf16 v[148:151], a[180:183], v[16:19], v[148:151]
    buffer_load_dwordx4 v6, s[12:15], s29 offen lds
    ds_read_b128 a[68:71], v9 offset:64
    v_mfma_f32_16x16x32_bf16 v[152:155], a[184:187], v[16:19], v[152:155]
    s_add_u32 m0, s30, 12928
    ds_read_b128 a[72:75], v10 offset:0
    v_mfma_f32_16x16x32_bf16 v[156:159], a[188:191], v[16:19], v[156:159]
    buffer_load_dwordx4 v7, s[12:15], s29 offen lds
    ds_read_b128 a[76:79], v10 offset:64
    s_add_u32 s28, s28, s101
    s_add_u32 s29, s29, s101
    v_accvgpr_read_b32 v112, a208
    v_accvgpr_read_b32 v113, a210
    v_accvgpr_read_b32 v114, a212
    v_accvgpr_read_b32 v115, a214
    v_accvgpr_read_b32 v116, a209
    v_accvgpr_read_b32 v117, a211
    v_accvgpr_read_b32 v118, a213
    v_accvgpr_read_b32 v119, a215
    v_add_f32 v112, v112, v116
    v_add_f32 v113, v113, v117
    v_add_f32 v114, v114, v118
    v_add_f32 v115, v115, v119
    v_cmp_nge_f32 vcc, 0x44800000, v112
    v_rcp_f32 v120, v112
    s_nop 0
    s_mov_b64 s[84:85], vcc
    v_cmp_nge_f32 vcc, 0x44800000, v113
    v_rcp_f32 v121, v113
    s_nop 0
    s_or_b64 s[84:85], s[84:85], vcc
    v_cmp_nge_f32 vcc, 0x44800000, v114
    v_rcp_f32 v122, v114
    s_nop 0
    s_or_b64 s[84:85], s[84:85], vcc
    v_cmp_nge_f32 vcc, 0x44800000, v115
    v_rcp_f32 v123, v115
    s_nop 0
    s_or_b64 s[84:85], s[84:85], vcc
    s_mov_b32 s40, s34
    s_cbranch_scc1 L_es4_1
    s_waitcnt vmcnt(8) lgkmcnt(0)
    v_mfma_f32_16x16x32_bf16 v[160:163], a[160:163], v[20:23], v[160:163]
    v_mul_f32 v128, v120, v128
    v_mul_f32 v129, v120, v129
    v_mul_f32 v130, v120, v130
    v_mul_f32 v131, v120, v131
    v_mfma_f32_16x16x32_bf16 v[164:167], a[164:167], v[20:23], v[164:167]
    v_mul_f32 v132, v120, v132
    v_mul_f32 v133, v120, v133
    v_mul_f32 v134, v120, v134
    v_mul_f32 v135, v120, v135
    v_mfma_f32_16x16x32_bf16 v[168:171], a[168:171], v[20:23], v[168:171]
    v_cvt_pk_bf16_f32 v128, v128, v129
    v_cvt_pk_bf16_f32 v129, v130, v131
    v_mul_f32 v136, v120, v136
    v_mul_f32 v137, v120, v137
    v_mfma_f32_16x16x32_bf16 v[172:175], a[172:175], v[20:23], v[172:175]
    v_mul_f32 v138, v120, v138
    v_mul_f32 v139, v120, v139
    v_cvt_pk_bf16_f32 v132, v132, v133
    v_cvt_pk_bf16_f32 v133, v134, v135
    v_mfma_f32_16x16x32_bf16 v[176:179], a[176:179], v[20:23], v[176:179]
    ds_write_b64 v11, v[128:129] offset:0
    v_mul_f32 v140, v120, v140
    v_mul_f32 v141, v120, v141
    v_mul_f32 v142, v120, v142
    v_mfma_f32_16x16x32_bf16 v[180:183], a[180:183], v[20:23], v[180:183]
    v_mul_f32 v143, v120, v143
    v_cvt_pk_bf16_f32 v136, v136, v137
    v_cvt_pk_bf16_f32 v137, v138, v139
    ds_write_b64 v11, v[132:133] offset:32
    v_mfma_f32_16x16x32_bf16 v[184:187], a[184:187], v[20:23], v[184:187]
    v_mul_f32 v144, v120, v144
    v_mul_f32 v145, v120, v145
    v_mul_f32 v146, v120, v146
    v_mul_f32 v147, v120, v147
    v_mfma_f32_16x16x32_bf16 v[188:191], a[188:191], v[20:23], v[188:191]
    v_cvt_pk_bf16_f32 v140, v140, v141
    v_cvt_pk_bf16_f32 v141, v142, v143
    ds_write_b64 v11, v[136:137] offset:64
    v_mul_f32 v148, v120, v148
    v_mul_f32 v149, v120, v149
    v_mul_f32 v150, v120, v150
    v_mul_f32 v151, v120, v151
    v_cvt_pk_bf16_f32 v144, v144, v145
    v_cvt_pk_bf16_f32 v145, v146, v147
    ds_write_b64 v11, v[140:141] offset:96
    v_mul_f32 v152, v120, v152
    v_mul_f32 v153, v120, v153
    v_mul_f32 v154, v120, v154
    v_mul_f32 v155, v120, v155
    v_cvt_pk_bf16_f32 v148, v148, v149
    v_cvt_pk_bf16_f32 v149, v150, v151
    ds_write_b64 v11, v[144:145] offset:128
    v_mul_f32 v156, v120, v156
    v_mul_f32 v157, v120, v157
    v_mul_f32 v158, v120, v158
    v_mul_f32 v159, v120, v159
    v_cvt_pk_bf16_f32 v152, v152, v153
    v_cvt_pk_bf16_f32 v153, v154, v155
    ds_write_b64 v11, v[148:149] offset:160
    v_cvt_pk_bf16_f32 v156, v156, v157
    v_cvt_pk_bf16_f32 v157, v158, v159
    ds_write_b64 v11, v[152:153] offset:192
    ds_write_b64 v11, v[156:157] offset:224
    ds_read_b128 v[128:131], v12 offset:0
    ds_read_b128 v[132:135], v12 offset:1088
    ds_read_b128 v[136:139], v12 offset:2176
    ds_read_b128 v[140:143], v12 offset:3264
    v_mfma_f32_16x16x32_bf16 v[192:195], a[160:163], v[32:35], v[192:195]
    v_mul_f32 v160, v121, v160
    v_mul_f32 v161, v121, v161
    v_mul_f32 v162, v121, v162
    v_mul_f32 v163, v121, v163
    v_mfma_f32_32x32x16_bf16 v[96:111], a[192:195], a[64:67], 0
    v_mfma_f32_16x16x32_bf16 v[196:199], a[164:167], v[32:35], v[196:199]
    v_mul_f32 v164, v121, v164
    v_mul_f32 v165, v121, v165
    v_mul_f32 v166, v121, v166
    s_mov_b32 s80, s81
    s_mov_b32 s81, 0
    s_add_u32 s47, s47, 1
    v_mul_f32 v167, v121, v167
    v_mfma_f32_16x16x32_bf16 v[200:203], a[168:171], v[32:35], v[200:203]
    v_cvt_pk_bf16_f32 v160, v160, v161
    v_cvt_pk_bf16_f32 v161, v162, v163
    v_mul_f32 v168, v121, v168
    s_mov_b32 s42, s89
    s_mov_b32 s43, s90
    v_mul_f32 v169, v121, v169
    v_mfma_f32_16x16x32_bf16 v[204:207], a[172:175], v[32:35], v[204:207]
    v_mul_f32 v170, v121, v170
    v_mul_f32 v171, v121, v171
    v_mfma_f32_32x32x16_bf16 v[96:111], a[196:199], a[68:71], v[96:111]
    v_cvt_pk_bf16_f32 v164, v164, v165
    v_cvt_pk_bf16_f32 v165, v166, v167
    v_mfma_f32_16x16x32_bf16 v[208:211], a[176:179], v[32:35], v[208:211]
    ds_write_b64 v11, v[160:161] offset:4352
    s_waitcnt lgkmcnt(4)
    buffer_store_dwordx4 v[128:131], v13, s[16:19], s40 offen sc0 sc1
    s_mov_b32 s34, s91
    s_mov_b32 s88, s93
    s_bfe_u32 s37, s80, 0xa000d
    s_add_u32 s40, s40, 16384
    v_mul_f32 v172, v121, v172
    v_mul_f32 v173, v121, v173
    s_add_u32 s36, s37, 31
    s_lshr_b32 s36, s36, 5
    v_mul_f32 v174, v121, v174
    v_mfma_f32_16x16x32_bf16 v[212:215], a[180:183], v[32:35], v[212:215]
    v_mul_f32 v175, v121, v175
    v_cvt_pk_bf16_f32 v168, v168, v169
    v_cvt_pk_bf16_f32 v169, v170, v171
    v_mfma_f32_32x32x16_bf16 v[96:111], a[200:203], a[64:67], v[96:111]
    ds_write_b64 v11, v[164:165] offset:4384
    v_mfma_f32_16x16x32_bf16 v[216:219], a[184:187], v[32:35], v[216:219]
    v_mul_f32 v176, v121, v176
    v_mul_f32 v177, v121, v177
    s_sub_u32 s31, s36, 1
    s_lshl_b32 s39, s31, 5
    s_sub_u32 s35, s37, s39
    v_mul_f32 v178, v121, v178
    v_mul_f32 v179, v121, v179
    v_mfma_f32_16x16x32_bf16 v[220:223], a[188:191], v[32:35], v[220:223]
    v_cvt_pk_bf16_f32 v172, v172, v173
    v_cvt_pk_bf16_f32 v173, v174, v175
    s_mov_b32 s46, 0
    s_mov_b32 s99, s33
    ds_write_b64 v11, v[168:169] offset:4416
    s_waitcnt lgkmcnt(5)
    buffer_store_dwordx4 v[132:135], v13, s[16:19], s40 offen sc0 sc1
    s_add_u32 s40, s40, 16384
    v_mfma_f32_32x32x16_bf16 v[96:111], a[204:207], a[68:71], v[96:111]
    v_mul_f32 v180, v121, v180
    v_mul_f32 v181, v121, v181
    v_mul_f32 v182, v121, v182
    v_mul_f32 v183, v121, v183
    v_cvt_pk_bf16_f32 v176, v176, v177
    s_sub_u32 s31, s31, 1
    s_mov_b32 s32, 4
    s_mov_b32 s93, 0
    v_cvt_pk_bf16_f32 v177, v178, v179
    ds_write_b64 v11, v[172:173] offset:4448
    v_mul_f32 v184, v121, v184
    v_mul_f32 v185, v121, v185
    s_mov_b32 s90, 0
    v_mul_f32 v186, v121, v186
    v_mul_f32 v187, v121, v187
    v_cvt_pk_bf16_f32 v180, v180, v181
    v_cvt_pk_bf16_f32 v181, v182, v183
    ds_write_b64 v11, v[176:177] offset:4480
    v_mfma_f32_32x32x16_bf16 v[144:159], a[192:195], a[72:75], 0
    s_waitcnt lgkmcnt(6)
    buffer_store_dwordx4 v[136:139], v13, s[16:19], s40 offen sc0 sc1
    s_add_u32 s40, s40, 16384
    v_mul_f32 v188, v121, v188
    v_accvgpr_mov_b32 a232, a240
    v_accvgpr_mov_b32 a233, a241
    v_mul_f32 v189, v121, v189
    v_mul_f32 v190, v121, v190
    v_mul_f32 v191, v121, v191
    v_cvt_pk_bf16_f32 v184, v184, v185
    v_cvt_pk_bf16_f32 v185, v186, v187
    v_mfma_f32_32x32x16_bf16 v[144:159], a[196:199], a[76:79], v[144:159]
    ds_write_b64 v11, v[180:181] offset:4512
    v_cvt_pk_bf16_f32 v188, v188, v189
    v_cvt_pk_bf16_f32 v189, v190, v191
    ds_write_b64 v11, v[184:185] offset:4544
    v_accvgpr_mov_b32 a234, a242
    v_accvgpr_mov_b32 a235, a243
    s_waitcnt lgkmcnt(7)
    buffer_store_dwordx4 v[140:143], v13, s[16:19], s40 offen sc0 sc1
    s_add_u32 s40, s40, 16384
    ds_write_b64 v11, v[188:189] offset:4576
    ds_read_b128 v[160:163], v12 offset:4352
    v_mfma_f32_32x32x16_bf16 v[144:159], a[200:203], a[72:75], v[144:159]
    ds_read_b128 v[164:167], v12 offset:5440
    ds_read_b128 v[168:171], v12 offset:6528
    ds_read_b128 v[172:175], v12 offset:7616
    v_mfma_f32_32x32x16_bf16 v[128:143], v[124:127], v[124:127], 0
    v_accvgpr_mov_b32 a236, a244
    v_accvgpr_mov_b32 a237, a245
    v_mfma_f32_16x16x32_bf16 v[224:227], a[160:163], v[36:39], v[224:227]
    v_mul_f32 v192, v122, v192
    v_mul_f32 v193, v122, v193
    v_mul_f32 v194, v122, v194
    v_mfma_f32_32x32x16_bf16 v[144:159], a[204:207], a[76:79], v[144:159]
    v_mul_f32 v195, v122, v195
    v_mfma_f32_16x16x32_bf16 v[228:231], a[164:167], v[36:39], v[228:231]
    v_mul_f32 v196, v122, v196
    v_mul_f32 v197, v122, v197
    v_mul_f32 v198, v122, v198
    v_accvgpr_mov_b32 a238, a246
    v_accvgpr_mov_b32 a239, a247
    v_mul_f32 v199, v122, v199
    v_mfma_f32_16x16x32_bf16 v[232:235], a[168:171], v[36:39], v[232:235]
    v_cvt_pk_bf16_f32 v192, v192, v193
    v_cvt_pk_bf16_f32 v193, v194, v195
    v_mfma_f32_32x32x16_bf16 a[208:223], v[124:127], v[124:127], 0
    v_mul_f32 v200, v122, v200
    v_mul_f32 v201, v122, v201
    v_mfma_f32_16x16x32_bf16 v[236:239], a[172:175], v[36:39], v[236:239]
    v_mul_f32 v202, v122, v202
    v_mul_f32 v203, v122, v203
    v_cvt_pk_bf16_f32 v96, v96, v97
    v_cvt_pk_bf16_f32 v97, v98, v99
    v_cvt_pk_bf16_f32 v98, v100, v101
    v_cvt_pk_bf16_f32 v196, v196, v197
    v_cvt_pk_bf16_f32 v197, v198, v199
    v_mfma_f32_16x16x32_bf16 v[240:243], a[176:179], v[36:39], v[240:243]
    ds_write_b64 v11, v[192:193] offset:8704
    v_cvt_pk_bf16_f32 v99, v102, v103
    v_cvt_pk_bf16_f32 v100, v104, v105
    v_cvt_pk_bf16_f32 v101, v106, v107
    s_waitcnt lgkmcnt(4)
    buffer_store_dwordx4 v[160:163], v13, s[16:19], s40 offen sc0 sc1
    s_add_u32 s40, s40, 16384
    v_mul_f32 v204, v122, v204
    v_mul_f32 v205, v122, v205
    v_cvt_pk_bf16_f32 v102, v108, v109
    v_cvt_pk_bf16_f32 v103, v110, v111
    v_accvgpr_write_b32 a0, v96
    v_mul_f32 v206, v122, v206
    v_mfma_f32_16x16x32_bf16 v[244:247], a[180:183], v[36:39], v[244:247]
    v_mul_f32 v207, v122, v207
    v_cvt_pk_bf16_f32 v200, v200, v201
    v_accvgpr_write_b32 a1, v97
    v_accvgpr_write_b32 a2, v98
    v_accvgpr_write_b32 a3, v99
    v_cvt_pk_bf16_f32 v201, v202, v203
    ds_write_b64 v11, v[196:197] offset:8736
    v_mfma_f32_16x16x32_bf16 v[248:251], a[184:187], v[36:39], v[248:251]
    v_mul_f32 v208, v122, v208
    v_mul_f32 v209, v122, v209
    v_accvgpr_write_b32 a4, v100
    v_accvgpr_write_b32 a5, v101
    v_accvgpr_write_b32 a6, v102
    v_mul_f32 v210, v122, v210
    v_mul_f32 v211, v122, v211
    v_mfma_f32_16x16x32_bf16 v[252:255], a[188:191], v[36:39], v[252:255]
    v_cvt_pk_bf16_f32 v204, v204, v205
    v_accvgpr_write_b32 a7, v103
    v_cvt_pk_bf16_f32 v205, v206, v207
    ds_write_b64 v11, v[200:201] offset:8768
    s_waitcnt lgkmcnt(5)
    buffer_store_dwordx4 v[164:167], v13, s[16:19], s40 offen sc0 sc1
    s_add_u32 s40, s40, 16384
    v_cvt_pk_bf16_f32 v144, v144, v145
    v_cvt_pk_bf16_f32 v145, v146, v147
    v_cvt_pk_bf16_f32 v146, v148, v149
    v_mul_f32 v212, v122, v212
    v_mul_f32 v213, v122, v213
    v_mul_f32 v214, v122, v214
    v_mul_f32 v215, v122, v215
    v_cvt_pk_bf16_f32 v147, v150, v151
    v_cvt_pk_bf16_f32 v148, v152, v153
    v_cvt_pk_bf16_f32 v149, v154, v155
    v_cvt_pk_bf16_f32 v208, v208, v209
    v_cvt_pk_bf16_f32 v209, v210, v211
    ds_write_b64 v11, v[204:205] offset:8800
    v_mul_f32 v216, v122, v216
    v_mul_f32 v217, v122, v217
    v_cvt_pk_bf16_f32 v150, v156, v157
    v_cvt_pk_bf16_f32 v151, v158, v159
    v_accvgpr_write_b32 a8, v144
    v_mul_f32 v218, v122, v218
    v_mul_f32 v219, v122, v219
    v_cvt_pk_bf16_f32 v212, v212, v213
    v_cvt_pk_bf16_f32 v213, v214, v215
    v_accvgpr_write_b32 a9, v145
    v_accvgpr_write_b32 a10, v146
    v_accvgpr_write_b32 a11, v147
    ds_write_b64 v11, v[208:209] offset:8832
    s_waitcnt lgkmcnt(6)
    buffer_store_dwordx4 v[168:171], v13, s[16:19], s40 offen sc0 sc1
    s_add_u32 s40, s40, 16384
    v_mul_f32 v220, v122, v220
    v_accvgpr_write_b32 a12, v148
    v_accvgpr_write_b32 a13, v149
    v_accvgpr_write_b32 a14, v150
    v_mul_f32 v221, v122, v221
    v_mul_f32 v222, v122, v222
    v_mul_f32 v223, v122, v223
    v_cvt_pk_bf16_f32 v216, v216, v217
    v_accvgpr_write_b32 a15, v151
    v_cvt_pk_bf16_f32 v217, v218, v219
    ds_write_b64 v11, v[212:213] offset:8864
    v_cvt_pk_bf16_f32 v220, v220, v221
    v_cvt_pk_bf16_f32 v221, v222, v223
    ds_write_b64 v11, v[216:217] offset:8896
    s_nop 1
    v_mfma_f32_16x16x32_bf16 v[48:51], a[128:131], a[0:3], 0
    ds_read_b128 a[128:131], v1 offset:17408
    s_waitcnt lgkmcnt(8)
    buffer_store_dwordx4 v[172:175], v13, s[16:19], s40 offen sc0 sc1
    s_add_u32 s40, s40, 16384
    ds_write_b64 v11, v[220:221] offset:8928
    v_mfma_f32_16x16x32_bf16 v[48:51], a[132:135], a[4:7], v[48:51]
    ds_read_b128 a[132:135], v1 offset:17472
    ds_read_b128 v[192:195], v12 offset:8704
    ds_read_b128 v[196:199], v12 offset:9792
    ds_read_b128 v[200:203], v12 offset:10880
    ds_read_b128 v[204:207], v12 offset:11968
    v_mfma_f32_16x16x32_bf16 v[48:51], a[136:139], a[8:11], v[48:51]
    ds_read_b128 a[136:139], v2 offset:17408
    v_mul_f32 v224, v123, v224
    v_mul_f32 v225, v123, v225
    v_mul_f32 v226, v123, v226
    v_mul_f32 v227, v123, v227
    v_mul_f32 v228, v123, v228
    v_mfma_f32_16x16x32_bf16 v[48:51], a[140:143], a[12:15], v[48:51]
    ds_read_b128 a[140:143], v2 offset:17472
    v_mul_f32 v229, v123, v229
    v_mul_f32 v230, v123, v230
    v_mul_f32 v231, v123, v231
    v_cvt_pk_bf16_f32 v224, v224, v225
    v_mfma_f32_16x16x32_bf16 v[52:55], a[144:147], a[0:3], 0
    ds_read_b128 a[144:147], v1 offset:21632
    v_cvt_pk_bf16_f32 v225, v226, v227
    v_mul_f32 v232, v123, v232
    v_mul_f32 v233, v123, v233
    v_mul_f32 v234, v123, v234
    v_mul_f32 v235, v123, v235
    v_mfma_f32_16x16x32_bf16 v[52:55], a[148:151], a[4:7], v[52:55]
    ds_read_b128 a[148:151], v1 offset:21696
    v_cvt_pk_bf16_f32 v228, v228, v229
    v_cvt_pk_bf16_f32 v229, v230, v231
    ds_write_b64 v11, v[224:225] offset:13056
    s_waitcnt lgkmcnt(8)
    buffer_store_dwordx4 v[192:195], v13, s[16:19], s40 offen sc0 sc1
    v_mfma_f32_16x16x32_bf16 v[52:55], a[152:155], a[8:11], v[52:55]
    ds_read_b128 a[152:155], v2 offset:21632
    s_add_u32 s40, s40, 16384
    v_mul_f32 v236, v123, v236
    v_mul_f32 v237, v123, v237
    v_mul_f32 v238, v123, v238
    v_mfma_f32_16x16x32_bf16 v[52:55], a[156:159], a[12:15], v[52:55]
    ds_read_b128 a[156:159], v2 offset:21696
    v_mul_f32 v239, v123, v239
    v_cvt_pk_bf16_f32 v232, v232, v233
    v_cvt_pk_bf16_f32 v233, v234, v235
    ds_write_b64 v11, v[228:229] offset:13088
    s_nop 6
    v_mul_f32 v240, v123, v240
    v_mul_f32 v241, v123, v241
    v_mul_f32 v242, v123, v242
    v_mul_f32 v243, v123, v243
    v_cvt_pk_bf16_f32 v236, v236, v237
    v_max3_f32 v112, v48, v49, v50
    v_max3_f32 v116, v51, v52, v53
    v_max3_f32 v112, v112, v54, v55
    v_cvt_pk_bf16_f32 v237, v238, v239
    ds_write_b64 v11, v[232:233] offset:13120
    s_waitcnt lgkmcnt(11)
    buffer_store_dwordx4 v[196:199], v13, s[16:19], s40 offen sc0 sc1
    v_max_f32 v112, v112, v116
    v_mov_b32 v116, v112
    s_nop 1
    s_add_u32 s40, s40, 16384
    v_mul_f32 v244, v123, v244
    v_mul_f32 v245, v123, v245
    v_mul_f32 v246, v123, v246
    v_mul_f32 v247, v123, v247
    v_permlane32_swap_b32 v112, v116
    v_max_f32 v112, v112, v116
    v_mov_b32 v116, v112
    v_cvt_pk_bf16_f32 v240, v240, v241
    v_cvt_pk_bf16_f32 v241, v242, v243
    ds_write_b64 v11, v[236:237] offset:13152
    v_mul_f32 v248, v123, v248
    s_nop 1
    v_permlane16_swap_b32 v112, v116
    v_max_f32 v112, v112, v116
    v_mul_f32 v249, v123, v249
    v_mul_f32 v250, v123, v250
    v_mul_f32 v251, v123, v251
    v_cvt_pk_bf16_f32 v244, v244, v245
    v_cvt_pk_bf16_f32 v245, v246, v247
    v_sub_f32 v48, v48, v112
    v_sub_f32 v49, v49, v112
    v_sub_f32 v50, v50, v112
    ds_write_b64 v11, v[240:241] offset:13184
    s_waitcnt lgkmcnt(12)
    buffer_store_dwordx4 v[200:203], v13, s[16:19], s40 offen sc0 sc1
    s_add_u32 s40, s40, 16384
    v_sub_f32 v51, v51, v112
    v_sub_f32 v52, v52, v112
    v_sub_f32 v53, v53, v112
    v_mul_f32 v252, v123, v252
    v_mul_f32 v253, v123, v253
    v_mul_f32 v254, v123, v254
    v_mul_f32 v255, v123, v255
    v_cvt_pk_bf16_f32 v248, v248, v249
    v_sub_f32 v54, v54, v112
    v_sub_f32 v55, v55, v112
    v_sub_f32 v80, 0, v112
    v_cvt_pk_bf16_f32 v249, v250, v251
    ds_write_b64 v11, v[244:245] offset:13216
    v_cvt_pk_bf16_f32 v252, v252, v253
    v_cvt_pk_bf16_f32 v253, v254, v255
    v_sub_f32 v81, 0, v112
    v_sub_f32 v82, 0, v112
    v_sub_f32 v83, 0, v112
    ds_write_b64 v11, v[248:249] offset:13248
    s_waitcnt lgkmcnt(13)
    buffer_store_dwordx4 v[204:207], v13, s[16:19], s40 offen sc0 sc1
    s_add_u32 s40, s40, 16384
    ds_write_b64 v11, v[252:253] offset:13280
    v_exp_f32 v48, v48
    v_exp_f32 v49, v49
    v_exp_f32 v50, v50
    ds_read_b128 v[224:227], v12 offset:13056
    ds_read_b128 v[228:231], v12 offset:14144
    ds_read_b128 v[232:235], v12 offset:15232
    ds_read_b128 v[236:239], v12 offset:16320
    v_cvt_pk_bf16_f32 v48, v48, v49
    v_exp_f32 v51, v51
    s_nop 0
    s_waitcnt lgkmcnt(3)
    buffer_store_dwordx4 v[224:227], v13, s[16:19], s40 offen sc0 sc1
    s_add_u32 s40, s40, 16384
    s_waitcnt lgkmcnt(2)
    buffer_store_dwordx4 v[228:231], v13, s[16:19], s40 offen sc0 sc1
    s_add_u32 s40, s40, 16384
    s_waitcnt lgkmcnt(1)
    buffer_store_dwordx4 v[232:235], v13, s[16:19], s40 offen sc0 sc1
    s_add_u32 s40, s40, 16384
    s_waitcnt lgkmcnt(0)
    buffer_store_dwordx4 v[236:239], v13, s[16:19], s40 offen sc0 sc1
    s_add_u32 s40, s40, 16384
    v_cvt_pk_bf16_f32 v49, v50, v51
    v_mfma_f32_32x32x16_bf16 v[144:159], v[124:127], v[124:127], 0
    s_mov_b32 s18, s43
    s_waitcnt lgkmcnt(0)
    s_branch L_itb1_2
L_e4_2:
    s_mov_b32 s44, 2
    s_waitcnt vmcnt(4)
    s_barrier
L_e4_2_0:
    v_mfma_f32_16x16x32_bf16 v[16:19], a[128:131], a[0:3], v[80:83]
    ds_read_b64_tr_b16 a[160:161], v3 offset:34816
    v_exp_f32 v73, v73
    v_mfma_f32_16x16x32_bf16 v[16:19], a[132:135], a[4:7], v[16:19]
    ds_read_b64_tr_b16 a[162:163], v3 offset:35328
    v_exp_f32 v74, v74
    v_cvt_pk_bf16_f32 v68, v72, v73
    v_mfma_f32_16x16x32_bf16 v[16:19], a[136:139], a[8:11], v[16:19]
    ds_read_b64_tr_b16 a[164:165], v3 offset:34848
    v_exp_f32 v75, v75
    v_mfma_f32_16x16x32_bf16 v[16:19], a[140:143], a[12:15], v[16:19]
    ds_read_b64_tr_b16 a[166:167], v3 offset:35360
    v_exp_f32 v76, v76
    v_cvt_pk_bf16_f32 v69, v74, v75
    v_mfma_f32_16x16x32_bf16 v[20:23], a[144:147], a[0:3], v[80:83]
    ds_read_b64_tr_b16 a[168:169], v3 offset:34880
    v_exp_f32 v77, v77
    v_mfma_f32_16x16x32_bf16 v[20:23], a[148:151], a[4:7], v[20:23]
    ds_read_b64_tr_b16 a[170:171], v3 offset:35392
    v_exp_f32 v78, v78
    v_cvt_pk_bf16_f32 v70, v76, v77
    v_mfma_f32_16x16x32_bf16 v[20:23], a[152:155], a[8:11], v[20:23]
    ds_read_b64_tr_b16 a[172:173], v3 offset:34912
    v_exp_f32 v79, v79
    v_mfma_f32_16x16x32_bf16 v[20:23], a[156:159], a[12:15], v[20:23]
    ds_read_b64_tr_b16 a[174:175], v3 offset:35424
    v_cvt_pk_bf16_f32 v71, v78, v79
    v_mfma_f32_16x16x32_bf16 v[24:27], a[128:131], a[16:19], v[84:87]
    ds_read_b64_tr_b16 a[176:177], v3 offset:34944
    v_mfma_f32_16x16x32_bf16 v[24:27], a[132:135], a[20:23], v[24:27]
    ds_read_b64_tr_b16 a[178:179], v3 offset:35456
    v_mfma_f32_16x16x32_bf16 v[24:27], a[136:139], a[24:27], v[24:27]
    ds_read_b64_tr_b16 a[180:181], v3 offset:34976
    v_mfma_f32_16x16x32_bf16 v[24:27], a[140:143], a[28:31], v[24:27]
    ds_read_b64_tr_b16 a[182:183], v3 offset:35488
    v_mfma_f32_16x16x32_bf16 v[28:31], a[144:147], a[16:19], v[84:87]
    ds_read_b64_tr_b16 a[184:185], v3 offset:35008
    v_exp_f32 v16, v16
    v_mfma_f32_16x16x32_bf16 v[28:31], a[148:151], a[20:23], v[28:31]
    ds_read_b64_tr_b16 a[186:187], v3 offset:35520
    v_exp_f32 v17, v17
    v_mfma_f32_16x16x32_bf16 v[28:31], a[152:155], a[24:27], v[28:31]
    ds_read_b64_tr_b16 a[188:189], v3 offset:35040
    v_exp_f32 v18, v18
    v_cvt_pk_bf16_f32 v16, v16, v17
    v_mfma_f32_16x16x32_bf16 v[28:31], a[156:159], a[28:31], v[28:31]
    ds_read_b64_tr_b16 a[190:191], v3 offset:35552
    v_exp_f32 v19, v19
    v_mfma_f32_16x16x32_bf16 v[32:35], a[128:131], a[32:35], v[88:91]
    ds_read_b64_tr_b16 a[64:65], v3 offset:52224
    v_exp_f32 v20, v20
    v_cvt_pk_bf16_f32 v17, v18, v19
    v_mfma_f32_16x16x32_bf16 v[32:35], a[132:135], a[36:39], v[32:35]
    ds_read_b64_tr_b16 a[66:67], v3 offset:52736
    v_exp_f32 v21, v21
    v_mfma_f32_16x16x32_bf16 v[32:35], a[136:139], a[40:43], v[32:35]
    ds_read_b64_tr_b16 a[68:69], v3 offset:52256
    v_exp_f32 v22, v22
    v_cvt_pk_bf16_f32 v18, v20, v21
    v_mfma_f32_16x16x32_bf16 v[32:35], a[140:143], a[44:47], v[32:35]
    ds_read_b64_tr_b16 a[70:71], v3 offset:52768
    v_exp_f32 v23, v23
    v_mfma_f32_16x16x32_bf16 v[36:39], a[144:147], a[32:35], v[88:91]
    ds_read_b64_tr_b16 a[72:73], v3 offset:52288
    v_exp_f32 v24, v24
    v_cvt_pk_bf16_f32 v19, v22, v23
    v_mfma_f32_16x16x32_bf16 v[36:39], a[148:151], a[36:39], v[36:39]
    ds_read_b64_tr_b16 a[74:75], v3 offset:52800
    v_exp_f32 v25, v25
    v_mfma_f32_16x16x32_bf16 v[36:39], a[152:155], a[40:43], v[36:39]
    ds_read_b64_tr_b16 a[76:77], v3 offset:52320
    v_exp_f32 v26, v26
    v_cvt_pk_bf16_f32 v20, v24, v25
    v_mfma_f32_16x16x32_bf16 v[36:39], a[156:159], a[44:47], v[36:39]
    ds_read_b64_tr_b16 a[78:79], v3 offset:52832
    v_exp_f32 v27, v27
    v_mfma_f32_16x16x32_bf16 v[40:43], a[128:131], a[48:51], v[92:95]
    ds_read_b64_tr_b16 a[80:81], v3 offset:52352
    v_exp_f32 v28, v28
    v_cvt_pk_bf16_f32 v21, v26, v27
    v_mfma_f32_16x16x32_bf16 v[40:43], a[132:135], a[52:55], v[40:43]
    ds_read_b64_tr_b16 a[82:83], v3 offset:52864
    v_exp_f32 v29, v29
    v_mfma_f32_16x16x32_bf16 v[40:43], a[136:139], a[56:59], v[40:43]
    ds_read_b64_tr_b16 a[84:85], v3 offset:52384
    v_exp_f32 v30, v30
    v_cvt_pk_bf16_f32 v22, v28, v29
    v_mfma_f32_16x16x32_bf16 v[40:43], a[140:143], a[60:63], v[40:43]
    ds_read_b64_tr_b16 a[86:87], v3 offset:52896
    v_exp_f32 v31, v31
    v_mfma_f32_16x16x32_bf16 v[44:47], a[144:147], a[48:51], v[92:95]
    ds_read_b64_tr_b16 a[88:89], v3 offset:52416
    v_exp_f32 v32, v32
    v_cvt_pk_bf16_f32 v23, v30, v31
    v_mfma_f32_16x16x32_bf16 v[44:47], a[148:151], a[52:55], v[44:47]
    ds_read_b64_tr_b16 a[90:91], v3 offset:52928
    v_exp_f32 v33, v33
    v_mfma_f32_16x16x32_bf16 v[44:47], a[152:155], a[56:59], v[44:47]
    ds_read_b64_tr_b16 a[92:93], v3 offset:52448
    v_exp_f32 v34, v34
    v_cvt_pk_bf16_f32 v32, v32, v33
    v_mfma_f32_16x16x32_bf16 v[44:47], a[156:159], a[60:63], v[44:47]
    ds_read_b64_tr_b16 a[94:95], v3 offset:52960
    v_exp_f32 v35, v35
    s_waitcnt lgkmcnt(15)
    v_mfma_f32_16x16x32_bf16 v[128:131], a[160:163], v[48:51], v[128:131]
    v_exp_f32 v36, v36
    v_cvt_pk_bf16_f32 v33, v34, v35
    v_mfma_f32_16x16x32_bf16 v[132:135], a[164:167], v[48:51], v[132:135]
    v_exp_f32 v37, v37
    v_mfma_f32_16x16x32_bf16 v[136:139], a[168:171], v[48:51], v[136:139]
    v_exp_f32 v38, v38
    v_cvt_pk_bf16_f32 v34, v36, v37
    v_mfma_f32_16x16x32_bf16 v[140:143], a[172:175], v[48:51], v[140:143]
    v_exp_f32 v39, v39
    v_mfma_f32_16x16x32_bf16 v[144:147], a[176:179], v[48:51], v[144:147]
    v_exp_f32 v40, v40
    v_cvt_pk_bf16_f32 v35, v38, v39
    v_mfma_f32_16x16x32_bf16 v[148:151], a[180:183], v[48:51], v[148:151]
    v_exp_f32 v41, v41
    v_mfma_f32_16x16x32_bf16 v[152:155], a[184:187], v[48:51], v[152:155]
    v_exp_f32 v42, v42
    v_cvt_pk_bf16_f32 v36, v40, v41
    v_mfma_f32_16x16x32_bf16 v[156:159], a[188:191], v[48:51], v[156:159]
    v_exp_f32 v43, v43
    v_mfma_f32_16x16x32_bf16 v[160:163], a[160:163], v[52:55], v[160:163]
    v_exp_f32 v44, v44
    v_cvt_pk_bf16_f32 v37, v42, v43
    v_mfma_f32_16x16x32_bf16 v[164:167], a[164:167], v[52:55], v[164:167]
    v_exp_f32 v45, v45
    v_mfma_f32_16x16x32_bf16 v[168:171], a[168:171], v[52:55], v[168:171]
    v_exp_f32 v46, v46
    v_cvt_pk_bf16_f32 v38, v44, v45
    v_mfma_f32_16x16x32_bf16 v[172:175], a[172:175], v[52:55], v[172:175]
    v_exp_f32 v47, v47
    v_mfma_f32_16x16x32_bf16 v[176:179], a[176:179], v[52:55], v[176:179]
    v_cvt_pk_bf16_f32 v39, v46, v47
    s_nop 1
    v_smfmac_f32_16x16x64_bf16 a[208:211], a[228:231], v[48:55], v15
    v_smfmac_f32_16x16x64_bf16 a[212:215], a[228:231], v[64:71], v15
    v_smfmac_f32_16x16x64_bf16 a[208:211], a[236:239], v[16:23], v15
    v_smfmac_f32_16x16x64_bf16 a[212:215], a[236:239], v[32:39], v15
    s_waitcnt lgkmcnt(0)
    v_mfma_f32_16x16x32_bf16 v[128:131], a[64:67], v[16:19], v[128:131]
    v_mfma_f32_16x16x32_bf16 v[132:135], a[68:71], v[16:19], v[132:135]
    v_mfma_f32_16x16x32_bf16 v[136:139], a[72:75], v[16:19], v[136:139]
    v_mfma_f32_16x16x32_bf16 v[140:143], a[76:79], v[16:19], v[140:143]
    v_mfma_f32_16x16x32_bf16 v[144:147], a[80:83], v[16:19], v[144:147]
    v_mfma_f32_16x16x32_bf16 v[148:151], a[84:87], v[16:19], v[148:151]
    v_mfma_f32_16x16x32_bf16 v[152:155], a[88:91], v[16:19], v[152:155]
    v_mfma_f32_16x16x32_bf16 v[156:159], a[92:95], v[16:19], v[156:159]
    s_nop 3
    v_accvgpr_read_b32 v112, a208
    v_accvgpr_read_b32 v113, a210
    v_accvgpr_read_b32 v114, a212
    v_accvgpr_read_b32 v115, a214
    v_accvgpr_read_b32 v116, a209
    v_accvgpr_read_b32 v117, a211
    v_accvgpr_read_b32 v118, a213
    v_accvgpr_read_b32 v119, a215
    v_add_f32 v112, v112, v116
    v_add_f32 v113, v113, v117
    v_add_f32 v114, v114, v118
    v_add_f32 v115, v115, v119
    v_cmp_nge_f32 vcc, 0x44800000, v112
    v_rcp_f32 v120, v112
    s_nop 0
    s_mov_b64 s[84:85], vcc
    v_cmp_nge_f32 vcc, 0x44800000, v113
    v_rcp_f32 v121, v113
    s_nop 0
    s_or_b64 s[84:85], s[84:85], vcc
    v_cmp_nge_f32 vcc, 0x44800000, v114
    v_rcp_f32 v122, v114
    s_nop 0
    s_or_b64 s[84:85], s[84:85], vcc
    v_cmp_nge_f32 vcc, 0x44800000, v115
    v_rcp_f32 v123, v115
    s_nop 0
    s_or_b64 s[84:85], s[84:85], vcc
    s_mov_b32 s40, s34
    s_cbranch_scc1 L_el4_0
    v_mfma_f32_16x16x32_bf16 v[180:183], a[180:183], v[52:55], v[180:183]
    v_mul_f32 v128, v120, v128
    v_mul_f32 v129, v120, v129
    v_mul_f32 v130, v120, v130
    v_mfma_f32_16x16x32_bf16 v[184:187], a[184:187], v[52:55], v[184:187]
    v_mul_f32 v131, v120, v131
    v_mul_f32 v132, v120, v132
    v_mul_f32 v133, v120, v133
    v_mfma_f32_16x16x32_bf16 v[188:191], a[188:191], v[52:55], v[188:191]
    v_mul_f32 v134, v120, v134
    v_mul_f32 v135, v120, v135
    v_cvt_pk_bf16_f32 v128, v128, v129
    v_mfma_f32_16x16x32_bf16 v[160:163], a[64:67], v[20:23], v[160:163]
    v_cvt_pk_bf16_f32 v129, v130, v131
    v_mul_f32 v136, v120, v136
    v_mul_f32 v137, v120, v137
    v_mfma_f32_16x16x32_bf16 v[164:167], a[68:71], v[20:23], v[164:167]
    v_mul_f32 v138, v120, v138
    v_mul_f32 v139, v120, v139
    v_cvt_pk_bf16_f32 v132, v132, v133
    v_mfma_f32_16x16x32_bf16 v[168:171], a[72:75], v[20:23], v[168:171]
    v_cvt_pk_bf16_f32 v133, v134, v135
    ds_write_b64 v11, v[128:129] offset:0
    v_mul_f32 v140, v120, v140
    v_mfma_f32_16x16x32_bf16 v[172:175], a[76:79], v[20:23], v[172:175]
    v_mul_f32 v141, v120, v141
    v_mul_f32 v142, v120, v142
    v_mul_f32 v143, v120, v143
    v_mfma_f32_16x16x32_bf16 v[176:179], a[80:83], v[20:23], v[176:179]
    v_cvt_pk_bf16_f32 v136, v136, v137
    v_cvt_pk_bf16_f32 v137, v138, v139
    ds_write_b64 v11, v[132:133] offset:32
    v_mfma_f32_16x16x32_bf16 v[180:183], a[84:87], v[20:23], v[180:183]
    v_mul_f32 v144, v120, v144
    v_mul_f32 v145, v120, v145
    v_mul_f32 v146, v120, v146
    v_mfma_f32_16x16x32_bf16 v[184:187], a[88:91], v[20:23], v[184:187]
    v_mul_f32 v147, v120, v147
    v_cvt_pk_bf16_f32 v140, v140, v141
    v_cvt_pk_bf16_f32 v141, v142, v143
    v_mfma_f32_16x16x32_bf16 v[188:191], a[92:95], v[20:23], v[188:191]
    ds_write_b64 v11, v[136:137] offset:64
    v_mul_f32 v148, v120, v148
    v_mul_f32 v149, v120, v149
    v_mul_f32 v150, v120, v150
    v_mul_f32 v151, v120, v151
    v_cvt_pk_bf16_f32 v144, v144, v145
    v_cvt_pk_bf16_f32 v145, v146, v147
    ds_write_b64 v11, v[140:141] offset:96
    v_mul_f32 v152, v120, v152
    v_mul_f32 v153, v120, v153
    v_mul_f32 v154, v120, v154
    v_mul_f32 v155, v120, v155
    v_cvt_pk_bf16_f32 v148, v148, v149
    v_cvt_pk_bf16_f32 v149, v150, v151
    ds_write_b64 v11, v[144:145] offset:128
    v_mul_f32 v156, v120, v156
    v_mul_f32 v157, v120, v157
    v_mul_f32 v158, v120, v158
    v_mul_f32 v159, v120, v159
    v_cvt_pk_bf16_f32 v152, v152, v153
    v_cvt_pk_bf16_f32 v153, v154, v155
    ds_write_b64 v11, v[148:149] offset:160
    v_cvt_pk_bf16_f32 v156, v156, v157
    v_cvt_pk_bf16_f32 v157, v158, v159
    ds_write_b64 v11, v[152:153] offset:192
    ds_write_b64 v11, v[156:157] offset:224
    ds_read_b128 v[128:131], v12 offset:0
    ds_read_b128 v[132:135], v12 offset:1088
    ds_read_b128 v[136:139], v12 offset:2176
    ds_read_b128 v[140:143], v12 offset:3264
    v_mfma_f32_16x16x32_bf16 v[192:195], a[160:163], v[64:67], v[192:195]
    v_mul_f32 v160, v121, v160
    v_mul_f32 v161, v121, v161
    v_mul_f32 v162, v121, v162
    v_mfma_f32_16x16x32_bf16 v[196:199], a[164:167], v[64:67], v[196:199]
    v_mul_f32 v163, v121, v163
    v_mul_f32 v164, v121, v164
    v_mul_f32 v165, v121, v165
    v_mfma_f32_16x16x32_bf16 v[200:203], a[168:171], v[64:67], v[200:203]
    v_mul_f32 v166, v121, v166
    v_mul_f32 v167, v121, v167
    v_cvt_pk_bf16_f32 v160, v160, v161
    v_mfma_f32_16x16x32_bf16 v[204:207], a[172:175], v[64:67], v[204:207]
    v_cvt_pk_bf16_f32 v161, v162, v163
    v_mul_f32 v168, v121, v168
    v_mul_f32 v169, v121, v169
    v_mfma_f32_16x16x32_bf16 v[208:211], a[176:179], v[64:67], v[208:211]
    v_mul_f32 v170, v121, v170
    v_mul_f32 v171, v121, v171
    v_cvt_pk_bf16_f32 v164, v164, v165
    v_mfma_f32_16x16x32_bf16 v[212:215], a[180:183], v[64:67], v[212:215]
    v_cvt_pk_bf16_f32 v165, v166, v167
    ds_write_b64 v11, v[160:161] offset:4352
    s_waitcnt lgkmcnt(4)
    buffer_store_dwordx4 v[128:131], v13, s[16:19], s40 offen sc0 sc1
    s_add_u32 s40, s40, 16384
    v_mul_f32 v172, v121, v172
    v_mfma_f32_16x16x32_bf16 v[216:219], a[184:187], v[64:67], v[216:219]
    v_mul_f32 v173, v121, v173
    v_mul_f32 v174, v121, v174
    v_mul_f32 v175, v121, v175
    v_mfma_f32_16x16x32_bf16 v[220:223], a[188:191], v[64:67], v[220:223]
    v_cvt_pk_bf16_f32 v168, v168, v169
    v_cvt_pk_bf16_f32 v169, v170, v171
    ds_write_b64 v11, v[164:165] offset:4384
    v_mfma_f32_16x16x32_bf16 v[192:195], a[64:67], v[32:35], v[192:195]
    v_mul_f32 v176, v121, v176
    v_mul_f32 v177, v121, v177
    v_mul_f32 v178, v121, v178
    v_mfma_f32_16x16x32_bf16 v[196:199], a[68:71], v[32:35], v[196:199]
    v_mul_f32 v179, v121, v179
    v_cvt_pk_bf16_f32 v172, v172, v173
    v_cvt_pk_bf16_f32 v173, v174, v175
    v_mfma_f32_16x16x32_bf16 v[200:203], a[72:75], v[32:35], v[200:203]
    ds_write_b64 v11, v[168:169] offset:4416
    s_waitcnt lgkmcnt(5)
    buffer_store_dwordx4 v[132:135], v13, s[16:19], s40 offen sc0 sc1
    s_add_u32 s40, s40, 16384
    v_mul_f32 v180, v121, v180
    v_mul_f32 v181, v121, v181
    v_mfma_f32_16x16x32_bf16 v[204:207], a[76:79], v[32:35], v[204:207]
    v_mul_f32 v182, v121, v182
    v_mul_f32 v183, v121, v183
    v_cvt_pk_bf16_f32 v176, v176, v177
    v_mfma_f32_16x16x32_bf16 v[208:211], a[80:83], v[32:35], v[208:211]
    v_cvt_pk_bf16_f32 v177, v178, v179
    ds_write_b64 v11, v[172:173] offset:4448
    v_mul_f32 v184, v121, v184
    v_mfma_f32_16x16x32_bf16 v[212:215], a[84:87], v[32:35], v[212:215]
    v_mul_f32 v185, v121, v185
    v_mul_f32 v186, v121, v186
    v_mul_f32 v187, v121, v187
    v_mfma_f32_16x16x32_bf16 v[216:219], a[88:91], v[32:35], v[216:219]
    v_cvt_pk_bf16_f32 v180, v180, v181
    v_cvt_pk_bf16_f32 v181, v182, v183
    ds_write_b64 v11, v[176:177] offset:4480
    s_waitcnt lgkmcnt(6)
    buffer_store_dwordx4 v[136:139], v13, s[16:19], s40 offen sc0 sc1
    s_add_u32 s40, s40, 16384
    v_mfma_f32_16x16x32_bf16 v[220:223], a[92:95], v[32:35], v[220:223]
    v_mul_f32 v188, v121, v188
    v_mul_f32 v189, v121, v189
    v_mul_f32 v190, v121, v190
    v_mul_f32 v191, v121, v191
    v_cvt_pk_bf16_f32 v184, v184, v185
    v_cvt_pk_bf16_f32 v185, v186, v187
    ds_write_b64 v11, v[180:181] offset:4512
    v_cvt_pk_bf16_f32 v188, v188, v189
    v_cvt_pk_bf16_f32 v189, v190, v191
    ds_write_b64 v11, v[184:185] offset:4544
    s_waitcnt lgkmcnt(7)
    buffer_store_dwordx4 v[140:143], v13, s[16:19], s40 offen sc0 sc1
    s_add_u32 s40, s40, 16384
    ds_write_b64 v11, v[188:189] offset:4576
    ds_read_b128 v[160:163], v12 offset:4352
    ds_read_b128 v[164:167], v12 offset:5440
    ds_read_b128 v[168:171], v12 offset:6528
    ds_read_b128 v[172:175], v12 offset:7616
    v_mfma_f32_16x16x32_bf16 v[224:227], a[160:163], v[68:71], v[224:227]
    v_mul_f32 v192, v122, v192
    v_mul_f32 v193, v122, v193
    v_mul_f32 v194, v122, v194
    v_mfma_f32_16x16x32_bf16 v[228:231], a[164:167], v[68:71], v[228:231]
    v_mul_f32 v195, v122, v195
    v_mul_f32 v196, v122, v196
    v_mul_f32 v197, v122, v197
    v_mfma_f32_16x16x32_bf16 v[232:235], a[168:171], v[68:71], v[232:235]
    v_mul_f32 v198, v122, v198
    v_mul_f32 v199, v122, v199
    v_cvt_pk_bf16_f32 v192, v192, v193
    v_mfma_f32_16x16x32_bf16 v[236:239], a[172:175], v[68:71], v[236:239]
    v_cvt_pk_bf16_f32 v193, v194, v195
    v_mul_f32 v200, v122, v200
    v_mul_f32 v201, v122, v201
    v_mfma_f32_16x16x32_bf16 v[240:243], a[176:179], v[68:71], v[240:243]
    v_mul_f32 v202, v122, v202
    v_mul_f32 v203, v122, v203
    v_cvt_pk_bf16_f32 v196, v196, v197
    v_mfma_f32_16x16x32_bf16 v[244:247], a[180:183], v[68:71], v[244:247]
    v_cvt_pk_bf16_f32 v197, v198, v199
    ds_write_b64 v11, v[192:193] offset:8704
    s_waitcnt lgkmcnt(4)
    buffer_store_dwordx4 v[160:163], v13, s[16:19], s40 offen sc0 sc1
    s_add_u32 s40, s40, 16384
    v_mul_f32 v204, v122, v204
    v_mfma_f32_16x16x32_bf16 v[248:251], a[184:187], v[68:71], v[248:251]
    v_mul_f32 v205, v122, v205
    v_mul_f32 v206, v122, v206
    v_mul_f32 v207, v122, v207
    v_mfma_f32_16x16x32_bf16 v[252:255], a[188:191], v[68:71], v[252:255]
    v_cvt_pk_bf16_f32 v200, v200, v201
    v_cvt_pk_bf16_f32 v201, v202, v203
    ds_write_b64 v11, v[196:197] offset:8736
    v_mfma_f32_16x16x32_bf16 v[224:227], a[64:67], v[36:39], v[224:227]
    v_mul_f32 v208, v122, v208
    v_mul_f32 v209, v122, v209
    v_mul_f32 v210, v122, v210
    v_mfma_f32_16x16x32_bf16 v[228:231], a[68:71], v[36:39], v[228:231]
    v_mul_f32 v211, v122, v211
    v_cvt_pk_bf16_f32 v204, v204, v205
    v_cvt_pk_bf16_f32 v205, v206, v207
    v_mfma_f32_16x16x32_bf16 v[232:235], a[72:75], v[36:39], v[232:235]
    ds_write_b64 v11, v[200:201] offset:8768
    s_waitcnt lgkmcnt(5)
    buffer_store_dwordx4 v[164:167], v13, s[16:19], s40 offen sc0 sc1
    s_add_u32 s40, s40, 16384
    v_mul_f32 v212, v122, v212
    v_mul_f32 v213, v122, v213
    v_mfma_f32_16x16x32_bf16 v[236:239], a[76:79], v[36:39], v[236:239]
    v_mul_f32 v214, v122, v214
    v_mul_f32 v215, v122, v215
    v_cvt_pk_bf16_f32 v208, v208, v209
    v_mfma_f32_16x16x32_bf16 v[240:243], a[80:83], v[36:39], v[240:243]
    v_cvt_pk_bf16_f32 v209, v210, v211
    ds_write_b64 v11, v[204:205] offset:8800
    v_mul_f32 v216, v122, v216
    v_mfma_f32_16x16x32_bf16 v[244:247], a[84:87], v[36:39], v[244:247]
    v_mul_f32 v217, v122, v217
    v_mul_f32 v218, v122, v218
    v_mul_f32 v219, v122, v219
    v_mfma_f32_16x16x32_bf16 v[248:251], a[88:91], v[36:39], v[248:251]
    v_cvt_pk_bf16_f32 v212, v212, v213
    v_cvt_pk_bf16_f32 v213, v214, v215
    ds_write_b64 v11, v[208:209] offset:8832
    s_waitcnt lgkmcnt(6)
    buffer_store_dwordx4 v[168:171], v13, s[16:19], s40 offen sc0 sc1
    s_add_u32 s40, s40, 16384
    v_mfma_f32_16x16x32_bf16 v[252:255], a[92:95], v[36:39], v[252:255]
    v_mul_f32 v220, v122, v220
    v_mul_f32 v221, v122, v221
    v_mul_f32 v222, v122, v222
    v_mul_f32 v223, v122, v223
    v_cvt_pk_bf16_f32 v216, v216, v217
    v_cvt_pk_bf16_f32 v217, v218, v219
    ds_write_b64 v11, v[212:213] offset:8864
    v_cvt_pk_bf16_f32 v220, v220, v221
    v_cvt_pk_bf16_f32 v221, v222, v223
    ds_write_b64 v11, v[216:217] offset:8896
    s_waitcnt lgkmcnt(7)
    buffer_store_dwordx4 v[172:175], v13, s[16:19], s40 offen sc0 sc1
    s_add_u32 s40, s40, 16384
    ds_write_b64 v11, v[220:221] offset:8928
    ds_read_b128 v[192:195], v12 offset:8704
    ds_read_b128 v[196:199], v12 offset:9792
    ds_read_b128 v[200:203], v12 offset:10880
    ds_read_b128 v[204:207], v12 offset:11968
    v_mul_f32 v224, v123, v224
    v_mul_f32 v225, v123, v225
    v_mul_f32 v226, v123, v226
    v_mul_f32 v227, v123, v227
    v_mul_f32 v228, v123, v228
    v_mul_f32 v229, v123, v229
    v_mul_f32 v230, v123, v230
    v_mul_f32 v231, v123, v231
    v_cvt_pk_bf16_f32 v224, v224, v225
    v_cvt_pk_bf16_f32 v225, v226, v227
    v_mul_f32 v232, v123, v232
    v_mul_f32 v233, v123, v233
    v_mul_f32 v234, v123, v234
    v_mul_f32 v235, v123, v235
    v_cvt_pk_bf16_f32 v228, v228, v229
    v_cvt_pk_bf16_f32 v229, v230, v231
    ds_write_b64 v11, v[224:225] offset:13056
    s_waitcnt lgkmcnt(4)
    buffer_store_dwordx4 v[192:195], v13, s[16:19], s40 offen sc0 sc1
    s_add_u32 s40, s40, 16384
    v_mul_f32 v236, v123, v236
    v_mul_f32 v237, v123, v237
    v_mul_f32 v238, v123, v238
    v_mul_f32 v239, v123, v239
    v_cvt_pk_bf16_f32 v232, v232, v233
    v_cvt_pk_bf16_f32 v233, v234, v235
    ds_write_b64 v11, v[228:229] offset:13088
    v_mul_f32 v240, v123, v240
    v_mul_f32 v241, v123, v241
    v_mul_f32 v242, v123, v242
    v_mul_f32 v243, v123, v243
    v_cvt_pk_bf16_f32 v236, v236, v237
    v_cvt_pk_bf16_f32 v237, v238, v239
    ds_write_b64 v11, v[232:233] offset:13120
    s_waitcnt lgkmcnt(5)
    buffer_store_dwordx4 v[196:199], v13, s[16:19], s40 offen sc0 sc1
    s_add_u32 s40, s40, 16384
    v_mul_f32 v244, v123, v244
    v_mul_f32 v245, v123, v245
    v_mul_f32 v246, v123, v246
    v_mul_f32 v247, v123, v247
    v_cvt_pk_bf16_f32 v240, v240, v241
    v_cvt_pk_bf16_f32 v241, v242, v243
    ds_write_b64 v11, v[236:237] offset:13152
    v_mul_f32 v248, v123, v248
    v_mul_f32 v249, v123, v249
    v_mul_f32 v250, v123, v250
    v_mul_f32 v251, v123, v251
    v_cvt_pk_bf16_f32 v244, v244, v245
    v_cvt_pk_bf16_f32 v245, v246, v247
    ds_write_b64 v11, v[240:241] offset:13184
    s_waitcnt lgkmcnt(6)
    buffer_store_dwordx4 v[200:203], v13, s[16:19], s40 offen sc0 sc1
    s_add_u32 s40, s40, 16384
    v_mul_f32 v252, v123, v252
    v_mul_f32 v253, v123, v253
    v_mul_f32 v254, v123, v254
    v_mul_f32 v255, v123, v255
    v_cvt_pk_bf16_f32 v248, v248, v249
    v_cvt_pk_bf16_f32 v249, v250, v251
    ds_write_b64 v11, v[244:245] offset:13216
    v_cvt_pk_bf16_f32 v252, v252, v253
    v_cvt_pk_bf16_f32 v253, v254, v255
    ds_write_b64 v11, v[248:249] offset:13248
    s_waitcnt lgkmcnt(7)
    buffer_store_dwordx4 v[204:207], v13, s[16:19], s40 offen sc0 sc1
    s_add_u32 s40, s40, 16384
    ds_write_b64 v11, v[252:253] offset:13280
    ds_read_b128 v[224:227], v12 offset:13056
    ds_read_b128 v[228:231], v12 offset:14144
    ds_read_b128 v[232:235], v12 offset:15232
    ds_read_b128 v[236:239], v12 offset:16320
    s_waitcnt lgkmcnt(3)
    buffer_store_dwordx4 v[224:227], v13, s[16:19], s40 offen sc0 sc1
    s_add_u32 s40, s40, 16384
    s_waitcnt lgkmcnt(2)
    buffer_store_dwordx4 v[228:231], v13, s[16:19], s40 offen sc0 sc1
    s_add_u32 s40, s40, 16384
    s_waitcnt lgkmcnt(1)
    buffer_store_dwordx4 v[232:235], v13, s[16:19], s40 offen sc0 sc1
    s_add_u32 s40, s40, 16384
    s_waitcnt lgkmcnt(0)
    buffer_store_dwordx4 v[236:239], v13, s[16:19], s40 offen sc0 sc1
    s_add_u32 s40, s40, 16384
    s_endpgm
L_e4_3:
    s_mov_b32 s44, 3
    s_waitcnt vmcnt(4)
    s_barrier
L_e4_3_0:
    v_mfma_f32_16x16x32_bf16 v[48:51], a[128:131], a[0:3], v[80:83]
    ds_read_b64_tr_b16 a[160:161], v3 offset:52224
    v_exp_f32 v41, v41
    v_mfma_f32_16x16x32_bf16 v[48:51], a[132:135], a[4:7], v[48:51]
    ds_read_b64_tr_b16 a[162:163], v3 offset:52736
    v_exp_f32 v42, v42
    v_cvt_pk_bf16_f32 v36, v40, v41
    v_mfma_f32_16x16x32_bf16 v[48:51], a[136:139], a[8:11], v[48:51]
    ds_read_b64_tr_b16 a[164:165], v3 offset:52256
    v_exp_f32 v43, v43
    v_mfma_f32_16x16x32_bf16 v[48:51], a[140:143], a[12:15], v[48:51]
    ds_read_b64_tr_b16 a[166:167], v3 offset:52768
    v_exp_f32 v44, v44
    v_cvt_pk_bf16_f32 v37, v42, v43
    v_mfma_f32_16x16x32_bf16 v[52:55], a[144:147], a[0:3], v[80:83]
    ds_read_b64_tr_b16 a[168:169], v3 offset:52288
    v_exp_f32 v45, v45
    v_mfma_f32_16x16x32_bf16 v[52:55], a[148:151], a[4:7], v[52:55]
    ds_read_b64_tr_b16 a[170:171], v3 offset:52800
    v_exp_f32 v46, v46
    v_cvt_pk_bf16_f32 v38, v44, v45
    v_mfma_f32_16x16x32_bf16 v[52:55], a[152:155], a[8:11], v[52:55]
    ds_read_b64_tr_b16 a[172:173], v3 offset:52320
    v_exp_f32 v47, v47
    v_mfma_f32_16x16x32_bf16 v[52:55], a[156:159], a[12:15], v[52:55]
    ds_read_b64_tr_b16 a[174:175], v3 offset:52832
    v_cvt_pk_bf16_f32 v39, v46, v47
    v_mfma_f32_16x16x32_bf16 v[56:59], a[128:131], a[16:19], v[84:87]
    ds_read_b64_tr_b16 a[176:177], v3 offset:52352
    v_mfma_f32_16x16x32_bf16 v[56:59], a[132:135], a[20:23], v[56:59]
    ds_read_b64_tr_b16 a[178:179], v3 offset:52864
    v_mfma_f32_16x16x32_bf16 v[56:59], a[136:139], a[24:27], v[56:59]
    ds_read_b64_tr_b16 a[180:181], v3 offset:52384
    v_mfma_f32_16x16x32_bf16 v[56:59], a[140:143], a[28:31], v[56:59]
    ds_read_b64_tr_b16 a[182:183], v3 offset:52896
    v_mfma_f32_16x16x32_bf16 v[60:63], a[144:147], a[16:19], v[84:87]
    ds_read_b64_tr_b16 a[184:185], v3 offset:52416
    v_exp_f32 v48, v48
    v_mfma_f32_16x16x32_bf16 v[60:63], a[148:151], a[20:23], v[60:63]
    ds_read_b64_tr_b16 a[186:187], v3 offset:52928
    v_exp_f32 v49, v49
    v_mfma_f32_16x16x32_bf16 v[60:63], a[152:155], a[24:27], v[60:63]
    ds_read_b64_tr_b16 a[188:189], v3 offset:52448
    v_exp_f32 v50, v50
    v_cvt_pk_bf16_f32 v48, v48, v49
    v_mfma_f32_16x16x32_bf16 v[60:63], a[156:159], a[28:31], v[60:63]
    ds_read_b64_tr_b16 a[190:191], v3 offset:52960
    v_exp_f32 v51, v51
    v_mfma_f32_16x16x32_bf16 v[64:67], a[128:131], a[32:35], v[88:91]
    ds_read_b64_tr_b16 a[64:65], v3 offset:0
    v_exp_f32 v52, v52
    v_cvt_pk_bf16_f32 v49, v50, v51
    v_mfma_f32_16x16x32_bf16 v[64:67], a[132:135], a[36:39], v[64:67]
    ds_read_b64_tr_b16 a[66:67], v3 offset:512
    v_exp_f32 v53, v53
    v_mfma_f32_16x16x32_bf16 v[64:67], a[136:139], a[40:43], v[64:67]
    ds_read_b64_tr_b16 a[68:69], v3 offset:32
    v_exp_f32 v54, v54
    v_cvt_pk_bf16_f32 v50, v52, v53
    v_mfma_f32_16x16x32_bf16 v[64:67], a[140:143], a[44:47], v[64:67]
    ds_read_b64_tr_b16 a[70:71], v3 offset:544
    v_exp_f32 v55, v55
    v_mfma_f32_16x16x32_bf16 v[68:71], a[144:147], a[32:35], v[88:91]
    ds_read_b64_tr_b16 a[72:73], v3 offset:64
    v_exp_f32 v56, v56
    v_cvt_pk_bf16_f32 v51, v54, v55
    v_mfma_f32_16x16x32_bf16 v[68:71], a[148:151], a[36:39], v[68:71]
    ds_read_b64_tr_b16 a[74:75], v3 offset:576
    v_exp_f32 v57, v57
    v_mfma_f32_16x16x32_bf16 v[68:71], a[152:155], a[40:43], v[68:71]
    ds_read_b64_tr_b16 a[76:77], v3 offset:96
    v_exp_f32 v58, v58
    v_cvt_pk_bf16_f32 v52, v56, v57
    v_mfma_f32_16x16x32_bf16 v[68:71], a[156:159], a[44:47], v[68:71]
    ds_read_b64_tr_b16 a[78:79], v3 offset:608
    v_exp_f32 v59, v59
    v_mfma_f32_16x16x32_bf16 v[72:75], a[128:131], a[48:51], v[92:95]
    ds_read_b64_tr_b16 a[80:81], v3 offset:128
    v_exp_f32 v60, v60
    v_cvt_pk_bf16_f32 v53, v58, v59
    v_mfma_f32_16x16x32_bf16 v[72:75], a[132:135], a[52:55], v[72:75]
    ds_read_b64_tr_b16 a[82:83], v3 offset:640
    v_exp_f32 v61, v61
    v_mfma_f32_16x16x32_bf16 v[72:75], a[136:139], a[56:59], v[72:75]
    ds_read_b64_tr_b16 a[84:85], v3 offset:160
    v_exp_f32 v62, v62
    v_cvt_pk_bf16_f32 v54, v60, v61
    v_mfma_f32_16x16x32_bf16 v[72:75], a[140:143], a[60:63], v[72:75]
    ds_read_b64_tr_b16 a[86:87], v3 offset:672
    v_exp_f32 v63, v63
    v_mfma_f32_16x16x32_bf16 v[76:79], a[144:147], a[48:51], v[92:95]
    ds_read_b64_tr_b16 a[88:89], v3 offset:192
    v_exp_f32 v64, v64
    v_cvt_pk_bf16_f32 v55, v62, v63
    v_mfma_f32_16x16x32_bf16 v[76:79], a[148:151], a[52:55], v[76:79]
    ds_read_b64_tr_b16 a[90:91], v3 offset:704
    v_exp_f32 v65, v65
    v_mfma_f32_16x16x32_bf16 v[76:79], a[152:155], a[56:59], v[76:79]
    ds_read_b64_tr_b16 a[92:93], v3 offset:224
    v_exp_f32 v66, v66
    v_cvt_pk_bf16_f32 v64, v64, v65
    v_mfma_f32_16x16x32_bf16 v[76:79], a[156:159], a[60:63], v[76:79]
    ds_read_b64_tr_b16 a[94:95], v3 offset:736
    v_exp_f32 v67, v67
    s_waitcnt lgkmcnt(15)
    v_mfma_f32_16x16x32_bf16 v[128:131], a[160:163], v[16:19], v[128:131]
    v_exp_f32 v68, v68
    v_cvt_pk_bf16_f32 v65, v66, v67
    v_mfma_f32_16x16x32_bf16 v[132:135], a[164:167], v[16:19], v[132:135]
    v_exp_f32 v69, v69
    v_mfma_f32_16x16x32_bf16 v[136:139], a[168:171], v[16:19], v[136:139]
    v_exp_f32 v70, v70
    v_cvt_pk_bf16_f32 v66, v68, v69
    v_mfma_f32_16x16x32_bf16 v[140:143], a[172:175], v[16:19], v[140:143]
    v_exp_f32 v71, v71
    v_mfma_f32_16x16x32_bf16 v[144:147], a[176:179], v[16:19], v[144:147]
    v_exp_f32 v72, v72
    v_cvt_pk_bf16_f32 v67, v70, v71
    v_mfma_f32_16x16x32_bf16 v[148:151], a[180:183], v[16:19], v[148:151]
    v_exp_f32 v73, v73
    v_mfma_f32_16x16x32_bf16 v[152:155], a[184:187], v[16:19], v[152:155]
    v_exp_f32 v74, v74
    v_cvt_pk_bf16_f32 v68, v72, v73
    v_mfma_f32_16x16x32_bf16 v[156:159], a[188:191], v[16:19], v[156:159]
    v_exp_f32 v75, v75
    v_mfma_f32_16x16x32_bf16 v[160:163], a[160:163], v[20:23], v[160:163]
    v_exp_f32 v76, v76
    v_cvt_pk_bf16_f32 v69, v74, v75
    v_mfma_f32_16x16x32_bf16 v[164:167], a[164:167], v[20:23], v[164:167]
    v_exp_f32 v77, v77
    v_mfma_f32_16x16x32_bf16 v[168:171], a[168:171], v[20:23], v[168:171]
    v_exp_f32 v78, v78
    v_cvt_pk_bf16_f32 v70, v76, v77
    v_mfma_f32_16x16x32_bf16 v[172:175], a[172:175], v[20:23], v[172:175]
    v_exp_f32 v79, v79
    v_mfma_f32_16x16x32_bf16 v[176:179], a[176:179], v[20:23], v[176:179]
    v_cvt_pk_bf16_f32 v71, v78, v79
    s_nop 1
    v_smfmac_f32_16x16x64_bf16 a[208:211], a[228:231], v[16:23], v15
    v_smfmac_f32_16x16x64_bf16 a[212:215], a[228:231], v[32:39], v15
    v_smfmac_f32_16x16x64_bf16 a[208:211], a[236:239], v[48:55], v15
    v_smfmac_f32_16x16x64_bf16 a[212:215], a[236:239], v[64:71], v15
    s_waitcnt lgkmcnt(0)
    v_mfma_f32_16x16x32_bf16 v[128:131], a[64:67], v[48:51], v[128:131]
    v_mfma_f32_16x16x32_bf16 v[132:135], a[68:71], v[48:51], v[132:135]
    v_mfma_f32_16x16x32_bf16 v[136:139], a[72:75], v[48:51], v[136:139]
    v_mfma_f32_16x16x32_bf16 v[140:143], a[76:79], v[48:51], v[140:143]
    v_mfma_f32_16x16x32_bf16 v[144:147], a[80:83], v[48:51], v[144:147]
    v_mfma_f32_16x16x32_bf16 v[148:151], a[84:87], v[48:51], v[148:151]
    v_mfma_f32_16x16x32_bf16 v[152:155], a[88:91], v[48:51], v[152:155]
    v_mfma_f32_16x16x32_bf16 v[156:159], a[92:95], v[48:51], v[156:159]
    s_nop 3
    v_accvgpr_read_b32 v112, a208
    v_accvgpr_read_b32 v113, a210
    v_accvgpr_read_b32 v114, a212
    v_accvgpr_read_b32 v115, a214
    v_accvgpr_read_b32 v116, a209
    v_accvgpr_read_b32 v117, a211
    v_accvgpr_read_b32 v118, a213
    v_accvgpr_read_b32 v119, a215
    v_add_f32 v112, v112, v116
    v_add_f32 v113, v113, v117
    v_add_f32 v114, v114, v118
    v_add_f32 v115, v115, v119
    v_cmp_nge_f32 vcc, 0x44800000, v112
    v_rcp_f32 v120, v112
    s_nop 0
    s_mov_b64 s[84:85], vcc
    v_cmp_nge_f32 vcc, 0x44800000, v113
    v_rcp_f32 v121, v113
    s_nop 0
    s_or_b64 s[84:85], s[84:85], vcc
    v_cmp_nge_f32 vcc, 0x44800000, v114
    v_rcp_f32 v122, v114
    s_nop 0
    s_or_b64 s[84:85], s[84:85], vcc
    v_cmp_nge_f32 vcc, 0x44800000, v115
    v_rcp_f32 v123, v115
    s_nop 0
    s_or_b64 s[84:85], s[84:85], vcc
    s_mov_b32 s40, s34
    s_cbranch_scc1 L_el4_1
    v_mfma_f32_16x16x32_bf16 v[180:183], a[180:183], v[20:23], v[180:183]
    v_mul_f32 v128, v120, v128
    v_mul_f32 v129, v120, v129
    v_mul_f32 v130, v120, v130
    v_mfma_f32_16x16x32_bf16 v[184:187], a[184:187], v[20:23], v[184:187]
    v_mul_f32 v131, v120, v131
    v_mul_f32 v132, v120, v132
    v_mul_f32 v133, v120, v133
    v_mfma_f32_16x16x32_bf16 v[188:191], a[188:191], v[20:23], v[188:191]
    v_mul_f32 v134, v120, v134
    v_mul_f32 v135, v120, v135
    v_cvt_pk_bf16_f32 v128, v128, v129
    v_mfma_f32_16x16x32_bf16 v[160:163], a[64:67], v[52:55], v[160:163]
    v_cvt_pk_bf16_f32 v129, v130, v131
    v_mul_f32 v136, v120, v136
    v_mul_f32 v137, v120, v137
    v_mfma_f32_16x16x32_bf16 v[164:167], a[68:71], v[52:55], v[164:167]
    v_mul_f32 v138, v120, v138
    v_mul_f32 v139, v120, v139
    v_cvt_pk_bf16_f32 v132, v132, v133
    v_mfma_f32_16x16x32_bf16 v[168:171], a[72:75], v[52:55], v[168:171]
    v_cvt_pk_bf16_f32 v133, v134, v135
    ds_write_b64 v11, v[128:129] offset:0
    v_mul_f32 v140, v120, v140
    v_mfma_f32_16x16x32_bf16 v[172:175], a[76:79], v[52:55], v[172:175]
    v_mul_f32 v141, v120, v141
    v_mul_f32 v142, v120, v142
    v_mul_f32 v143, v120, v143
    v_mfma_f32_16x16x32_bf16 v[176:179], a[80:83], v[52:55], v[176:179]
    v_cvt_pk_bf16_f32 v136, v136, v137
    v_cvt_pk_bf16_f32 v137, v138, v139
    ds_write_b64 v11, v[132:133] offset:32
    v_mfma_f32_16x16x32_bf16 v[180:183], a[84:87], v[52:55], v[180:183]
    v_mul_f32 v144, v120, v144
    v_mul_f32 v145, v120, v145
    v_mul_f32 v146, v120, v146
    v_mfma_f32_16x16x32_bf16 v[184:187], a[88:91], v[52:55], v[184:187]
    v_mul_f32 v147, v120, v147
    v_cvt_pk_bf16_f32 v140, v140, v141
    v_cvt_pk_bf16_f32 v141, v142, v143
    v_mfma_f32_16x16x32_bf16 v[188:191], a[92:95], v[52:55], v[188:191]
    ds_write_b64 v11, v[136:137] offset:64
    v_mul_f32 v148, v120, v148
    v_mul_f32 v149, v120, v149
    v_mul_f32 v150, v120, v150
    v_mul_f32 v151, v120, v151
    v_cvt_pk_bf16_f32 v144, v144, v145
    v_cvt_pk_bf16_f32 v145, v146, v147
    ds_write_b64 v11, v[140:141] offset:96
    v_mul_f32 v152, v120, v152
    v_mul_f32 v153, v120, v153
    v_mul_f32 v154, v120, v154
    v_mul_f32 v155, v120, v155
    v_cvt_pk_bf16_f32 v148, v148, v149
    v_cvt_pk_bf16_f32 v149, v150, v151
    ds_write_b64 v11, v[144:145] offset:128
    v_mul_f32 v156, v120, v156
    v_mul_f32 v157, v120, v157
    v_mul_f32 v158, v120, v158
    v_mul_f32 v159, v120, v159
    v_cvt_pk_bf16_f32 v152, v152, v153
    v_cvt_pk_bf16_f32 v153, v154, v155
    ds_write_b64 v11, v[148:149] offset:160
    v_cvt_pk_bf16_f32 v156, v156, v157
    v_cvt_pk_bf16_f32 v157, v158, v159
    ds_write_b64 v11, v[152:153] offset:192
    ds_write_b64 v11, v[156:157] offset:224
    ds_read_b128 v[128:131], v12 offset:0
    ds_read_b128 v[132:135], v12 offset:1088
    ds_read_b128 v[136:139], v12 offset:2176
    ds_read_b128 v[140:143], v12 offset:3264
    v_mfma_f32_16x16x32_bf16 v[192:195], a[160:163], v[32:35], v[192:195]
    v_mul_f32 v160, v121, v160
    v_mul_f32 v161, v121, v161
    v_mul_f32 v162, v121, v162
    v_mfma_f32_16x16x32_bf16 v[196:199], a[164:167], v[32:35], v[196:199]
    v_mul_f32 v163, v121, v163
    v_mul_f32 v164, v121, v164
    v_mul_f32 v165, v121, v165
    v_mfma_f32_16x16x32_bf16 v[200:203], a[168:171], v[32:35], v[200:203]
    v_mul_f32 v166, v121, v166
    v_mul_f32 v167, v121, v167
    v_cvt_pk_bf16_f32 v160, v160, v161
    v_mfma_f32_16x16x32_bf16 v[204:207], a[172:175], v[32:35], v[204:207]
    v_cvt_pk_bf16_f32 v161, v162, v163
    v_mul_f32 v168, v121, v168
    v_mul_f32 v169, v121, v169
    v_mfma_f32_16x16x32_bf16 v[208:211], a[176:179], v[32:35], v[208:211]
    v_mul_f32 v170, v121, v170
    v_mul_f32 v171, v121, v171
    v_cvt_pk_bf16_f32 v164, v164, v165
    v_mfma_f32_16x16x32_bf16 v[212:215], a[180:183], v[32:35], v[212:215]
    v_cvt_pk_bf16_f32 v165, v166, v167
    ds_write_b64 v11, v[160:161] offset:4352
    s_waitcnt lgkmcnt(4)
    buffer_store_dwordx4 v[128:131], v13, s[16:19], s40 offen sc0 sc1
    s_add_u32 s40, s40, 16384
    v_mul_f32 v172, v121, v172
    v_mfma_f32_16x16x32_bf16 v[216:219], a[184:187], v[32:35], v[216:219]
    v_mul_f32 v173, v121, v173
    v_mul_f32 v174, v121, v174
    v_mul_f32 v175, v121, v175
    v_mfma_f32_16x16x32_bf16 v[220:223], a[188:191], v[32:35], v[220:223]
    v_cvt_pk_bf16_f32 v168, v168, v169
    v_cvt_pk_bf16_f32 v169, v170, v171
    ds_write_b64 v11, v[164:165] offset:4384
    v_mfma_f32_16x16x32_bf16 v[192:195], a[64:67], v[64:67], v[192:195]
    v_mul_f32 v176, v121, v176
    v_mul_f32 v177, v121, v177
    v_mul_f32 v178, v121, v178
    v_mfma_f32_16x16x32_bf16 v[196:199], a[68:71], v[64:67], v[196:199]
    v_mul_f32 v179, v121, v179
    v_cvt_pk_bf16_f32 v172, v172, v173
    v_cvt_pk_bf16_f32 v173, v174, v175
    v_mfma_f32_16x16x32_bf16 v[200:203], a[72:75], v[64:67], v[200:203]
    ds_write_b64 v11, v[168:169] offset:4416
    s_waitcnt lgkmcnt(5)
    buffer_store_dwordx4 v[132:135], v13, s[16:19], s40 offen sc0 sc1
    s_add_u32 s40, s40, 16384
    v_mul_f32 v180, v121, v180
    v_mul_f32 v181, v121, v181
    v_mfma_f32_16x16x32_bf16 v[204:207], a[76:79], v[64:67], v[204:207]
    v_mul_f32 v182, v121, v182
    v_mul_f32 v183, v121, v183
    v_cvt_pk_bf16_f32 v176, v176, v177
    v_mfma_f32_16x16x32_bf16 v[208:211], a[80:83], v[64:67], v[208:211]
    v_cvt_pk_bf16_f32 v177, v178, v179
    ds_write_b64 v11, v[172:173] offset:4448
    v_mul_f32 v184, v121, v184
    v_mfma_f32_16x16x32_bf16 v[212:215], a[84:87], v[64:67], v[212:215]
    v_mul_f32 v185, v121, v185
    v_mul_f32 v186, v121, v186
    v_mul_f32 v187, v121, v187
    v_mfma_f32_16x16x32_bf16 v[216:219], a[88:91], v[64:67], v[216:219]
    v_cvt_pk_bf16_f32 v180, v180, v181
    v_cvt_pk_bf16_f32 v181, v182, v183
    ds_write_b64 v11, v[176:177] offset:4480
    s_waitcnt lgkmcnt(6)
    buffer_store_dwordx4 v[136:139], v13, s[16:19], s40 offen sc0 sc1
    s_add_u32 s40, s40, 16384
    v_mfma_f32_16x16x32_bf16 v[220:223], a[92:95], v[64:67], v[220:223]
    v_mul_f32 v188, v121, v188
    v_mul_f32 v189, v121, v189
    v_mul_f32 v190, v121, v190
    v_mul_f32 v191, v121, v191
    v_cvt_pk_bf16_f32 v184, v184, v185
    v_cvt_pk_bf16_f32 v185, v186, v187
    ds_write_b64 v11, v[180:181] offset:4512
    v_cvt_pk_bf16_f32 v188, v188, v189
    v_cvt_pk_bf16_f32 v189, v190, v191
    ds_write_b64 v11, v[184:185] offset:4544
    s_waitcnt lgkmcnt(7)
    buffer_store_dwordx4 v[140:143], v13, s[16:19], s40 offen sc0 sc1
    s_add_u32 s40, s40, 16384
    ds_write_b64 v11, v[188:189] offset:4576
    ds_read_b128 v[160:163], v12 offset:4352
    ds_read_b128 v[164:167], v12 offset:5440
    ds_read_b128 v[168:171], v12 offset:6528
    ds_read_b128 v[172:175], v12 offset:7616
    v_mfma_f32_16x16x32_bf16 v[224:227], a[160:163], v[36:39], v[224:227]
    v_mul_f32 v192, v122, v192
    v_mul_f32 v193, v122, v193
    v_mul_f32 v194, v122, v194
    v_mfma_f32_16x16x32_bf16 v[228:231], a[164:167], v[36:39], v[228:231]
    v_mul_f32 v195, v122, v195
    v_mul_f32 v196, v122, v196
    v_mul_f32 v197, v122, v197
    v_mfma_f32_16x16x32_bf16 v[232:235], a[168:171], v[36:39], v[232:235]
    v_mul_f32 v198, v122, v198
    v_mul_f32 v199, v122, v199
    v_cvt_pk_bf16_f32 v192, v192, v193
    v_mfma_f32_16x16x32_bf16 v[236:239], a[172:175], v[36:39], v[236:239]
    v_cvt_pk_bf16_f32 v193, v194, v195
    v_mul_f32 v200, v122, v200
    v_mul_f32 v201, v122, v201
    v_mfma_f32_16x16x32_bf16 v[240:243], a[176:179], v[36:39], v[240:243]
    v_mul_f32 v202, v122, v202
    v_mul_f32 v203, v122, v203
    v_cvt_pk_bf16_f32 v196, v196, v197
    v_mfma_f32_16x16x32_bf16 v[244:247], a[180:183], v[36:39], v[244:247]
    v_cvt_pk_bf16_f32 v197, v198, v199
    ds_write_b64 v11, v[192:193] offset:8704
    s_waitcnt lgkmcnt(4)
    buffer_store_dwordx4 v[160:163], v13, s[16:19], s40 offen sc0 sc1
    s_add_u32 s40, s40, 16384
    v_mul_f32 v204, v122, v204
    v_mfma_f32_16x16x32_bf16 v[248:251], a[184:187], v[36:39], v[248:251]
    v_mul_f32 v205, v122, v205
    v_mul_f32 v206, v122, v206
    v_mul_f32 v207, v122, v207
    v_mfma_f32_16x16x32_bf16 v[252:255], a[188:191], v[36:39], v[252:255]
    v_cvt_pk_bf16_f32 v200, v200, v201
    v_cvt_pk_bf16_f32 v201, v202, v203
    ds_write_b64 v11, v[196:197] offset:8736
    v_mfma_f32_16x16x32_bf16 v[224:227], a[64:67], v[68:71], v[224:227]
    v_mul_f32 v208, v122, v208
    v_mul_f32 v209, v122, v209
    v_mul_f32 v210, v122, v210
    v_mfma_f32_16x16x32_bf16 v[228:231], a[68:71], v[68:71], v[228:231]
    v_mul_f32 v211, v122, v211
    v_cvt_pk_bf16_f32 v204, v204, v205
    v_cvt_pk_bf16_f32 v205, v206, v207
    v_mfma_f32_16x16x32_bf16 v[232:235], a[72:75], v[68:71], v[232:235]
    ds_write_b64 v11, v[200:201] offset:8768
    s_waitcnt lgkmcnt(5)
    buffer_store_dwordx4 v[164:167], v13, s[16:19], s40 offen sc0 sc1
    s_add_u32 s40, s40, 16384
    v_mul_f32 v212, v122, v212
    v_mul_f32 v213, v122, v213
    v_mfma_f32_16x16x32_bf16 v[236:239], a[76:79], v[68:71], v[236:239]
    v_mul_f32 v214, v122, v214
    v_mul_f32 v215, v122, v215
    v_cvt_pk_bf16_f32 v208, v208, v209
    v_mfma_f32_16x16x32_bf16 v[240:243], a[80:83], v[68:71], v[240:243]
    v_cvt_pk_bf16_f32 v209, v210, v211
    ds_write_b64 v11, v[204:205] offset:8800
    v_mul_f32 v216, v122, v216
    v_mfma_f32_16x16x32_bf16 v[244:247], a[84:87], v[68:71], v[244:247]
    v_mul_f32 v217, v122, v217
    v_mul_f32 v218, v122, v218
    v_mul_f32 v219, v122, v219
    v_mfma_f32_16x16x32_bf16 v[248:251], a[88:91], v[68:71], v[248:251]
    v_cvt_pk_bf16_f32 v212, v212, v213
    v_cvt_pk_bf16_f32 v213, v214, v215
    ds_write_b64 v11, v[208:209] offset:8832
    s_waitcnt lgkmcnt(6)
    buffer_store_dwordx4 v[168:171], v13, s[16:19], s40 offen sc0 sc1
    s_add_u32 s40, s40, 16384
    v_mfma_f32_16x16x32_bf16 v[252:255], a[92:95], v[68:71], v[252:255]
    v_mul_f32 v220, v122, v220
    v_mul_f32 v221, v122, v221
    v_mul_f32 v222, v122, v222
    v_mul_f32 v223, v122, v223
    v_cvt_pk_bf16_f32 v216, v216, v217
    v_cvt_pk_bf16_f32 v217, v218, v219
    ds_write_b64 v11, v[212:213] offset:8864
    v_cvt_pk_bf16_f32 v220, v220, v221
    v_cvt_pk_bf16_f32 v221, v222, v223
    ds_write_b64 v11, v[216:217] offset:8896
    s_waitcnt lgkmcnt(7)
    buffer_store_dwordx4 v[172:175], v13, s[16:19], s40 offen sc0 sc1
    s_add_u32 s40, s40, 16384
    ds_write_b64 v11, v[220:221] offset:8928
    ds_read_b128 v[192:195], v12 offset:8704
    ds_read_b128 v[196:199], v12 offset:9792
    ds_read_b128 v[200:203], v12 offset:10880
    ds_read_b128 v[204:207], v12 offset:11968
    v_mul_f32 v224, v123, v224
    v_mul_f32 v225, v123, v225
    v_mul_f32 v226, v123, v226
    v_mul_f32 v227, v123, v227
    v_mul_f32 v228, v123, v228
    v_mul_f32 v229, v123, v229
    v_mul_f32 v230, v123, v230
    v_mul_f32 v231, v123, v231
    v_cvt_pk_bf16_f32 v224, v224, v225
    v_cvt_pk_bf16_f32 v225, v226, v227
    v_mul_f32 v232, v123, v232
    v_mul_f32 v233, v123, v233
    v_mul_f32 v234, v123, v234
    v_mul_f32 v235, v123, v235
    v_cvt_pk_bf16_f32 v228, v228, v229
    v_cvt_pk_bf16_f32 v229, v230, v231
    ds_write_b64 v11, v[224:225] offset:13056
    s_waitcnt lgkmcnt(4)
    buffer_store_dwordx4 v[192:195], v13, s[16:19], s40 offen sc0 sc1
    s_add_u32 s40, s40, 16384
    v_mul_f32 v236, v123, v236
    v_mul_f32 v237, v123, v237
    v_mul_f32 v238, v123, v238
    v_mul_f32 v239, v123, v239
    v_cvt_pk_bf16_f32 v232, v232, v233
    v_cvt_pk_bf16_f32 v233, v234, v235
    ds_write_b64 v11, v[228:229] offset:13088
    v_mul_f32 v240, v123, v240
    v_mul_f32 v241, v123, v241
    v_mul_f32 v242, v123, v242
    v_mul_f32 v243, v123, v243
    v_cvt_pk_bf16_f32 v236, v236, v237
    v_cvt_pk_bf16_f32 v237, v238, v239
    ds_write_b64 v11, v[232:233] offset:13120
    s_waitcnt lgkmcnt(5)
    buffer_store_dwordx4 v[196:199], v13, s[16:19], s40 offen sc0 sc1
    s_add_u32 s40, s40, 16384
    v_mul_f32 v244, v123, v244
    v_mul_f32 v245, v123, v245
    v_mul_f32 v246, v123, v246
    v_mul_f32 v247, v123, v247
    v_cvt_pk_bf16_f32 v240, v240, v241
    v_cvt_pk_bf16_f32 v241, v242, v243
    ds_write_b64 v11, v[236:237] offset:13152
    v_mul_f32 v248, v123, v248
    v_mul_f32 v249, v123, v249
    v_mul_f32 v250, v123, v250
    v_mul_f32 v251, v123, v251
    v_cvt_pk_bf16_f32 v244, v244, v245
    v_cvt_pk_bf16_f32 v245, v246, v247
    ds_write_b64 v11, v[240:241] offset:13184
    s_waitcnt lgkmcnt(6)
    buffer_store_dwordx4 v[200:203], v13, s[16:19], s40 offen sc0 sc1
    s_add_u32 s40, s40, 16384
    v_mul_f32 v252, v123, v252
    v_mul_f32 v253, v123, v253
    v_mul_f32 v254, v123, v254
    v_mul_f32 v255, v123, v255
    v_cvt_pk_bf16_f32 v248, v248, v249
    v_cvt_pk_bf16_f32 v249, v250, v251
    ds_write_b64 v11, v[244:245] offset:13216
    v_cvt_pk_bf16_f32 v252, v252, v253
    v_cvt_pk_bf16_f32 v253, v254, v255
    ds_write_b64 v11, v[248:249] offset:13248
    s_waitcnt lgkmcnt(7)
    buffer_store_dwordx4 v[204:207], v13, s[16:19], s40 offen sc0 sc1
    s_add_u32 s40, s40, 16384
    ds_write_b64 v11, v[252:253] offset:13280
    ds_read_b128 v[224:227], v12 offset:13056
    ds_read_b128 v[228:231], v12 offset:14144
    ds_read_b128 v[232:235], v12 offset:15232
    ds_read_b128 v[236:239], v12 offset:16320
    s_waitcnt lgkmcnt(3)
    buffer_store_dwordx4 v[224:227], v13, s[16:19], s40 offen sc0 sc1
    s_add_u32 s40, s40, 16384
    s_waitcnt lgkmcnt(2)
    buffer_store_dwordx4 v[228:231], v13, s[16:19], s40 offen sc0 sc1
    s_add_u32 s40, s40, 16384
    s_waitcnt lgkmcnt(1)
    buffer_store_dwordx4 v[232:235], v13, s[16:19], s40 offen sc0 sc1
    s_add_u32 s40, s40, 16384
    s_waitcnt lgkmcnt(0)
    buffer_store_dwordx4 v[236:239], v13, s[16:19], s40 offen sc0 sc1
    s_add_u32 s40, s40, 16384
    s_endpgm
L_e4x_3:
    s_mov_b32 s44, 3
    s_barrier
L_e4_3_3:
    v_smfmac_f32_16x16x64_bf16 a[208:211], a[236:239], v[16:23], v15
    ds_read_b64_tr_b16 a[160:161], v3 offset:52224
    v_exp_f32 v41, v41
    ds_read_b64_tr_b16 a[162:163], v3 offset:52736
    v_exp_f32 v42, v42
    ds_read_b64_tr_b16 a[164:165], v3 offset:52256
    v_cvt_pk_bf16_f32 v36, v40, v41
    ds_read_b64_tr_b16 a[166:167], v3 offset:52768
    v_exp_f32 v43, v43
    ds_read_b64_tr_b16 a[168:169], v3 offset:52288
    v_exp_f32 v44, v44
    ds_read_b64_tr_b16 a[170:171], v3 offset:52800
    v_cvt_pk_bf16_f32 v37, v42, v43
    ds_read_b64_tr_b16 a[172:173], v3 offset:52320
    v_exp_f32 v45, v45
    ds_read_b64_tr_b16 a[174:175], v3 offset:52832
    v_exp_f32 v46, v46
    ds_read_b64_tr_b16 a[176:177], v3 offset:52352
    v_cvt_pk_bf16_f32 v38, v44, v45
    ds_read_b64_tr_b16 a[178:179], v3 offset:52864
    v_exp_f32 v47, v47
    ds_read_b64_tr_b16 a[180:181], v3 offset:52384
    s_nop 0
    ds_read_b64_tr_b16 a[182:183], v3 offset:52896
    v_cvt_pk_bf16_f32 v39, v46, v47
    ds_read_b64_tr_b16 a[184:185], v3 offset:52416
    ds_read_b64_tr_b16 a[186:187], v3 offset:52928
    ds_read_b64_tr_b16 a[188:189], v3 offset:52448
    ds_read_b64_tr_b16 a[190:191], v3 offset:52960
    s_nop 1
    v_smfmac_f32_16x16x64_bf16 a[212:215], a[236:239], v[32:39], v15
    s_waitcnt lgkmcnt(8)
    v_mfma_f32_16x16x32_bf16 v[128:131], a[160:163], v[16:19], v[128:131]
    s_add_u32 m0, s30, 34816
    v_mfma_f32_16x16x32_bf16 v[132:135], a[164:167], v[16:19], v[132:135]
    buffer_load_dwordx4 v4, s[8:11], s28 offen lds
    v_mfma_f32_16x16x32_bf16 v[136:139], a[168:171], v[16:19], v[136:139]
    s_add_u32 m0, s30, 39040
    v_mfma_f32_16x16x32_bf16 v[140:143], a[172:175], v[16:19], v[140:143]
    buffer_load_dwordx4 v5, s[8:11], s28 offen lds
    s_waitcnt lgkmcnt(0)
    v_mfma_f32_16x16x32_bf16 v[144:147], a[176:179], v[16:19], v[144:147]
    s_add_u32 m0, s30, 43520
    ds_read_b128 a[64:67], v9 offset:0
    ds_read_b128 a[68:71], v9 offset:64
    ds_read_b128 a[72:75], v10 offset:0
    v_mfma_f32_16x16x32_bf16 v[148:151], a[180:183], v[16:19], v[148:151]
    buffer_load_dwordx4 v6, s[12:15], s29 offen lds
    ds_read_b128 a[76:79], v10 offset:64
    ds_read_b128 a[80:83], v9 offset:4224
    ds_read_b128 a[84:87], v9 offset:4288
    v_mfma_f32_16x16x32_bf16 v[152:155], a[184:187], v[16:19], v[152:155]
    s_add_u32 m0, s30, 47744
    ds_read_b128 a[88:91], v10 offset:4224
    ds_read_b128 a[92:95], v10 offset:4288
    ds_read_b128 a[96:99], v9 offset:8448
    v_mfma_f32_16x16x32_bf16 v[156:159], a[188:191], v[16:19], v[156:159]
    buffer_load_dwordx4 v7, s[12:15], s29 offen lds
    ds_read_b128 a[100:103], v9 offset:8512
    ds_read_b128 a[104:107], v10 offset:8448
    ds_read_b128 a[108:111], v10 offset:8512
    s_add_u32 s28, s28, s101
    s_add_u32 s29, s29, s101
    v_accvgpr_read_b32 v112, a208
    v_accvgpr_read_b32 v113, a210
    v_accvgpr_read_b32 v114, a212
    v_accvgpr_read_b32 v115, a214
    v_accvgpr_read_b32 v116, a209
    v_accvgpr_read_b32 v117, a211
    v_accvgpr_read_b32 v118, a213
    v_accvgpr_read_b32 v119, a215
    v_add_f32 v112, v112, v116
    v_add_f32 v113, v113, v117
    v_add_f32 v114, v114, v118
    v_add_f32 v115, v115, v119
    v_cmp_nge_f32 vcc, 0x44800000, v112
    v_rcp_f32 v120, v112
    s_nop 0
    s_mov_b64 s[84:85], vcc
    v_cmp_nge_f32 vcc, 0x44800000, v113
    v_rcp_f32 v121, v113
    s_nop 0
    s_or_b64 s[84:85], s[84:85], vcc
    v_cmp_nge_f32 vcc, 0x44800000, v114
    v_rcp_f32 v122, v114
    s_nop 0
    s_or_b64 s[84:85], s[84:85], vcc
    v_cmp_nge_f32 vcc, 0x44800000, v115
    v_rcp_f32 v123, v115
    s_nop 0
    s_or_b64 s[84:85], s[84:85], vcc
    s_mov_b32 s40, s34
    s_cbranch_scc1 L_es4_1
    s_waitcnt vmcnt(8) lgkmcnt(0)
    v_mfma_f32_16x16x32_bf16 v[160:163], a[160:163], v[20:23], v[160:163]
    v_mul_f32 v128, v120, v128
    v_mul_f32 v129, v120, v129
    v_mul_f32 v130, v120, v130
    v_mul_f32 v131, v120, v131
    v_mfma_f32_16x16x32_bf16 v[164:167], a[164:167], v[20:23], v[164:167]
    v_mul_f32 v132, v120, v132
    v_mul_f32 v133, v120, v133
    v_mul_f32 v134, v120, v134
    v_mul_f32 v135, v120, v135
    v_mfma_f32_16x16x32_bf16 v[168:171], a[168:171], v[20:23], v[168:171]
    v_cvt_pk_bf16_f32 v128, v128, v129
    v_cvt_pk_bf16_f32 v129, v130, v131
    v_mul_f32 v136, v120, v136
    v_mul_f32 v137, v120, v137
    v_mfma_f32_16x16x32_bf16 v[172:175], a[172:175], v[20:23], v[172:175]
    v_mul_f32 v138, v120, v138
    v_mul_f32 v139, v120, v139
    v_cvt_pk_bf16_f32 v132, v132, v133
    v_cvt_pk_bf16_f32 v133, v134, v135
    v_mfma_f32_16x16x32_bf16 v[176:179], a[176:179], v[20:23], v[176:179]
    ds_write_b64 v11, v[128:129] offset:0
    v_mul_f32 v140, v120, v140
    v_mul_f32 v141, v120, v141
    v_mul_f32 v142, v120, v142
    v_mfma_f32_16x16x32_bf16 v[180:183], a[180:183], v[20:23], v[180:183]
    v_mul_f32 v143, v120, v143
    v_cvt_pk_bf16_f32 v136, v136, v137
    v_cvt_pk_bf16_f32 v137, v138, v139
    ds_write_b64 v11, v[132:133] offset:32
    v_mfma_f32_16x16x32_bf16 v[184:187], a[184:187], v[20:23], v[184:187]
    v_mul_f32 v144, v120, v144
    v_mul_f32 v145, v120, v145
    v_mul_f32 v146, v120, v146
    v_mul_f32 v147, v120, v147
    v_mfma_f32_16x16x32_bf16 v[188:191], a[188:191], v[20:23], v[188:191]
    v_cvt_pk_bf16_f32 v140, v140, v141
    v_cvt_pk_bf16_f32 v141, v142, v143
    ds_write_b64 v11, v[136:137] offset:64
    v_mul_f32 v148, v120, v148
    v_mul_f32 v149, v120, v149
    v_mul_f32 v150, v120, v150
    v_mul_f32 v151, v120, v151
    v_cvt_pk_bf16_f32 v144, v144, v145
    v_cvt_pk_bf16_f32 v145, v146, v147
    ds_write_b64 v11, v[140:141] offset:96
    v_mul_f32 v152, v120, v152
    v_mul_f32 v153, v120, v153
    v_mul_f32 v154, v120, v154
    v_mul_f32 v155, v120, v155
    v_cvt_pk_bf16_f32 v148, v148, v149
    v_cvt_pk_bf16_f32 v149, v150, v151
    ds_write_b64 v11, v[144:145] offset:128
    v_mul_f32 v156, v120, v156
    v_mul_f32 v157, v120, v157
    v_mul_f32 v158, v120, v158
    v_mul_f32 v159, v120, v159
    v_cvt_pk_bf16_f32 v152, v152, v153
    v_cvt_pk_bf16_f32 v153, v154, v155
    ds_write_b64 v11, v[148:149] offset:160
    v_cvt_pk_bf16_f32 v156, v156, v157
    v_cvt_pk_bf16_f32 v157, v158, v159
    ds_write_b64 v11, v[152:153] offset:192
    ds_write_b64 v11, v[156:157] offset:224
    ds_read_b128 v[128:131], v12 offset:0
    ds_read_b128 v[132:135], v12 offset:1088
    ds_read_b128 v[136:139], v12 offset:2176
    ds_read_b128 v[140:143], v12 offset:3264
    v_mfma_f32_16x16x32_bf16 v[192:195], a[160:163], v[32:35], v[192:195]
    v_mul_f32 v160, v121, v160
    v_mfma_f32_32x32x16_bf16 v[96:111], a[192:195], a[64:67], 0
    v_mul_f32 v161, v121, v161
    v_mul_f32 v162, v121, v162
    s_mov_b32 s80, s81
    s_mov_b32 s81, 0
    s_add_u32 s47, s47, 1
    v_mul_f32 v163, v121, v163
    v_mfma_f32_16x16x32_bf16 v[196:199], a[164:167], v[32:35], v[196:199]
    s_mov_b32 s42, s89
    s_mov_b32 s43, s90
    v_mul_f32 v164, v121, v164
    v_mul_f32 v165, v121, v165
    v_mfma_f32_32x32x16_bf16 v[96:111], a[196:199], a[68:71], v[96:111]
    v_mul_f32 v166, v121, v166
    s_mov_b32 s34, s91
    s_mov_b32 s88, s93
    s_bfe_u32 s37, s80, 0xa000d
    v_mul_f32 v167, v121, v167
    v_mfma_f32_16x16x32_bf16 v[200:203], a[168:171], v[32:35], v[200:203]
    s_add_u32 s36, s37, 31
    s_lshr_b32 s36, s36, 5
    v_cvt_pk_bf16_f32 v160, v160, v161
    v_cvt_pk_bf16_f32 v161, v162, v163
    v_mfma_f32_32x32x16_bf16 v[96:111], a[200:203], a[64:67], v[96:111]
    v_mul_f32 v168, v121, v168
    v_mul_f32 v169, v121, v169
    s_sub_u32 s31, s36, 1
    s_lshl_b32 s39, s31, 5
    s_sub_u32 s35, s37, s39
    v_mfma_f32_16x16x32_bf16 v[204:207], a[172:175], v[32:35], v[204:207]
    v_mul_f32 v170, v121, v170
    s_mov_b32 s46, 0
    s_mov_b32 s99, s33
    v_mul_f32 v171, v121, v171
    v_mfma_f32_32x32x16_bf16 v[96:111], a[204:207], a[68:71], v[96:111]
    v_cvt_pk_bf16_f32 v164, v164, v165
    v_cvt_pk_bf16_f32 v165, v166, v167
    s_sub_u32 s31, s31, 1
    s_mov_b32 s32, 4
    s_mov_b32 s93, 0
    v_mfma_f32_16x16x32_bf16 v[208:211], a[176:179], v[32:35], v[208:211]
    ds_write_b64 v11, v[160:161] offset:4352
    s_mov_b32 s90, 0
    s_waitcnt lgkmcnt(4)
    buffer_store_dwordx4 v[128:131], v13, s[16:19], s40 offen sc0 sc1
    v_mfma_f32_32x32x16_bf16 v[144:159], a[192:195], a[72:75], 0
    s_add_u32 s40, s40, 16384
    v_accvgpr_mov_b32 a232, a240
    v_accvgpr_mov_b32 a233, a241
    v_mul_f32 v172, v121, v172
    v_mul_f32 v173, v121, v173
    v_mfma_f32_32x32x16_bf16 v[144:159], a[196:199], a[76:79], v[144:159]
    v_mul_f32 v174, v121, v174
    v_mfma_f32_16x16x32_bf16 v[212:215], a[180:183], v[32:35], v[212:215]
    v_accvgpr_mov_b32 a234, a242
    v_accvgpr_mov_b32 a235, a243
    v_mul_f32 v175, v121, v175
    v_cvt_pk_bf16_f32 v168, v168, v169
    v_mfma_f32_32x32x16_bf16 v[144:159], a[200:203], a[72:75], v[144:159]
    v_cvt_pk_bf16_f32 v169, v170, v171
    ds_write_b64 v11, v[164:165] offset:4384
    v_accvgpr_mov_b32 a236, a244
    v_accvgpr_mov_b32 a237, a245
    v_mfma_f32_16x16x32_bf16 v[216:219], a[184:187], v[32:35], v[216:219]
    v_mfma_f32_32x32x16_bf16 v[144:159], a[204:207], a[76:79], v[144:159]
    v_mul_f32 v176, v121, v176
    v_mul_f32 v177, v121, v177
    v_accvgpr_mov_b32 a238, a246
    v_accvgpr_mov_b32 a239, a247
    v_mul_f32 v178, v121, v178
    v_mul_f32 v179, v121, v179
    v_mfma_f32_32x32x16_bf16 a[208:223], v[124:127], v[124:127], 0
    v_mfma_f32_16x16x32_bf16 v[220:223], a[188:191], v[32:35], v[220:223]
    v_cvt_pk_bf16_f32 v172, v172, v173
    v_cvt_pk_bf16_f32 v96, v96, v97
    v_cvt_pk_bf16_f32 v97, v98, v99
    v_cvt_pk_bf16_f32 v98, v100, v101
    v_cvt_pk_bf16_f32 v173, v174, v175
    ds_write_b64 v11, v[168:169] offset:4416
    v_cvt_pk_bf16_f32 v99, v102, v103
    v_cvt_pk_bf16_f32 v100, v104, v105
    v_cvt_pk_bf16_f32 v101, v106, v107
    s_waitcnt lgkmcnt(5)
    buffer_store_dwordx4 v[132:135], v13, s[16:19], s40 offen sc0 sc1
    v_cvt_pk_bf16_f32 v102, v108, v109
    v_cvt_pk_bf16_f32 v103, v110, v111
    v_accvgpr_write_b32 a0, v96
    s_add_u32 s40, s40, 16384
    v_accvgpr_write_b32 a1, v97
    v_accvgpr_write_b32 a2, v98
    v_accvgpr_write_b32 a3, v99
    v_mul_f32 v180, v121, v180
    v_mul_f32 v181, v121, v181
    v_accvgpr_write_b32 a4, v100
    v_accvgpr_write_b32 a5, v101
    v_accvgpr_write_b32 a6, v102
    v_mul_f32 v182, v121, v182
    v_mul_f32 v183, v121, v183
    v_accvgpr_write_b32 a7, v103
    v_cvt_pk_bf16_f32 v176, v176, v177
    v_mfma_f32_32x32x16_bf16 v[96:111], a[192:195], a[80:83], 0
    v_cvt_pk_bf16_f32 v177, v178, v179
    ds_write_b64 v11, v[172:173] offset:4448
    v_cvt_pk_bf16_f32 v144, v144, v145
    v_cvt_pk_bf16_f32 v145, v146, v147
    v_cvt_pk_bf16_f32 v146, v148, v149
    v_mul_f32 v184, v121, v184
    v_mul_f32 v185, v121, v185
    v_cvt_pk_bf16_f32 v147, v150, v151
    v_mul_f32 v186, v121, v186
    v_mul_f32 v187, v121, v187
    v_mfma_f32_32x32x16_bf16 v[96:111], a[196:199], a[84:87], v[96:111]
    v_cvt_pk_bf16_f32 v180, v180, v181
    v_cvt_pk_bf16_f32 v181, v182, v183
    v_cvt_pk_bf16_f32 v148, v152, v153
    v_cvt_pk_bf16_f32 v149, v154, v155
    v_cvt_pk_bf16_f32 v150, v156, v157
    ds_write_b64 v11, v[176:177] offset:4480
    v_cvt_pk_bf16_f32 v151, v158, v159
    s_waitcnt lgkmcnt(6)
    buffer_store_dwordx4 v[136:139], v13, s[16:19], s40 offen sc0 sc1
    v_mfma_f32_32x32x16_bf16 v[96:111], a[200:203], a[80:83], v[96:111]
    s_add_u32 s40, s40, 16384
    v_mul_f32 v188, v121, v188
    v_accvgpr_write_b32 a8, v144
    v_accvgpr_write_b32 a9, v145
    v_accvgpr_write_b32 a10, v146
    v_mul_f32 v189, v121, v189
    v_mul_f32 v190, v121, v190
    v_accvgpr_write_b32 a11, v147
    v_mul_f32 v191, v121, v191
    v_cvt_pk_bf16_f32 v184, v184, v185
    v_mfma_f32_32x32x16_bf16 v[96:111], a[204:207], a[84:87], v[96:111]
    v_cvt_pk_bf16_f32 v185, v186, v187
    v_accvgpr_write_b32 a12, v148
    v_accvgpr_write_b32 a13, v149
    v_accvgpr_write_b32 a14, v150
    ds_write_b64 v11, v[180:181] offset:4512
    v_cvt_pk_bf16_f32 v188, v188, v189
    v_accvgpr_write_b32 a15, v151
    v_cvt_pk_bf16_f32 v189, v190, v191
    ds_write_b64 v11, v[184:185] offset:4544
    s_nop 1
    v_mfma_f32_16x16x32_bf16 v[48:51], a[128:131], a[0:3], 0
    s_waitcnt lgkmcnt(7)
    buffer_store_dwordx4 v[140:143], v13, s[16:19], s40 offen sc0 sc1
    v_mfma_f32_16x16x32_bf16 v[48:51], a[132:135], a[4:7], v[48:51]
    s_add_u32 s40, s40, 16384
    v_mfma_f32_16x16x32_bf16 v[48:51], a[136:139], a[8:11], v[48:51]
    ds_write_b64 v11, v[188:189] offset:4576
    ds_read_b128 v[160:163], v12 offset:4352
    v_mfma_f32_16x16x32_bf16 v[48:51], a[140:143], a[12:15], v[48:51]
    ds_read_b128 v[164:167], v12 offset:5440
    ds_read_b128 v[168:171], v12 offset:6528
    v_mfma_f32_16x16x32_bf16 v[52:55], a[144:147], a[0:3], 0
    ds_read_b128 v[172:175], v12 offset:7616
    v_mfma_f32_32x32x16_bf16 v[128:143], v[124:127], v[124:127], 0
    v_mfma_f32_16x16x32_bf16 v[52:55], a[148:151], a[4:7], v[52:55]
    v_mfma_f32_16x16x32_bf16 v[224:227], a[160:163], v[36:39], v[224:227]
    v_mul_f32 v192, v122, v192
    v_mfma_f32_16x16x32_bf16 v[52:55], a[152:155], a[8:11], v[52:55]
    v_mul_f32 v193, v122, v193
    v_mfma_f32_16x16x32_bf16 v[52:55], a[156:159], a[12:15], v[52:55]
    v_mul_f32 v194, v122, v194
    v_mul_f32 v195, v122, v195
    v_mfma_f32_32x32x16_bf16 v[144:159], a[192:195], a[88:91], 0
    v_mfma_f32_16x16x32_bf16 v[228:231], a[164:167], v[36:39], v[228:231]
    v_mul_f32 v196, v122, v196
    v_mfma_f32_32x32x16_bf16 v[144:159], a[196:199], a[92:95], v[144:159]
    v_mul_f32 v197, v122, v197
    v_mul_f32 v198, v122, v198
    v_mfma_f32_32x32x16_bf16 v[144:159], a[200:203], a[88:91], v[144:159]
    v_mul_f32 v199, v122, v199
    v_mfma_f32_16x16x32_bf16 v[232:235], a[168:171], v[36:39], v[232:235]
    v_mfma_f32_32x32x16_bf16 v[144:159], a[204:207], a[92:95], v[144:159]
    v_cvt_pk_bf16_f32 v192, v192, v193
    v_cvt_pk_bf16_f32 v96, v96, v97
    v_cvt_pk_bf16_f32 v97, v98, v99
    v_cvt_pk_bf16_f32 v98, v100, v101
    v_cvt_pk_bf16_f32 v193, v194, v195
    v_mul_f32 v200, v122, v200
    v_cvt_pk_bf16_f32 v99, v102, v103
    v_cvt_pk_bf16_f32 v100, v104, v105
    v_cvt_pk_bf16_f32 v101, v106, v107
    v_mul_f32 v201, v122, v201
    v_mfma_f32_16x16x32_bf16 v[236:239], a[172:175], v[36:39], v[236:239]
    v_cvt_pk_bf16_f32 v102, v108, v109
    v_cvt_pk_bf16_f32 v103, v110, v111
    v_accvgpr_write_b32 a16, v96
    v_mul_f32 v202, v122, v202
    v_mul_f32 v203, v122, v203
    v_accvgpr_write_b32 a17, v97
    v_accvgpr_write_b32 a18, v98
    v_accvgpr_write_b32 a19, v99
    v_cvt_pk_bf16_f32 v196, v196, v197
    v_accvgpr_write_b32 a20, v100
    v_accvgpr_write_b32 a21, v101
    v_accvgpr_write_b32 a22, v102
    v_cvt_pk_bf16_f32 v197, v198, v199
    v_mfma_f32_16x16x32_bf16 v[240:243], a[176:179], v[36:39], v[240:243]
    v_accvgpr_write_b32 a23, v103
    ds_write_b64 v11, v[192:193] offset:8704
    s_waitcnt lgkmcnt(4)
    buffer_store_dwordx4 v[160:163], v13, s[16:19], s40 offen sc0 sc1
    v_mfma_f32_32x32x16_bf16 v[96:111], a[192:195], a[96:99], 0
    s_add_u32 s40, s40, 16384
    v_max3_f32 v112, v48, v49, v50
    v_max3_f32 v116, v51, v52, v53
    v_max3_f32 v112, v112, v54, v55
    v_mul_f32 v204, v122, v204
    v_mul_f32 v205, v122, v205
    v_max_f32 v112, v112, v116
    v_mov_b32 v116, v112
    s_nop 1
    v_mul_f32 v206, v122, v206
    v_permlane32_swap_b32 v112, v116
    v_mfma_f32_16x16x32_bf16 v[244:247], a[180:183], v[36:39], v[244:247]
    v_mul_f32 v207, v122, v207
    v_mfma_f32_32x32x16_bf16 v[96:111], a[196:199], a[100:103], v[96:111]
    v_cvt_pk_bf16_f32 v200, v200, v201
    v_cvt_pk_bf16_f32 v201, v202, v203
    v_max_f32 v112, v112, v116
    v_mov_b32 v116, v112
    s_nop 1
    ds_write_b64 v11, v[196:197] offset:8736
    v_mfma_f32_16x16x32_bf16 v[248:251], a[184:187], v[36:39], v[248:251]
    v_permlane16_swap_b32 v112, v116
    v_max_f32 v112, v112, v116
    v_cvt_pk_bf16_f32 v144, v144, v145
    v_mul_f32 v208, v122, v208
    v_mul_f32 v209, v122, v209
    v_cvt_pk_bf16_f32 v145, v146, v147
    v_mul_f32 v210, v122, v210
    v_mfma_f32_32x32x16_bf16 v[96:111], a[200:203], a[96:99], v[96:111]
    v_mul_f32 v211, v122, v211
    v_mfma_f32_16x16x32_bf16 v[252:255], a[188:191], v[36:39], v[252:255]
    v_cvt_pk_bf16_f32 v146, v148, v149
    v_cvt_pk_bf16_f32 v147, v150, v151
    v_cvt_pk_bf16_f32 v148, v152, v153
    v_cvt_pk_bf16_f32 v204, v204, v205
    v_cvt_pk_bf16_f32 v205, v206, v207
    v_cvt_pk_bf16_f32 v149, v154, v155
    v_cvt_pk_bf16_f32 v150, v156, v157
    v_cvt_pk_bf16_f32 v151, v158, v159
    ds_write_b64 v11, v[200:201] offset:8768
    s_waitcnt lgkmcnt(5)
    buffer_store_dwordx4 v[164:167], v13, s[16:19], s40 offen sc0 sc1
    v_accvgpr_write_b32 a24, v144
    v_mfma_f32_32x32x16_bf16 v[96:111], a[204:207], a[100:103], v[96:111]
    s_add_u32 s40, s40, 16384
    v_mul_f32 v212, v122, v212
    v_accvgpr_write_b32 a25, v145
    v_accvgpr_write_b32 a26, v146
    v_accvgpr_write_b32 a27, v147
    v_mul_f32 v213, v122, v213
    v_mul_f32 v214, v122, v214
    v_accvgpr_write_b32 a28, v148
    v_accvgpr_write_b32 a29, v149
    v_accvgpr_write_b32 a30, v150
    v_mul_f32 v215, v122, v215
    v_cvt_pk_bf16_f32 v208, v208, v209
    v_accvgpr_write_b32 a31, v151
    v_cvt_pk_bf16_f32 v209, v210, v211
    ds_write_b64 v11, v[204:205] offset:8800
    s_nop 1
    v_mfma_f32_16x16x32_bf16 v[56:59], a[128:131], a[16:19], 0
    v_mul_f32 v216, v122, v216
    v_sub_f32 v48, v48, v112
    v_sub_f32 v49, v49, v112
    v_sub_f32 v50, v50, v112
    v_mul_f32 v217, v122, v217
    v_mul_f32 v218, v122, v218
    v_mfma_f32_16x16x32_bf16 v[56:59], a[132:135], a[20:23], v[56:59]
    v_mul_f32 v219, v122, v219
    v_cvt_pk_bf16_f32 v212, v212, v213
    v_sub_f32 v51, v51, v112
    v_sub_f32 v52, v52, v112
    v_sub_f32 v53, v53, v112
    v_cvt_pk_bf16_f32 v213, v214, v215
    ds_write_b64 v11, v[208:209] offset:8832
    v_mfma_f32_16x16x32_bf16 v[56:59], a[136:139], a[24:27], v[56:59]
    s_waitcnt lgkmcnt(6)
    buffer_store_dwordx4 v[168:171], v13, s[16:19], s40 offen sc0 sc1
    v_sub_f32 v54, v54, v112
    v_sub_f32 v55, v55, v112
    v_sub_f32 v80, 0, v112
    s_add_u32 s40, s40, 16384
    v_mfma_f32_16x16x32_bf16 v[56:59], a[140:143], a[28:31], v[56:59]
    v_mul_f32 v220, v122, v220
    v_mul_f32 v221, v122, v221
    v_sub_f32 v81, 0, v112
    v_sub_f32 v82, 0, v112
    v_sub_f32 v83, 0, v112
    v_mul_f32 v222, v122, v222
    v_mul_f32 v223, v122, v223
    v_mfma_f32_16x16x32_bf16 v[60:63], a[144:147], a[16:19], 0
    v_cvt_pk_bf16_f32 v216, v216, v217
    v_cvt_pk_bf16_f32 v217, v218, v219
    v_exp_f32 v48, v48
    v_exp_f32 v49, v49
    v_exp_f32 v50, v50
    ds_write_b64 v11, v[212:213] offset:8864
    v_mfma_f32_16x16x32_bf16 v[60:63], a[148:151], a[20:23], v[60:63]
    v_cvt_pk_bf16_f32 v220, v220, v221
    v_cvt_pk_bf16_f32 v221, v222, v223
    v_cvt_pk_bf16_f32 v48, v48, v49
    v_exp_f32 v51, v51
    v_exp_f32 v52, v52
    ds_write_b64 v11, v[216:217] offset:8896
    s_waitcnt lgkmcnt(7)
    buffer_store_dwordx4 v[172:175], v13, s[16:19], s40 offen sc0 sc1
    v_mfma_f32_16x16x32_bf16 v[60:63], a[152:155], a[24:27], v[60:63]
    s_add_u32 s40, s40, 16384
    v_cvt_pk_bf16_f32 v49, v50, v51
    v_exp_f32 v53, v53
    v_exp_f32 v54, v54
    ds_write_b64 v11, v[220:221] offset:8928
    ds_read_b128 v[192:195], v12 offset:8704
    v_mfma_f32_16x16x32_bf16 v[60:63], a[156:159], a[28:31], v[60:63]
    ds_read_b128 v[196:199], v12 offset:9792
    v_cvt_pk_bf16_f32 v50, v52, v53
    v_exp_f32 v55, v55
    s_nop 0
    ds_read_b128 v[200:203], v12 offset:10880
    ds_read_b128 v[204:207], v12 offset:11968
    v_mfma_f32_32x32x16_bf16 v[144:159], a[192:195], a[104:107], 0
    v_mfma_f32_32x32x16_bf16 v[160:175], v[124:127], v[124:127], 0
    v_mfma_f32_32x32x16_bf16 v[176:191], v[124:127], v[124:127], 0
    v_cvt_pk_bf16_f32 v51, v54, v55
    v_mul_f32 v224, v123, v224
    v_mul_f32 v225, v123, v225
    v_mfma_f32_32x32x16_bf16 v[144:159], a[196:199], a[108:111], v[144:159]
    v_mul_f32 v226, v123, v226
    v_mul_f32 v227, v123, v227
    v_mfma_f32_32x32x16_bf16 v[144:159], a[200:203], a[104:107], v[144:159]
    v_mul_f32 v228, v123, v228
    v_mfma_f32_32x32x16_bf16 v[144:159], a[204:207], a[108:111], v[144:159]
    v_mul_f32 v229, v123, v229
    v_mul_f32 v230, v123, v230
    v_cvt_pk_bf16_f32 v96, v96, v97
    v_cvt_pk_bf16_f32 v97, v98, v99
    v_cvt_pk_bf16_f32 v98, v100, v101
    v_mul_f32 v231, v123, v231
    v_cvt_pk_bf16_f32 v224, v224, v225
    v_cvt_pk_bf16_f32 v99, v102, v103
    v_cvt_pk_bf16_f32 v100, v104, v105
    v_cvt_pk_bf16_f32 v101, v106, v107
    v_cvt_pk_bf16_f32 v225, v226, v227
    v_mul_f32 v232, v123, v232
    v_cvt_pk_bf16_f32 v102, v108, v109
    v_cvt_pk_bf16_f32 v103, v110, v111
    v_accvgpr_write_b32 a32, v96
    v_mul_f32 v233, v123, v233
    v_accvgpr_write_b32 a33, v97
    v_accvgpr_write_b32 a34, v98
    v_accvgpr_write_b32 a35, v99
    v_mul_f32 v234, v123, v234
    v_mul_f32 v235, v123, v235
    v_accvgpr_write_b32 a36, v100
    v_accvgpr_write_b32 a37, v101
    v_accvgpr_write_b32 a38, v102
    v_cvt_pk_bf16_f32 v228, v228, v229
    v_cvt_pk_bf16_f32 v229, v230, v231
    v_accvgpr_write_b32 a39, v103
    ds_write_b64 v11, v[224:225] offset:13056
    s_waitcnt lgkmcnt(4)
    buffer_store_dwordx4 v[192:195], v13, s[16:19], s40 offen sc0 sc1
    v_max3_f32 v113, v56, v57, v58
    v_max3_f32 v117, v59, v60, v61
    v_max3_f32 v113, v113, v62, v63
    s_add_u32 s40, s40, 16384
    v_max_f32 v113, v113, v117
    v_mov_b32 v117, v113
    s_nop 1
    v_mul_f32 v236, v123, v236
    v_permlane32_swap_b32 v113, v117
    v_max_f32 v113, v113, v117
    v_mov_b32 v117, v113
    v_mul_f32 v237, v123, v237
    v_mul_f32 v238, v123, v238
    s_nop 1
    v_permlane16_swap_b32 v113, v117
    v_max_f32 v113, v113, v117
    v_mul_f32 v239, v123, v239
    v_cvt_pk_bf16_f32 v232, v232, v233
    v_cvt_pk_bf16_f32 v144, v144, v145
    v_cvt_pk_bf16_f32 v145, v146, v147
    v_cvt_pk_bf16_f32 v146, v148, v149
    v_cvt_pk_bf16_f32 v233, v234, v235
    ds_write_b64 v11, v[228:229] offset:13088
    v_cvt_pk_bf16_f32 v147, v150, v151
    v_cvt_pk_bf16_f32 v148, v152, v153
    v_cvt_pk_bf16_f32 v149, v154, v155
    v_mul_f32 v240, v123, v240
    v_mul_f32 v241, v123, v241
    v_cvt_pk_bf16_f32 v150, v156, v157
    v_cvt_pk_bf16_f32 v151, v158, v159
    v_accvgpr_write_b32 a40, v144
    v_mul_f32 v242, v123, v242
    v_accvgpr_write_b32 a41, v145
    v_accvgpr_write_b32 a42, v146
    v_accvgpr_write_b32 a43, v147
    v_mul_f32 v243, v123, v243
    v_cvt_pk_bf16_f32 v236, v236, v237
    v_accvgpr_write_b32 a44, v148
    v_accvgpr_write_b32 a45, v149
    v_accvgpr_write_b32 a46, v150
    v_cvt_pk_bf16_f32 v237, v238, v239
    ds_write_b64 v11, v[232:233] offset:13120
    v_accvgpr_write_b32 a47, v151
    s_waitcnt lgkmcnt(5)
    buffer_store_dwordx4 v[196:199], v13, s[16:19], s40 offen sc0 sc1
    s_nop 1
    v_mfma_f32_16x16x32_bf16 v[64:67], a[128:131], a[32:35], 0
    ds_read_b128 a[128:131], v1 offset:52224
    s_add_u32 s40, s40, 16384
    v_sub_f32 v56, v56, v113
    v_sub_f32 v57, v57, v113
    v_mul_f32 v244, v123, v244
    v_mul_f32 v245, v123, v245
    v_mfma_f32_16x16x32_bf16 v[64:67], a[132:135], a[36:39], v[64:67]
    ds_read_b128 a[132:135], v1 offset:52288
    v_mul_f32 v246, v123, v246
    v_mul_f32 v247, v123, v247
    v_sub_f32 v58, v58, v113
    v_sub_f32 v59, v59, v113
    v_cvt_pk_bf16_f32 v240, v240, v241
    v_cvt_pk_bf16_f32 v241, v242, v243
    v_mfma_f32_16x16x32_bf16 v[64:67], a[136:139], a[40:43], v[64:67]
    ds_read_b128 a[136:139], v2 offset:52224
    ds_write_b64 v11, v[236:237] offset:13152
    v_mul_f32 v248, v123, v248
    v_sub_f32 v60, v60, v113
    v_sub_f32 v61, v61, v113
    v_mul_f32 v249, v123, v249
    v_mfma_f32_16x16x32_bf16 v[64:67], a[140:143], a[44:47], v[64:67]
    ds_read_b128 a[140:143], v2 offset:52288
    v_mul_f32 v250, v123, v250
    v_mul_f32 v251, v123, v251
    v_sub_f32 v62, v62, v113
    v_sub_f32 v63, v63, v113
    v_cvt_pk_bf16_f32 v244, v244, v245
    v_cvt_pk_bf16_f32 v245, v246, v247
    v_mfma_f32_16x16x32_bf16 v[68:71], a[144:147], a[32:35], 0
    ds_read_b128 a[144:147], v1 offset:56448
    ds_write_b64 v11, v[240:241] offset:13184
    s_waitcnt lgkmcnt(11)
    buffer_store_dwordx4 v[200:203], v13, s[16:19], s40 offen sc0 sc1
    v_sub_f32 v84, 0, v113
    v_sub_f32 v85, 0, v113
    s_add_u32 s40, s40, 16384
    v_mfma_f32_16x16x32_bf16 v[68:71], a[148:151], a[36:39], v[68:71]
    ds_read_b128 a[148:151], v1 offset:56512
    v_mul_f32 v252, v123, v252
    v_sub_f32 v86, 0, v113
    v_sub_f32 v87, 0, v113
    v_mul_f32 v253, v123, v253
    v_mul_f32 v254, v123, v254
    v_mfma_f32_16x16x32_bf16 v[68:71], a[152:155], a[40:43], v[68:71]
    ds_read_b128 a[152:155], v2 offset:56448
    v_mul_f32 v255, v123, v255
    v_cvt_pk_bf16_f32 v248, v248, v249
    v_exp_f32 v56, v56
    v_exp_f32 v57, v57
    v_cvt_pk_bf16_f32 v249, v250, v251
    ds_write_b64 v11, v[244:245] offset:13216
    v_mfma_f32_16x16x32_bf16 v[68:71], a[156:159], a[44:47], v[68:71]
    ds_read_b128 a[156:159], v2 offset:56512
    v_cvt_pk_bf16_f32 v252, v252, v253
    v_exp_f32 v58, v58
    v_cvt_pk_bf16_f32 v52, v56, v57
    v_cvt_pk_bf16_f32 v253, v254, v255
    ds_write_b64 v11, v[248:249] offset:13248
    s_nop 6
    s_waitcnt lgkmcnt(15)
    buffer_store_dwordx4 v[204:207], v13, s[16:19], s40 offen sc0 sc1
    v_max3_f32 v114, v64, v65, v66
    v_max3_f32 v118, v67, v68, v69
    v_max3_f32 v114, v114, v70, v71
    s_add_u32 s40, s40, 16384
    ds_write_b64 v11, v[252:253] offset:13280
    v_max_f32 v114, v114, v118
    v_mov_b32 v118, v114
    s_nop 1
    ds_read_b128 v[224:227], v12 offset:13056
    ds_read_b128 v[228:231], v12 offset:14144
    v_permlane32_swap_b32 v114, v118
    v_max_f32 v114, v114, v118
    v_mov_b32 v118, v114
    ds_read_b128 v[232:235], v12 offset:15232
    s_nop 1
    v_permlane16_swap_b32 v114, v118
    v_max_f32 v114, v114, v118
    ds_read_b128 v[236:239], v12 offset:16320
    v_mfma_f32_32x32x16_bf16 v[192:207], v[124:127], v[124:127], 0
    v_sub_f32 v64, v64, v114
    v_sub_f32 v65, v65, v114
    v_sub_f32 v66, v66, v114
    v_mfma_f32_32x32x16_bf16 v[208:223], v[124:127], v[124:127], 0
    s_waitcnt lgkmcnt(3)
    buffer_store_dwordx4 v[224:227], v13, s[16:19], s40 offen sc0 sc1
    s_add_u32 s40, s40, 16384
    v_sub_f32 v67, v67, v114
    v_sub_f32 v68, v68, v114
    v_sub_f32 v69, v69, v114
    s_waitcnt lgkmcnt(2)
    buffer_store_dwordx4 v[228:231], v13, s[16:19], s40 offen sc0 sc1
    s_add_u32 s40, s40, 16384
    s_waitcnt lgkmcnt(1)
    buffer_store_dwordx4 v[232:235], v13, s[16:19], s40 offen sc0 sc1
    s_add_u32 s40, s40, 16384
    v_sub_f32 v70, v70, v114
    v_sub_f32 v71, v71, v114
    v_sub_f32 v88, 0, v114
    s_waitcnt lgkmcnt(0)
    buffer_store_dwordx4 v[236:239], v13, s[16:19], s40 offen sc0 sc1
    s_add_u32 s40, s40, 16384
    v_sub_f32 v89, 0, v114
    v_sub_f32 v90, 0, v114
    v_sub_f32 v91, 0, v114
    v_mfma_f32_32x32x16_bf16 v[144:159], v[124:127], v[124:127], 0
    s_mov_b32 s18, s43
    s_waitcnt lgkmcnt(0)
    s_branch L_itb3_0
L_e3x_0:
    s_mov_b32 s44, 0
    s_barrier
    s_cmp_eq_u32 s93, 3
    s_cbranch_scc1 L_e3_0_3
L_e3_0_2:
    ds_read_b64_tr_b16 a[160:161], v3 offset:0
    v_exp_f32 v59, v59
    ds_read_b64_tr_b16 a[162:163], v3 offset:512
    v_exp_f32 v60, v60
    ds_read_b64_tr_b16 a[164:165], v3 offset:32
    v_cvt_pk_bf16_f32 v53, v58, v59
    ds_read_b64_tr_b16 a[166:167], v3 offset:544
    v_exp_f32 v61, v61
    ds_read_b64_tr_b16 a[168:169], v3 offset:64
    v_exp_f32 v62, v62
    ds_read_b64_tr_b16 a[170:171], v3 offset:576
    v_cvt_pk_bf16_f32 v54, v60, v61
    ds_read_b64_tr_b16 a[172:173], v3 offset:96
    v_exp_f32 v63, v63
    ds_read_b64_tr_b16 a[174:175], v3 offset:608
    v_exp_f32 v64, v64
    ds_read_b64_tr_b16 a[176:177], v3 offset:128
    v_cvt_pk_bf16_f32 v55, v62, v63
    ds_read_b64_tr_b16 a[178:179], v3 offset:640
    v_exp_f32 v65, v65
    ds_read_b64_tr_b16 a[180:181], v3 offset:160
    v_exp_f32 v66, v66
    ds_read_b64_tr_b16 a[182:183], v3 offset:672
    v_cvt_pk_bf16_f32 v64, v64, v65
    ds_read_b64_tr_b16 a[184:185], v3 offset:192
    v_exp_f32 v67, v67
    ds_read_b64_tr_b16 a[186:187], v3 offset:704
    v_exp_f32 v68, v68
    ds_read_b64_tr_b16 a[188:189], v3 offset:224
    v_cvt_pk_bf16_f32 v65, v66, v67
    ds_read_b64_tr_b16 a[190:191], v3 offset:736
    v_exp_f32 v69, v69
    v_exp_f32 v70, v70
    v_cvt_pk_bf16_f32 v66, v68, v69
    v_exp_f32 v71, v71
    s_nop 0
    v_cvt_pk_bf16_f32 v67, v70, v71
    s_nop 1
    v_smfmac_f32_16x16x64_bf16 a[208:211], a[236:239], v[48:55], v15
    v_mfma_f32_16x16x32_bf16 a[212:215], a[232:235], v[64:67], a[212:215]
    s_waitcnt lgkmcnt(8)
    v_mfma_f32_16x16x32_bf16 v[128:131], a[160:163], v[48:51], v[128:131]
    s_add_u32 m0, s30, 52224
    v_mfma_f32_16x16x32_bf16 v[132:135], a[164:167], v[48:51], v[132:135]
    buffer_load_dwordx4 v4, s[8:11], s28 offen lds
    v_mfma_f32_16x16x32_bf16 v[136:139], a[168:171], v[48:51], v[136:139]
    s_add_u32 m0, s30, 56448
    v_mfma_f32_16x16x32_bf16 v[140:143], a[172:175], v[48:51], v[140:143]
    buffer_load_dwordx4 v5, s[8:11], s28 offen lds
    s_waitcnt lgkmcnt(0)
    v_mfma_f32_16x16x32_bf16 v[144:147], a[176:179], v[48:51], v[144:147]
    s_add_u32 m0, s30, 60928
    ds_read_b128 a[64:67], v9 offset:0
    ds_read_b128 a[68:71], v9 offset:64
    v_mfma_f32_16x16x32_bf16 v[148:151], a[180:183], v[48:51], v[148:151]
    buffer_load_dwordx4 v6, s[12:15], s29 offen lds
    ds_read_b128 a[72:75], v10 offset:0
    ds_read_b128 a[76:79], v10 offset:64
    v_mfma_f32_16x16x32_bf16 v[152:155], a[184:187], v[48:51], v[152:155]
    s_add_u32 m0, s30, 65152
    ds_read_b128 a[80:83], v9 offset:4224
    ds_read_b128 a[84:87], v9 offset:4288
    v_mfma_f32_16x16x32_bf16 v[156:159], a[188:191], v[48:51], v[156:159]
    buffer_load_dwordx4 v7, s[12:15], s29 offen lds
    ds_read_b128 a[88:91], v10 offset:4224
    ds_read_b128 a[92:95], v10 offset:4288
    s_add_u32 s28, s28, s101
    s_add_u32 s29, s29, s101
    v_accvgpr_read_b32 v112, a208
    v_accvgpr_read_b32 v113, a210
    v_accvgpr_read_b32 v114, a212
    v_accvgpr_read_b32 v116, a209
    v_accvgpr_read_b32 v117, a211
    v_add_f32 v112, v112, v116
    v_add_f32 v113, v113, v117
    v_cmp_nge_f32 vcc, 0x44800000, v112
    v_rcp_f32 v120, v112
    s_nop 0
    s_mov_b64 s[84:85], vcc
    v_cmp_nge_f32 vcc, 0x44800000, v113
    v_rcp_f32 v121, v113
    s_nop 0
    s_or_b64 s[84:85], s[84:85], vcc
    v_cmp_nge_f32 vcc, 0x44800000, v114
    v_rcp_f32 v122, v114
    s_nop 0
    s_or_b64 s[84:85], s[84:85], vcc
    s_mov_b32 s40, s34
    s_cbranch_scc1 L_es3_0
    s_waitcnt vmcnt(8) lgkmcnt(0)
    v_mfma_f32_16x16x32_bf16 v[160:163], a[160:163], v[52:55], v[160:163]
    v_mul_f32 v128, v120, v128
    v_mul_f32 v129, v120, v129
    v_mfma_f32_32x32x16_bf16 v[96:111], a[192:195], a[64:67], 0
    v_mul_f32 v130, v120, v130
    v_mul_f32 v131, v120, v131
    s_mov_b32 s80, s81
    s_mov_b32 s81, 0
    s_add_u32 s47, s47, 1
    v_mfma_f32_16x16x32_bf16 v[164:167], a[164:167], v[52:55], v[164:167]
    v_mul_f32 v132, v120, v132
    v_mul_f32 v133, v120, v133
    s_mov_b32 s42, s89
    s_mov_b32 s43, s90
    v_mul_f32 v134, v120, v134
    v_mul_f32 v135, v120, v135
    v_mfma_f32_32x32x16_bf16 v[96:111], a[196:199], a[68:71], v[96:111]
    v_mfma_f32_16x16x32_bf16 v[168:171], a[168:171], v[52:55], v[168:171]
    v_cvt_pk_bf16_f32 v128, v128, v129
    v_cvt_pk_bf16_f32 v129, v130, v131
    s_mov_b32 s34, s91
    s_mov_b32 s88, s93
    s_bfe_u32 s37, s80, 0xa000d
    v_mul_f32 v136, v120, v136
    v_mul_f32 v137, v120, v137
    s_add_u32 s36, s37, 31
    s_lshr_b32 s36, s36, 5
    v_mfma_f32_16x16x32_bf16 v[172:175], a[172:175], v[52:55], v[172:175]
    v_mul_f32 v138, v120, v138
    v_mul_f32 v139, v120, v139
    v_mfma_f32_32x32x16_bf16 v[96:111], a[200:203], a[64:67], v[96:111]
    v_cvt_pk_bf16_f32 v132, v132, v133
    v_cvt_pk_bf16_f32 v133, v134, v135
    s_sub_u32 s31, s36, 1
    s_lshl_b32 s39, s31, 5
    s_sub_u32 s35, s37, s39
    v_mfma_f32_16x16x32_bf16 v[176:179], a[176:179], v[52:55], v[176:179]
    ds_write_b64 v11, v[128:129] offset:0
    v_mul_f32 v140, v120, v140
    s_mov_b32 s46, 0
    s_mov_b32 s99, s33
    v_mul_f32 v141, v120, v141
    v_mul_f32 v142, v120, v142
    v_mfma_f32_32x32x16_bf16 v[96:111], a[204:207], a[68:71], v[96:111]
    v_mfma_f32_16x16x32_bf16 v[180:183], a[180:183], v[52:55], v[180:183]
    v_mul_f32 v143, v120, v143
    v_cvt_pk_bf16_f32 v136, v136, v137
    s_sub_u32 s31, s31, 1
    s_mov_b32 s32, 4
    s_mov_b32 s93, 0
    v_cvt_pk_bf16_f32 v137, v138, v139
    ds_write_b64 v11, v[132:133] offset:32
    s_mov_b32 s90, 0
    v_mfma_f32_16x16x32_bf16 v[184:187], a[184:187], v[52:55], v[184:187]
    v_mul_f32 v144, v120, v144
    v_mul_f32 v145, v120, v145
    v_mfma_f32_32x32x16_bf16 v[224:239], a[192:195], a[72:75], 0
    v_mul_f32 v146, v120, v146
    v_mul_f32 v147, v120, v147
    v_accvgpr_mov_b32 a232, a240
    v_accvgpr_mov_b32 a233, a241
    v_mfma_f32_16x16x32_bf16 v[188:191], a[188:191], v[52:55], v[188:191]
    v_cvt_pk_bf16_f32 v140, v140, v141
    v_cvt_pk_bf16_f32 v141, v142, v143
    v_mfma_f32_32x32x16_bf16 v[224:239], a[196:199], a[76:79], v[224:239]
    ds_write_b64 v11, v[136:137] offset:64
    v_mul_f32 v148, v120, v148
    v_accvgpr_mov_b32 a234, a242
    v_accvgpr_mov_b32 a235, a243
    v_mul_f32 v149, v120, v149
    v_mul_f32 v150, v120, v150
    v_mul_f32 v151, v120, v151
    v_mfma_f32_32x32x16_bf16 v[224:239], a[200:203], a[72:75], v[224:239]
    v_cvt_pk_bf16_f32 v144, v144, v145
    v_cvt_pk_bf16_f32 v145, v146, v147
    v_accvgpr_mov_b32 a236, a244
    v_accvgpr_mov_b32 a237, a245
    ds_write_b64 v11, v[140:141] offset:96
    v_mul_f32 v152, v120, v152
    v_mul_f32 v153, v120, v153
    v_mfma_f32_32x32x16_bf16 v[224:239], a[204:207], a[76:79], v[224:239]
    v_mul_f32 v154, v120, v154
    v_mul_f32 v155, v120, v155
    v_accvgpr_mov_b32 a238, a246
    v_accvgpr_mov_b32 a239, a247
    v_cvt_pk_bf16_f32 v148, v148, v149
    v_cvt_pk_bf16_f32 v149, v150, v151
    ds_write_b64 v11, v[144:145] offset:128
    v_mfma_f32_32x32x16_bf16 a[208:223], v[124:127], v[124:127], 0
    v_mul_f32 v156, v120, v156
    v_mul_f32 v157, v120, v157
    v_cvt_pk_bf16_f32 v96, v96, v97
    v_cvt_pk_bf16_f32 v97, v98, v99
    v_cvt_pk_bf16_f32 v98, v100, v101
    v_mul_f32 v158, v120, v158
    v_mul_f32 v159, v120, v159
    v_cvt_pk_bf16_f32 v152, v152, v153
    v_cvt_pk_bf16_f32 v99, v102, v103
    v_cvt_pk_bf16_f32 v100, v104, v105
    v_cvt_pk_bf16_f32 v101, v106, v107
    v_cvt_pk_bf16_f32 v153, v154, v155
    ds_write_b64 v11, v[148:149] offset:160
    v_cvt_pk_bf16_f32 v102, v108, v109
    v_cvt_pk_bf16_f32 v103, v110, v111
    v_accvgpr_write_b32 a0, v96
    v_cvt_pk_bf16_f32 v156, v156, v157
    v_cvt_pk_bf16_f32 v157, v158, v159
    v_accvgpr_write_b32 a1, v97
    v_accvgpr_write_b32 a2, v98
    v_accvgpr_write_b32 a3, v99
    ds_write_b64 v11, v[152:153] offset:192
    ds_write_b64 v11, v[156:157] offset:224
    ds_read_b128 v[128:131], v12 offset:0
    v_accvgpr_write_b32 a4, v100
    v_accvgpr_write_b32 a5, v101
    v_accvgpr_write_b32 a6, v102
    ds_read_b128 v[132:135], v12 offset:1088
    ds_read_b128 v[136:139], v12 offset:2176
    v_accvgpr_write_b32 a7, v103
    ds_read_b128 v[140:143], v12 offset:3264
    v_mfma_f32_16x16x32_bf16 v[192:195], a[160:163], v[64:67], v[192:195]
    v_mul_f32 v160, v121, v160
    v_mfma_f32_32x32x16_bf16 v[96:111], a[192:195], a[80:83], 0
    v_mul_f32 v161, v121, v161
    v_mul_f32 v162, v121, v162
    v_cvt_pk_bf16_f32 v224, v224, v225
    v_cvt_pk_bf16_f32 v225, v226, v227
    v_cvt_pk_bf16_f32 v226, v228, v229
    v_mul_f32 v163, v121, v163
    v_mfma_f32_16x16x32_bf16 v[196:199], a[164:167], v[64:67], v[196:199]
    v_mul_f32 v164, v121, v164
    v_cvt_pk_bf16_f32 v227, v230, v231
    v_mul_f32 v165, v121, v165
    v_mul_f32 v166, v121, v166
    v_mfma_f32_32x32x16_bf16 v[96:111], a[196:199], a[84:87], v[96:111]
    v_mul_f32 v167, v121, v167
    v_mfma_f32_16x16x32_bf16 v[200:203], a[168:171], v[64:67], v[200:203]
    v_cvt_pk_bf16_f32 v160, v160, v161
    v_cvt_pk_bf16_f32 v228, v232, v233
    v_cvt_pk_bf16_f32 v229, v234, v235
    v_cvt_pk_bf16_f32 v230, v236, v237
    v_cvt_pk_bf16_f32 v161, v162, v163
    v_mul_f32 v168, v121, v168
    v_cvt_pk_bf16_f32 v231, v238, v239
    v_mul_f32 v169, v121, v169
    v_mfma_f32_16x16x32_bf16 v[204:207], a[172:175], v[64:67], v[204:207]
    v_mul_f32 v170, v121, v170
    v_mfma_f32_32x32x16_bf16 v[96:111], a[200:203], a[80:83], v[96:111]
    v_mul_f32 v171, v121, v171
    v_cvt_pk_bf16_f32 v164, v164, v165
    v_accvgpr_write_b32 a8, v224
    v_accvgpr_write_b32 a9, v225
    v_accvgpr_write_b32 a10, v226
    v_cvt_pk_bf16_f32 v165, v166, v167
    v_mfma_f32_16x16x32_bf16 v[208:211], a[176:179], v[64:67], v[208:211]
    ds_write_b64 v11, v[160:161] offset:4352
    v_accvgpr_write_b32 a11, v227
    s_waitcnt lgkmcnt(4)
    buffer_store_dwordx4 v[128:131], v13, s[16:19], s40 offen sc0 sc1
    v_mfma_f32_32x32x16_bf16 v[96:111], a[204:207], a[84:87], v[96:111]
    s_add_u32 s40, s40, 16384
    v_mul_f32 v172, v121, v172
    v_mul_f32 v173, v121, v173
    v_accvgpr_write_b32 a12, v228
    v_accvgpr_write_b32 a13, v229
    v_accvgpr_write_b32 a14, v230
    v_mul_f32 v174, v121, v174
    v_mfma_f32_16x16x32_bf16 v[212:215], a[180:183], v[64:67], v[212:215]
    v_accvgpr_write_b32 a15, v231
    v_mul_f32 v175, v121, v175
    v_cvt_pk_bf16_f32 v168, v168, v169
    v_cvt_pk_bf16_f32 v169, v170, v171
    s_nop 1
    v_mfma_f32_16x16x32_bf16 v[16:19], a[128:131], a[0:3], 0
    ds_write_b64 v11, v[164:165] offset:4384
    v_mfma_f32_16x16x32_bf16 v[216:219], a[184:187], v[64:67], v[216:219]
    v_mfma_f32_16x16x32_bf16 v[16:19], a[132:135], a[4:7], v[16:19]
    v_mul_f32 v176, v121, v176
    v_mul_f32 v177, v121, v177
    v_mul_f32 v178, v121, v178
    v_mfma_f32_16x16x32_bf16 v[16:19], a[136:139], a[8:11], v[16:19]
    v_mul_f32 v179, v121, v179
    v_mfma_f32_16x16x32_bf16 v[220:223], a[188:191], v[64:67], v[220:223]
    v_mfma_f32_16x16x32_bf16 v[16:19], a[140:143], a[12:15], v[16:19]
    v_cvt_pk_bf16_f32 v172, v172, v173
    v_cvt_pk_bf16_f32 v173, v174, v175
    ds_write_b64 v11, v[168:169] offset:4416
    v_mfma_f32_16x16x32_bf16 v[20:23], a[144:147], a[0:3], 0
    s_waitcnt lgkmcnt(5)
    buffer_store_dwordx4 v[132:135], v13, s[16:19], s40 offen sc0 sc1
    v_mfma_f32_16x16x32_bf16 v[20:23], a[148:151], a[4:7], v[20:23]
    s_add_u32 s40, s40, 16384
    v_mul_f32 v180, v121, v180
    v_mul_f32 v181, v121, v181
    v_mfma_f32_16x16x32_bf16 v[20:23], a[152:155], a[8:11], v[20:23]
    v_mul_f32 v182, v121, v182
    v_mul_f32 v183, v121, v183
    v_mfma_f32_16x16x32_bf16 v[20:23], a[156:159], a[12:15], v[20:23]
    v_cvt_pk_bf16_f32 v176, v176, v177
    v_cvt_pk_bf16_f32 v177, v178, v179
    v_mfma_f32_32x32x16_bf16 v[224:239], a[192:195], a[88:91], 0
    ds_write_b64 v11, v[172:173] offset:4448
    v_mul_f32 v184, v121, v184
    v_mul_f32 v185, v121, v185
    v_mfma_f32_32x32x16_bf16 v[224:239], a[196:199], a[92:95], v[224:239]
    v_mul_f32 v186, v121, v186
    v_mul_f32 v187, v121, v187
    v_mfma_f32_32x32x16_bf16 v[224:239], a[200:203], a[88:91], v[224:239]
    v_cvt_pk_bf16_f32 v180, v180, v181
    v_cvt_pk_bf16_f32 v181, v182, v183
    ds_write_b64 v11, v[176:177] offset:4480
    v_mfma_f32_32x32x16_bf16 v[224:239], a[204:207], a[92:95], v[224:239]
    s_waitcnt lgkmcnt(6)
    buffer_store_dwordx4 v[136:139], v13, s[16:19], s40 offen sc0 sc1
    v_cvt_pk_bf16_f32 v96, v96, v97
    v_cvt_pk_bf16_f32 v97, v98, v99
    v_cvt_pk_bf16_f32 v98, v100, v101
    s_add_u32 s40, s40, 16384
    v_mul_f32 v188, v121, v188
    v_mul_f32 v189, v121, v189
    v_cvt_pk_bf16_f32 v99, v102, v103
    v_cvt_pk_bf16_f32 v100, v104, v105
    v_cvt_pk_bf16_f32 v101, v106, v107
    v_mul_f32 v190, v121, v190
    v_mul_f32 v191, v121, v191
    v_cvt_pk_bf16_f32 v102, v108, v109
    v_cvt_pk_bf16_f32 v103, v110, v111
    v_accvgpr_write_b32 a16, v96
    v_cvt_pk_bf16_f32 v184, v184, v185
    v_cvt_pk_bf16_f32 v185, v186, v187
    ds_write_b64 v11, v[180:181] offset:4512
    v_accvgpr_write_b32 a17, v97
    v_accvgpr_write_b32 a18, v98
    v_accvgpr_write_b32 a19, v99
    v_cvt_pk_bf16_f32 v188, v188, v189
    v_cvt_pk_bf16_f32 v189, v190, v191
    v_accvgpr_write_b32 a20, v100
    v_accvgpr_write_b32 a21, v101
    v_accvgpr_write_b32 a22, v102
    ds_write_b64 v11, v[184:185] offset:4544
    s_waitcnt lgkmcnt(7)
    buffer_store_dwordx4 v[140:143], v13, s[16:19], s40 offen sc0 sc1
    v_accvgpr_write_b32 a23, v103
    s_add_u32 s40, s40, 16384
    ds_write_b64 v11, v[188:189] offset:4576
    v_max3_f32 v112, v16, v17, v18
    v_max3_f32 v116, v19, v20, v21
    v_max3_f32 v112, v112, v22, v23
    ds_read_b128 v[160:163], v12 offset:4352
    ds_read_b128 v[164:167], v12 offset:5440
    ds_read_b128 v[168:171], v12 offset:6528
    v_max_f32 v112, v112, v116
    v_mov_b32 v116, v112
    s_nop 1
    ds_read_b128 v[172:175], v12 offset:7616
    v_mfma_f32_32x32x16_bf16 v[128:143], v[124:127], v[124:127], 0
    v_permlane32_swap_b32 v112, v116
    v_max_f32 v112, v112, v116
    v_mov_b32 v116, v112
    v_mfma_f32_32x32x16_bf16 v[144:159], v[124:127], v[124:127], 0
    v_mul_f32 v192, v122, v192
    v_mul_f32 v193, v122, v193
    s_nop 1
    v_permlane16_swap_b32 v112, v116
    v_max_f32 v112, v112, v116
    v_mul_f32 v194, v122, v194
    v_mul_f32 v195, v122, v195
    v_cvt_pk_bf16_f32 v224, v224, v225
    v_cvt_pk_bf16_f32 v225, v226, v227
    v_cvt_pk_bf16_f32 v226, v228, v229
    v_mul_f32 v196, v122, v196
    v_mul_f32 v197, v122, v197
    v_mul_f32 v198, v122, v198
    v_cvt_pk_bf16_f32 v227, v230, v231
    v_cvt_pk_bf16_f32 v228, v232, v233
    v_cvt_pk_bf16_f32 v229, v234, v235
    v_mul_f32 v199, v122, v199
    v_cvt_pk_bf16_f32 v192, v192, v193
    v_cvt_pk_bf16_f32 v230, v236, v237
    v_cvt_pk_bf16_f32 v231, v238, v239
    v_accvgpr_write_b32 a24, v224
    v_cvt_pk_bf16_f32 v193, v194, v195
    v_mul_f32 v200, v122, v200
    v_mul_f32 v201, v122, v201
    v_accvgpr_write_b32 a25, v225
    v_accvgpr_write_b32 a26, v226
    v_accvgpr_write_b32 a27, v227
    v_mul_f32 v202, v122, v202
    v_mul_f32 v203, v122, v203
    v_accvgpr_write_b32 a28, v228
    v_accvgpr_write_b32 a29, v229
    v_accvgpr_write_b32 a30, v230
    v_cvt_pk_bf16_f32 v196, v196, v197
    v_cvt_pk_bf16_f32 v197, v198, v199
    ds_write_b64 v11, v[192:193] offset:8704
    v_accvgpr_write_b32 a31, v231
    s_waitcnt lgkmcnt(4)
    buffer_store_dwordx4 v[160:163], v13, s[16:19], s40 offen sc0 sc1
    s_nop 1
    v_mfma_f32_16x16x32_bf16 v[24:27], a[128:131], a[16:19], 0
    ds_read_b128 a[128:131], v1 offset:0
    s_add_u32 s40, s40, 16384
    v_mul_f32 v204, v122, v204
    v_mul_f32 v205, v122, v205
    v_sub_f32 v16, v16, v112
    v_sub_f32 v17, v17, v112
    v_sub_f32 v18, v18, v112
    v_mul_f32 v206, v122, v206
    v_mul_f32 v207, v122, v207
    v_mfma_f32_16x16x32_bf16 v[24:27], a[132:135], a[20:23], v[24:27]
    ds_read_b128 a[132:135], v1 offset:64
    v_cvt_pk_bf16_f32 v200, v200, v201
    v_cvt_pk_bf16_f32 v201, v202, v203
    v_sub_f32 v19, v19, v112
    v_sub_f32 v20, v20, v112
    v_sub_f32 v21, v21, v112
    ds_write_b64 v11, v[196:197] offset:8736
    v_mul_f32 v208, v122, v208
    v_mul_f32 v209, v122, v209
    v_mfma_f32_16x16x32_bf16 v[24:27], a[136:139], a[24:27], v[24:27]
    ds_read_b128 a[136:139], v2 offset:0
    v_mul_f32 v210, v122, v210
    v_mul_f32 v211, v122, v211
    v_sub_f32 v22, v22, v112
    v_sub_f32 v23, v23, v112
    v_sub_f32 v80, 0, v112
    v_cvt_pk_bf16_f32 v204, v204, v205
    v_cvt_pk_bf16_f32 v205, v206, v207
    ds_write_b64 v11, v[200:201] offset:8768
    v_mfma_f32_16x16x32_bf16 v[24:27], a[140:143], a[28:31], v[24:27]
    ds_read_b128 a[140:143], v2 offset:64
    s_waitcnt lgkmcnt(9)
    buffer_store_dwordx4 v[164:167], v13, s[16:19], s40 offen sc0 sc1
    v_sub_f32 v81, 0, v112
    v_sub_f32 v82, 0, v112
    v_sub_f32 v83, 0, v112
    s_add_u32 s40, s40, 16384
    v_mul_f32 v212, v122, v212
    v_mul_f32 v213, v122, v213
    v_mfma_f32_16x16x32_bf16 v[28:31], a[144:147], a[16:19], 0
    ds_read_b128 a[144:147], v1 offset:4224
    v_mul_f32 v214, v122, v214
    v_mul_f32 v215, v122, v215
    v_exp_f32 v16, v16
    v_exp_f32 v17, v17
    v_exp_f32 v18, v18
    v_cvt_pk_bf16_f32 v208, v208, v209
    v_cvt_pk_bf16_f32 v209, v210, v211
    ds_write_b64 v11, v[204:205] offset:8800
    v_mfma_f32_16x16x32_bf16 v[28:31], a[148:151], a[20:23], v[28:31]
    ds_read_b128 a[148:151], v1 offset:4288
    v_mul_f32 v216, v122, v216
    v_mul_f32 v217, v122, v217
    v_cvt_pk_bf16_f32 v16, v16, v17
    v_exp_f32 v19, v19
    v_exp_f32 v20, v20
    v_mul_f32 v218, v122, v218
    v_mul_f32 v219, v122, v219
    v_cvt_pk_bf16_f32 v212, v212, v213
    v_mfma_f32_16x16x32_bf16 v[28:31], a[152:155], a[24:27], v[28:31]
    ds_read_b128 a[152:155], v2 offset:4224
    v_cvt_pk_bf16_f32 v213, v214, v215
    ds_write_b64 v11, v[208:209] offset:8832
    v_cvt_pk_bf16_f32 v17, v18, v19
    v_exp_f32 v21, v21
    v_exp_f32 v22, v22
    s_waitcnt lgkmcnt(13)
    buffer_store_dwordx4 v[168:171], v13, s[16:19], s40 offen sc0 sc1
    s_add_u32 s40, s40, 16384
    v_mfma_f32_16x16x32_bf16 v[28:31], a[156:159], a[28:31], v[28:31]
    ds_read_b128 a[156:159], v2 offset:4288
    v_mul_f32 v220, v122, v220
    v_mul_f32 v221, v122, v221
    v_cvt_pk_bf16_f32 v18, v20, v21
    v_mul_f32 v222, v122, v222
    v_mul_f32 v223, v122, v223
    v_cvt_pk_bf16_f32 v216, v216, v217
    s_nop 6
    v_cvt_pk_bf16_f32 v217, v218, v219
    ds_write_b64 v11, v[212:213] offset:8864
    v_max3_f32 v113, v24, v25, v26
    v_max3_f32 v117, v27, v28, v29
    v_max3_f32 v113, v113, v30, v31
    v_cvt_pk_bf16_f32 v220, v220, v221
    v_cvt_pk_bf16_f32 v221, v222, v223
    ds_write_b64 v11, v[216:217] offset:8896
    v_max_f32 v113, v113, v117
    v_mov_b32 v117, v113
    s_nop 1
    s_waitcnt lgkmcnt(15)
    buffer_store_dwordx4 v[172:175], v13, s[16:19], s40 offen sc0 sc1
    v_permlane32_swap_b32 v113, v117
    v_max_f32 v113, v113, v117
    v_mov_b32 v117, v113
    s_add_u32 s40, s40, 16384
    ds_write_b64 v11, v[220:221] offset:8928
    ds_read_b128 v[192:195], v12 offset:8704
    s_nop 1
    v_permlane16_swap_b32 v113, v117
    v_max_f32 v113, v113, v117
    ds_read_b128 v[196:199], v12 offset:9792
    ds_read_b128 v[200:203], v12 offset:10880
    v_sub_f32 v24, v24, v113
    v_sub_f32 v25, v25, v113
    v_sub_f32 v26, v26, v113
    ds_read_b128 v[204:207], v12 offset:11968
    v_mfma_f32_32x32x16_bf16 v[160:175], v[124:127], v[124:127], 0
    v_mfma_f32_32x32x16_bf16 v[176:191], v[124:127], v[124:127], 0
    v_sub_f32 v27, v27, v113
    v_sub_f32 v28, v28, v113
    v_sub_f32 v29, v29, v113
    s_waitcnt lgkmcnt(3)
    buffer_store_dwordx4 v[192:195], v13, s[16:19], s40 offen sc0 sc1
    s_add_u32 s40, s40, 16384
    s_waitcnt lgkmcnt(2)
    buffer_store_dwordx4 v[196:199], v13, s[16:19], s40 offen sc0 sc1
    s_add_u32 s40, s40, 16384
    v_sub_f32 v30, v30, v113
    v_sub_f32 v31, v31, v113
    v_sub_f32 v84, 0, v113
    s_waitcnt lgkmcnt(1)
    buffer_store_dwordx4 v[200:203], v13, s[16:19], s40 offen sc0 sc1
    s_add_u32 s40, s40, 16384
    s_waitcnt lgkmcnt(0)
    buffer_store_dwordx4 v[204:207], v13, s[16:19], s40 offen sc0 sc1
    s_add_u32 s40, s40, 16384
    v_sub_f32 v85, 0, v113
    v_sub_f32 v86, 0, v113
    v_sub_f32 v87, 0, v113
    s_mov_b32 s18, s43
    s_waitcnt lgkmcnt(0)
    s_branch L_itb2_1
L_e3_0_3:
    ds_read_b64_tr_b16 a[160:161], v3 offset:0
    v_exp_f32 v59, v59
    ds_read_b64_tr_b16 a[162:163], v3 offset:512
    v_exp_f32 v60, v60
    ds_read_b64_tr_b16 a[164:165], v3 offset:32
    v_cvt_pk_bf16_f32 v53, v58, v59
    ds_read_b64_tr_b16 a[166:167], v3 offset:544
    v_exp_f32 v61, v61
    ds_read_b64_tr_b16 a[168:169], v3 offset:64
    v_exp_f32 v62, v62
    ds_read_b64_tr_b16 a[170:171], v3 offset:576
    v_cvt_pk_bf16_f32 v54, v60, v61
    ds_read_b64_tr_b16 a[172:173], v3 offset:96
    v_exp_f32 v63, v63
    ds_read_b64_tr_b16 a[174:175], v3 offset:608
    v_exp_f32 v64, v64
    ds_read_b64_tr_b16 a[176:177], v3 offset:128
    v_cvt_pk_bf16_f32 v55, v62, v63
    ds_read_b64_tr_b16 a[178:179], v3 offset:640
    v_exp_f32 v65, v65
    ds_read_b64_tr_b16 a[180:181], v3 offset:160
    v_exp_f32 v66, v66
    ds_read_b64_tr_b16 a[182:183], v3 offset:672
    v_cvt_pk_bf16_f32 v64, v64, v65
    ds_read_b64_tr_b16 a[184:185], v3 offset:192
    v_exp_f32 v67, v67
    ds_read_b64_tr_b16 a[186:187], v3 offset:704
    v_exp_f32 v68, v68
    ds_read_b64_tr_b16 a[188:189], v3 offset:224
    v_cvt_pk_bf16_f32 v65, v66, v67
    ds_read_b64_tr_b16 a[190:191], v3 offset:736
    v_exp_f32 v69, v69
    v_exp_f32 v70, v70
    v_cvt_pk_bf16_f32 v66, v68, v69
    v_exp_f32 v71, v71
    s_nop 0
    v_cvt_pk_bf16_f32 v67, v70, v71
    s_nop 1
    v_smfmac_f32_16x16x64_bf16 a[208:211], a[236:239], v[48:55], v15
    v_mfma_f32_16x16x32_bf16 a[212:215], a[232:235], v[64:67], a[212:215]
    s_waitcnt lgkmcnt(8)
    v_mfma_f32_16x16x32_bf16 v[128:131], a[160:163], v[48:51], v[128:131]
    s_add_u32 m0, s30, 52224
    v_mfma_f32_16x16x32_bf16 v[132:135], a[164:167], v[48:51], v[132:135]
    buffer_load_dwordx4 v4, s[8:11], s28 offen lds
    v_mfma_f32_16x16x32_bf16 v[136:139], a[168:171], v[48:51], v[136:139]
    s_add_u32 m0, s30, 56448
    v_mfma_f32_16x16x32_bf16 v[140:143], a[172:175], v[48:51], v[140:143]
    buffer_load_dwordx4 v5, s[8:11], s28 offen lds
    s_waitcnt lgkmcnt(0)
    v_mfma_f32_16x16x32_bf16 v[144:147], a[176:179], v[48:51], v[144:147]
    s_add_u32 m0, s30, 60928
    ds_read_b128 a[64:67], v9 offset:0
    ds_read_b128 a[68:71], v9 offset:64
    ds_read_b128 a[72:75], v10 offset:0
    v_mfma_f32_16x16x32_bf16 v[148:151], a[180:183], v[48:51], v[148:151]
    buffer_load_dwordx4 v6, s[12:15], s29 offen lds
    ds_read_b128 a[76:79], v10 offset:64
    ds_read_b128 a[80:83], v9 offset:4224
    ds_read_b128 a[84:87], v9 offset:4288
    v_mfma_f32_16x16x32_bf16 v[152:155], a[184:187], v[48:51], v[152:155]
    s_add_u32 m0, s30, 65152
    ds_read_b128 a[88:91], v10 offset:4224
    ds_read_b128 a[92:95], v10 offset:4288
    ds_read_b128 a[96:99], v9 offset:8448
    v_mfma_f32_16x16x32_bf16 v[156:159], a[188:191], v[48:51], v[156:159]
    buffer_load_dwordx4 v7, s[12:15], s29 offen lds
    ds_read_b128 a[100:103], v9 offset:8512
    ds_read_b128 a[104:107], v10 offset:8448
    ds_read_b128 a[108:111], v10 offset:8512
    s_add_u32 s28, s28, s101
    s_add_u32 s29, s29, s101
    v_accvgpr_read_b32 v112, a208
    v_accvgpr_read_b32 v113, a210
    v_accvgpr_read_b32 v114, a212
    v_accvgpr_read_b32 v116, a209
    v_accvgpr_read_b32 v117, a211
    v_add_f32 v112, v112, v116
    v_add_f32 v113, v113, v117
    v_cmp_nge_f32 vcc, 0x44800000, v112
    v_rcp_f32 v120, v112
    s_nop 0
    s_mov_b64 s[84:85], vcc
    v_cmp_nge_f32 vcc, 0x44800000, v113
    v_rcp_f32 v121, v113
    s_nop 0
    s_or_b64 s[84:85], s[84:85], vcc
    v_cmp_nge_f32 vcc, 0x44800000, v114
    v_rcp_f32 v122, v114
    s_nop 0
    s_or_b64 s[84:85], s[84:85], vcc
    s_mov_b32 s40, s34
    s_cbranch_scc1 L_es3_0
    s_waitcnt vmcnt(8) lgkmcnt(0)
    v_mfma_f32_16x16x32_bf16 v[160:163], a[160:163], v[52:55], v[160:163]
    v_mul_f32 v128, v120, v128
    v_mfma_f32_32x32x16_bf16 v[96:111], a[192:195], a[64:67], 0
    v_mul_f32 v129, v120, v129
    v_mul_f32 v130, v120, v130
    s_mov_b32 s80, s81
    s_mov_b32 s81, 0
    s_add_u32 s47, s47, 1
    v_mul_f32 v131, v120, v131
    v_mfma_f32_16x16x32_bf16 v[164:167], a[164:167], v[52:55], v[164:167]
    s_mov_b32 s42, s89
    s_mov_b32 s43, s90
    v_mul_f32 v132, v120, v132
    v_mfma_f32_32x32x16_bf16 v[96:111], a[196:199], a[68:71], v[96:111]
    v_mul_f32 v133, v120, v133
    v_mul_f32 v134, v120, v134
    s_mov_b32 s34, s91
    s_mov_b32 s88, s93
    s_bfe_u32 s37, s80, 0xa000d
    v_mul_f32 v135, v120, v135
    v_mfma_f32_16x16x32_bf16 v[168:171], a[168:171], v[52:55], v[168:171]
    s_add_u32 s36, s37, 31
    s_lshr_b32 s36, s36, 5
    v_cvt_pk_bf16_f32 v128, v128, v129
    v_mfma_f32_32x32x16_bf16 v[96:111], a[200:203], a[64:67], v[96:111]
    v_cvt_pk_bf16_f32 v129, v130, v131
    v_mul_f32 v136, v120, v136
    s_sub_u32 s31, s36, 1
    s_lshl_b32 s39, s31, 5
    s_sub_u32 s35, s37, s39
    v_mul_f32 v137, v120, v137
    v_mfma_f32_16x16x32_bf16 v[172:175], a[172:175], v[52:55], v[172:175]
    s_mov_b32 s46, 0
    s_mov_b32 s99, s33
    v_mul_f32 v138, v120, v138
    v_mfma_f32_32x32x16_bf16 v[96:111], a[204:207], a[68:71], v[96:111]
    v_mul_f32 v139, v120, v139
    v_cvt_pk_bf16_f32 v132, v132, v133
    s_sub_u32 s31, s31, 1
    s_mov_b32 s32, 4
    s_mov_b32 s93, 0
    v_cvt_pk_bf16_f32 v133, v134, v135
    v_mfma_f32_16x16x32_bf16 v[176:179], a[176:179], v[52:55], v[176:179]
    s_mov_b32 s90, 0
    ds_write_b64 v11, v[128:129] offset:0
    v_mfma_f32_32x32x16_bf16 v[224:239], a[192:195], a[72:75], 0
    v_mul_f32 v140, v120, v140
    v_mul_f32 v141, v120, v141
    v_accvgpr_mov_b32 a232, a240
    v_accvgpr_mov_b32 a233, a241
    v_mul_f32 v142, v120, v142
    v_mfma_f32_16x16x32_bf16 v[180:183], a[180:183], v[52:55], v[180:183]
    v_mfma_f32_32x32x16_bf16 v[224:239], a[196:199], a[76:79], v[224:239]
    v_mul_f32 v143, v120, v143
    v_cvt_pk_bf16_f32 v136, v136, v137
    v_accvgpr_mov_b32 a234, a242
    v_accvgpr_mov_b32 a235, a243
    v_cvt_pk_bf16_f32 v137, v138, v139
    v_mfma_f32_32x32x16_bf16 v[224:239], a[200:203], a[72:75], v[224:239]
    ds_write_b64 v11, v[132:133] offset:32
    v_mfma_f32_16x16x32_bf16 v[184:187], a[184:187], v[52:55], v[184:187]
    v_accvgpr_mov_b32 a236, a244
    v_accvgpr_mov_b32 a237, a245
    v_mul_f32 v144, v120, v144
    v_mul_f32 v145, v120, v145
    v_mfma_f32_32x32x16_bf16 v[224:239], a[204:207], a[76:79], v[224:239]
    v_mul_f32 v146, v120, v146
    v_accvgpr_mov_b32 a238, a246
    v_accvgpr_mov_b32 a239, a247
    v_mul_f32 v147, v120, v147
    v_mfma_f32_16x16x32_bf16 v[188:191], a[188:191], v[52:55], v[188:191]
    v_mfma_f32_32x32x16_bf16 a[208:223], v[124:127], v[124:127], 0
    v_cvt_pk_bf16_f32 v140, v140, v141
    v_cvt_pk_bf16_f32 v141, v142, v143
    v_cvt_pk_bf16_f32 v96, v96, v97
    v_cvt_pk_bf16_f32 v97, v98, v99
    v_cvt_pk_bf16_f32 v98, v100, v101
    ds_write_b64 v11, v[136:137] offset:64
    v_cvt_pk_bf16_f32 v99, v102, v103
    v_cvt_pk_bf16_f32 v100, v104, v105
    v_cvt_pk_bf16_f32 v101, v106, v107
    v_mul_f32 v148, v120, v148
    v_mul_f32 v149, v120, v149
    v_cvt_pk_bf16_f32 v102, v108, v109
    v_cvt_pk_bf16_f32 v103, v110, v111
    v_accvgpr_write_b32 a0, v96
    v_mul_f32 v150, v120, v150
    v_mul_f32 v151, v120, v151
    v_accvgpr_write_b32 a1, v97
    v_accvgpr_write_b32 a2, v98
    v_accvgpr_write_b32 a3, v99
    v_cvt_pk_bf16_f32 v144, v144, v145
    v_accvgpr_write_b32 a4, v100
    v_accvgpr_write_b32 a5, v101
    v_accvgpr_write_b32 a6, v102
    v_cvt_pk_bf16_f32 v145, v146, v147
    ds_write_b64 v11, v[140:141] offset:96
    v_accvgpr_write_b32 a7, v103
    v_mul_f32 v152, v120, v152
    v_mul_f32 v153, v120, v153
    v_mfma_f32_32x32x16_bf16 v[96:111], a[192:195], a[80:83], 0
    v_mul_f32 v154, v120, v154
    v_cvt_pk_bf16_f32 v224, v224, v225
    v_cvt_pk_bf16_f32 v225, v226, v227
    v_cvt_pk_bf16_f32 v226, v228, v229
    v_mul_f32 v155, v120, v155
    v_cvt_pk_bf16_f32 v148, v148, v149
    v_cvt_pk_bf16_f32 v227, v230, v231
    v_cvt_pk_bf16_f32 v149, v150, v151
    ds_write_b64 v11, v[144:145] offset:128
    v_mfma_f32_32x32x16_bf16 v[96:111], a[196:199], a[84:87], v[96:111]
    v_mul_f32 v156, v120, v156
    v_mul_f32 v157, v120, v157
    v_cvt_pk_bf16_f32 v228, v232, v233
    v_cvt_pk_bf16_f32 v229, v234, v235
    v_cvt_pk_bf16_f32 v230, v236, v237
    v_mul_f32 v158, v120, v158
    v_cvt_pk_bf16_f32 v231, v238, v239
    v_mul_f32 v159, v120, v159
    v_cvt_pk_bf16_f32 v152, v152, v153
    v_mfma_f32_32x32x16_bf16 v[96:111], a[200:203], a[80:83], v[96:111]
    v_cvt_pk_bf16_f32 v153, v154, v155
    ds_write_b64 v11, v[148:149] offset:160
    v_accvgpr_write_b32 a8, v224
    v_accvgpr_write_b32 a9, v225
    v_accvgpr_write_b32 a10, v226
    v_cvt_pk_bf16_f32 v156, v156, v157
    v_accvgpr_write_b32 a11, v227
    v_cvt_pk_bf16_f32 v157, v158, v159
    ds_write_b64 v11, v[152:153] offset:192
    v_mfma_f32_32x32x16_bf16 v[96:111], a[204:207], a[84:87], v[96:111]
    ds_write_b64 v11, v[156:157] offset:224
    ds_read_b128 v[128:131], v12 offset:0
    v_accvgpr_write_b32 a12, v228
    v_accvgpr_write_b32 a13, v229
    v_accvgpr_write_b32 a14, v230
    ds_read_b128 v[132:135], v12 offset:1088
    v_accvgpr_write_b32 a15, v231
    ds_read_b128 v[136:139], v12 offset:2176
    ds_read_b128 v[140:143], v12 offset:3264
    s_nop 1
    v_mfma_f32_16x16x32_bf16 v[16:19], a[128:131], a[0:3], 0
    v_mfma_f32_16x16x32_bf16 v[192:195], a[160:163], v[64:67], v[192:195]
    v_mul_f32 v160, v121, v160
    v_mfma_f32_16x16x32_bf16 v[16:19], a[132:135], a[4:7], v[16:19]
    v_mul_f32 v161, v121, v161
    v_mfma_f32_16x16x32_bf16 v[16:19], a[136:139], a[8:11], v[16:19]
    v_mul_f32 v162, v121, v162
    v_mul_f32 v163, v121, v163
    v_mfma_f32_16x16x32_bf16 v[16:19], a[140:143], a[12:15], v[16:19]
    v_mfma_f32_16x16x32_bf16 v[196:199], a[164:167], v[64:67], v[196:199]
    v_mul_f32 v164, v121, v164
    v_mfma_f32_16x16x32_bf16 v[20:23], a[144:147], a[0:3], 0
    v_mul_f32 v165, v121, v165
    v_mul_f32 v166, v121, v166
    v_mfma_f32_16x16x32_bf16 v[20:23], a[148:151], a[4:7], v[20:23]
    v_mul_f32 v167, v121, v167
    v_mfma_f32_16x16x32_bf16 v[20:23], a[152:155], a[8:11], v[20:23]
    v_mfma_f32_16x16x32_bf16 v[200:203], a[168:171], v[64:67], v[200:203]
    v_cvt_pk_bf16_f32 v160, v160, v161
    v_mfma_f32_16x16x32_bf16 v[20:23], a[156:159], a[12:15], v[20:23]
    v_cvt_pk_bf16_f32 v161, v162, v163
    v_mul_f32 v168, v121, v168
    v_mfma_f32_32x32x16_bf16 v[224:239], a[192:195], a[88:91], 0
    v_mul_f32 v169, v121, v169
    v_mfma_f32_32x32x16_bf16 v[224:239], a[196:199], a[92:95], v[224:239]
    v_mfma_f32_16x16x32_bf16 v[204:207], a[172:175], v[64:67], v[204:207]
    v_mul_f32 v170, v121, v170
    v_mfma_f32_32x32x16_bf16 v[224:239], a[200:203], a[88:91], v[224:239]
    v_mul_f32 v171, v121, v171
    v_cvt_pk_bf16_f32 v164, v164, v165
    v_mfma_f32_32x32x16_bf16 v[224:239], a[204:207], a[92:95], v[224:239]
    v_cvt_pk_bf16_f32 v165, v166, v167
    v_cvt_pk_bf16_f32 v96, v96, v97
    v_cvt_pk_bf16_f32 v97, v98, v99
    v_cvt_pk_bf16_f32 v98, v100, v101
    v_mfma_f32_16x16x32_bf16 v[208:211], a[176:179], v[64:67], v[208:211]
    ds_write_b64 v11, v[160:161] offset:4352
    v_cvt_pk_bf16_f32 v99, v102, v103
    v_cvt_pk_bf16_f32 v100, v104, v105
    v_cvt_pk_bf16_f32 v101, v106, v107
    s_waitcnt lgkmcnt(4)
    buffer_store_dwordx4 v[128:131], v13, s[16:19], s40 offen sc0 sc1
    v_cvt_pk_bf16_f32 v102, v108, v109
    v_cvt_pk_bf16_f32 v103, v110, v111
    v_accvgpr_write_b32 a16, v96
    s_add_u32 s40, s40, 16384
    v_accvgpr_write_b32 a17, v97
    v_accvgpr_write_b32 a18, v98
    v_accvgpr_write_b32 a19, v99
    v_mul_f32 v172, v121, v172
    v_mul_f32 v173, v121, v173
    v_accvgpr_write_b32 a20, v100
    v_accvgpr_write_b32 a21, v101
    v_accvgpr_write_b32 a22, v102
    v_mul_f32 v174, v121, v174
    v_mfma_f32_16x16x32_bf16 v[212:215], a[180:183], v[64:67], v[212:215]
    v_accvgpr_write_b32 a23, v103
    v_mul_f32 v175, v121, v175
    v_mfma_f32_32x32x16_bf16 v[96:111], a[192:195], a[96:99], 0
    v_cvt_pk_bf16_f32 v168, v168, v169
    v_cvt_pk_bf16_f32 v169, v170, v171
    v_max3_f32 v112, v16, v17, v18
    v_max3_f32 v116, v19, v20, v21
    v_max3_f32 v112, v112, v22, v23
    ds_write_b64 v11, v[164:165] offset:4384
    v_mfma_f32_16x16x32_bf16 v[216:219], a[184:187], v[64:67], v[216:219]
    v_max_f32 v112, v112, v116
    v_mov_b32 v116, v112
    s_nop 1
    v_mul_f32 v176, v121, v176
    v_mul_f32 v177, v121, v177
    v_permlane32_swap_b32 v112, v116
    v_mul_f32 v178, v121, v178
    v_mfma_f32_32x32x16_bf16 v[96:111], a[196:199], a[100:103], v[96:111]
    v_mul_f32 v179, v121, v179
    v_mfma_f32_16x16x32_bf16 v[220:223], a[188:191], v[64:67], v[220:223]
    v_max_f32 v112, v112, v116
    v_mov_b32 v116, v112
    s_nop 1
    v_cvt_pk_bf16_f32 v172, v172, v173
    v_cvt_pk_bf16_f32 v173, v174, v175
    v_permlane16_swap_b32 v112, v116
    v_max_f32 v112, v112, v116
    v_cvt_pk_bf16_f32 v224, v224, v225
    ds_write_b64 v11, v[168:169] offset:4416
    v_cvt_pk_bf16_f32 v225, v226, v227
    s_waitcnt lgkmcnt(5)
    buffer_store_dwordx4 v[132:135], v13, s[16:19], s40 offen sc0 sc1
    v_mfma_f32_32x32x16_bf16 v[96:111], a[200:203], a[96:99], v[96:111]
    s_add_u32 s40, s40, 16384
    v_mul_f32 v180, v121, v180
    v_cvt_pk_bf16_f32 v226, v228, v229
    v_cvt_pk_bf16_f32 v227, v230, v231
    v_cvt_pk_bf16_f32 v228, v232, v233
    v_mul_f32 v181, v121, v181
    v_cvt_pk_bf16_f32 v229, v234, v235
    v_cvt_pk_bf16_f32 v230, v236, v237
    v_cvt_pk_bf16_f32 v231, v238, v239
    v_mul_f32 v182, v121, v182
    v_mul_f32 v183, v121, v183
    v_accvgpr_write_b32 a24, v224
    v_cvt_pk_bf16_f32 v176, v176, v177
    v_cvt_pk_bf16_f32 v177, v178, v179
    v_mfma_f32_32x32x16_bf16 v[96:111], a[204:207], a[100:103], v[96:111]
    ds_write_b64 v11, v[172:173] offset:4448
    v_accvgpr_write_b32 a25, v225
    v_accvgpr_write_b32 a26, v226
    v_accvgpr_write_b32 a27, v227
    v_mul_f32 v184, v121, v184
    v_mul_f32 v185, v121, v185
    v_accvgpr_write_b32 a28, v228
    v_accvgpr_write_b32 a29, v229
    v_accvgpr_write_b32 a30, v230
    v_mul_f32 v186, v121, v186
    v_mul_f32 v187, v121, v187
    v_accvgpr_write_b32 a31, v231
    v_cvt_pk_bf16_f32 v180, v180, v181
    s_nop 1
    v_mfma_f32_16x16x32_bf16 v[24:27], a[128:131], a[16:19], 0
    v_cvt_pk_bf16_f32 v181, v182, v183
    ds_write_b64 v11, v[176:177] offset:4480
    v_sub_f32 v16, v16, v112
    v_sub_f32 v17, v17, v112
    v_sub_f32 v18, v18, v112
    s_waitcnt lgkmcnt(6)
    buffer_store_dwordx4 v[136:139], v13, s[16:19], s40 offen sc0 sc1
    v_mfma_f32_16x16x32_bf16 v[24:27], a[132:135], a[20:23], v[24:27]
    s_add_u32 s40, s40, 16384
    v_mul_f32 v188, v121, v188
    v_sub_f32 v19, v19, v112
    v_sub_f32 v20, v20, v112
    v_sub_f32 v21, v21, v112
    v_mul_f32 v189, v121, v189
    v_mfma_f32_16x16x32_bf16 v[24:27], a[136:139], a[24:27], v[24:27]
    v_mul_f32 v190, v121, v190
    v_mul_f32 v191, v121, v191
    v_sub_f32 v22, v22, v112
    v_sub_f32 v23, v23, v112
    v_sub_f32 v80, 0, v112
    v_cvt_pk_bf16_f32 v184, v184, v185
    v_cvt_pk_bf16_f32 v185, v186, v187
    v_mfma_f32_16x16x32_bf16 v[24:27], a[140:143], a[28:31], v[24:27]
    ds_write_b64 v11, v[180:181] offset:4512
    v_sub_f32 v81, 0, v112
    v_sub_f32 v82, 0, v112
    v_sub_f32 v83, 0, v112
    v_cvt_pk_bf16_f32 v188, v188, v189
    v_cvt_pk_bf16_f32 v189, v190, v191
    v_mfma_f32_16x16x32_bf16 v[28:31], a[144:147], a[16:19], 0
    ds_write_b64 v11, v[184:185] offset:4544
    s_waitcnt lgkmcnt(7)
    buffer_store_dwordx4 v[140:143], v13, s[16:19], s40 offen sc0 sc1
    v_exp_f32 v16, v16
    v_exp_f32 v17, v17
    v_exp_f32 v18, v18
    v_mfma_f32_16x16x32_bf16 v[28:31], a[148:151], a[20:23], v[28:31]
    s_add_u32 s40, s40, 16384
    ds_write_b64 v11, v[188:189] offset:4576
    v_cvt_pk_bf16_f32 v16, v16, v17
    v_exp_f32 v19, v19
    v_exp_f32 v20, v20
    ds_read_b128 v[160:163], v12 offset:4352
    ds_read_b128 v[164:167], v12 offset:5440
    v_mfma_f32_16x16x32_bf16 v[28:31], a[152:155], a[24:27], v[28:31]
    ds_read_b128 v[168:171], v12 offset:6528
    v_cvt_pk_bf16_f32 v17, v18, v19
    v_exp_f32 v21, v21
    v_exp_f32 v22, v22
    ds_read_b128 v[172:175], v12 offset:7616
    v_mfma_f32_32x32x16_bf16 v[128:143], v[124:127], v[124:127], 0
    v_mfma_f32_16x16x32_bf16 v[28:31], a[156:159], a[28:31], v[28:31]
    v_mfma_f32_32x32x16_bf16 v[144:159], v[124:127], v[124:127], 0
    v_mul_f32 v192, v122, v192
    v_cvt_pk_bf16_f32 v18, v20, v21
    v_exp_f32 v23, v23
    s_nop 0
    v_mul_f32 v193, v122, v193
    v_mul_f32 v194, v122, v194
    v_mfma_f32_32x32x16_bf16 v[224:239], a[192:195], a[104:107], 0
    v_mul_f32 v195, v122, v195
    v_cvt_pk_bf16_f32 v19, v22, v23
    v_mul_f32 v196, v122, v196
    v_mul_f32 v197, v122, v197
    v_mfma_f32_32x32x16_bf16 v[224:239], a[196:199], a[108:111], v[224:239]
    v_mul_f32 v198, v122, v198
    v_mul_f32 v199, v122, v199
    v_mfma_f32_32x32x16_bf16 v[224:239], a[200:203], a[104:107], v[224:239]
    v_cvt_pk_bf16_f32 v192, v192, v193
    v_mfma_f32_32x32x16_bf16 v[224:239], a[204:207], a[108:111], v[224:239]
    v_cvt_pk_bf16_f32 v193, v194, v195
    v_mul_f32 v200, v122, v200
    v_cvt_pk_bf16_f32 v96, v96, v97
    v_cvt_pk_bf16_f32 v97, v98, v99
    v_cvt_pk_bf16_f32 v98, v100, v101
    v_mul_f32 v201, v122, v201
    v_mul_f32 v202, v122, v202
    v_cvt_pk_bf16_f32 v99, v102, v103
    v_cvt_pk_bf16_f32 v100, v104, v105
    v_cvt_pk_bf16_f32 v101, v106, v107
    v_mul_f32 v203, v122, v203
    v_cvt_pk_bf16_f32 v102, v108, v109
    v_cvt_pk_bf16_f32 v103, v110, v111
    v_accvgpr_write_b32 a32, v96
    v_cvt_pk_bf16_f32 v196, v196, v197
    v_cvt_pk_bf16_f32 v197, v198, v199
    v_accvgpr_write_b32 a33, v97
    v_accvgpr_write_b32 a34, v98
    v_accvgpr_write_b32 a35, v99
    ds_write_b64 v11, v[192:193] offset:8704
    s_waitcnt lgkmcnt(4)
    buffer_store_dwordx4 v[160:163], v13, s[16:19], s40 offen sc0 sc1
    v_accvgpr_write_b32 a36, v100
    v_accvgpr_write_b32 a37, v101
    v_accvgpr_write_b32 a38, v102
    v_accvgpr_write_b32 a39, v103
    s_add_u32 s40, s40, 16384
    v_mul_f32 v204, v122, v204
    v_max3_f32 v113, v24, v25, v26
    v_max3_f32 v117, v27, v28, v29
    v_max3_f32 v113, v113, v30, v31
    v_mul_f32 v205, v122, v205
    v_mul_f32 v206, v122, v206
    v_max_f32 v113, v113, v117
    v_mov_b32 v117, v113
    s_nop 1
    v_mul_f32 v207, v122, v207
    v_permlane32_swap_b32 v113, v117
    v_max_f32 v113, v113, v117
    v_mov_b32 v117, v113
    v_cvt_pk_bf16_f32 v200, v200, v201
    v_cvt_pk_bf16_f32 v201, v202, v203
    s_nop 1
    v_permlane16_swap_b32 v113, v117
    v_max_f32 v113, v113, v117
    ds_write_b64 v11, v[196:197] offset:8736
    v_mul_f32 v208, v122, v208
    v_cvt_pk_bf16_f32 v224, v224, v225
    v_cvt_pk_bf16_f32 v225, v226, v227
    v_cvt_pk_bf16_f32 v226, v228, v229
    v_mul_f32 v209, v122, v209
    v_mul_f32 v210, v122, v210
    v_cvt_pk_bf16_f32 v227, v230, v231
    v_cvt_pk_bf16_f32 v228, v232, v233
    v_cvt_pk_bf16_f32 v229, v234, v235
    v_mul_f32 v211, v122, v211
    v_cvt_pk_bf16_f32 v230, v236, v237
    v_cvt_pk_bf16_f32 v231, v238, v239
    v_accvgpr_write_b32 a40, v224
    v_cvt_pk_bf16_f32 v204, v204, v205
    v_cvt_pk_bf16_f32 v205, v206, v207
    v_accvgpr_write_b32 a41, v225
    v_accvgpr_write_b32 a42, v226
    v_accvgpr_write_b32 a43, v227
    ds_write_b64 v11, v[200:201] offset:8768
    s_waitcnt lgkmcnt(5)
    buffer_store_dwordx4 v[164:167], v13, s[16:19], s40 offen sc0 sc1
    v_accvgpr_write_b32 a44, v228
    v_accvgpr_write_b32 a45, v229
    v_accvgpr_write_b32 a46, v230
    v_accvgpr_write_b32 a47, v231
    s_add_u32 s40, s40, 16384
    v_mul_f32 v212, v122, v212
    s_nop 1
    v_mfma_f32_16x16x32_bf16 v[32:35], a[128:131], a[32:35], 0
    ds_read_b128 a[128:131], v1 offset:0
    v_mul_f32 v213, v122, v213
    v_mul_f32 v214, v122, v214
    v_sub_f32 v24, v24, v113
    v_sub_f32 v25, v25, v113
    v_mul_f32 v215, v122, v215
    v_mfma_f32_16x16x32_bf16 v[32:35], a[132:135], a[36:39], v[32:35]
    ds_read_b128 a[132:135], v1 offset:64
    v_cvt_pk_bf16_f32 v208, v208, v209
    v_cvt_pk_bf16_f32 v209, v210, v211
    v_sub_f32 v26, v26, v113
    v_sub_f32 v27, v27, v113
    ds_write_b64 v11, v[204:205] offset:8800
    v_mul_f32 v216, v122, v216
    v_mfma_f32_16x16x32_bf16 v[32:35], a[136:139], a[40:43], v[32:35]
    ds_read_b128 a[136:139], v2 offset:0
    v_mul_f32 v217, v122, v217
    v_sub_f32 v28, v28, v113
    v_sub_f32 v29, v29, v113
    v_mul_f32 v218, v122, v218
    v_mul_f32 v219, v122, v219
    v_mfma_f32_16x16x32_bf16 v[32:35], a[140:143], a[44:47], v[32:35]
    ds_read_b128 a[140:143], v2 offset:64
    v_cvt_pk_bf16_f32 v212, v212, v213
    v_cvt_pk_bf16_f32 v213, v214, v215
    v_sub_f32 v30, v30, v113
    v_sub_f32 v31, v31, v113
    ds_write_b64 v11, v[208:209] offset:8832
    v_mfma_f32_16x16x32_bf16 v[36:39], a[144:147], a[32:35], 0
    ds_read_b128 a[144:147], v1 offset:4224
    s_waitcnt lgkmcnt(11)
    buffer_store_dwordx4 v[168:171], v13, s[16:19], s40 offen sc0 sc1
    v_sub_f32 v84, 0, v113
    v_sub_f32 v85, 0, v113
    s_add_u32 s40, s40, 16384
    v_mul_f32 v220, v122, v220
    v_mfma_f32_16x16x32_bf16 v[36:39], a[148:151], a[36:39], v[36:39]
    ds_read_b128 a[148:151], v1 offset:4288
    v_mul_f32 v221, v122, v221
    v_mul_f32 v222, v122, v222
    v_sub_f32 v86, 0, v113
    v_sub_f32 v87, 0, v113
    v_mul_f32 v223, v122, v223
    v_mfma_f32_16x16x32_bf16 v[36:39], a[152:155], a[40:43], v[36:39]
    ds_read_b128 a[152:155], v2 offset:4224
    v_cvt_pk_bf16_f32 v216, v216, v217
    v_cvt_pk_bf16_f32 v217, v218, v219
    v_exp_f32 v24, v24
    v_exp_f32 v25, v25
    ds_write_b64 v11, v[212:213] offset:8864
    v_cvt_pk_bf16_f32 v220, v220, v221
    v_mfma_f32_16x16x32_bf16 v[36:39], a[156:159], a[44:47], v[36:39]
    ds_read_b128 a[156:159], v2 offset:4288
    v_cvt_pk_bf16_f32 v221, v222, v223
    v_exp_f32 v26, v26
    v_cvt_pk_bf16_f32 v20, v24, v25
    ds_write_b64 v11, v[216:217] offset:8896
    s_waitcnt lgkmcnt(15)
    buffer_store_dwordx4 v[172:175], v13, s[16:19], s40 offen sc0 sc1
    s_nop 6
    s_add_u32 s40, s40, 16384
    v_max3_f32 v114, v32, v33, v34
    v_max3_f32 v118, v35, v36, v37
    v_max3_f32 v114, v114, v38, v39
    ds_write_b64 v11, v[220:221] offset:8928
    v_max_f32 v114, v114, v118
    v_mov_b32 v118, v114
    s_nop 1
    ds_read_b128 v[192:195], v12 offset:8704
    ds_read_b128 v[196:199], v12 offset:9792
    v_permlane32_swap_b32 v114, v118
    v_max_f32 v114, v114, v118
    v_mov_b32 v118, v114
    ds_read_b128 v[200:203], v12 offset:10880
    ds_read_b128 v[204:207], v12 offset:11968
    s_nop 1
    v_permlane16_swap_b32 v114, v118
    v_max_f32 v114, v114, v118
    v_mfma_f32_32x32x16_bf16 v[160:175], v[124:127], v[124:127], 0
    v_sub_f32 v32, v32, v114
    v_sub_f32 v33, v33, v114
    v_sub_f32 v34, v34, v114
    v_mfma_f32_32x32x16_bf16 v[176:191], v[124:127], v[124:127], 0
    s_waitcnt lgkmcnt(3)
    buffer_store_dwordx4 v[192:195], v13, s[16:19], s40 offen sc0 sc1
    s_add_u32 s40, s40, 16384
    v_sub_f32 v35, v35, v114
    v_sub_f32 v36, v36, v114
    v_sub_f32 v37, v37, v114
    s_waitcnt lgkmcnt(2)
    buffer_store_dwordx4 v[196:199], v13, s[16:19], s40 offen sc0 sc1
    s_add_u32 s40, s40, 16384
    s_waitcnt lgkmcnt(1)
    buffer_store_dwordx4 v[200:203], v13, s[16:19], s40 offen sc0 sc1
    s_add_u32 s40, s40, 16384
    v_sub_f32 v38, v38, v114
    v_sub_f32 v39, v39, v114
    v_sub_f32 v88, 0, v114
    s_waitcnt lgkmcnt(0)
    buffer_store_dwordx4 v[204:207], v13, s[16:19], s40 offen sc0 sc1
    s_add_u32 s40, s40, 16384
    v_sub_f32 v89, 0, v114
    v_sub_f32 v90, 0, v114
    v_sub_f32 v91, 0, v114
    v_mfma_f32_32x32x16_bf16 v[192:207], v[124:127], v[124:127], 0
    v_mfma_f32_32x32x16_bf16 v[208:223], v[124:127], v[124:127], 0
    s_mov_b32 s18, s43
    s_waitcnt lgkmcnt(0)
    s_branch L_itb3_1
L_e3_0:
    s_mov_b32 s44, 0
    s_waitcnt vmcnt(4)
    s_barrier
L_e3_0_0:
    v_mfma_f32_16x16x32_bf16 v[16:19], a[128:131], a[0:3], v[80:83]
    ds_read_b64_tr_b16 a[160:161], v3 offset:0
    ds_read_b64_tr_b16 a[162:163], v3 offset:512
    v_exp_f32 v59, v59
    v_mfma_f32_16x16x32_bf16 v[16:19], a[132:135], a[4:7], v[16:19]
    ds_read_b64_tr_b16 a[164:165], v3 offset:32
    ds_read_b64_tr_b16 a[166:167], v3 offset:544
    v_exp_f32 v60, v60
    v_cvt_pk_bf16_f32 v53, v58, v59
    v_mfma_f32_16x16x32_bf16 v[16:19], a[136:139], a[8:11], v[16:19]
    ds_read_b64_tr_b16 a[168:169], v3 offset:64
    ds_read_b64_tr_b16 a[170:171], v3 offset:576
    v_exp_f32 v61, v61
    v_mfma_f32_16x16x32_bf16 v[16:19], a[140:143], a[12:15], v[16:19]
    ds_read_b64_tr_b16 a[172:173], v3 offset:96
    ds_read_b64_tr_b16 a[174:175], v3 offset:608
    v_exp_f32 v62, v62
    v_cvt_pk_bf16_f32 v54, v60, v61
    v_mfma_f32_16x16x32_bf16 v[20:23], a[144:147], a[0:3], v[80:83]
    ds_read_b64_tr_b16 a[176:177], v3 offset:128
    ds_read_b64_tr_b16 a[178:179], v3 offset:640
    v_exp_f32 v63, v63
    v_mfma_f32_16x16x32_bf16 v[20:23], a[148:151], a[4:7], v[20:23]
    ds_read_b64_tr_b16 a[180:181], v3 offset:160
    ds_read_b64_tr_b16 a[182:183], v3 offset:672
    v_exp_f32 v64, v64
    v_cvt_pk_bf16_f32 v55, v62, v63
    v_mfma_f32_16x16x32_bf16 v[20:23], a[152:155], a[8:11], v[20:23]
    ds_read_b64_tr_b16 a[184:185], v3 offset:192
    ds_read_b64_tr_b16 a[186:187], v3 offset:704
    v_exp_f32 v65, v65
    v_mfma_f32_16x16x32_bf16 v[20:23], a[156:159], a[12:15], v[20:23]
    ds_read_b64_tr_b16 a[188:189], v3 offset:224
    ds_read_b64_tr_b16 a[190:191], v3 offset:736
    v_exp_f32 v66, v66
    v_cvt_pk_bf16_f32 v64, v64, v65
    v_mfma_f32_16x16x32_bf16 v[24:27], a[128:131], a[16:19], v[84:87]
    ds_read_b64_tr_b16 a[64:65], v3 offset:17408
    ds_read_b64_tr_b16 a[66:67], v3 offset:17920
    v_exp_f32 v67, v67
    v_mfma_f32_16x16x32_bf16 v[24:27], a[132:135], a[20:23], v[24:27]
    ds_read_b64_tr_b16 a[68:69], v3 offset:17440
    ds_read_b64_tr_b16 a[70:71], v3 offset:17952
    v_exp_f32 v68, v68
    v_cvt_pk_bf16_f32 v65, v66, v67
    v_mfma_f32_16x16x32_bf16 v[24:27], a[136:139], a[24:27], v[24:27]
    ds_read_b64_tr_b16 a[72:73], v3 offset:17472
    ds_read_b64_tr_b16 a[74:75], v3 offset:17984
    v_exp_f32 v69, v69
    v_mfma_f32_16x16x32_bf16 v[24:27], a[140:143], a[28:31], v[24:27]
    ds_read_b64_tr_b16 a[76:77], v3 offset:17504
    ds_read_b64_tr_b16 a[78:79], v3 offset:18016
    v_exp_f32 v70, v70
    v_cvt_pk_bf16_f32 v66, v68, v69
    v_mfma_f32_16x16x32_bf16 v[28:31], a[144:147], a[16:19], v[84:87]
    ds_read_b64_tr_b16 a[80:81], v3 offset:17536
    ds_read_b64_tr_b16 a[82:83], v3 offset:18048
    v_exp_f32 v71, v71
    v_mfma_f32_16x16x32_bf16 v[28:31], a[148:151], a[20:23], v[28:31]
    ds_read_b64_tr_b16 a[84:85], v3 offset:17568
    ds_read_b64_tr_b16 a[86:87], v3 offset:18080
    v_cvt_pk_bf16_f32 v67, v70, v71
    v_exp_f32 v16, v16
    v_mfma_f32_16x16x32_bf16 v[28:31], a[152:155], a[24:27], v[28:31]
    ds_read_b64_tr_b16 a[88:89], v3 offset:17600
    ds_read_b64_tr_b16 a[90:91], v3 offset:18112
    v_exp_f32 v17, v17
    v_mfma_f32_16x16x32_bf16 v[28:31], a[156:159], a[28:31], v[28:31]
    ds_read_b64_tr_b16 a[92:93], v3 offset:17632
    ds_read_b64_tr_b16 a[94:95], v3 offset:18144
    v_exp_f32 v18, v18
    v_cvt_pk_bf16_f32 v16, v16, v17
    v_mfma_f32_16x16x32_bf16 v[32:35], a[128:131], a[32:35], v[88:91]
    v_exp_f32 v19, v19
    v_mfma_f32_16x16x32_bf16 v[32:35], a[132:135], a[36:39], v[32:35]
    v_exp_f32 v20, v20
    v_cvt_pk_bf16_f32 v17, v18, v19
    v_mfma_f32_16x16x32_bf16 v[32:35], a[136:139], a[40:43], v[32:35]
    v_exp_f32 v21, v21
    v_mfma_f32_16x16x32_bf16 v[32:35], a[140:143], a[44:47], v[32:35]
    v_exp_f32 v22, v22
    v_cvt_pk_bf16_f32 v18, v20, v21
    v_mfma_f32_16x16x32_bf16 v[36:39], a[144:147], a[32:35], v[88:91]
    v_exp_f32 v23, v23
    v_mfma_f32_16x16x32_bf16 v[36:39], a[148:151], a[36:39], v[36:39]
    v_exp_f32 v24, v24
    v_cvt_pk_bf16_f32 v19, v22, v23
    v_mfma_f32_16x16x32_bf16 v[36:39], a[152:155], a[40:43], v[36:39]
    v_exp_f32 v25, v25
    v_mfma_f32_16x16x32_bf16 v[36:39], a[156:159], a[44:47], v[36:39]
    v_exp_f32 v26, v26
    v_cvt_pk_bf16_f32 v20, v24, v25
    s_waitcnt lgkmcnt(15)
    v_mfma_f32_16x16x32_bf16 v[128:131], a[160:163], v[48:51], v[128:131]
    v_exp_f32 v27, v27
    v_mfma_f32_16x16x32_bf16 v[132:135], a[164:167], v[48:51], v[132:135]
    v_exp_f32 v28, v28
    v_cvt_pk_bf16_f32 v21, v26, v27
    v_mfma_f32_16x16x32_bf16 v[136:139], a[168:171], v[48:51], v[136:139]
    v_exp_f32 v29, v29
    v_mfma_f32_16x16x32_bf16 v[140:143], a[172:175], v[48:51], v[140:143]
    v_exp_f32 v30, v30
    v_cvt_pk_bf16_f32 v22, v28, v29
    v_mfma_f32_16x16x32_bf16 v[144:147], a[176:179], v[48:51], v[144:147]
    v_exp_f32 v31, v31
    v_mfma_f32_16x16x32_bf16 v[148:151], a[180:183], v[48:51], v[148:151]
    v_exp_f32 v32, v32
    v_cvt_pk_bf16_f32 v23, v30, v31
    v_mfma_f32_16x16x32_bf16 v[152:155], a[184:187], v[48:51], v[152:155]
    v_exp_f32 v33, v33
    v_mfma_f32_16x16x32_bf16 v[156:159], a[188:191], v[48:51], v[156:159]
    v_exp_f32 v34, v34
    v_cvt_pk_bf16_f32 v32, v32, v33
    v_mfma_f32_16x16x32_bf16 v[160:163], a[160:163], v[52:55], v[160:163]
    v_exp_f32 v35, v35
    v_mfma_f32_16x16x32_bf16 v[164:167], a[164:167], v[52:55], v[164:167]
    v_exp_f32 v36, v36
    v_cvt_pk_bf16_f32 v33, v34, v35
    v_mfma_f32_16x16x32_bf16 v[168:171], a[168:171], v[52:55], v[168:171]
    v_exp_f32 v37, v37
    v_mfma_f32_16x16x32_bf16 v[172:175], a[172:175], v[52:55], v[172:175]
    v_exp_f32 v38, v38
    v_cvt_pk_bf16_f32 v34, v36, v37
    v_mfma_f32_16x16x32_bf16 v[176:179], a[176:179], v[52:55], v[176:179]
    v_exp_f32 v39, v39
    v_mfma_f32_16x16x32_bf16 v[180:183], a[180:183], v[52:55], v[180:183]
    v_cvt_pk_bf16_f32 v35, v38, v39
    s_nop 1
    v_smfmac_f32_16x16x64_bf16 a[208:211], a[228:231], v[48:55], v15
    v_mfma_f32_16x16x32_bf16 a[212:215], a[224:227], v[64:67], a[212:215]
    v_smfmac_f32_16x16x64_bf16 a[208:211], a[236:239], v[16:23], v15
    v_mfma_f32_16x16x32_bf16 a[212:215], a[232:235], v[32:35], a[212:215]
    s_waitcnt lgkmcnt(0)
    v_mfma_f32_16x16x32_bf16 v[128:131], a[64:67], v[16:19], v[128:131]
    v_mfma_f32_16x16x32_bf16 v[132:135], a[68:71], v[16:19], v[132:135]
    v_mfma_f32_16x16x32_bf16 v[136:139], a[72:75], v[16:19], v[136:139]
    v_mfma_f32_16x16x32_bf16 v[140:143], a[76:79], v[16:19], v[140:143]
    v_mfma_f32_16x16x32_bf16 v[144:147], a[80:83], v[16:19], v[144:147]
    v_mfma_f32_16x16x32_bf16 v[148:151], a[84:87], v[16:19], v[148:151]
    v_mfma_f32_16x16x32_bf16 v[152:155], a[88:91], v[16:19], v[152:155]
    v_mfma_f32_16x16x32_bf16 v[156:159], a[92:95], v[16:19], v[156:159]
    s_nop 3
    v_accvgpr_read_b32 v112, a208
    v_accvgpr_read_b32 v113, a210
    v_accvgpr_read_b32 v114, a212
    v_accvgpr_read_b32 v116, a209
    v_accvgpr_read_b32 v117, a211
    v_add_f32 v112, v112, v116
    v_add_f32 v113, v113, v117
    v_cmp_nge_f32 vcc, 0x44800000, v112
    v_rcp_f32 v120, v112
    s_nop 0
    s_mov_b64 s[84:85], vcc
    v_cmp_nge_f32 vcc, 0x44800000, v113
    v_rcp_f32 v121, v113
    s_nop 0
    s_or_b64 s[84:85], s[84:85], vcc
    v_cmp_nge_f32 vcc, 0x44800000, v114
    v_rcp_f32 v122, v114
    s_nop 0
    s_or_b64 s[84:85], s[84:85], vcc
    s_mov_b32 s40, s34
    s_cbranch_scc1 L_el3_0
    v_mfma_f32_16x16x32_bf16 v[184:187], a[184:187], v[52:55], v[184:187]
    v_mul_f32 v128, v120, v128
    v_mul_f32 v129, v120, v129
    v_mul_f32 v130, v120, v130
    v_mfma_f32_16x16x32_bf16 v[188:191], a[188:191], v[52:55], v[188:191]
    v_mul_f32 v131, v120, v131
    v_mul_f32 v132, v120, v132
    v_mul_f32 v133, v120, v133
    v_mfma_f32_16x16x32_bf16 v[160:163], a[64:67], v[20:23], v[160:163]
    v_mul_f32 v134, v120, v134
    v_mul_f32 v135, v120, v135
    v_cvt_pk_bf16_f32 v128, v128, v129
    v_mfma_f32_16x16x32_bf16 v[164:167], a[68:71], v[20:23], v[164:167]
    v_cvt_pk_bf16_f32 v129, v130, v131
    v_mul_f32 v136, v120, v136
    v_mul_f32 v137, v120, v137
    v_mfma_f32_16x16x32_bf16 v[168:171], a[72:75], v[20:23], v[168:171]
    v_mul_f32 v138, v120, v138
    v_mul_f32 v139, v120, v139
    v_cvt_pk_bf16_f32 v132, v132, v133
    v_mfma_f32_16x16x32_bf16 v[172:175], a[76:79], v[20:23], v[172:175]
    v_cvt_pk_bf16_f32 v133, v134, v135
    ds_write_b64 v11, v[128:129] offset:0
    v_mul_f32 v140, v120, v140
    v_mfma_f32_16x16x32_bf16 v[176:179], a[80:83], v[20:23], v[176:179]
    v_mul_f32 v141, v120, v141
    v_mul_f32 v142, v120, v142
    v_mul_f32 v143, v120, v143
    v_mfma_f32_16x16x32_bf16 v[180:183], a[84:87], v[20:23], v[180:183]
    v_cvt_pk_bf16_f32 v136, v136, v137
    v_cvt_pk_bf16_f32 v137, v138, v139
    ds_write_b64 v11, v[132:133] offset:32
    v_mfma_f32_16x16x32_bf16 v[184:187], a[88:91], v[20:23], v[184:187]
    v_mul_f32 v144, v120, v144
    v_mul_f32 v145, v120, v145
    v_mul_f32 v146, v120, v146
    v_mfma_f32_16x16x32_bf16 v[188:191], a[92:95], v[20:23], v[188:191]
    v_mul_f32 v147, v120, v147
    v_cvt_pk_bf16_f32 v140, v140, v141
    v_cvt_pk_bf16_f32 v141, v142, v143
    ds_write_b64 v11, v[136:137] offset:64
    v_mul_f32 v148, v120, v148
    v_mul_f32 v149, v120, v149
    v_mul_f32 v150, v120, v150
    v_mul_f32 v151, v120, v151
    v_cvt_pk_bf16_f32 v144, v144, v145
    v_cvt_pk_bf16_f32 v145, v146, v147
    ds_write_b64 v11, v[140:141] offset:96
    v_mul_f32 v152, v120, v152
    v_mul_f32 v153, v120, v153
    v_mul_f32 v154, v120, v154
    v_mul_f32 v155, v120, v155
    v_cvt_pk_bf16_f32 v148, v148, v149
    v_cvt_pk_bf16_f32 v149, v150, v151
    ds_write_b64 v11, v[144:145] offset:128
    v_mul_f32 v156, v120, v156
    v_mul_f32 v157, v120, v157
    v_mul_f32 v158, v120, v158
    v_mul_f32 v159, v120, v159
    v_cvt_pk_bf16_f32 v152, v152, v153
    v_cvt_pk_bf16_f32 v153, v154, v155
    ds_write_b64 v11, v[148:149] offset:160
    v_cvt_pk_bf16_f32 v156, v156, v157
    v_cvt_pk_bf16_f32 v157, v158, v159
    ds_write_b64 v11, v[152:153] offset:192
    ds_write_b64 v11, v[156:157] offset:224
    ds_read_b128 v[128:131], v12 offset:0
    ds_read_b128 v[132:135], v12 offset:1088
    ds_read_b128 v[136:139], v12 offset:2176
    ds_read_b128 v[140:143], v12 offset:3264
    v_mfma_f32_16x16x32_bf16 v[192:195], a[160:163], v[64:67], v[192:195]
    v_mul_f32 v160, v121, v160
    v_mul_f32 v161, v121, v161
    v_mul_f32 v162, v121, v162
    v_mfma_f32_16x16x32_bf16 v[196:199], a[164:167], v[64:67], v[196:199]
    v_mul_f32 v163, v121, v163
    v_mul_f32 v164, v121, v164
    v_mul_f32 v165, v121, v165
    v_mfma_f32_16x16x32_bf16 v[200:203], a[168:171], v[64:67], v[200:203]
    v_mul_f32 v166, v121, v166
    v_mul_f32 v167, v121, v167
    v_cvt_pk_bf16_f32 v160, v160, v161
    v_mfma_f32_16x16x32_bf16 v[204:207], a[172:175], v[64:67], v[204:207]
    v_cvt_pk_bf16_f32 v161, v162, v163
    v_mul_f32 v168, v121, v168
    v_mul_f32 v169, v121, v169
    v_mfma_f32_16x16x32_bf16 v[208:211], a[176:179], v[64:67], v[208:211]
    v_mul_f32 v170, v121, v170
    v_mul_f32 v171, v121, v171
    v_cvt_pk_bf16_f32 v164, v164, v165
    v_mfma_f32_16x16x32_bf16 v[212:215], a[180:183], v[64:67], v[212:215]
    v_cvt_pk_bf16_f32 v165, v166, v167
    ds_write_b64 v11, v[160:161] offset:4352
    s_waitcnt lgkmcnt(4)
    buffer_store_dwordx4 v[128:131], v13, s[16:19], s40 offen sc0 sc1
    s_add_u32 s40, s40, 16384
    v_mul_f32 v172, v121, v172
    v_mfma_f32_16x16x32_bf16 v[216:219], a[184:187], v[64:67], v[216:219]
    v_mul_f32 v173, v121, v173
    v_mul_f32 v174, v121, v174
    v_mul_f32 v175, v121, v175
    v_mfma_f32_16x16x32_bf16 v[220:223], a[188:191], v[64:67], v[220:223]
    v_cvt_pk_bf16_f32 v168, v168, v169
    v_cvt_pk_bf16_f32 v169, v170, v171
    ds_write_b64 v11, v[164:165] offset:4384
    v_mfma_f32_16x16x32_bf16 v[192:195], a[64:67], v[32:35], v[192:195]
    v_mul_f32 v176, v121, v176
    v_mul_f32 v177, v121, v177
    v_mul_f32 v178, v121, v178
    v_mfma_f32_16x16x32_bf16 v[196:199], a[68:71], v[32:35], v[196:199]
    v_mul_f32 v179, v121, v179
    v_cvt_pk_bf16_f32 v172, v172, v173
    v_cvt_pk_bf16_f32 v173, v174, v175
    v_mfma_f32_16x16x32_bf16 v[200:203], a[72:75], v[32:35], v[200:203]
    ds_write_b64 v11, v[168:169] offset:4416
    s_waitcnt lgkmcnt(5)
    buffer_store_dwordx4 v[132:135], v13, s[16:19], s40 offen sc0 sc1
    s_add_u32 s40, s40, 16384
    v_mul_f32 v180, v121, v180
    v_mul_f32 v181, v121, v181
    v_mfma_f32_16x16x32_bf16 v[204:207], a[76:79], v[32:35], v[204:207]
    v_mul_f32 v182, v121, v182
    v_mul_f32 v183, v121, v183
    v_cvt_pk_bf16_f32 v176, v176, v177
    v_mfma_f32_16x16x32_bf16 v[208:211], a[80:83], v[32:35], v[208:211]
    v_cvt_pk_bf16_f32 v177, v178, v179
    ds_write_b64 v11, v[172:173] offset:4448
    v_mul_f32 v184, v121, v184
    v_mfma_f32_16x16x32_bf16 v[212:215], a[84:87], v[32:35], v[212:215]
    v_mul_f32 v185, v121, v185
    v_mul_f32 v186, v121, v186
    v_mul_f32 v187, v121, v187
    v_mfma_f32_16x16x32_bf16 v[216:219], a[88:91], v[32:35], v[216:219]
    v_cvt_pk_bf16_f32 v180, v180, v181
    v_cvt_pk_bf16_f32 v181, v182, v183
    ds_write_b64 v11, v[176:177] offset:4480
    s_waitcnt lgkmcnt(6)
    buffer_store_dwordx4 v[136:139], v13, s[16:19], s40 offen sc0 sc1
    s_add_u32 s40, s40, 16384
    v_mfma_f32_16x16x32_bf16 v[220:223], a[92:95], v[32:35], v[220:223]
    v_mul_f32 v188, v121, v188
    v_mul_f32 v189, v121, v189
    v_mul_f32 v190, v121, v190
    v_mul_f32 v191, v121, v191
    v_cvt_pk_bf16_f32 v184, v184, v185
    v_cvt_pk_bf16_f32 v185, v186, v187
    ds_write_b64 v11, v[180:181] offset:4512
    v_cvt_pk_bf16_f32 v188, v188, v189
    v_cvt_pk_bf16_f32 v189, v190, v191
    ds_write_b64 v11, v[184:185] offset:4544
    s_waitcnt lgkmcnt(7)
    buffer_store_dwordx4 v[140:143], v13, s[16:19], s40 offen sc0 sc1
    s_add_u32 s40, s40, 16384
    ds_write_b64 v11, v[188:189] offset:4576
    ds_read_b128 v[160:163], v12 offset:4352
    ds_read_b128 v[164:167], v12 offset:5440
    ds_read_b128 v[168:171], v12 offset:6528
    ds_read_b128 v[172:175], v12 offset:7616
    v_mul_f32 v192, v122, v192
    v_mul_f32 v193, v122, v193
    v_mul_f32 v194, v122, v194
    v_mul_f32 v195, v122, v195
    v_mul_f32 v196, v122, v196
    v_mul_f32 v197, v122, v197
    v_mul_f32 v198, v122, v198
    v_mul_f32 v199, v122, v199
    v_cvt_pk_bf16_f32 v192, v192, v193
    v_cvt_pk_bf16_f32 v193, v194, v195
    v_mul_f32 v200, v122, v200
    v_mul_f32 v201, v122, v201
    v_mul_f32 v202, v122, v202
    v_mul_f32 v203, v122, v203
    v_cvt_pk_bf16_f32 v196, v196, v197
    v_cvt_pk_bf16_f32 v197, v198, v199
    ds_write_b64 v11, v[192:193] offset:8704
    s_waitcnt lgkmcnt(4)
    buffer_store_dwordx4 v[160:163], v13, s[16:19], s40 offen sc0 sc1
    s_add_u32 s40, s40, 16384
    v_mul_f32 v204, v122, v204
    v_mul_f32 v205, v122, v205
    v_mul_f32 v206, v122, v206
    v_mul_f32 v207, v122, v207
    v_cvt_pk_bf16_f32 v200, v200, v201
    v_cvt_pk_bf16_f32 v201, v202, v203
    ds_write_b64 v11, v[196:197] offset:8736
    v_mul_f32 v208, v122, v208
    v_mul_f32 v209, v122, v209
    v_mul_f32 v210, v122, v210
    v_mul_f32 v211, v122, v211
    v_cvt_pk_bf16_f32 v204, v204, v205
    v_cvt_pk_bf16_f32 v205, v206, v207
    ds_write_b64 v11, v[200:201] offset:8768
    s_waitcnt lgkmcnt(5)
    buffer_store_dwordx4 v[164:167], v13, s[16:19], s40 offen sc0 sc1
    s_add_u32 s40, s40, 16384
    v_mul_f32 v212, v122, v212
    v_mul_f32 v213, v122, v213
    v_mul_f32 v214, v122, v214
    v_mul_f32 v215, v122, v215
    v_cvt_pk_bf16_f32 v208, v208, v209
    v_cvt_pk_bf16_f32 v209, v210, v211
    ds_write_b64 v11, v[204:205] offset:8800
    v_mul_f32 v216, v122, v216
    v_mul_f32 v217, v122, v217
    v_mul_f32 v218, v122, v218
    v_mul_f32 v219, v122, v219
    v_cvt_pk_bf16_f32 v212, v212, v213
    v_cvt_pk_bf16_f32 v213, v214, v215
    ds_write_b64 v11, v[208:209] offset:8832
    s_waitcnt lgkmcnt(6)
    buffer_store_dwordx4 v[168:171], v13, s[16:19], s40 offen sc0 sc1
    s_add_u32 s40, s40, 16384
    v_mul_f32 v220, v122, v220
    v_mul_f32 v221, v122, v221
    v_mul_f32 v222, v122, v222
    v_mul_f32 v223, v122, v223
    v_cvt_pk_bf16_f32 v216, v216, v217
    v_cvt_pk_bf16_f32 v217, v218, v219
    ds_write_b64 v11, v[212:213] offset:8864
    v_cvt_pk_bf16_f32 v220, v220, v221
    v_cvt_pk_bf16_f32 v221, v222, v223
    ds_write_b64 v11, v[216:217] offset:8896
    s_waitcnt lgkmcnt(7)
    buffer_store_dwordx4 v[172:175], v13, s[16:19], s40 offen sc0 sc1
    s_add_u32 s40, s40, 16384
    ds_write_b64 v11, v[220:221] offset:8928
    ds_read_b128 v[192:195], v12 offset:8704
    ds_read_b128 v[196:199], v12 offset:9792
    ds_read_b128 v[200:203], v12 offset:10880
    ds_read_b128 v[204:207], v12 offset:11968
    s_waitcnt lgkmcnt(3)
    buffer_store_dwordx4 v[192:195], v13, s[16:19], s40 offen sc0 sc1
    s_add_u32 s40, s40, 16384
    s_waitcnt lgkmcnt(2)
    buffer_store_dwordx4 v[196:199], v13, s[16:19], s40 offen sc0 sc1
    s_add_u32 s40, s40, 16384
    s_waitcnt lgkmcnt(1)
    buffer_store_dwordx4 v[200:203], v13, s[16:19], s40 offen sc0 sc1
    s_add_u32 s40, s40, 16384
    s_waitcnt lgkmcnt(0)
    buffer_store_dwordx4 v[204:207], v13, s[16:19], s40 offen sc0 sc1
    s_add_u32 s40, s40, 16384
    s_endpgm
L_e3x_1:
    s_mov_b32 s44, 1
    s_barrier
L_e3_1_2:
    ds_read_b64_tr_b16 a[160:161], v3 offset:17408
    v_exp_f32 v27, v27
    ds_read_b64_tr_b16 a[162:163], v3 offset:17920
    v_exp_f32 v28, v28
    ds_read_b64_tr_b16 a[164:165], v3 offset:17440
    v_cvt_pk_bf16_f32 v21, v26, v27
    ds_read_b64_tr_b16 a[166:167], v3 offset:17952
    v_exp_f32 v29, v29
    ds_read_b64_tr_b16 a[168:169], v3 offset:17472
    v_exp_f32 v30, v30
    ds_read_b64_tr_b16 a[170:171], v3 offset:17984
    v_cvt_pk_bf16_f32 v22, v28, v29
    ds_read_b64_tr_b16 a[172:173], v3 offset:17504
    v_exp_f32 v31, v31
    ds_read_b64_tr_b16 a[174:175], v3 offset:18016
    v_exp_f32 v32, v32
    ds_read_b64_tr_b16 a[176:177], v3 offset:17536
    v_cvt_pk_bf16_f32 v23, v30, v31
    ds_read_b64_tr_b16 a[178:179], v3 offset:18048
    v_exp_f32 v33, v33
    ds_read_b64_tr_b16 a[180:181], v3 offset:17568
    v_exp_f32 v34, v34
    ds_read_b64_tr_b16 a[182:183], v3 offset:18080
    v_cvt_pk_bf16_f32 v32, v32, v33
    ds_read_b64_tr_b16 a[184:185], v3 offset:17600
    v_exp_f32 v35, v35
    ds_read_b64_tr_b16 a[186:187], v3 offset:18112
    v_exp_f32 v36, v36
    ds_read_b64_tr_b16 a[188:189], v3 offset:17632
    v_cvt_pk_bf16_f32 v33, v34, v35
    ds_read_b64_tr_b16 a[190:191], v3 offset:18144
    v_exp_f32 v37, v37
    v_exp_f32 v38, v38
    v_cvt_pk_bf16_f32 v34, v36, v37
    v_exp_f32 v39, v39
    s_nop 0
    v_cvt_pk_bf16_f32 v35, v38, v39
    s_nop 1
    v_smfmac_f32_16x16x64_bf16 a[208:211], a[236:239], v[16:23], v15
    v_mfma_f32_16x16x32_bf16 a[212:215], a[232:235], v[32:35], a[212:215]
    s_waitcnt lgkmcnt(8)
    v_mfma_f32_16x16x32_bf16 v[128:131], a[160:163], v[16:19], v[128:131]
    s_add_u32 m0, s30, 0
    v_mfma_f32_16x16x32_bf16 v[132:135], a[164:167], v[16:19], v[132:135]
    buffer_load_dwordx4 v4, s[8:11], s28 offen lds
    v_mfma_f32_16x16x32_bf16 v[136:139], a[168:171], v[16:19], v[136:139]
    s_add_u32 m0, s30, 4224
    v_mfma_f32_16x16x32_bf16 v[140:143], a[172:175], v[16:19], v[140:143]
    buffer_load_dwordx4 v5, s[8:11], s28 offen lds
    s_waitcnt lgkmcnt(0)
    v_mfma_f32_16x16x32_bf16 v[144:147], a[176:179], v[16:19], v[144:147]
    s_add_u32 m0, s30, 8704
    ds_read_b128 a[64:67], v9 offset:0
    ds_read_b128 a[68:71], v9 offset:64
    v_mfma_f32_16x16x32_bf16 v[148:151], a[180:183], v[16:19], v[148:151]
    buffer_load_dwordx4 v6, s[12:15], s29 offen lds
    ds_read_b128 a[72:75], v10 offset:0
    ds_read_b128 a[76:79], v10 offset:64
    v_mfma_f32_16x16x32_bf16 v[152:155], a[184:187], v[16:19], v[152:155]
    s_add_u32 m0, s30, 12928
    ds_read_b128 a[80:83], v9 offset:4224
    ds_read_b128 a[84:87], v9 offset:4288
    v_mfma_f32_16x16x32_bf16 v[156:159], a[188:191], v[16:19], v[156:159]
    buffer_load_dwordx4 v7, s[12:15], s29 offen lds
    ds_read_b128 a[88:91], v10 offset:4224
    ds_read_b128 a[92:95], v10 offset:4288
    s_add_u32 s28, s28, s101
    s_add_u32 s29, s29, s101
    v_accvgpr_read_b32 v112, a208
    v_accvgpr_read_b32 v113, a210
    v_accvgpr_read_b32 v114, a212
    v_accvgpr_read_b32 v116, a209
    v_accvgpr_read_b32 v117, a211
    v_add_f32 v112, v112, v116
    v_add_f32 v113, v113, v117
    v_cmp_nge_f32 vcc, 0x44800000, v112
    v_rcp_f32 v120, v112
    s_nop 0
    s_mov_b64 s[84:85], vcc
    v_cmp_nge_f32 vcc, 0x44800000, v113
    v_rcp_f32 v121, v113
    s_nop 0
    s_or_b64 s[84:85], s[84:85], vcc
    v_cmp_nge_f32 vcc, 0x44800000, v114
    v_rcp_f32 v122, v114
    s_nop 0
    s_or_b64 s[84:85], s[84:85], vcc
    s_mov_b32 s40, s34
    s_cbranch_scc1 L_es3_1
    s_waitcnt vmcnt(8) lgkmcnt(0)
    v_mfma_f32_16x16x32_bf16 v[160:163], a[160:163], v[20:23], v[160:163]
    v_mul_f32 v128, v120, v128
    v_mul_f32 v129, v120, v129
    v_mfma_f32_32x32x16_bf16 v[96:111], a[192:195], a[64:67], 0
    v_mul_f32 v130, v120, v130
    v_mul_f32 v131, v120, v131
    s_mov_b32 s80, s81
    s_mov_b32 s81, 0
    s_add_u32 s47, s47, 1
    v_mfma_f32_16x16x32_bf16 v[164:167], a[164:167], v[20:23], v[164:167]
    v_mul_f32 v132, v120, v132
    v_mul_f32 v133, v120, v133
    s_mov_b32 s42, s89
    s_mov_b32 s43, s90
    v_mul_f32 v134, v120, v134
    v_mul_f32 v135, v120, v135
    v_mfma_f32_32x32x16_bf16 v[96:111], a[196:199], a[68:71], v[96:111]
    v_mfma_f32_16x16x32_bf16 v[168:171], a[168:171], v[20:23], v[168:171]
    v_cvt_pk_bf16_f32 v128, v128, v129
    v_cvt_pk_bf16_f32 v129, v130, v131
    s_mov_b32 s34, s91
    s_mov_b32 s88, s93
    s_bfe_u32 s37, s80, 0xa000d
    v_mul_f32 v136, v120, v136
    v_mul_f32 v137, v120, v137
    s_add_u32 s36, s37, 31
    s_lshr_b32 s36, s36, 5
    v_mfma_f32_16x16x32_bf16 v[172:175], a[172:175], v[20:23], v[172:175]
    v_mul_f32 v138, v120, v138
    v_mul_f32 v139, v120, v139
    v_mfma_f32_32x32x16_bf16 v[96:111], a[200:203], a[64:67], v[96:111]
    v_cvt_pk_bf16_f32 v132, v132, v133
    v_cvt_pk_bf16_f32 v133, v134, v135
    s_sub_u32 s31, s36, 1
    s_lshl_b32 s39, s31, 5
    s_sub_u32 s35, s37, s39
    v_mfma_f32_16x16x32_bf16 v[176:179], a[176:179], v[20:23], v[176:179]
    ds_write_b64 v11, v[128:129] offset:0
    v_mul_f32 v140, v120, v140
    s_mov_b32 s46, 0
    s_mov_b32 s99, s33
    v_mul_f32 v141, v120, v141
    v_mul_f32 v142, v120, v142
    v_mfma_f32_32x32x16_bf16 v[96:111], a[204:207], a[68:71], v[96:111]
    v_mfma_f32_16x16x32_bf16 v[180:183], a[180:183], v[20:23], v[180:183]
    v_mul_f32 v143, v120, v143
    v_cvt_pk_bf16_f32 v136, v136, v137
    s_sub_u32 s31, s31, 1
    s_mov_b32 s32, 4
    s_mov_b32 s93, 0
    v_cvt_pk_bf16_f32 v137, v138, v139
    ds_write_b64 v11, v[132:133] offset:32
    s_mov_b32 s90, 0
    v_mfma_f32_16x16x32_bf16 v[184:187], a[184:187], v[20:23], v[184:187]
    v_mul_f32 v144, v120, v144
    v_mul_f32 v145, v120, v145
    v_mfma_f32_32x32x16_bf16 v[224:239], a[192:195], a[72:75], 0
    v_mul_f32 v146, v120, v146
    v_mul_f32 v147, v120, v147
    v_accvgpr_mov_b32 a232, a240
    v_accvgpr_mov_b32 a233, a241
    v_mfma_f32_16x16x32_bf16 v[188:191], a[188:191], v[20:23], v[188:191]
    v_cvt_pk_bf16_f32 v140, v140, v141
    v_cvt_pk_bf16_f32 v141, v142, v143
    v_mfma_f32_32x32x16_bf16 v[224:239], a[196:199], a[76:79], v[224:239]
    ds_write_b64 v11, v[136:137] offset:64
    v_mul_f32 v148, v120, v148
    v_accvgpr_mov_b32 a234, a242
    v_accvgpr_mov_b32 a235, a243
    v_mul_f32 v149, v120, v149
    v_mul_f32 v150, v120, v150
    v_mul_f32 v151, v120, v151
    v_mfma_f32_32x32x16_bf16 v[224:239], a[200:203], a[72:75], v[224:239]
    v_cvt_pk_bf16_f32 v144, v144, v145
    v_cvt_pk_bf16_f32 v145, v146, v147
    v_accvgpr_mov_b32 a236, a244
    v_accvgpr_mov_b32 a237, a245
    ds_write_b64 v11, v[140:141] offset:96
    v_mul_f32 v152, v120, v152
    v_mul_f32 v153, v120, v153
    v_mfma_f32_32x32x16_bf16 v[224:239], a[204:207], a[76:79], v[224:239]
    v_mul_f32 v154, v120, v154
    v_mul_f32 v155, v120, v155
    v_accvgpr_mov_b32 a238, a246
    v_accvgpr_mov_b32 a239, a247
    v_cvt_pk_bf16_f32 v148, v148, v149
    v_cvt_pk_bf16_f32 v149, v150, v151
    ds_write_b64 v11, v[144:145] offset:128
    v_mfma_f32_32x32x16_bf16 a[208:223], v[124:127], v[124:127], 0
    v_mul_f32 v156, v120, v156
    v_mul_f32 v157, v120, v157
    v_cvt_pk_bf16_f32 v96, v96, v97
    v_cvt_pk_bf16_f32 v97, v98, v99
    v_cvt_pk_bf16_f32 v98, v100, v101
    v_mul_f32 v158, v120, v158
    v_mul_f32 v159, v120, v159
    v_cvt_pk_bf16_f32 v152, v152, v153
    v_cvt_pk_bf16_f32 v99, v102, v103
    v_cvt_pk_bf16_f32 v100, v104, v105
    v_cvt_pk_bf16_f32 v101, v106, v107
    v_cvt_pk_bf16_f32 v153, v154, v155
    ds_write_b64 v11, v[148:149] offset:160
    v_cvt_pk_bf16_f32 v102, v108, v109
    v_cvt_pk_bf16_f32 v103, v110, v111
    v_accvgpr_write_b32 a0, v96
    v_cvt_pk_bf16_f32 v156, v156, v157
    v_cvt_pk_bf16_f32 v157, v158, v159
    v_accvgpr_write_b32 a1, v97
    v_accvgpr_write_b32 a2, v98
    v_accvgpr_write_b32 a3, v99
    ds_write_b64 v11, v[152:153] offset:192
    ds_write_b64 v11, v[156:157] offset:224
    ds_read_b128 v[128:131], v12 offset:0
    v_accvgpr_write_b32 a4, v100
    v_accvgpr_write_b32 a5, v101
    v_accvgpr_write_b32 a6, v102
    ds_read_b128 v[132:135], v12 offset:1088
    ds_read_b128 v[136:139], v12 offset:2176
    v_accvgpr_write_b32 a7, v103
    ds_read_b128 v[140:143], v12 offset:3264
    v_mfma_f32_16x16x32_bf16 v[192:195], a[160:163], v[32:35], v[192:195]
    v_mul_f32 v160, v121, v160
    v_mfma_f32_32x32x16_bf16 v[96:111], a[192:195], a[80:83], 0
    v_mul_f32 v161, v121, v161
    v_mul_f32 v162, v121, v162
    v_cvt_pk_bf16_f32 v224, v224, v225
    v_cvt_pk_bf16_f32 v225, v226, v227
    v_cvt_pk_bf16_f32 v226, v228, v229
    v_mul_f32 v163, v121, v163
    v_mfma_f32_16x16x32_bf16 v[196:199], a[164:167], v[32:35], v[196:199]
    v_mul_f32 v164, v121, v164
    v_cvt_pk_bf16_f32 v227, v230, v231
    v_mul_f32 v165, v121, v165
    v_mul_f32 v166, v121, v166
    v_mfma_f32_32x32x16_bf16 v[96:111], a[196:199], a[84:87], v[96:111]
    v_mul_f32 v167, v121, v167
    v_mfma_f32_16x16x32_bf16 v[200:203], a[168:171], v[32:35], v[200:203]
    v_cvt_pk_bf16_f32 v160, v160, v161
    v_cvt_pk_bf16_f32 v228, v232, v233
    v_cvt_pk_bf16_f32 v229, v234, v235
    v_cvt_pk_bf16_f32 v230, v236, v237
    v_cvt_pk_bf16_f32 v161, v162, v163
    v_mul_f32 v168, v121, v168
    v_cvt_pk_bf16_f32 v231, v238, v239
    v_mul_f32 v169, v121, v169
    v_mfma_f32_16x16x32_bf16 v[204:207], a[172:175], v[32:35], v[204:207]
    v_mul_f32 v170, v121, v170
    v_mfma_f32_32x32x16_bf16 v[96:111], a[200:203], a[80:83], v[96:111]
    v_mul_f32 v171, v121, v171
    v_cvt_pk_bf16_f32 v164, v164, v165
    v_accvgpr_write_b32 a8, v224
    v_accvgpr_write_b32 a9, v225
    v_accvgpr_write_b32 a10, v226
    v_cvt_pk_bf16_f32 v165, v166, v167
    v_mfma_f32_16x16x32_bf16 v[208:211], a[176:179], v[32:35], v[208:211]
    ds_write_b64 v11, v[160:161] offset:4352
    v_accvgpr_write_b32 a11, v227
    s_waitcnt lgkmcnt(4)
    buffer_store_dwordx4 v[128:131], v13, s[16:19], s40 offen sc0 sc1
    v_mfma_f32_32x32x16_bf16 v[96:111], a[204:207], a[84:87], v[96:111]
    s_add_u32 s40, s40, 16384
    v_mul_f32 v172, v121, v172
    v_mul_f32 v173, v121, v173
    v_accvgpr_write_b32 a12, v228
    v_accvgpr_write_b32 a13, v229
    v_accvgpr_write_b32 a14, v230
    v_mul_f32 v174, v121, v174
    v_mfma_f32_16x16x32_bf16 v[212:215], a[180:183], v[32:35], v[212:215]
    v_accvgpr_write_b32 a15, v231
    v_mul_f32 v175, v121, v175
    v_cvt_pk_bf16_f32 v168, v168, v169
    v_cvt_pk_bf16_f32 v169, v170, v171
    s_nop 1
    v_mfma_f32_16x16x32_bf16 v[48:51], a[128:131], a[0:3], 0
    ds_write_b64 v11, v[164:165] offset:4384
    v_mfma_f32_16x16x32_bf16 v[216:219], a[184:187], v[32:35], v[216:219]
    v_mfma_f32_16x16x32_bf16 v[48:51], a[132:135], a[4:7], v[48:51]
    v_mul_f32 v176, v121, v176
    v_mul_f32 v177, v121, v177
    v_mul_f32 v178, v121, v178
    v_mfma_f32_16x16x32_bf16 v[48:51], a[136:139], a[8:11], v[48:51]
    v_mul_f32 v179, v121, v179
    v_mfma_f32_16x16x32_bf16 v[220:223], a[188:191], v[32:35], v[220:223]
    v_mfma_f32_16x16x32_bf16 v[48:51], a[140:143], a[12:15], v[48:51]
    v_cvt_pk_bf16_f32 v172, v172, v173
    v_cvt_pk_bf16_f32 v173, v174, v175
    ds_write_b64 v11, v[168:169] offset:4416
    v_mfma_f32_16x16x32_bf16 v[52:55], a[144:147], a[0:3], 0
    s_waitcnt lgkmcnt(5)
    buffer_store_dwordx4 v[132:135], v13, s[16:19], s40 offen sc0 sc1
    v_mfma_f32_16x16x32_bf16 v[52:55], a[148:151], a[4:7], v[52:55]
    s_add_u32 s40, s40, 16384
    v_mul_f32 v180, v121, v180
    v_mul_f32 v181, v121, v181
    v_mfma_f32_16x16x32_bf16 v[52:55], a[152:155], a[8:11], v[52:55]
    v_mul_f32 v182, v121, v182
    v_mul_f32 v183, v121, v183
    v_mfma_f32_16x16x32_bf16 v[52:55], a[156:159], a[12:15], v[52:55]
    v_cvt_pk_bf16_f32 v176, v176, v177
    v_cvt_pk_bf16_f32 v177, v178, v179
    v_mfma_f32_32x32x16_bf16 v[224:239], a[192:195], a[88:91], 0
    ds_write_b64 v11, v[172:173] offset:4448
    v_mul_f32 v184, v121, v184
    v_mul_f32 v185, v121, v185
    v_mfma_f32_32x32x16_bf16 v[224:239], a[196:199], a[92:95], v[224:239]
    v_mul_f32 v186, v121, v186
    v_mul_f32 v187, v121, v187
    v_mfma_f32_32x32x16_bf16 v[224:239], a[200:203], a[88:91], v[224:239]
    v_cvt_pk_bf16_f32 v180, v180, v181
    v_cvt_pk_bf16_f32 v181, v182, v183
    ds_write_b64 v11, v[176:177] offset:4480
    v_mfma_f32_32x32x16_bf16 v[224:239], a[204:207], a[92:95], v[224:239]
    s_waitcnt lgkmcnt(6)
    buffer_store_dwordx4 v[136:139], v13, s[16:19], s40 offen sc0 sc1
    v_cvt_pk_bf16_f32 v96, v96, v97
    v_cvt_pk_bf16_f32 v97, v98, v99
    v_cvt_pk_bf16_f32 v98, v100, v101
    s_add_u32 s40, s40, 16384
    v_mul_f32 v188, v121, v188
    v_mul_f32 v189, v121, v189
    v_cvt_pk_bf16_f32 v99, v102, v103
    v_cvt_pk_bf16_f32 v100, v104, v105
    v_cvt_pk_bf16_f32 v101, v106, v107
    v_mul_f32 v190, v121, v190
    v_mul_f32 v191, v121, v191
    v_cvt_pk_bf16_f32 v102, v108, v109
    v_cvt_pk_bf16_f32 v103, v110, v111
    v_accvgpr_write_b32 a16, v96
    v_cvt_pk_bf16_f32 v184, v184, v185
    v_cvt_pk_bf16_f32 v185, v186, v187
    ds_write_b64 v11, v[180:181] offset:4512
    v_accvgpr_write_b32 a17, v97
    v_accvgpr_write_b32 a18, v98
    v_accvgpr_write_b32 a19, v99
    v_cvt_pk_bf16_f32 v188, v188, v189
    v_cvt_pk_bf16_f32 v189, v190, v191
    v_accvgpr_write_b32 a20, v100
    v_accvgpr_write_b32 a21, v101
    v_accvgpr_write_b32 a22, v102
    ds_write_b64 v11, v[184:185] offset:4544
    s_waitcnt lgkmcnt(7)
    buffer_store_dwordx4 v[140:143], v13, s[16:19], s40 offen sc0 sc1
    v_accvgpr_write_b32 a23, v103
    s_add_u32 s40, s40, 16384
    ds_write_b64 v11, v[188:189] offset:4576
    v_max3_f32 v112, v48, v49, v50
    v_max3_f32 v116, v51, v52, v53
    v_max3_f32 v112, v112, v54, v55
    ds_read_b128 v[160:163], v12 offset:4352
    ds_read_b128 v[164:167], v12 offset:5440
    ds_read_b128 v[168:171], v12 offset:6528
    v_max_f32 v112, v112, v116
    v_mov_b32 v116, v112
    s_nop 1
    ds_read_b128 v[172:175], v12 offset:7616
    v_mfma_f32_32x32x16_bf16 v[128:143], v[124:127], v[124:127], 0
    v_permlane32_swap_b32 v112, v116
    v_max_f32 v112, v112, v116
    v_mov_b32 v116, v112
    v_mfma_f32_32x32x16_bf16 v[144:159], v[124:127], v[124:127], 0
    v_mul_f32 v192, v122, v192
    v_mul_f32 v193, v122, v193
    s_nop 1
    v_permlane16_swap_b32 v112, v116
    v_max_f32 v112, v112, v116
    v_mul_f32 v194, v122, v194
    v_mul_f32 v195, v122, v195
    v_cvt_pk_bf16_f32 v224, v224, v225
    v_cvt_pk_bf16_f32 v225, v226, v227
    v_cvt_pk_bf16_f32 v226, v228, v229
    v_mul_f32 v196, v122, v196
    v_mul_f32 v197, v122, v197
    v_mul_f32 v198, v122, v198
    v_cvt_pk_bf16_f32 v227, v230, v231
    v_cvt_pk_bf16_f32 v228, v232, v233
    v_cvt_pk_bf16_f32 v229, v234, v235
    v_mul_f32 v199, v122, v199
    v_cvt_pk_bf16_f32 v192, v192, v193
    v_cvt_pk_bf16_f32 v230, v236, v237
    v_cvt_pk_bf16_f32 v231, v238, v239
    v_accvgpr_write_b32 a24, v224
    v_cvt_pk_bf16_f32 v193, v194, v195
    v_mul_f32 v200, v122, v200
    v_mul_f32 v201, v122, v201
    v_accvgpr_write_b32 a25, v225
    v_accvgpr_write_b32 a26, v226
    v_accvgpr_write_b32 a27, v227
    v_mul_f32 v202, v122, v202
    v_mul_f32 v203, v122, v203
    v_accvgpr_write_b32 a28, v228
    v_accvgpr_write_b32 a29, v229
    v_accvgpr_write_b32 a30, v230
    v_cvt_pk_bf16_f32 v196, v196, v197
    v_cvt_pk_bf16_f32 v197, v198, v199
    ds_write_b64 v11, v[192:193] offset:8704
    v_accvgpr_write_b32 a31, v231
    s_waitcnt lgkmcnt(4)
    buffer_store_dwordx4 v[160:163], v13, s[16:19], s40 offen sc0 sc1
    s_nop 1
    v_mfma_f32_16x16x32_bf16 v[56:59], a[128:131], a[16:19], 0
    ds_read_b128 a[128:131], v1 offset:17408
    s_add_u32 s40, s40, 16384
    v_mul_f32 v204, v122, v204
    v_mul_f32 v205, v122, v205
    v_sub_f32 v48, v48, v112
    v_sub_f32 v49, v49, v112
    v_sub_f32 v50, v50, v112
    v_mul_f32 v206, v122, v206
    v_mul_f32 v207, v122, v207
    v_mfma_f32_16x16x32_bf16 v[56:59], a[132:135], a[20:23], v[56:59]
    ds_read_b128 a[132:135], v1 offset:17472
    v_cvt_pk_bf16_f32 v200, v200, v201
    v_cvt_pk_bf16_f32 v201, v202, v203
    v_sub_f32 v51, v51, v112
    v_sub_f32 v52, v52, v112
    v_sub_f32 v53, v53, v112
    ds_write_b64 v11, v[196:197] offset:8736
    v_mul_f32 v208, v122, v208
    v_mul_f32 v209, v122, v209
    v_mfma_f32_16x16x32_bf16 v[56:59], a[136:139], a[24:27], v[56:59]
    ds_read_b128 a[136:139], v2 offset:17408
    v_mul_f32 v210, v122, v210
    v_mul_f32 v211, v122, v211
    v_sub_f32 v54, v54, v112
    v_sub_f32 v55, v55, v112
    v_sub_f32 v80, 0, v112
    v_cvt_pk_bf16_f32 v204, v204, v205
    v_cvt_pk_bf16_f32 v205, v206, v207
    ds_write_b64 v11, v[200:201] offset:8768
    v_mfma_f32_16x16x32_bf16 v[56:59], a[140:143], a[28:31], v[56:59]
    ds_read_b128 a[140:143], v2 offset:17472
    s_waitcnt lgkmcnt(9)
    buffer_store_dwordx4 v[164:167], v13, s[16:19], s40 offen sc0 sc1
    v_sub_f32 v81, 0, v112
    v_sub_f32 v82, 0, v112
    v_sub_f32 v83, 0, v112
    s_add_u32 s40, s40, 16384
    v_mul_f32 v212, v122, v212
    v_mul_f32 v213, v122, v213
    v_mfma_f32_16x16x32_bf16 v[60:63], a[144:147], a[16:19], 0
    ds_read_b128 a[144:147], v1 offset:21632
    v_mul_f32 v214, v122, v214
    v_mul_f32 v215, v122, v215
    v_exp_f32 v48, v48
    v_exp_f32 v49, v49
    v_exp_f32 v50, v50
    v_cvt_pk_bf16_f32 v208, v208, v209
    v_cvt_pk_bf16_f32 v209, v210, v211
    ds_write_b64 v11, v[204:205] offset:8800
    v_mfma_f32_16x16x32_bf16 v[60:63], a[148:151], a[20:23], v[60:63]
    ds_read_b128 a[148:151], v1 offset:21696
    v_mul_f32 v216, v122, v216
    v_mul_f32 v217, v122, v217
    v_cvt_pk_bf16_f32 v48, v48, v49
    v_exp_f32 v51, v51
    v_exp_f32 v52, v52
    v_mul_f32 v218, v122, v218
    v_mul_f32 v219, v122, v219
    v_cvt_pk_bf16_f32 v212, v212, v213
    v_mfma_f32_16x16x32_bf16 v[60:63], a[152:155], a[24:27], v[60:63]
    ds_read_b128 a[152:155], v2 offset:21632
    v_cvt_pk_bf16_f32 v213, v214, v215
    ds_write_b64 v11, v[208:209] offset:8832
    v_cvt_pk_bf16_f32 v49, v50, v51
    v_exp_f32 v53, v53
    v_exp_f32 v54, v54
    s_waitcnt lgkmcnt(13)
    buffer_store_dwordx4 v[168:171], v13, s[16:19], s40 offen sc0 sc1
    s_add_u32 s40, s40, 16384
    v_mfma_f32_16x16x32_bf16 v[60:63], a[156:159], a[28:31], v[60:63]
    ds_read_b128 a[156:159], v2 offset:21696
    v_mul_f32 v220, v122, v220
    v_mul_f32 v221, v122, v221
    v_cvt_pk_bf16_f32 v50, v52, v53
    v_mul_f32 v222, v122, v222
    v_mul_f32 v223, v122, v223
    v_cvt_pk_bf16_f32 v216, v216, v217
    s_nop 6
    v_cvt_pk_bf16_f32 v217, v218, v219
    ds_write_b64 v11, v[212:213] offset:8864
    v_max3_f32 v113, v56, v57, v58
    v_max3_f32 v117, v59, v60, v61
    v_max3_f32 v113, v113, v62, v63
    v_cvt_pk_bf16_f32 v220, v220, v221
    v_cvt_pk_bf16_f32 v221, v222, v223
    ds_write_b64 v11, v[216:217] offset:8896
    v_max_f32 v113, v113, v117
    v_mov_b32 v117, v113
    s_nop 1
    s_waitcnt lgkmcnt(15)
    buffer_store_dwordx4 v[172:175], v13, s[16:19], s40 offen sc0 sc1
    v_permlane32_swap_b32 v113, v117
    v_max_f32 v113, v113, v117
    v_mov_b32 v117, v113
    s_add_u32 s40, s40, 16384
    ds_write_b64 v11, v[220:221] offset:8928
    ds_read_b128 v[192:195], v12 offset:8704
    s_nop 1
    v_permlane16_swap_b32 v113, v117
    v_max_f32 v113, v113, v117
    ds_read_b128 v[196:199], v12 offset:9792
    ds_read_b128 v[200:203], v12 offset:10880
    v_sub_f32 v56, v56, v113
    v_sub_f32 v57, v57, v113
    v_sub_f32 v58, v58, v113
    ds_read_b128 v[204:207], v12 offset:11968
    v_mfma_f32_32x32x16_bf16 v[160:175], v[124:127], v[124:127], 0
    v_mfma_f32_32x32x16_bf16 v[176:191], v[124:127], v[124:127], 0
    v_sub_f32 v59, v59, v113
    v_sub_f32 v60, v60, v113
    v_sub_f32 v61, v61, v113
    s_waitcnt lgkmcnt(3)
    buffer_store_dwordx4 v[192:195], v13, s[16:19], s40 offen sc0 sc1
    s_add_u32 s40, s40, 16384
    s_waitcnt lgkmcnt(2)
    buffer_store_dwordx4 v[196:199], v13, s[16:19], s40 offen sc0 sc1
    s_add_u32 s40, s40, 16384
    v_sub_f32 v62, v62, v113
    v_sub_f32 v63, v63, v113
    v_sub_f32 v84, 0, v113
    s_waitcnt lgkmcnt(1)
    buffer_store_dwordx4 v[200:203], v13, s[16:19], s40 offen sc0 sc1
    s_add_u32 s40, s40, 16384
    s_waitcnt lgkmcnt(0)
    buffer_store_dwordx4 v[204:207], v13, s[16:19], s40 offen sc0 sc1
    s_add_u32 s40, s40, 16384
    v_sub_f32 v85, 0, v113
    v_sub_f32 v86, 0, v113
    v_sub_f32 v87, 0, v113
    s_mov_b32 s18, s43
    s_waitcnt lgkmcnt(0)
    s_branch L_itb2_2
L_e3x_2:
    s_mov_b32 s44, 2
    s_barrier
L_e3_2_3:
    ds_read_b64_tr_b16 a[160:161], v3 offset:34816
    v_exp_f32 v59, v59
    ds_read_b64_tr_b16 a[162:163], v3 offset:35328
    v_exp_f32 v60, v60
    ds_read_b64_tr_b16 a[164:165], v3 offset:34848
    v_cvt_pk_bf16_f32 v53, v58, v59
    ds_read_b64_tr_b16 a[166:167], v3 offset:35360
    v_exp_f32 v61, v61
    ds_read_b64_tr_b16 a[168:169], v3 offset:34880
    v_exp_f32 v62, v62
    ds_read_b64_tr_b16 a[170:171], v3 offset:35392
    v_cvt_pk_bf16_f32 v54, v60, v61
    ds_read_b64_tr_b16 a[172:173], v3 offset:34912
    v_exp_f32 v63, v63
    ds_read_b64_tr_b16 a[174:175], v3 offset:35424
    v_exp_f32 v64, v64
    ds_read_b64_tr_b16 a[176:177], v3 offset:34944
    v_cvt_pk_bf16_f32 v55, v62, v63
    ds_read_b64_tr_b16 a[178:179], v3 offset:35456
    v_exp_f32 v65, v65
    ds_read_b64_tr_b16 a[180:181], v3 offset:34976
    v_exp_f32 v66, v66
    ds_read_b64_tr_b16 a[182:183], v3 offset:35488
    v_cvt_pk_bf16_f32 v64, v64, v65
    ds_read_b64_tr_b16 a[184:185], v3 offset:35008
    v_exp_f32 v67, v67
    ds_read_b64_tr_b16 a[186:187], v3 offset:35520
    v_exp_f32 v68, v68
    ds_read_b64_tr_b16 a[188:189], v3 offset:35040
    v_cvt_pk_bf16_f32 v65, v66, v67
    ds_read_b64_tr_b16 a[190:191], v3 offset:35552
    v_exp_f32 v69, v69
    v_exp_f32 v70, v70
    v_cvt_pk_bf16_f32 v66, v68, v69
    v_exp_f32 v71, v71
    s_nop 0
    v_cvt_pk_bf16_f32 v67, v70, v71
    s_nop 1
    v_smfmac_f32_16x16x64_bf16 a[208:211], a[236:239], v[48:55], v15
    v_mfma_f32_16x16x32_bf16 a[212:215], a[232:235], v[64:67], a[212:215]
    s_waitcnt lgkmcnt(8)
    v_mfma_f32_16x16x32_bf16 v[128:131], a[160:163], v[48:51], v[128:131]
    s_add_u32 m0, s30, 17408
    v_mfma_f32_16x16x32_bf16 v[132:135], a[164:167], v[48:51], v[132:135]
    buffer_load_dwordx4 v4, s[8:11], s28 offen lds
    v_mfma_f32_16x16x32_bf16 v[136:139], a[168:171], v[48:51], v[136:139]
    s_add_u32 m0, s30, 21632
    v_mfma_f32_16x16x32_bf16 v[140:143], a[172:175], v[48:51], v[140:143]
    buffer_load_dwordx4 v5, s[8:11], s28 offen lds
    s_waitcnt lgkmcnt(0)
    v_mfma_f32_16x16x32_bf16 v[144:147], a[176:179], v[48:51], v[144:147]
    s_add_u32 m0, s30, 26112
    ds_read_b128 a[64:67], v9 offset:0
    ds_read_b128 a[68:71], v9 offset:64
    ds_read_b128 a[72:75], v10 offset:0
    v_mfma_f32_16x16x32_bf16 v[148:151], a[180:183], v[48:51], v[148:151]
    buffer_load_dwordx4 v6, s[12:15], s29 offen lds
    ds_read_b128 a[76:79], v10 offset:64
    ds_read_b128 a[80:83], v9 offset:4224
    ds_read_b128 a[84:87], v9 offset:4288
    v_mfma_f32_16x16x32_bf16 v[152:155], a[184:187], v[48:51], v[152:155]
    s_add_u32 m0, s30, 30336
    ds_read_b128 a[88:91], v10 offset:4224
    ds_read_b128 a[92:95], v10 offset:4288
    ds_read_b128 a[96:99], v9 offset:8448
    v_mfma_f32_16x16x32_bf16 v[156:159], a[188:191], v[48:51], v[156:159]
    buffer_load_dwordx4 v7, s[12:15], s29 offen lds
    ds_read_b128 a[100:103], v9 offset:8512
    ds_read_b128 a[104:107], v10 offset:8448
    ds_read_b128 a[108:111], v10 offset:8512
    s_add_u32 s28, s28, s101
    s_add_u32 s29, s29, s101
    v_accvgpr_read_b32 v112, a208
    v_accvgpr_read_b32 v113, a210
    v_accvgpr_read_b32 v114, a212
    v_accvgpr_read_b32 v116, a209
    v_accvgpr_read_b32 v117, a211
    v_add_f32 v112, v112, v116
    v_add_f32 v113, v113, v117
    v_cmp_nge_f32 vcc, 0x44800000, v112
    v_rcp_f32 v120, v112
    s_nop 0
    s_mov_b64 s[84:85], vcc
    v_cmp_nge_f32 vcc, 0x44800000, v113
    v_rcp_f32 v121, v113
    s_nop 0
    s_or_b64 s[84:85], s[84:85], vcc
    v_cmp_nge_f32 vcc, 0x44800000, v114
    v_rcp_f32 v122, v114
    s_nop 0
    s_or_b64 s[84:85], s[84:85], vcc
    s_mov_b32 s40, s34
    s_cbranch_scc1 L_es3_0
    s_waitcnt vmcnt(8) lgkmcnt(0)
    v_mfma_f32_16x16x32_bf16 v[160:163], a[160:163], v[52:55], v[160:163]
    v_mul_f32 v128, v120, v128
    v_mfma_f32_32x32x16_bf16 v[96:111], a[192:195], a[64:67], 0
    v_mul_f32 v129, v120, v129
    v_mul_f32 v130, v120, v130
    s_mov_b32 s80, s81
    s_mov_b32 s81, 0
    s_add_u32 s47, s47, 1
    v_mul_f32 v131, v120, v131
    v_mfma_f32_16x16x32_bf16 v[164:167], a[164:167], v[52:55], v[164:167]
    s_mov_b32 s42, s89
    s_mov_b32 s43, s90
    v_mul_f32 v132, v120, v132
    v_mfma_f32_32x32x16_bf16 v[96:111], a[196:199], a[68:71], v[96:111]
    v_mul_f32 v133, v120, v133
    v_mul_f32 v134, v120, v134
    s_mov_b32 s34, s91
    s_mov_b32 s88, s93
    s_bfe_u32 s37, s80, 0xa000d
    v_mul_f32 v135, v120, v135
    v_mfma_f32_16x16x32_bf16 v[168:171], a[168:171], v[52:55], v[168:171]
    s_add_u32 s36, s37, 31
    s_lshr_b32 s36, s36, 5
    v_cvt_pk_bf16_f32 v128, v128, v129
    v_mfma_f32_32x32x16_bf16 v[96:111], a[200:203], a[64:67], v[96:111]
    v_cvt_pk_bf16_f32 v129, v130, v131
    v_mul_f32 v136, v120, v136
    s_sub_u32 s31, s36, 1
    s_lshl_b32 s39, s31, 5
    s_sub_u32 s35, s37, s39
    v_mul_f32 v137, v120, v137
    v_mfma_f32_16x16x32_bf16 v[172:175], a[172:175], v[52:55], v[172:175]
    s_mov_b32 s46, 0
    s_mov_b32 s99, s33
    v_mul_f32 v138, v120, v138
    v_mfma_f32_32x32x16_bf16 v[96:111], a[204:207], a[68:71], v[96:111]
    v_mul_f32 v139, v120, v139
    v_cvt_pk_bf16_f32 v132, v132, v133
    s_sub_u32 s31, s31, 1
    s_mov_b32 s32, 4
    s_mov_b32 s93, 0
    v_cvt_pk_bf16_f32 v133, v134, v135
    v_mfma_f32_16x16x32_bf16 v[176:179], a[176:179], v[52:55], v[176:179]
    s_mov_b32 s90, 0
    ds_write_b64 v11, v[128:129] offset:0
    v_mfma_f32_32x32x16_bf16 v[224:239], a[192:195], a[72:75], 0
    v_mul_f32 v140, v120, v140
    v_mul_f32 v141, v120, v141
    v_accvgpr_mov_b32 a232, a240
    v_accvgpr_mov_b32 a233, a241
    v_mul_f32 v142, v120, v142
    v_mfma_f32_16x16x32_bf16 v[180:183], a[180:183], v[52:55], v[180:183]
    v_mfma_f32_32x32x16_bf16 v[224:239], a[196:199], a[76:79], v[224:239]
    v_mul_f32 v143, v120, v143
    v_cvt_pk_bf16_f32 v136, v136, v137
    v_accvgpr_mov_b32 a234, a242
    v_accvgpr_mov_b32 a235, a243
    v_cvt_pk_bf16_f32 v137, v138, v139
    v_mfma_f32_32x32x16_bf16 v[224:239], a[200:203], a[72:75], v[224:239]
    ds_write_b64 v11, v[132:133] offset:32
    v_mfma_f32_16x16x32_bf16 v[184:187], a[184:187], v[52:55], v[184:187]
    v_accvgpr_mov_b32 a236, a244
    v_accvgpr_mov_b32 a237, a245
    v_mul_f32 v144, v120, v144
    v_mul_f32 v145, v120, v145
    v_mfma_f32_32x32x16_bf16 v[224:239], a[204:207], a[76:79], v[224:239]
    v_mul_f32 v146, v120, v146
    v_accvgpr_mov_b32 a238, a246
    v_accvgpr_mov_b32 a239, a247
    v_mul_f32 v147, v120, v147
    v_mfma_f32_16x16x32_bf16 v[188:191], a[188:191], v[52:55], v[188:191]
    v_mfma_f32_32x32x16_bf16 a[208:223], v[124:127], v[124:127], 0
    v_cvt_pk_bf16_f32 v140, v140, v141
    v_cvt_pk_bf16_f32 v141, v142, v143
    v_cvt_pk_bf16_f32 v96, v96, v97
    v_cvt_pk_bf16_f32 v97, v98, v99
    v_cvt_pk_bf16_f32 v98, v100, v101
    ds_write_b64 v11, v[136:137] offset:64
    v_cvt_pk_bf16_f32 v99, v102, v103
    v_cvt_pk_bf16_f32 v100, v104, v105
    v_cvt_pk_bf16_f32 v101, v106, v107
    v_mul_f32 v148, v120, v148
    v_mul_f32 v149, v120, v149
    v_cvt_pk_bf16_f32 v102, v108, v109
    v_cvt_pk_bf16_f32 v103, v110, v111
    v_accvgpr_write_b32 a0, v96
    v_mul_f32 v150, v120, v150
    v_mul_f32 v151, v120, v151
    v_accvgpr_write_b32 a1, v97
    v_accvgpr_write_b32 a2, v98
    v_accvgpr_write_b32 a3, v99
    v_cvt_pk_bf16_f32 v144, v144, v145
    v_accvgpr_write_b32 a4, v100
    v_accvgpr_write_b32 a5, v101
    v_accvgpr_write_b32 a6, v102
    v_cvt_pk_bf16_f32 v145, v146, v147
    ds_write_b64 v11, v[140:141] offset:96
    v_accvgpr_write_b32 a7, v103
    v_mul_f32 v152, v120, v152
    v_mul_f32 v153, v120, v153
    v_mfma_f32_32x32x16_bf16 v[96:111], a[192:195], a[80:83], 0
    v_mul_f32 v154, v120, v154
    v_cvt_pk_bf16_f32 v224, v224, v225
    v_cvt_pk_bf16_f32 v225, v226, v227
    v_cvt_pk_bf16_f32 v226, v228, v229
    v_mul_f32 v155, v120, v155
    v_cvt_pk_bf16_f32 v148, v148, v149
    v_cvt_pk_bf16_f32 v227, v230, v231
    v_cvt_pk_bf16_f32 v149, v150, v151
    ds_write_b64 v11, v[144:145] offset:128
    v_mfma_f32_32x32x16_bf16 v[96:111], a[196:199], a[84:87], v[96:111]
    v_mul_f32 v156, v120, v156
    v_mul_f32 v157, v120, v157
    v_cvt_pk_bf16_f32 v228, v232, v233
    v_cvt_pk_bf16_f32 v229, v234, v235
    v_cvt_pk_bf16_f32 v230, v236, v237
    v_mul_f32 v158, v120, v158
    v_cvt_pk_bf16_f32 v231, v238, v239
    v_mul_f32 v159, v120, v159
    v_cvt_pk_bf16_f32 v152, v152, v153
    v_mfma_f32_32x32x16_bf16 v[96:111], a[200:203], a[80:83], v[96:111]
    v_cvt_pk_bf16_f32 v153, v154, v155
    ds_write_b64 v11, v[148:149] offset:160
    v_accvgpr_write_b32 a8, v224
    v_accvgpr_write_b32 a9, v225
    v_accvgpr_write_b32 a10, v226
    v_cvt_pk_bf16_f32 v156, v156, v157
    v_accvgpr_write_b32 a11, v227
    v_cvt_pk_bf16_f32 v157, v158, v159
    ds_write_b64 v11, v[152:153] offset:192
    v_mfma_f32_32x32x16_bf16 v[96:111], a[204:207], a[84:87], v[96:111]
    ds_write_b64 v11, v[156:157] offset:224
    ds_read_b128 v[128:131], v12 offset:0
    v_accvgpr_write_b32 a12, v228
    v_accvgpr_write_b32 a13, v229
    v_accvgpr_write_b32 a14, v230
    ds_read_b128 v[132:135], v12 offset:1088
    v_accvgpr_write_b32 a15, v231
    ds_read_b128 v[136:139], v12 offset:2176
    ds_read_b128 v[140:143], v12 offset:3264
    s_nop 1
    v_mfma_f32_16x16x32_bf16 v[16:19], a[128:131], a[0:3], 0
    v_mfma_f32_16x16x32_bf16 v[192:195], a[160:163], v[64:67], v[192:195]
    v_mul_f32 v160, v121, v160
    v_mfma_f32_16x16x32_bf16 v[16:19], a[132:135], a[4:7], v[16:19]
    v_mul_f32 v161, v121, v161
    v_mfma_f32_16x16x32_bf16 v[16:19], a[136:139], a[8:11], v[16:19]
    v_mul_f32 v162, v121, v162
    v_mul_f32 v163, v121, v163
    v_mfma_f32_16x16x32_bf16 v[16:19], a[140:143], a[12:15], v[16:19]
    v_mfma_f32_16x16x32_bf16 v[196:199], a[164:167], v[64:67], v[196:199]
    v_mul_f32 v164, v121, v164
    v_mfma_f32_16x16x32_bf16 v[20:23], a[144:147], a[0:3], 0
    v_mul_f32 v165, v121, v165
    v_mul_f32 v166, v121, v166
    v_mfma_f32_16x16x32_bf16 v[20:23], a[148:151], a[4:7], v[20:23]
    v_mul_f32 v167, v121, v167
    v_mfma_f32_16x16x32_bf16 v[20:23], a[152:155], a[8:11], v[20:23]
    v_mfma_f32_16x16x32_bf16 v[200:203], a[168:171], v[64:67], v[200:203]
    v_cvt_pk_bf16_f32 v160, v160, v161
    v_mfma_f32_16x16x32_bf16 v[20:23], a[156:159], a[12:15], v[20:23]
    v_cvt_pk_bf16_f32 v161, v162, v163
    v_mul_f32 v168, v121, v168
    v_mfma_f32_32x32x16_bf16 v[224:239], a[192:195], a[88:91], 0
    v_mul_f32 v169, v121, v169
    v_mfma_f32_32x32x16_bf16 v[224:239], a[196:199], a[92:95], v[224:239]
    v_mfma_f32_16x16x32_bf16 v[204:207], a[172:175], v[64:67], v[204:207]
    v_mul_f32 v170, v121, v170
    v_mfma_f32_32x32x16_bf16 v[224:239], a[200:203], a[88:91], v[224:239]
    v_mul_f32 v171, v121, v171
    v_cvt_pk_bf16_f32 v164, v164, v165
    v_mfma_f32_32x32x16_bf16 v[224:239], a[204:207], a[92:95], v[224:239]
    v_cvt_pk_bf16_f32 v165, v166, v167
    v_cvt_pk_bf16_f32 v96, v96, v97
    v_cvt_pk_bf16_f32 v97, v98, v99
    v_cvt_pk_bf16_f32 v98, v100, v101
    v_mfma_f32_16x16x32_bf16 v[208:211], a[176:179], v[64:67], v[208:211]
    ds_write_b64 v11, v[160:161] offset:4352
    v_cvt_pk_bf16_f32 v99, v102, v103
    v_cvt_pk_bf16_f32 v100, v104, v105
    v_cvt_pk_bf16_f32 v101, v106, v107
    s_waitcnt lgkmcnt(4)
    buffer_store_dwordx4 v[128:131], v13, s[16:19], s40 offen sc0 sc1
    v_cvt_pk_bf16_f32 v102, v108, v109
    v_cvt_pk_bf16_f32 v103, v110, v111
    v_accvgpr_write_b32 a16, v96
    s_add_u32 s40, s40, 16384
    v_accvgpr_write_b32 a17, v97
    v_accvgpr_write_b32 a18, v98
    v_accvgpr_write_b32 a19, v99
    v_mul_f32 v172, v121, v172
    v_mul_f32 v173, v121, v173
    v_accvgpr_write_b32 a20, v100
    v_accvgpr_write_b32 a21, v101
    v_accvgpr_write_b32 a22, v102
    v_mul_f32 v174, v121, v174
    v_mfma_f32_16x16x32_bf16 v[212:215], a[180:183], v[64:67], v[212:215]
    v_accvgpr_write_b32 a23, v103
    v_mul_f32 v175, v121, v175
    v_mfma_f32_32x32x16_bf16 v[96:111], a[192:195], a[96:99], 0
    v_cvt_pk_bf16_f32 v168, v168, v169
    v_cvt_pk_bf16_f32 v169, v170, v171
    v_max3_f32 v112, v16, v17, v18
    v_max3_f32 v116, v19, v20, v21
    v_max3_f32 v112, v112, v22, v23
    ds_write_b64 v11, v[164:165] offset:4384
    v_mfma_f32_16x16x32_bf16 v[216:219], a[184:187], v[64:67], v[216:219]
    v_max_f32 v112, v112, v116
    v_mov_b32 v116, v112
    s_nop 1
    v_mul_f32 v176, v121, v176
    v_mul_f32 v177, v121, v177
    v_permlane32_swap_b32 v112, v116
    v_mul_f32 v178, v121, v178
    v_mfma_f32_32x32x16_bf16 v[96:111], a[196:199], a[100:103], v[96:111]
    v_mul_f32 v179, v121, v179
    v_mfma_f32_16x16x32_bf16 v[220:223], a[188:191], v[64:67], v[220:223]
    v_max_f32 v112, v112, v116
    v_mov_b32 v116, v112
    s_nop 1
    v_cvt_pk_bf16_f32 v172, v172, v173
    v_cvt_pk_bf16_f32 v173, v174, v175
    v_permlane16_swap_b32 v112, v116
    v_max_f32 v112, v112, v116
    v_cvt_pk_bf16_f32 v224, v224, v225
    ds_write_b64 v11, v[168:169] offset:4416
    v_cvt_pk_bf16_f32 v225, v226, v227
    s_waitcnt lgkmcnt(5)
    buffer_store_dwordx4 v[132:135], v13, s[16:19], s40 offen sc0 sc1
    v_mfma_f32_32x32x16_bf16 v[96:111], a[200:203], a[96:99], v[96:111]
    s_add_u32 s40, s40, 16384
    v_mul_f32 v180, v121, v180
    v_cvt_pk_bf16_f32 v226, v228, v229
    v_cvt_pk_bf16_f32 v227, v230, v231
    v_cvt_pk_bf16_f32 v228, v232, v233
    v_mul_f32 v181, v121, v181
    v_cvt_pk_bf16_f32 v229, v234, v235
    v_cvt_pk_bf16_f32 v230, v236, v237
    v_cvt_pk_bf16_f32 v231, v238, v239
    v_mul_f32 v182, v121, v182
    v_mul_f32 v183, v121, v183
    v_accvgpr_write_b32 a24, v224
    v_cvt_pk_bf16_f32 v176, v176, v177
    v_cvt_pk_bf16_f32 v177, v178, v179
    v_mfma_f32_32x32x16_bf16 v[96:111], a[204:207], a[100:103], v[96:111]
    ds_write_b64 v11, v[172:173] offset:4448
    v_accvgpr_write_b32 a25, v225
    v_accvgpr_write_b32 a26, v226
    v_accvgpr_write_b32 a27, v227
    v_mul_f32 v184, v121, v184
    v_mul_f32 v185, v121, v185
    v_accvgpr_write_b32 a28, v228
    v_accvgpr_write_b32 a29, v229
    v_accvgpr_write_b32 a30, v230
    v_mul_f32 v186, v121, v186
    v_mul_f32 v187, v121, v187
    v_accvgpr_write_b32 a31, v231
    v_cvt_pk_bf16_f32 v180, v180, v181
    s_nop 1
    v_mfma_f32_16x16x32_bf16 v[24:27], a[128:131], a[16:19], 0
    v_cvt_pk_bf16_f32 v181, v182, v183
    ds_write_b64 v11, v[176:177] offset:4480
    v_sub_f32 v16, v16, v112
    v_sub_f32 v17, v17, v112
    v_sub_f32 v18, v18, v112
    s_waitcnt lgkmcnt(6)
    buffer_store_dwordx4 v[136:139], v13, s[16:19], s40 offen sc0 sc1
    v_mfma_f32_16x16x32_bf16 v[24:27], a[132:135], a[20:23], v[24:27]
    s_add_u32 s40, s40, 16384
    v_mul_f32 v188, v121, v188
    v_sub_f32 v19, v19, v112
    v_sub_f32 v20, v20, v112
    v_sub_f32 v21, v21, v112
    v_mul_f32 v189, v121, v189
    v_mfma_f32_16x16x32_bf16 v[24:27], a[136:139], a[24:27], v[24:27]
    v_mul_f32 v190, v121, v190
    v_mul_f32 v191, v121, v191
    v_sub_f32 v22, v22, v112
    v_sub_f32 v23, v23, v112
    v_sub_f32 v80, 0, v112
    v_cvt_pk_bf16_f32 v184, v184, v185
    v_cvt_pk_bf16_f32 v185, v186, v187
    v_mfma_f32_16x16x32_bf16 v[24:27], a[140:143], a[28:31], v[24:27]
    ds_write_b64 v11, v[180:181] offset:4512
    v_sub_f32 v81, 0, v112
    v_sub_f32 v82, 0, v112
    v_sub_f32 v83, 0, v112
    v_cvt_pk_bf16_f32 v188, v188, v189
    v_cvt_pk_bf16_f32 v189, v190, v191
    v_mfma_f32_16x16x32_bf16 v[28:31], a[144:147], a[16:19], 0
    ds_write_b64 v11, v[184:185] offset:4544
    s_waitcnt lgkmcnt(7)
    buffer_store_dwordx4 v[140:143], v13, s[16:19], s40 offen sc0 sc1
    v_exp_f32 v16, v16
    v_exp_f32 v17, v17
    v_exp_f32 v18, v18
    v_mfma_f32_16x16x32_bf16 v[28:31], a[148:151], a[20:23], v[28:31]
    s_add_u32 s40, s40, 16384
    ds_write_b64 v11, v[188:189] offset:4576
    v_cvt_pk_bf16_f32 v16, v16, v17
    v_exp_f32 v19, v19
    v_exp_f32 v20, v20
    ds_read_b128 v[160:163], v12 offset:4352
    ds_read_b128 v[164:167], v12 offset:5440
    v_mfma_f32_16x16x32_bf16 v[28:31], a[152:155], a[24:27], v[28:31]
    ds_read_b128 v[168:171], v12 offset:6528
    v_cvt_pk_bf16_f32 v17, v18, v19
    v_exp_f32 v21, v21
    v_exp_f32 v22, v22
    ds_read_b128 v[172:175], v12 offset:7616
    v_mfma_f32_32x32x16_bf16 v[128:143], v[124:127], v[124:127], 0
    v_mfma_f32_16x16x32_bf16 v[28:31], a[156:159], a[28:31], v[28:31]
    v_mfma_f32_32x32x16_bf16 v[144:159], v[124:127], v[124:127], 0
    v_mul_f32 v192, v122, v192
    v_cvt_pk_bf16_f32 v18, v20, v21
    v_exp_f32 v23, v23
    s_nop 0
    v_mul_f32 v193, v122, v193
    v_mul_f32 v194, v122, v194
    v_mfma_f32_32x32x16_bf16 v[224:239], a[192:195], a[104:107], 0
    v_mul_f32 v195, v122, v195
    v_cvt_pk_bf16_f32 v19, v22, v23
    v_mul_f32 v196, v122, v196
    v_mul_f32 v197, v122, v197
    v_mfma_f32_32x32x16_bf16 v[224:239], a[196:199], a[108:111], v[224:239]
    v_mul_f32 v198, v122, v198
    v_mul_f32 v199, v122, v199
    v_mfma_f32_32x32x16_bf16 v[224:239], a[200:203], a[104:107], v[224:239]
    v_cvt_pk_bf16_f32 v192, v192, v193
    v_mfma_f32_32x32x16_bf16 v[224:239], a[204:207], a[108:111], v[224:239]
    v_cvt_pk_bf16_f32 v193, v194, v195
    v_mul_f32 v200, v122, v200
    v_cvt_pk_bf16_f32 v96, v96, v97
    v_cvt_pk_bf16_f32 v97, v98, v99
    v_cvt_pk_bf16_f32 v98, v100, v101
    v_mul_f32 v201, v122, v201
    v_mul_f32 v202, v122, v202
    v_cvt_pk_bf16_f32 v99, v102, v103
    v_cvt_pk_bf16_f32 v100, v104, v105
    v_cvt_pk_bf16_f32 v101, v106, v107
    v_mul_f32 v203, v122, v203
    v_cvt_pk_bf16_f32 v102, v108, v109
    v_cvt_pk_bf16_f32 v103, v110, v111
    v_accvgpr_write_b32 a32, v96
    v_cvt_pk_bf16_f32 v196, v196, v197
    v_cvt_pk_bf16_f32 v197, v198, v199
    v_accvgpr_write_b32 a33, v97
    v_accvgpr_write_b32 a34, v98
    v_accvgpr_write_b32 a35, v99
    ds_write_b64 v11, v[192:193] offset:8704
    s_waitcnt lgkmcnt(4)
    buffer_store_dwordx4 v[160:163], v13, s[16:19], s40 offen sc0 sc1
    v_accvgpr_write_b32 a36, v100
    v_accvgpr_write_b32 a37, v101
    v_accvgpr_write_b32 a38, v102
    v_accvgpr_write_b32 a39, v103
    s_add_u32 s40, s40, 16384
    v_mul_f32 v204, v122, v204
    v_max3_f32 v113, v24, v25, v26
    v_max3_f32 v117, v27, v28, v29
    v_max3_f32 v113, v113, v30, v31
    v_mul_f32 v205, v122, v205
    v_mul_f32 v206, v122, v206
    v_max_f32 v113, v113, v117
    v_mov_b32 v117, v113
    s_nop 1
    v_mul_f32 v207, v122, v207
    v_permlane32_swap_b32 v113, v117
    v_max_f32 v113, v113, v117
    v_mov_b32 v117, v113
    v_cvt_pk_bf16_f32 v200, v200, v201
    v_cvt_pk_bf16_f32 v201, v202, v203
    s_nop 1
    v_permlane16_swap_b32 v113, v117
    v_max_f32 v113, v113, v117
    ds_write_b64 v11, v[196:197] offset:8736
    v_mul_f32 v208, v122, v208
    v_cvt_pk_bf16_f32 v224, v224, v225
    v_cvt_pk_bf16_f32 v225, v226, v227
    v_cvt_pk_bf16_f32 v226, v228, v229
    v_mul_f32 v209, v122, v209
    v_mul_f32 v210, v122, v210
    v_cvt_pk_bf16_f32 v227, v230, v231
    v_cvt_pk_bf16_f32 v228, v232, v233
    v_cvt_pk_bf16_f32 v229, v234, v235
    v_mul_f32 v211, v122, v211
    v_cvt_pk_bf16_f32 v230, v236, v237
    v_cvt_pk_bf16_f32 v231, v238, v239
    v_accvgpr_write_b32 a40, v224
    v_cvt_pk_bf16_f32 v204, v204, v205
    v_cvt_pk_bf16_f32 v205, v206, v207
    v_accvgpr_write_b32 a41, v225
    v_accvgpr_write_b32 a42, v226
    v_accvgpr_write_b32 a43, v227
    ds_write_b64 v11, v[200:201] offset:8768
    s_waitcnt lgkmcnt(5)
    buffer_store_dwordx4 v[164:167], v13, s[16:19], s40 offen sc0 sc1
    v_accvgpr_write_b32 a44, v228
    v_accvgpr_write_b32 a45, v229
    v_accvgpr_write_b32 a46, v230
    v_accvgpr_write_b32 a47, v231
    s_add_u32 s40, s40, 16384
    v_mul_f32 v212, v122, v212
    s_nop 1
    v_mfma_f32_16x16x32_bf16 v[32:35], a[128:131], a[32:35], 0
    ds_read_b128 a[128:131], v1 offset:34816
    v_mul_f32 v213, v122, v213
    v_mul_f32 v214, v122, v214
    v_sub_f32 v24, v24, v113
    v_sub_f32 v25, v25, v113
    v_mul_f32 v215, v122, v215
    v_mfma_f32_16x16x32_bf16 v[32:35], a[132:135], a[36:39], v[32:35]
    ds_read_b128 a[132:135], v1 offset:34880
    v_cvt_pk_bf16_f32 v208, v208, v209
    v_cvt_pk_bf16_f32 v209, v210, v211
    v_sub_f32 v26, v26, v113
    v_sub_f32 v27, v27, v113
    ds_write_b64 v11, v[204:205] offset:8800
    v_mul_f32 v216, v122, v216
    v_mfma_f32_16x16x32_bf16 v[32:35], a[136:139], a[40:43], v[32:35]
    ds_read_b128 a[136:139], v2 offset:34816
    v_mul_f32 v217, v122, v217
    v_sub_f32 v28, v28, v113
    v_sub_f32 v29, v29, v113
    v_mul_f32 v218, v122, v218
    v_mul_f32 v219, v122, v219
    v_mfma_f32_16x16x32_bf16 v[32:35], a[140:143], a[44:47], v[32:35]
    ds_read_b128 a[140:143], v2 offset:34880
    v_cvt_pk_bf16_f32 v212, v212, v213
    v_cvt_pk_bf16_f32 v213, v214, v215
    v_sub_f32 v30, v30, v113
    v_sub_f32 v31, v31, v113
    ds_write_b64 v11, v[208:209] offset:8832
    v_mfma_f32_16x16x32_bf16 v[36:39], a[144:147], a[32:35], 0
    ds_read_b128 a[144:147], v1 offset:39040
    s_waitcnt lgkmcnt(11)
    buffer_store_dwordx4 v[168:171], v13, s[16:19], s40 offen sc0 sc1
    v_sub_f32 v84, 0, v113
    v_sub_f32 v85, 0, v113
    s_add_u32 s40, s40, 16384
    v_mul_f32 v220, v122, v220
    v_mfma_f32_16x16x32_bf16 v[36:39], a[148:151], a[36:39], v[36:39]
    ds_read_b128 a[148:151], v1 offset:39104
    v_mul_f32 v221, v122, v221
    v_mul_f32 v222, v122, v222
    v_sub_f32 v86, 0, v113
    v_sub_f32 v87, 0, v113
    v_mul_f32 v223, v122, v223
    v_mfma_f32_16x16x32_bf16 v[36:39], a[152:155], a[40:43], v[36:39]
    ds_read_b128 a[152:155], v2 offset:39040
    v_cvt_pk_bf16_f32 v216, v216, v217
    v_cvt_pk_bf16_f32 v217, v218, v219
    v_exp_f32 v24, v24
    v_exp_f32 v25, v25
    ds_write_b64 v11, v[212:213] offset:8864
    v_cvt_pk_bf16_f32 v220, v220, v221
    v_mfma_f32_16x16x32_bf16 v[36:39], a[156:159], a[44:47], v[36:39]
    ds_read_b128 a[156:159], v2 offset:39104
    v_cvt_pk_bf16_f32 v221, v222, v223
    v_exp_f32 v26, v26
    v_cvt_pk_bf16_f32 v20, v24, v25
    ds_write_b64 v11, v[216:217] offset:8896
    s_waitcnt lgkmcnt(15)
    buffer_store_dwordx4 v[172:175], v13, s[16:19], s40 offen sc0 sc1
    s_nop 6
    s_add_u32 s40, s40, 16384
    v_max3_f32 v114, v32, v33, v34
    v_max3_f32 v118, v35, v36, v37
    v_max3_f32 v114, v114, v38, v39
    ds_write_b64 v11, v[220:221] offset:8928
    v_max_f32 v114, v114, v118
    v_mov_b32 v118, v114
    s_nop 1
    ds_read_b128 v[192:195], v12 offset:8704
    ds_read_b128 v[196:199], v12 offset:9792
    v_permlane32_swap_b32 v114, v118
    v_max_f32 v114, v114, v118
    v_mov_b32 v118, v114
    ds_read_b128 v[200:203], v12 offset:10880
    ds_read_b128 v[204:207], v12 offset:11968
    s_nop 1
    v_permlane16_swap_b32 v114, v118
    v_max_f32 v114, v114, v118
    v_mfma_f32_32x32x16_bf16 v[160:175], v[124:127], v[124:127], 0
    v_sub_f32 v32, v32, v114
    v_sub_f32 v33, v33, v114
    v_sub_f32 v34, v34, v114
    v_mfma_f32_32x32x16_bf16 v[176:191], v[124:127], v[124:127], 0
    s_waitcnt lgkmcnt(3)
    buffer_store_dwordx4 v[192:195], v13, s[16:19], s40 offen sc0 sc1
    s_add_u32 s40, s40, 16384
    v_sub_f32 v35, v35, v114
    v_sub_f32 v36, v36, v114
    v_sub_f32 v37, v37, v114
    s_waitcnt lgkmcnt(2)
    buffer_store_dwordx4 v[196:199], v13, s[16:19], s40 offen sc0 sc1
    s_add_u32 s40, s40, 16384
    s_waitcnt lgkmcnt(1)
    buffer_store_dwordx4 v[200:203], v13, s[16:19], s40 offen sc0 sc1
    s_add_u32 s40, s40, 16384
    v_sub_f32 v38, v38, v114
    v_sub_f32 v39, v39, v114
    v_sub_f32 v88, 0, v114
    s_waitcnt lgkmcnt(0)
    buffer_store_dwordx4 v[204:207], v13, s[16:19], s40 offen sc0 sc1
    s_add_u32 s40, s40, 16384
    v_sub_f32 v89, 0, v114
    v_sub_f32 v90, 0, v114
    v_sub_f32 v91, 0, v114
    v_mfma_f32_32x32x16_bf16 v[192:207], v[124:127], v[124:127], 0
    v_mfma_f32_32x32x16_bf16 v[208:223], v[124:127], v[124:127], 0
    s_mov_b32 s18, s43
    s_waitcnt lgkmcnt(0)
    s_branch L_itb3_3
L_e3_2:
    s_mov_b32 s44, 2
    s_waitcnt vmcnt(4)
    s_barrier
L_e3_2_0:
    v_mfma_f32_16x16x32_bf16 v[16:19], a[128:131], a[0:3], v[80:83]
    ds_read_b64_tr_b16 a[160:161], v3 offset:34816
    ds_read_b64_tr_b16 a[162:163], v3 offset:35328
    v_exp_f32 v59, v59
    v_mfma_f32_16x16x32_bf16 v[16:19], a[132:135], a[4:7], v[16:19]
    ds_read_b64_tr_b16 a[164:165], v3 offset:34848
    ds_read_b64_tr_b16 a[166:167], v3 offset:35360
    v_exp_f32 v60, v60
    v_cvt_pk_bf16_f32 v53, v58, v59
    v_mfma_f32_16x16x32_bf16 v[16:19], a[136:139], a[8:11], v[16:19]
    ds_read_b64_tr_b16 a[168:169], v3 offset:34880
    ds_read_b64_tr_b16 a[170:171], v3 offset:35392
    v_exp_f32 v61, v61
    v_mfma_f32_16x16x32_bf16 v[16:19], a[140:143], a[12:15], v[16:19]
    ds_read_b64_tr_b16 a[172:173], v3 offset:34912
    ds_read_b64_tr_b16 a[174:175], v3 offset:35424
    v_exp_f32 v62, v62
    v_cvt_pk_bf16_f32 v54, v60, v61
    v_mfma_f32_16x16x32_bf16 v[20:23], a[144:147], a[0:3], v[80:83]
    ds_read_b64_tr_b16 a[176:177], v3 offset:34944
    ds_read_b64_tr_b16 a[178:179], v3 offset:35456
    v_exp_f32 v63, v63
    v_mfma_f32_16x16x32_bf16 v[20:23], a[148:151], a[4:7], v[20:23]
    ds_read_b64_tr_b16 a[180:181], v3 offset:34976
    ds_read_b64_tr_b16 a[182:183], v3 offset:35488
    v_exp_f32 v64, v64
    v_cvt_pk_bf16_f32 v55, v62, v63
    v_mfma_f32_16x16x32_bf16 v[20:23], a[152:155], a[8:11], v[20:23]
    ds_read_b64_tr_b16 a[184:185], v3 offset:35008
    ds_read_b64_tr_b16 a[186:187], v3 offset:35520
    v_exp_f32 v65, v65
    v_mfma_f32_16x16x32_bf16 v[20:23], a[156:159], a[12:15], v[20:23]
    ds_read_b64_tr_b16 a[188:189], v3 offset:35040
    ds_read_b64_tr_b16 a[190:191], v3 offset:35552
    v_exp_f32 v66, v66
    v_cvt_pk_bf16_f32 v64, v64, v65
    v_mfma_f32_16x16x32_bf16 v[24:27], a[128:131], a[16:19], v[84:87]
    ds_read_b64_tr_b16 a[64:65], v3 offset:52224
    ds_read_b64_tr_b16 a[66:67], v3 offset:52736
    v_exp_f32 v67, v67
    v_mfma_f32_16x16x32_bf16 v[24:27], a[132:135], a[20:23], v[24:27]
    ds_read_b64_tr_b16 a[68:69], v3 offset:52256
    ds_read_b64_tr_b16 a[70:71], v3 offset:52768
    v_exp_f32 v68, v68
    v_cvt_pk_bf16_f32 v65, v66, v67
    v_mfma_f32_16x16x32_bf16 v[24:27], a[136:139], a[24:27], v[24:27]
    ds_read_b64_tr_b16 a[72:73], v3 offset:52288
    ds_read_b64_tr_b16 a[74:75], v3 offset:52800
    v_exp_f32 v69, v69
    v_mfma_f32_16x16x32_bf16 v[24:27], a[140:143], a[28:31], v[24:27]
    ds_read_b64_tr_b16 a[76:77], v3 offset:52320
    ds_read_b64_tr_b16 a[78:79], v3 offset:52832
    v_exp_f32 v70, v70
    v_cvt_pk_bf16_f32 v66, v68, v69
    v_mfma_f32_16x16x32_bf16 v[28:31], a[144:147], a[16:19], v[84:87]
    ds_read_b64_tr_b16 a[80:81], v3 offset:52352
    ds_read_b64_tr_b16 a[82:83], v3 offset:52864
    v_exp_f32 v71, v71
    v_mfma_f32_16x16x32_bf16 v[28:31], a[148:151], a[20:23], v[28:31]
    ds_read_b64_tr_b16 a[84:85], v3 offset:52384
    ds_read_b64_tr_b16 a[86:87], v3 offset:52896
    v_cvt_pk_bf16_f32 v67, v70, v71
    v_exp_f32 v16, v16
    v_mfma_f32_16x16x32_bf16 v[28:31], a[152:155], a[24:27], v[28:31]
    ds_read_b64_tr_b16 a[88:89], v3 offset:52416
    ds_read_b64_tr_b16 a[90:91], v3 offset:52928
    v_exp_f32 v17, v17
    v_mfma_f32_16x16x32_bf16 v[28:31], a[156:159], a[28:31], v[28:31]
    ds_read_b64_tr_b16 a[92:93], v3 offset:52448
    ds_read_b64_tr_b16 a[94:95], v3 offset:52960
    v_exp_f32 v18, v18
    v_cvt_pk_bf16_f32 v16, v16, v17
    v_mfma_f32_16x16x32_bf16 v[32:35], a[128:131], a[32:35], v[88:91]
    v_exp_f32 v19, v19
    v_mfma_f32_16x16x32_bf16 v[32:35], a[132:135], a[36:39], v[32:35]
    v_exp_f32 v20, v20
    v_cvt_pk_bf16_f32 v17, v18, v19
    v_mfma_f32_16x16x32_bf16 v[32:35], a[136:139], a[40:43], v[32:35]
    v_exp_f32 v21, v21
    v_mfma_f32_16x16x32_bf16 v[32:35], a[140:143], a[44:47], v[32:35]
    v_exp_f32 v22, v22
    v_cvt_pk_bf16_f32 v18, v20, v21
    v_mfma_f32_16x16x32_bf16 v[36:39], a[144:147], a[32:35], v[88:91]
    v_exp_f32 v23, v23
    v_mfma_f32_16x16x32_bf16 v[36:39], a[148:151], a[36:39], v[36:39]
    v_exp_f32 v24, v24
    v_cvt_pk_bf16_f32 v19, v22, v23
    v_mfma_f32_16x16x32_bf16 v[36:39], a[152:155], a[40:43], v[36:39]
    v_exp_f32 v25, v25
    v_mfma_f32_16x16x32_bf16 v[36:39], a[156:159], a[44:47], v[36:39]
    v_exp_f32 v26, v26
    v_cvt_pk_bf16_f32 v20, v24, v25
    s_waitcnt lgkmcnt(15)
    v_mfma_f32_16x16x32_bf16 v[128:131], a[160:163], v[48:51], v[128:131]
    v_exp_f32 v27, v27
    v_mfma_f32_16x16x32_bf16 v[132:135], a[164:167], v[48:51], v[132:135]
    v_exp_f32 v28, v28
    v_cvt_pk_bf16_f32 v21, v26, v27
    v_mfma_f32_16x16x32_bf16 v[136:139], a[168:171], v[48:51], v[136:139]
    v_exp_f32 v29, v29
    v_mfma_f32_16x16x32_bf16 v[140:143], a[172:175], v[48:51], v[140:143]
    v_exp_f32 v30, v30
    v_cvt_pk_bf16_f32 v22, v28, v29
    v_mfma_f32_16x16x32_bf16 v[144:147], a[176:179], v[48:51], v[144:147]
    v_exp_f32 v31, v31
    v_mfma_f32_16x16x32_bf16 v[148:151], a[180:183], v[48:51], v[148:151]
    v_exp_f32 v32, v32
    v_cvt_pk_bf16_f32 v23, v30, v31
    v_mfma_f32_16x16x32_bf16 v[152:155], a[184:187], v[48:51], v[152:155]
    v_exp_f32 v33, v33
    v_mfma_f32_16x16x32_bf16 v[156:159], a[188:191], v[48:51], v[156:159]
    v_exp_f32 v34, v34
    v_cvt_pk_bf16_f32 v32, v32, v33
    v_mfma_f32_16x16x32_bf16 v[160:163], a[160:163], v[52:55], v[160:163]
    v_exp_f32 v35, v35
    v_mfma_f32_16x16x32_bf16 v[164:167], a[164:167], v[52:55], v[164:167]
    v_exp_f32 v36, v36
    v_cvt_pk_bf16_f32 v33, v34, v35
    v_mfma_f32_16x16x32_bf16 v[168:171], a[168:171], v[52:55], v[168:171]
    v_exp_f32 v37, v37
    v_mfma_f32_16x16x32_bf16 v[172:175], a[172:175], v[52:55], v[172:175]
    v_exp_f32 v38, v38
    v_cvt_pk_bf16_f32 v34, v36, v37
    v_mfma_f32_16x16x32_bf16 v[176:179], a[176:179], v[52:55], v[176:179]
    v_exp_f32 v39, v39
    v_mfma_f32_16x16x32_bf16 v[180:183], a[180:183], v[52:55], v[180:183]
    v_cvt_pk_bf16_f32 v35, v38, v39
    s_nop 1
    v_smfmac_f32_16x16x64_bf16 a[208:211], a[228:231], v[48:55], v15
    v_mfma_f32_16x16x32_bf16 a[212:215], a[224:227], v[64:67], a[212:215]
    v_smfmac_f32_16x16x64_bf16 a[208:211], a[236:239], v[16:23], v15
    v_mfma_f32_16x16x32_bf16 a[212:215], a[232:235], v[32:35], a[212:215]
    s_waitcnt lgkmcnt(0)
    v_mfma_f32_16x16x32_bf16 v[128:131], a[64:67], v[16:19], v[128:131]
    v_mfma_f32_16x16x32_bf16 v[132:135], a[68:71], v[16:19], v[132:135]
    v_mfma_f32_16x16x32_bf16 v[136:139], a[72:75], v[16:19], v[136:139]
    v_mfma_f32_16x16x32_bf16 v[140:143], a[76:79], v[16:19], v[140:143]
    v_mfma_f32_16x16x32_bf16 v[144:147], a[80:83], v[16:19], v[144:147]
    v_mfma_f32_16x16x32_bf16 v[148:151], a[84:87], v[16:19], v[148:151]
    v_mfma_f32_16x16x32_bf16 v[152:155], a[88:91], v[16:19], v[152:155]
    v_mfma_f32_16x16x32_bf16 v[156:159], a[92:95], v[16:19], v[156:159]
    s_nop 3
    v_accvgpr_read_b32 v112, a208
    v_accvgpr_read_b32 v113, a210
    v_accvgpr_read_b32 v114, a212
    v_accvgpr_read_b32 v116, a209
    v_accvgpr_read_b32 v117, a211
    v_add_f32 v112, v112, v116
    v_add_f32 v113, v113, v117
    v_cmp_nge_f32 vcc, 0x44800000, v112
    v_rcp_f32 v120, v112
    s_nop 0
    s_mov_b64 s[84:85], vcc
    v_cmp_nge_f32 vcc, 0x44800000, v113
    v_rcp_f32 v121, v113
    s_nop 0
    s_or_b64 s[84:85], s[84:85], vcc
    v_cmp_nge_f32 vcc, 0x44800000, v114
    v_rcp_f32 v122, v114
    s_nop 0
    s_or_b64 s[84:85], s[84:85], vcc
    s_mov_b32 s40, s34
    s_cbranch_scc1 L_el3_0
    v_mfma_f32_16x16x32_bf16 v[184:187], a[184:187], v[52:55], v[184:187]
    v_mul_f32 v128, v120, v128
    v_mul_f32 v129, v120, v129
    v_mul_f32 v130, v120, v130
    v_mfma_f32_16x16x32_bf16 v[188:191], a[188:191], v[52:55], v[188:191]
    v_mul_f32 v131, v120, v131
    v_mul_f32 v132, v120, v132
    v_mul_f32 v133, v120, v133
    v_mfma_f32_16x16x32_bf16 v[160:163], a[64:67], v[20:23], v[160:163]
    v_mul_f32 v134, v120, v134
    v_mul_f32 v135, v120, v135
    v_cvt_pk_bf16_f32 v128, v128, v129
    v_mfma_f32_16x16x32_bf16 v[164:167], a[68:71], v[20:23], v[164:167]
    v_cvt_pk_bf16_f32 v129, v130, v131
    v_mul_f32 v136, v120, v136
    v_mul_f32 v137, v120, v137
    v_mfma_f32_16x16x32_bf16 v[168:171], a[72:75], v[20:23], v[168:171]
    v_mul_f32 v138, v120, v138
    v_mul_f32 v139, v120, v139
    v_cvt_pk_bf16_f32 v132, v132, v133
    v_mfma_f32_16x16x32_bf16 v[172:175], a[76:79], v[20:23], v[172:175]
    v_cvt_pk_bf16_f32 v133, v134, v135
    ds_write_b64 v11, v[128:129] offset:0
    v_mul_f32 v140, v120, v140
    v_mfma_f32_16x16x32_bf16 v[176:179], a[80:83], v[20:23], v[176:179]
    v_mul_f32 v141, v120, v141
    v_mul_f32 v142, v120, v142
    v_mul_f32 v143, v120, v143
    v_mfma_f32_16x16x32_bf16 v[180:183], a[84:87], v[20:23], v[180:183]
    v_cvt_pk_bf16_f32 v136, v136, v137
    v_cvt_pk_bf16_f32 v137, v138, v139
    ds_write_b64 v11, v[132:133] offset:32
    v_mfma_f32_16x16x32_bf16 v[184:187], a[88:91], v[20:23], v[184:187]
    v_mul_f32 v144, v120, v144
    v_mul_f32 v145, v120, v145
    v_mul_f32 v146, v120, v146
    v_mfma_f32_16x16x32_bf16 v[188:191], a[92:95], v[20:23], v[188:191]
    v_mul_f32 v147, v120, v147
    v_cvt_pk_bf16_f32 v140, v140, v141
    v_cvt_pk_bf16_f32 v141, v142, v143
    ds_write_b64 v11, v[136:137] offset:64
    v_mul_f32 v148, v120, v148
    v_mul_f32 v149, v120, v149
    v_mul_f32 v150, v120, v150
    v_mul_f32 v151, v120, v151
    v_cvt_pk_bf16_f32 v144, v144, v145
    v_cvt_pk_bf16_f32 v145, v146, v147
    ds_write_b64 v11, v[140:141] offset:96
    v_mul_f32 v152, v120, v152
    v_mul_f32 v153, v120, v153
    v_mul_f32 v154, v120, v154
    v_mul_f32 v155, v120, v155
    v_cvt_pk_bf16_f32 v148, v148, v149
    v_cvt_pk_bf16_f32 v149, v150, v151
    ds_write_b64 v11, v[144:145] offset:128
    v_mul_f32 v156, v120, v156
    v_mul_f32 v157, v120, v157
    v_mul_f32 v158, v120, v158
    v_mul_f32 v159, v120, v159
    v_cvt_pk_bf16_f32 v152, v152, v153
    v_cvt_pk_bf16_f32 v153, v154, v155
    ds_write_b64 v11, v[148:149] offset:160
    v_cvt_pk_bf16_f32 v156, v156, v157
    v_cvt_pk_bf16_f32 v157, v158, v159
    ds_write_b64 v11, v[152:153] offset:192
    ds_write_b64 v11, v[156:157] offset:224
    ds_read_b128 v[128:131], v12 offset:0
    ds_read_b128 v[132:135], v12 offset:1088
    ds_read_b128 v[136:139], v12 offset:2176
    ds_read_b128 v[140:143], v12 offset:3264
    v_mfma_f32_16x16x32_bf16 v[192:195], a[160:163], v[64:67], v[192:195]
    v_mul_f32 v160, v121, v160
    v_mul_f32 v161, v121, v161
    v_mul_f32 v162, v121, v162
    v_mfma_f32_16x16x32_bf16 v[196:199], a[164:167], v[64:67], v[196:199]
    v_mul_f32 v163, v121, v163
    v_mul_f32 v164, v121, v164
    v_mul_f32 v165, v121, v165
    v_mfma_f32_16x16x32_bf16 v[200:203], a[168:171], v[64:67], v[200:203]
    v_mul_f32 v166, v121, v166
    v_mul_f32 v167, v121, v167
    v_cvt_pk_bf16_f32 v160, v160, v161
    v_mfma_f32_16x16x32_bf16 v[204:207], a[172:175], v[64:67], v[204:207]
    v_cvt_pk_bf16_f32 v161, v162, v163
    v_mul_f32 v168, v121, v168
    v_mul_f32 v169, v121, v169
    v_mfma_f32_16x16x32_bf16 v[208:211], a[176:179], v[64:67], v[208:211]
    v_mul_f32 v170, v121, v170
    v_mul_f32 v171, v121, v171
    v_cvt_pk_bf16_f32 v164, v164, v165
    v_mfma_f32_16x16x32_bf16 v[212:215], a[180:183], v[64:67], v[212:215]
    v_cvt_pk_bf16_f32 v165, v166, v167
    ds_write_b64 v11, v[160:161] offset:4352
    s_waitcnt lgkmcnt(4)
    buffer_store_dwordx4 v[128:131], v13, s[16:19], s40 offen sc0 sc1
    s_add_u32 s40, s40, 16384
    v_mul_f32 v172, v121, v172
    v_mfma_f32_16x16x32_bf16 v[216:219], a[184:187], v[64:67], v[216:219]
    v_mul_f32 v173, v121, v173
    v_mul_f32 v174, v121, v174
    v_mul_f32 v175, v121, v175
    v_mfma_f32_16x16x32_bf16 v[220:223], a[188:191], v[64:67], v[220:223]
    v_cvt_pk_bf16_f32 v168, v168, v169
    v_cvt_pk_bf16_f32 v169, v170, v171
    ds_write_b64 v11, v[164:165] offset:4384
    v_mfma_f32_16x16x32_bf16 v[192:195], a[64:67], v[32:35], v[192:195]
    v_mul_f32 v176, v121, v176
    v_mul_f32 v177, v121, v177
    v_mul_f32 v178, v121, v178
    v_mfma_f32_16x16x32_bf16 v[196:199], a[68:71], v[32:35], v[196:199]
    v_mul_f32 v179, v121, v179
    v_cvt_pk_bf16_f32 v172, v172, v173
    v_cvt_pk_bf16_f32 v173, v174, v175
    v_mfma_f32_16x16x32_bf16 v[200:203], a[72:75], v[32:35], v[200:203]
    ds_write_b64 v11, v[168:169] offset:4416
    s_waitcnt lgkmcnt(5)
    buffer_store_dwordx4 v[132:135], v13, s[16:19], s40 offen sc0 sc1
    s_add_u32 s40, s40, 16384
    v_mul_f32 v180, v121, v180
    v_mul_f32 v181, v121, v181
    v_mfma_f32_16x16x32_bf16 v[204:207], a[76:79], v[32:35], v[204:207]
    v_mul_f32 v182, v121, v182
    v_mul_f32 v183, v121, v183
    v_cvt_pk_bf16_f32 v176, v176, v177
    v_mfma_f32_16x16x32_bf16 v[208:211], a[80:83], v[32:35], v[208:211]
    v_cvt_pk_bf16_f32 v177, v178, v179
    ds_write_b64 v11, v[172:173] offset:4448
    v_mul_f32 v184, v121, v184
    v_mfma_f32_16x16x32_bf16 v[212:215], a[84:87], v[32:35], v[212:215]
    v_mul_f32 v185, v121, v185
    v_mul_f32 v186, v121, v186
    v_mul_f32 v187, v121, v187
    v_mfma_f32_16x16x32_bf16 v[216:219], a[88:91], v[32:35], v[216:219]
    v_cvt_pk_bf16_f32 v180, v180, v181
    v_cvt_pk_bf16_f32 v181, v182, v183
    ds_write_b64 v11, v[176:177] offset:4480
    s_waitcnt lgkmcnt(6)
    buffer_store_dwordx4 v[136:139], v13, s[16:19], s40 offen sc0 sc1
    s_add_u32 s40, s40, 16384
    v_mfma_f32_16x16x32_bf16 v[220:223], a[92:95], v[32:35], v[220:223]
    v_mul_f32 v188, v121, v188
    v_mul_f32 v189, v121, v189
    v_mul_f32 v190, v121, v190
    v_mul_f32 v191, v121, v191
    v_cvt_pk_bf16_f32 v184, v184, v185
    v_cvt_pk_bf16_f32 v185, v186, v187
    ds_write_b64 v11, v[180:181] offset:4512
    v_cvt_pk_bf16_f32 v188, v188, v189
    v_cvt_pk_bf16_f32 v189, v190, v191
    ds_write_b64 v11, v[184:185] offset:4544
    s_waitcnt lgkmcnt(7)
    buffer_store_dwordx4 v[140:143], v13, s[16:19], s40 offen sc0 sc1
    s_add_u32 s40, s40, 16384
    ds_write_b64 v11, v[188:189] offset:4576
    ds_read_b128 v[160:163], v12 offset:4352
    ds_read_b128 v[164:167], v12 offset:5440
    ds_read_b128 v[168:171], v12 offset:6528
    ds_read_b128 v[172:175], v12 offset:7616
    v_mul_f32 v192, v122, v192
    v_mul_f32 v193, v122, v193
    v_mul_f32 v194, v122, v194
    v_mul_f32 v195, v122, v195
    v_mul_f32 v196, v122, v196
    v_mul_f32 v197, v122, v197
    v_mul_f32 v198, v122, v198
    v_mul_f32 v199, v122, v199
    v_cvt_pk_bf16_f32 v192, v192, v193
    v_cvt_pk_bf16_f32 v193, v194, v195
    v_mul_f32 v200, v122, v200
    v_mul_f32 v201, v122, v201
    v_mul_f32 v202, v122, v202
    v_mul_f32 v203, v122, v203
    v_cvt_pk_bf16_f32 v196, v196, v197
    v_cvt_pk_bf16_f32 v197, v198, v199
    ds_write_b64 v11, v[192:193] offset:8704
    s_waitcnt lgkmcnt(4)
    buffer_store_dwordx4 v[160:163], v13, s[16:19], s40 offen sc0 sc1
    s_add_u32 s40, s40, 16384
    v_mul_f32 v204, v122, v204
    v_mul_f32 v205, v122, v205
    v_mul_f32 v206, v122, v206
    v_mul_f32 v207, v122, v207
    v_cvt_pk_bf16_f32 v200, v200, v201
    v_cvt_pk_bf16_f32 v201, v202, v203
    ds_write_b64 v11, v[196:197] offset:8736
    v_mul_f32 v208, v122, v208
    v_mul_f32 v209, v122, v209
    v_mul_f32 v210, v122, v210
    v_mul_f32 v211, v122, v211
    v_cvt_pk_bf16_f32 v204, v204, v205
    v_cvt_pk_bf16_f32 v205, v206, v207
    ds_write_b64 v11, v[200:201] offset:8768
    s_waitcnt lgkmcnt(5)
    buffer_store_dwordx4 v[164:167], v13, s[16:19], s40 offen sc0 sc1
    s_add_u32 s40, s40, 16384
    v_mul_f32 v212, v122, v212
    v_mul_f32 v213, v122, v213
    v_mul_f32 v214, v122, v214
    v_mul_f32 v215, v122, v215
    v_cvt_pk_bf16_f32 v208, v208, v209
    v_cvt_pk_bf16_f32 v209, v210, v211
    ds_write_b64 v11, v[204:205] offset:8800
    v_mul_f32 v216, v122, v216
    v_mul_f32 v217, v122, v217
    v_mul_f32 v218, v122, v218
    v_mul_f32 v219, v122, v219
    v_cvt_pk_bf16_f32 v212, v212, v213
    v_cvt_pk_bf16_f32 v213, v214, v215
    ds_write_b64 v11, v[208:209] offset:8832
    s_waitcnt lgkmcnt(6)
    buffer_store_dwordx4 v[168:171], v13, s[16:19], s40 offen sc0 sc1
    s_add_u32 s40, s40, 16384
    v_mul_f32 v220, v122, v220
    v_mul_f32 v221, v122, v221
    v_mul_f32 v222, v122, v222
    v_mul_f32 v223, v122, v223
    v_cvt_pk_bf16_f32 v216, v216, v217
    v_cvt_pk_bf16_f32 v217, v218, v219
    ds_write_b64 v11, v[212:213] offset:8864
    v_cvt_pk_bf16_f32 v220, v220, v221
    v_cvt_pk_bf16_f32 v221, v222, v223
    ds_write_b64 v11, v[216:217] offset:8896
    s_waitcnt lgkmcnt(7)
    buffer_store_dwordx4 v[172:175], v13, s[16:19], s40 offen sc0 sc1
    s_add_u32 s40, s40, 16384
    ds_write_b64 v11, v[220:221] offset:8928
    ds_read_b128 v[192:195], v12 offset:8704
    ds_read_b128 v[196:199], v12 offset:9792
    ds_read_b128 v[200:203], v12 offset:10880
    ds_read_b128 v[204:207], v12 offset:11968
    s_waitcnt lgkmcnt(3)
    buffer_store_dwordx4 v[192:195], v13, s[16:19], s40 offen sc0 sc1
    s_add_u32 s40, s40, 16384
    s_waitcnt lgkmcnt(2)
    buffer_store_dwordx4 v[196:199], v13, s[16:19], s40 offen sc0 sc1
    s_add_u32 s40, s40, 16384
    s_waitcnt lgkmcnt(1)
    buffer_store_dwordx4 v[200:203], v13, s[16:19], s40 offen sc0 sc1
    s_add_u32 s40, s40, 16384
    s_waitcnt lgkmcnt(0)
    buffer_store_dwordx4 v[204:207], v13, s[16:19], s40 offen sc0 sc1
    s_add_u32 s40, s40, 16384
    s_endpgm
L_e3x_3:
    s_mov_b32 s44, 3
    s_barrier
L_e3_3_3:
    ds_read_b64_tr_b16 a[160:161], v3 offset:52224
    v_exp_f32 v27, v27
    ds_read_b64_tr_b16 a[162:163], v3 offset:52736
    v_exp_f32 v28, v28
    ds_read_b64_tr_b16 a[164:165], v3 offset:52256
    v_cvt_pk_bf16_f32 v21, v26, v27
    ds_read_b64_tr_b16 a[166:167], v3 offset:52768
    v_exp_f32 v29, v29
    ds_read_b64_tr_b16 a[168:169], v3 offset:52288
    v_exp_f32 v30, v30
    ds_read_b64_tr_b16 a[170:171], v3 offset:52800
    v_cvt_pk_bf16_f32 v22, v28, v29
    ds_read_b64_tr_b16 a[172:173], v3 offset:52320
    v_exp_f32 v31, v31
    ds_read_b64_tr_b16 a[174:175], v3 offset:52832
    v_exp_f32 v32, v32
    ds_read_b64_tr_b16 a[176:177], v3 offset:52352
    v_cvt_pk_bf16_f32 v23, v30, v31
    ds_read_b64_tr_b16 a[178:179], v3 offset:52864
    v_exp_f32 v33, v33
    ds_read_b64_tr_b16 a[180:181], v3 offset:52384
    v_exp_f32 v34, v34
    ds_read_b64_tr_b16 a[182:183], v3 offset:52896
    v_cvt_pk_bf16_f32 v32, v32, v33
    ds_read_b64_tr_b16 a[184:185], v3 offset:52416
    v_exp_f32 v35, v35
    ds_read_b64_tr_b16 a[186:187], v3 offset:52928
    v_exp_f32 v36, v36
    ds_read_b64_tr_b16 a[188:189], v3 offset:52448
    v_cvt_pk_bf16_f32 v33, v34, v35
    ds_read_b64_tr_b16 a[190:191], v3 offset:52960
    v_exp_f32 v37, v37
    v_exp_f32 v38, v38
    v_cvt_pk_bf16_f32 v34, v36, v37
    v_exp_f32 v39, v39
    s_nop 0
    v_cvt_pk_bf16_f32 v35, v38, v39
    s_nop 1
    v_smfmac_f32_16x16x64_bf16 a[208:211], a[236:239], v[16:23], v15
    v_mfma_f32_16x16x32_bf16 a[212:215], a[232:235], v[32:35], a[212:215]
    s_waitcnt lgkmcnt(8)
    v_mfma_f32_16x16x32_bf16 v[128:131], a[160:163], v[16:19], v[128:131]
    s_add_u32 m0, s30, 34816
    v_mfma_f32_16x16x32_bf16 v[132:135], a[164:167], v[16:19], v[132:135]
    buffer_load_dwordx4 v4, s[8:11], s28 offen lds
    v_mfma_f32_16x16x32_bf16 v[136:139], a[168:171], v[16:19], v[136:139]
    s_add_u32 m0, s30, 39040
    v_mfma_f32_16x16x32_bf16 v[140:143], a[172:175], v[16:19], v[140:143]
    buffer_load_dwordx4 v5, s[8:11], s28 offen lds
    s_waitcnt lgkmcnt(0)
    v_mfma_f32_16x16x32_bf16 v[144:147], a[176:179], v[16:19], v[144:147]
    s_add_u32 m0, s30, 43520
    ds_read_b128 a[64:67], v9 offset:0
    ds_read_b128 a[68:71], v9 offset:64
    ds_read_b128 a[72:75], v10 offset:0
    v_mfma_f32_16x16x32_bf16 v[148:151], a[180:183], v[16:19], v[148:151]
    buffer_load_dwordx4 v6, s[12:15], s29 offen lds
    ds_read_b128 a[76:79], v10 offset:64
    ds_read_b128 a[80:83], v9 offset:4224
    ds_read_b128 a[84:87], v9 offset:4288
    v_mfma_f32_16x16x32_bf16 v[152:155], a[184:187], v[16:19], v[152:155]
    s_add_u32 m0, s30, 47744
    ds_read_b128 a[88:91], v10 offset:4224
    ds_read_b128 a[92:95], v10 offset:4288
    ds_read_b128 a[96:99], v9 offset:8448
    v_mfma_f32_16x16x32_bf16 v[156:159], a[188:191], v[16:19], v[156:159]
    buffer_load_dwordx4 v7, s[12:15], s29 offen lds
    ds_read_b128 a[100:103], v9 offset:8512
    ds_read_b128 a[104:107], v10 offset:8448
    ds_read_b128 a[108:111], v10 offset:8512
    s_add_u32 s28, s28, s101
    s_add_u32 s29, s29, s101
    v_accvgpr_read_b32 v112, a208
    v_accvgpr_read_b32 v113, a210
    v_accvgpr_read_b32 v114, a212
    v_accvgpr_read_b32 v116, a209
    v_accvgpr_read_b32 v117, a211
    v_add_f32 v112, v112, v116
    v_add_f32 v113, v113, v117
    v_cmp_nge_f32 vcc, 0x44800000, v112
    v_rcp_f32 v120, v112
    s_nop 0
    s_mov_b64 s[84:85], vcc
    v_cmp_nge_f32 vcc, 0x44800000, v113
    v_rcp_f32 v121, v113
    s_nop 0
    s_or_b64 s[84:85], s[84:85], vcc
    v_cmp_nge_f32 vcc, 0x44800000, v114
    v_rcp_f32 v122, v114
    s_nop 0
    s_or_b64 s[84:85], s[84:85], vcc
    s_mov_b32 s40, s34
    s_cbranch_scc1 L_es3_1
    s_waitcnt vmcnt(8) lgkmcnt(0)
    v_mfma_f32_16x16x32_bf16 v[160:163], a[160:163], v[20:23], v[160:163]
    v_mul_f32 v128, v120, v128
    v_mfma_f32_32x32x16_bf16 v[96:111], a[192:195], a[64:67], 0
    v_mul_f32 v129, v120, v129
    v_mul_f32 v130, v120, v130
    s_mov_b32 s80, s81
    s_mov_b32 s81, 0
    s_add_u32 s47, s47, 1
    v_mul_f32 v131, v120, v131
    v_mfma_f32_16x16x32_bf16 v[164:167], a[164:167], v[20:23], v[164:167]
    s_mov_b32 s42, s89
    s_mov_b32 s43, s90
    v_mul_f32 v132, v120, v132
    v_mfma_f32_32x32x16_bf16 v[96:111], a[196:199], a[68:71], v[96:111]
    v_mul_f32 v133, v120, v133
    v_mul_f32 v134, v120, v134
    s_mov_b32 s34, s91
    s_mov_b32 s88, s93
    s_bfe_u32 s37, s80, 0xa000d
    v_mul_f32 v135, v120, v135
    v_mfma_f32_16x16x32_bf16 v[168:171], a[168:171], v[20:23], v[168:171]
    s_add_u32 s36, s37, 31
    s_lshr_b32 s36, s36, 5
    v_cvt_pk_bf16_f32 v128, v128, v129
    v_mfma_f32_32x32x16_bf16 v[96:111], a[200:203], a[64:67], v[96:111]
    v_cvt_pk_bf16_f32 v129, v130, v131
    v_mul_f32 v136, v120, v136
    s_sub_u32 s31, s36, 1
    s_lshl_b32 s39, s31, 5
    s_sub_u32 s35, s37, s39
    v_mul_f32 v137, v120, v137
    v_mfma_f32_16x16x32_bf16 v[172:175], a[172:175], v[20:23], v[172:175]
    s_mov_b32 s46, 0
    s_mov_b32 s99, s33
    v_mul_f32 v138, v120, v138
    v_mfma_f32_32x32x16_bf16 v[96:111], a[204:207], a[68:71], v[96:111]
    v_mul_f32 v139, v120, v139
    v_cvt_pk_bf16_f32 v132, v132, v133
    s_sub_u32 s31, s31, 1
    s_mov_b32 s32, 4
    s_mov_b32 s93, 0
    v_cvt_pk_bf16_f32 v133, v134, v135
    v_mfma_f32_16x16x32_bf16 v[176:179], a[176:179], v[20:23], v[176:179]
    s_mov_b32 s90, 0
    ds_write_b64 v11, v[128:129] offset:0
    v_mfma_f32_32x32x16_bf16 v[224:239], a[192:195], a[72:75], 0
    v_mul_f32 v140, v120, v140
    v_mul_f32 v141, v120, v141
    v_accvgpr_mov_b32 a232, a240
    v_accvgpr_mov_b32 a233, a241
    v_mul_f32 v142, v120, v142
    v_mfma_f32_16x16x32_bf16 v[180:183], a[180:183], v[20:23], v[180:183]
    v_mfma_f32_32x32x16_bf16 v[224:239], a[196:199], a[76:79], v[224:239]
    v_mul_f32 v143, v120, v143
    v_cvt_pk_bf16_f32 v136, v136, v137
    v_accvgpr_mov_b32 a234, a242
    v_accvgpr_mov_b32 a235, a243
    v_cvt_pk_bf16_f32 v137, v138, v139
    v_mfma_f32_32x32x16_bf16 v[224:239], a[200:203], a[72:75], v[224:239]
    ds_write_b64 v11, v[132:133] offset:32
    v_mfma_f32_16x16x32_bf16 v[184:187], a[184:187], v[20:23], v[184:187]
    v_accvgpr_mov_b32 a236, a244
    v_accvgpr_mov_b32 a237, a245
    v_mul_f32 v144, v120, v144
    v_mul_f32 v145, v120, v145
    v_mfma_f32_32x32x16_bf16 v[224:239], a[204:207], a[76:79], v[224:239]
    v_mul_f32 v146, v120, v146
    v_accvgpr_mov_b32 a238, a246
    v_accvgpr_mov_b32 a239, a247
    v_mul_f32 v147, v120, v147
    v_mfma_f32_16x16x32_bf16 v[188:191], a[188:191], v[20:23], v[188:191]
    v_mfma_f32_32x32x16_bf16 a[208:223], v[124:127], v[124:127], 0
    v_cvt_pk_bf16_f32 v140, v140, v141
    v_cvt_pk_bf16_f32 v141, v142, v143
    v_cvt_pk_bf16_f32 v96, v96, v97
    v_cvt_pk_bf16_f32 v97, v98, v99
    v_cvt_pk_bf16_f32 v98, v100, v101
    ds_write_b64 v11, v[136:137] offset:64
    v_cvt_pk_bf16_f32 v99, v102, v103
    v_cvt_pk_bf16_f32 v100, v104, v105
    v_cvt_pk_bf16_f32 v101, v106, v107
    v_mul_f32 v148, v120, v148
    v_mul_f32 v149, v120, v149
    v_cvt_pk_bf16_f32 v102, v108, v109
    v_cvt_pk_bf16_f32 v103, v110, v111
    v_accvgpr_write_b32 a0, v96
    v_mul_f32 v150, v120, v150
    v_mul_f32 v151, v120, v151
    v_accvgpr_write_b32 a1, v97
    v_accvgpr_write_b32 a2, v98
    v_accvgpr_write_b32 a3, v99
    v_cvt_pk_bf16_f32 v144, v144, v145
    v_accvgpr_write_b32 a4, v100
    v_accvgpr_write_b32 a5, v101
    v_accvgpr_write_b32 a6, v102
    v_cvt_pk_bf16_f32 v145, v146, v147
    ds_write_b64 v11, v[140:141] offset:96
    v_accvgpr_write_b32 a7, v103
    v_mul_f32 v152, v120, v152
    v_mul_f32 v153, v120, v153
    v_mfma_f32_32x32x16_bf16 v[96:111], a[192:195], a[80:83], 0
    v_mul_f32 v154, v120, v154
    v_cvt_pk_bf16_f32 v224, v224, v225
    v_cvt_pk_bf16_f32 v225, v226, v227
    v_cvt_pk_bf16_f32 v226, v228, v229
    v_mul_f32 v155, v120, v155
    v_cvt_pk_bf16_f32 v148, v148, v149
    v_cvt_pk_bf16_f32 v227, v230, v231
    v_cvt_pk_bf16_f32 v149, v150, v151
    ds_write_b64 v11, v[144:145] offset:128
    v_mfma_f32_32x32x16_bf16 v[96:111], a[196:199], a[84:87], v[96:111]
    v_mul_f32 v156, v120, v156
    v_mul_f32 v157, v120, v157
    v_cvt_pk_bf16_f32 v228, v232, v233
    v_cvt_pk_bf16_f32 v229, v234, v235
    v_cvt_pk_bf16_f32 v230, v236, v237
    v_mul_f32 v158, v120, v158
    v_cvt_pk_bf16_f32 v231, v238, v239
    v_mul_f32 v159, v120, v159
    v_cvt_pk_bf16_f32 v152, v152, v153
    v_mfma_f32_32x32x16_bf16 v[96:111], a[200:203], a[80:83], v[96:111]
    v_cvt_pk_bf16_f32 v153, v154, v155
    ds_write_b64 v11, v[148:149] offset:160
    v_accvgpr_write_b32 a8, v224
    v_accvgpr_write_b32 a9, v225
    v_accvgpr_write_b32 a10, v226
    v_cvt_pk_bf16_f32 v156, v156, v157
    v_accvgpr_write_b32 a11, v227
    v_cvt_pk_bf16_f32 v157, v158, v159
    ds_write_b64 v11, v[152:153] offset:192
    v_mfma_f32_32x32x16_bf16 v[96:111], a[204:207], a[84:87], v[96:111]
    ds_write_b64 v11, v[156:157] offset:224
    ds_read_b128 v[128:131], v12 offset:0
    v_accvgpr_write_b32 a12, v228
    v_accvgpr_write_b32 a13, v229
    v_accvgpr_write_b32 a14, v230
    ds_read_b128 v[132:135], v12 offset:1088
    v_accvgpr_write_b32 a15, v231
    ds_read_b128 v[136:139], v12 offset:2176
    ds_read_b128 v[140:143], v12 offset:3264
    s_nop 1
    v_mfma_f32_16x16x32_bf16 v[48:51], a[128:131], a[0:3], 0
    v_mfma_f32_16x16x32_bf16 v[192:195], a[160:163], v[32:35], v[192:195]
    v_mul_f32 v160, v121, v160
    v_mfma_f32_16x16x32_bf16 v[48:51], a[132:135], a[4:7], v[48:51]
    v_mul_f32 v161, v121, v161
    v_mfma_f32_16x16x32_bf16 v[48:51], a[136:139], a[8:11], v[48:51]
    v_mul_f32 v162, v121, v162
    v_mul_f32 v163, v121, v163
    v_mfma_f32_16x16x32_bf16 v[48:51], a[140:143], a[12:15], v[48:51]
    v_mfma_f32_16x16x32_bf16 v[196:199], a[164:167], v[32:35], v[196:199]
    v_mul_f32 v164, v121, v164
    v_mfma_f32_16x16x32_bf16 v[52:55], a[144:147], a[0:3], 0
    v_mul_f32 v165, v121, v165
    v_mul_f32 v166, v121, v166
    v_mfma_f32_16x16x32_bf16 v[52:55], a[148:151], a[4:7], v[52:55]
    v_mul_f32 v167, v121, v167
    v_mfma_f32_16x16x32_bf16 v[52:55], a[152:155], a[8:11], v[52:55]
    v_mfma_f32_16x16x32_bf16 v[200:203], a[168:171], v[32:35], v[200:203]
    v_cvt_pk_bf16_f32 v160, v160, v161
    v_mfma_f32_16x16x32_bf16 v[52:55], a[156:159], a[12:15], v[52:55]
    v_cvt_pk_bf16_f32 v161, v162, v163
    v_mul_f32 v168, v121, v168
    v_mfma_f32_32x32x16_bf16 v[224:239], a[192:195], a[88:91], 0
    v_mul_f32 v169, v121, v169
    v_mfma_f32_32x32x16_bf16 v[224:239], a[196:199], a[92:95], v[224:239]
    v_mfma_f32_16x16x32_bf16 v[204:207], a[172:175], v[32:35], v[204:207]
    v_mul_f32 v170, v121, v170
    v_mfma_f32_32x32x16_bf16 v[224:239], a[200:203], a[88:91], v[224:239]
    v_mul_f32 v171, v121, v171
    v_cvt_pk_bf16_f32 v164, v164, v165
    v_mfma_f32_32x32x16_bf16 v[224:239], a[204:207], a[92:95], v[224:239]
    v_cvt_pk_bf16_f32 v165, v166, v167
    v_cvt_pk_bf16_f32 v96, v96, v97
    v_cvt_pk_bf16_f32 v97, v98, v99
    v_cvt_pk_bf16_f32 v98, v100, v101
    v_mfma_f32_16x16x32_bf16 v[208:211], a[176:179], v[32:35], v[208:211]
    ds_write_b64 v11, v[160:161] offset:4352
    v_cvt_pk_bf16_f32 v99, v102, v103
    v_cvt_pk_bf16_f32 v100, v104, v105
    v_cvt_pk_bf16_f32 v101, v106, v107
    s_waitcnt lgkmcnt(4)
    buffer_store_dwordx4 v[128:131], v13, s[16:19], s40 offen sc0 sc1
    v_cvt_pk_bf16_f32 v102, v108, v109
    v_cvt_pk_bf16_f32 v103, v110, v111
    v_accvgpr_write_b32 a16, v96
    s_add_u32 s40, s40, 16384
    v_accvgpr_write_b32 a17, v97
    v_accvgpr_write_b32 a18, v98
    v_accvgpr_write_b32 a19, v99
    v_mul_f32 v172, v121, v172
    v_mul_f32 v173, v121, v173
    v_accvgpr_write_b32 a20, v100
    v_accvgpr_write_b32 a21, v101
    v_accvgpr_write_b32 a22, v102
    v_mul_f32 v174, v121, v174
    v_mfma_f32_16x16x32_bf16 v[212:215], a[180:183], v[32:35], v[212:215]
    v_accvgpr_write_b32 a23, v103
    v_mul_f32 v175, v121, v175
    v_mfma_f32_32x32x16_bf16 v[96:111], a[192:195], a[96:99], 0
    v_cvt_pk_bf16_f32 v168, v168, v169
    v_cvt_pk_bf16_f32 v169, v170, v171
    v_max3_f32 v112, v48, v49, v50
    v_max3_f32 v116, v51, v52, v53
    v_max3_f32 v112, v112, v54, v55
    ds_write_b64 v11, v[164:165] offset:4384
    v_mfma_f32_16x16x32_bf16 v[216:219], a[184:187], v[32:35], v[216:219]
    v_max_f32 v112, v112, v116
    v_mov_b32 v116, v112
    s_nop 1
    v_mul_f32 v176, v121, v176
    v_mul_f32 v177, v121, v177
    v_permlane32_swap_b32 v112, v116
    v_mul_f32 v178, v121, v178
    v_mfma_f32_32x32x16_bf16 v[96:111], a[196:199], a[100:103], v[96:111]
    v_mul_f32 v179, v121, v179
    v_mfma_f32_16x16x32_bf16 v[220:223], a[188:191], v[32:35], v[220:223]
    v_max_f32 v112, v112, v116
    v_mov_b32 v116, v112
    s_nop 1
    v_cvt_pk_bf16_f32 v172, v172, v173
    v_cvt_pk_bf16_f32 v173, v174, v175
    v_permlane16_swap_b32 v112, v116
    v_max_f32 v112, v112, v116
    v_cvt_pk_bf16_f32 v224, v224, v225
    ds_write_b64 v11, v[168:169] offset:4416
    v_cvt_pk_bf16_f32 v225, v226, v227
    s_waitcnt lgkmcnt(5)
    buffer_store_dwordx4 v[132:135], v13, s[16:19], s40 offen sc0 sc1
    v_mfma_f32_32x32x16_bf16 v[96:111], a[200:203], a[96:99], v[96:111]
    s_add_u32 s40, s40, 16384
    v_mul_f32 v180, v121, v180
    v_cvt_pk_bf16_f32 v226, v228, v229
    v_cvt_pk_bf16_f32 v227, v230, v231
    v_cvt_pk_bf16_f32 v228, v232, v233
    v_mul_f32 v181, v121, v181
    v_cvt_pk_bf16_f32 v229, v234, v235
    v_cvt_pk_bf16_f32 v230, v236, v237
    v_cvt_pk_bf16_f32 v231, v238, v239
    v_mul_f32 v182, v121, v182
    v_mul_f32 v183, v121, v183
    v_accvgpr_write_b32 a24, v224
    v_cvt_pk_bf16_f32 v176, v176, v177
    v_cvt_pk_bf16_f32 v177, v178, v179
    v_mfma_f32_32x32x16_bf16 v[96:111], a[204:207], a[100:103], v[96:111]
    ds_write_b64 v11, v[172:173] offset:4448
    v_accvgpr_write_b32 a25, v225
    v_accvgpr_write_b32 a26, v226
    v_accvgpr_write_b32 a27, v227
    v_mul_f32 v184, v121, v184
    v_mul_f32 v185, v121, v185
    v_accvgpr_write_b32 a28, v228
    v_accvgpr_write_b32 a29, v229
    v_accvgpr_write_b32 a30, v230
    v_mul_f32 v186, v121, v186
    v_mul_f32 v187, v121, v187
    v_accvgpr_write_b32 a31, v231
    v_cvt_pk_bf16_f32 v180, v180, v181
    s_nop 1
    v_mfma_f32_16x16x32_bf16 v[56:59], a[128:131], a[16:19], 0
    v_cvt_pk_bf16_f32 v181, v182, v183
    ds_write_b64 v11, v[176:177] offset:4480
    v_sub_f32 v48, v48, v112
    v_sub_f32 v49, v49, v112
    v_sub_f32 v50, v50, v112
    s_waitcnt lgkmcnt(6)
    buffer_store_dwordx4 v[136:139], v13, s[16:19], s40 offen sc0 sc1
    v_mfma_f32_16x16x32_bf16 v[56:59], a[132:135], a[20:23], v[56:59]
    s_add_u32 s40, s40, 16384
    v_mul_f32 v188, v121, v188
    v_sub_f32 v51, v51, v112
    v_sub_f32 v52, v52, v112
    v_sub_f32 v53, v53, v112
    v_mul_f32 v189, v121, v189
    v_mfma_f32_16x16x32_bf16 v[56:59], a[136:139], a[24:27], v[56:59]
    v_mul_f32 v190, v121, v190
    v_mul_f32 v191, v121, v191
    v_sub_f32 v54, v54, v112
    v_sub_f32 v55, v55, v112
    v_sub_f32 v80, 0, v112
    v_cvt_pk_bf16_f32 v184, v184, v185
    v_cvt_pk_bf16_f32 v185, v186, v187
    v_mfma_f32_16x16x32_bf16 v[56:59], a[140:143], a[28:31], v[56:59]
    ds_write_b64 v11, v[180:181] offset:4512
    v_sub_f32 v81, 0, v112
    v_sub_f32 v82, 0, v112
    v_sub_f32 v83, 0, v112
    v_cvt_pk_bf16_f32 v188, v188, v189
    v_cvt_pk_bf16_f32 v189, v190, v191
    v_mfma_f32_16x16x32_bf16 v[60:63], a[144:147], a[16:19], 0
    ds_write_b64 v11, v[184:185] offset:4544
    s_waitcnt lgkmcnt(7)
    buffer_store_dwordx4 v[140:143], v13, s[16:19], s40 offen sc0 sc1
    v_exp_f32 v48, v48
    v_exp_f32 v49, v49
    v_exp_f32 v50, v50
    v_mfma_f32_16x16x32_bf16 v[60:63], a[148:151], a[20:23], v[60:63]
    s_add_u32 s40, s40, 16384
    ds_write_b64 v11, v[188:189] offset:4576
    v_cvt_pk_bf16_f32 v48, v48, v49
    v_exp_f32 v51, v51
    v_exp_f32 v52, v52
    ds_read_b128 v[160:163], v12 offset:4352
    ds_read_b128 v[164:167], v12 offset:5440
    v_mfma_f32_16x16x32_bf16 v[60:63], a[152:155], a[24:27], v[60:63]
    ds_read_b128 v[168:171], v12 offset:6528
    v_cvt_pk_bf16_f32 v49, v50, v51
    v_exp_f32 v53, v53
    v_exp_f32 v54, v54
    ds_read_b128 v[172:175], v12 offset:7616
    v_mfma_f32_32x32x16_bf16 v[128:143], v[124:127], v[124:127], 0
    v_mfma_f32_16x16x32_bf16 v[60:63], a[156:159], a[28:31], v[60:63]
    v_mfma_f32_32x32x16_bf16 v[144:159], v[124:127], v[124:127], 0
    v_mul_f32 v192, v122, v192
    v_cvt_pk_bf16_f32 v50, v52, v53
    v_exp_f32 v55, v55
    s_nop 0
    v_mul_f32 v193, v122, v193
    v_mul_f32 v194, v122, v194
    v_mfma_f32_32x32x16_bf16 v[224:239], a[192:195], a[104:107], 0
    v_mul_f32 v195, v122, v195
    v_cvt_pk_bf16_f32 v51, v54, v55
    v_mul_f32 v196, v122, v196
    v_mul_f32 v197, v122, v197
    v_mfma_f32_32x32x16_bf16 v[224:239], a[196:199], a[108:111], v[224:239]
    v_mul_f32 v198, v122, v198
    v_mul_f32 v199, v122, v199
    v_mfma_f32_32x32x16_bf16 v[224:239], a[200:203], a[104:107], v[224:239]
    v_cvt_pk_bf16_f32 v192, v192, v193
    v_mfma_f32_32x32x16_bf16 v[224:239], a[204:207], a[108:111], v[224:239]
    v_cvt_pk_bf16_f32 v193, v194, v195
    v_mul_f32 v200, v122, v200
    v_cvt_pk_bf16_f32 v96, v96, v97
    v_cvt_pk_bf16_f32 v97, v98, v99
    v_cvt_pk_bf16_f32 v98, v100, v101
    v_mul_f32 v201, v122, v201
    v_mul_f32 v202, v122, v202
    v_cvt_pk_bf16_f32 v99, v102, v103
    v_cvt_pk_bf16_f32 v100, v104, v105
    v_cvt_pk_bf16_f32 v101, v106, v107
    v_mul_f32 v203, v122, v203
    v_cvt_pk_bf16_f32 v102, v108, v109
    v_cvt_pk_bf16_f32 v103, v110, v111
    v_accvgpr_write_b32 a32, v96
    v_cvt_pk_bf16_f32 v196, v196, v197
    v_cvt_pk_bf16_f32 v197, v198, v199
    v_accvgpr_write_b32 a33, v97
    v_accvgpr_write_b32 a34, v98
    v_accvgpr_write_b32 a35, v99
    ds_write_b64 v11, v[192:193] offset:8704
    s_waitcnt lgkmcnt(4)
    buffer_store_dwordx4 v[160:163], v13, s[16:19], s40 offen sc0 sc1
    v_accvgpr_write_b32 a36, v100
    v_accvgpr_write_b32 a37, v101
    v_accvgpr_write_b32 a38, v102
    v_accvgpr_write_b32 a39, v103
    s_add_u32 s40, s40, 16384
    v_mul_f32 v204, v122, v204
    v_max3_f32 v113, v56, v57, v58
    v_max3_f32 v117, v59, v60, v61
    v_max3_f32 v113, v113, v62, v63
    v_mul_f32 v205, v122, v205
    v_mul_f32 v206, v122, v206
    v_max_f32 v113, v113, v117
    v_mov_b32 v117, v113
    s_nop 1
    v_mul_f32 v207, v122, v207
    v_permlane32_swap_b32 v113, v117
    v_max_f32 v113, v113, v117
    v_mov_b32 v117, v113
    v_cvt_pk_bf16_f32 v200, v200, v201
    v_cvt_pk_bf16_f32 v201, v202, v203
    s_nop 1
    v_permlane16_swap_b32 v113, v117
    v_max_f32 v113, v113, v117
    ds_write_b64 v11, v[196:197] offset:8736
    v_mul_f32 v208, v122, v208
    v_cvt_pk_bf16_f32 v224, v224, v225
    v_cvt_pk_bf16_f32 v225, v226, v227
    v_cvt_pk_bf16_f32 v226, v228, v229
    v_mul_f32 v209, v122, v209
    v_mul_f32 v210, v122, v210
    v_cvt_pk_bf16_f32 v227, v230, v231
    v_cvt_pk_bf16_f32 v228, v232, v233
    v_cvt_pk_bf16_f32 v229, v234, v235
    v_mul_f32 v211, v122, v211
    v_cvt_pk_bf16_f32 v230, v236, v237
    v_cvt_pk_bf16_f32 v231, v238, v239
    v_accvgpr_write_b32 a40, v224
    v_cvt_pk_bf16_f32 v204, v204, v205
    v_cvt_pk_bf16_f32 v205, v206, v207
    v_accvgpr_write_b32 a41, v225
    v_accvgpr_write_b32 a42, v226
    v_accvgpr_write_b32 a43, v227
    ds_write_b64 v11, v[200:201] offset:8768
    s_waitcnt lgkmcnt(5)
    buffer_store_dwordx4 v[164:167], v13, s[16:19], s40 offen sc0 sc1
    v_accvgpr_write_b32 a44, v228
    v_accvgpr_write_b32 a45, v229
    v_accvgpr_write_b32 a46, v230
    v_accvgpr_write_b32 a47, v231
    s_add_u32 s40, s40, 16384
    v_mul_f32 v212, v122, v212
    s_nop 1
    v_mfma_f32_16x16x32_bf16 v[64:67], a[128:131], a[32:35], 0
    ds_read_b128 a[128:131], v1 offset:52224
    v_mul_f32 v213, v122, v213
    v_mul_f32 v214, v122, v214
    v_sub_f32 v56, v56, v113
    v_sub_f32 v57, v57, v113
    v_mul_f32 v215, v122, v215
    v_mfma_f32_16x16x32_bf16 v[64:67], a[132:135], a[36:39], v[64:67]
    ds_read_b128 a[132:135], v1 offset:52288
    v_cvt_pk_bf16_f32 v208, v208, v209
    v_cvt_pk_bf16_f32 v209, v210, v211
    v_sub_f32 v58, v58, v113
    v_sub_f32 v59, v59, v113
    ds_write_b64 v11, v[204:205] offset:8800
    v_mul_f32 v216, v122, v216
    v_mfma_f32_16x16x32_bf16 v[64:67], a[136:139], a[40:43], v[64:67]
    ds_read_b128 a[136:139], v2 offset:52224
    v_mul_f32 v217, v122, v217
    v_sub_f32 v60, v60, v113
    v_sub_f32 v61, v61, v113
    v_mul_f32 v218, v122, v218
    v_mul_f32 v219, v122, v219
    v_mfma_f32_16x16x32_bf16 v[64:67], a[140:143], a[44:47], v[64:67]
    ds_read_b128 a[140:143], v2 offset:52288
    v_cvt_pk_bf16_f32 v212, v212, v213
    v_cvt_pk_bf16_f32 v213, v214, v215
    v_sub_f32 v62, v62, v113
    v_sub_f32 v63, v63, v113
    ds_write_b64 v11, v[208:209] offset:8832
    v_mfma_f32_16x16x32_bf16 v[68:71], a[144:147], a[32:35], 0
    ds_read_b128 a[144:147], v1 offset:56448
    s_waitcnt lgkmcnt(11)
    buffer_store_dwordx4 v[168:171], v13, s[16:19], s40 offen sc0 sc1
    v_sub_f32 v84, 0, v113
    v_sub_f32 v85, 0, v113
    s_add_u32 s40, s40, 16384
    v_mul_f32 v220, v122, v220
    v_mfma_f32_16x16x32_bf16 v[68:71], a[148:151], a[36:39], v[68:71]
    ds_read_b128 a[148:151], v1 offset:56512
    v_mul_f32 v221, v122, v221
    v_mul_f32 v222, v122, v222
    v_sub_f32 v86, 0, v113
    v_sub_f32 v87, 0, v113
    v_mul_f32 v223, v122, v223
    v_mfma_f32_16x16x32_bf16 v[68:71], a[152:155], a[40:43], v[68:71]
    ds_read_b128 a[152:155], v2 offset:56448
    v_cvt_pk_bf16_f32 v216, v216, v217
    v_cvt_pk_bf16_f32 v217, v218, v219
    v_exp_f32 v56, v56
    v_exp_f32 v57, v57
    ds_write_b64 v11, v[212:213] offset:8864
    v_cvt_pk_bf16_f32 v220, v220, v221
    v_mfma_f32_16x16x32_bf16 v[68:71], a[156:159], a[44:47], v[68:71]
    ds_read_b128 a[156:159], v2 offset:56512
    v_cvt_pk_bf16_f32 v221, v222, v223
    v_exp_f32 v58, v58
    v_cvt_pk_bf16_f32 v52, v56, v57
    ds_write_b64 v11, v[216:217] offset:8896
    s_waitcnt lgkmcnt(15)
    buffer_store_dwordx4 v[172:175], v13, s[16:19], s40 offen sc0 sc1
    s_nop 6
    s_add_u32 s40, s40, 16384
    v_max3_f32 v114, v64, v65, v66
    v_max3_f32 v118, v67, v68, v69
    v_max3_f32 v114, v114, v70, v71
    ds_write_b64 v11, v[220:221] offset:8928
    v_max_f32 v114, v114, v118
    v_mov_b32 v118, v114
    s_nop 1
    ds_read_b128 v[192:195], v12 offset:8704
    ds_read_b128 v[196:199], v12 offset:9792
    v_permlane32_swap_b32 v114, v118
    v_max_f32 v114, v114, v118
    v_mov_b32 v118, v114
    ds_read_b128 v[200:203], v12 offset:10880
    ds_read_b128 v[204:207], v12 offset:11968
    s_nop 1
    v_permlane16_swap_b32 v114, v118
    v_max_f32 v114, v114, v118
    v_mfma_f32_32x32x16_bf16 v[160:175], v[124:127], v[124:127], 0
    v_sub_f32 v64, v64, v114
    v_sub_f32 v65, v65, v114
    v_sub_f32 v66, v66, v114
    v_mfma_f32_32x32x16_bf16 v[176:191], v[124:127], v[124:127], 0
    s_waitcnt lgkmcnt(3)
    buffer_store_dwordx4 v[192:195], v13, s[16:19], s40 offen sc0 sc1
    s_add_u32 s40, s40, 16384
    v_sub_f32 v67, v67, v114
    v_sub_f32 v68, v68, v114
    v_sub_f32 v69, v69, v114
    s_waitcnt lgkmcnt(2)
    buffer_store_dwordx4 v[196:199], v13, s[16:19], s40 offen sc0 sc1
    s_add_u32 s40, s40, 16384
    s_waitcnt lgkmcnt(1)
    buffer_store_dwordx4 v[200:203], v13, s[16:19], s40 offen sc0 sc1
    s_add_u32 s40, s40, 16384
    v_sub_f32 v70, v70, v114
    v_sub_f32 v71, v71, v114
    v_sub_f32 v88, 0, v114
    s_waitcnt lgkmcnt(0)
    buffer_store_dwordx4 v[204:207], v13, s[16:19], s40 offen sc0 sc1
    s_add_u32 s40, s40, 16384
    v_sub_f32 v89, 0, v114
    v_sub_f32 v90, 0, v114
    v_sub_f32 v91, 0, v114
    v_mfma_f32_32x32x16_bf16 v[192:207], v[124:127], v[124:127], 0
    v_mfma_f32_32x32x16_bf16 v[208:223], v[124:127], v[124:127], 0
    s_mov_b32 s18, s43
    s_waitcnt lgkmcnt(0)
    s_branch L_itb3_0
L_e3_3:
    s_mov_b32 s44, 3
    s_waitcnt vmcnt(4)
    s_barrier
L_e3_3_0:
    v_mfma_f32_16x16x32_bf16 v[48:51], a[128:131], a[0:3], v[80:83]
    ds_read_b64_tr_b16 a[160:161], v3 offset:52224
    ds_read_b64_tr_b16 a[162:163], v3 offset:52736
    v_exp_f32 v27, v27
    v_mfma_f32_16x16x32_bf16 v[48:51], a[132:135], a[4:7], v[48:51]
    ds_read_b64_tr_b16 a[164:165], v3 offset:52256
    ds_read_b64_tr_b16 a[166:167], v3 offset:52768
    v_exp_f32 v28, v28
    v_cvt_pk_bf16_f32 v21, v26, v27
    v_mfma_f32_16x16x32_bf16 v[48:51], a[136:139], a[8:11], v[48:51]
    ds_read_b64_tr_b16 a[168:169], v3 offset:52288
    ds_read_b64_tr_b16 a[170:171], v3 offset:52800
    v_exp_f32 v29, v29
    v_mfma_f32_16x16x32_bf16 v[48:51], a[140:143], a[12:15], v[48:51]
    ds_read_b64_tr_b16 a[172:173], v3 offset:52320
    ds_read_b64_tr_b16 a[174:175], v3 offset:52832
    v_exp_f32 v30, v30
    v_cvt_pk_bf16_f32 v22, v28, v29
    v_mfma_f32_16x16x32_bf16 v[52:55], a[144:147], a[0:3], v[80:83]
    ds_read_b64_tr_b16 a[176:177], v3 offset:52352
    ds_read_b64_tr_b16 a[178:179], v3 offset:52864
    v_exp_f32 v31, v31
    v_mfma_f32_16x16x32_bf16 v[52:55], a[148:151], a[4:7], v[52:55]
    ds_read_b64_tr_b16 a[180:181], v3 offset:52384
    ds_read_b64_tr_b16 a[182:183], v3 offset:52896
    v_exp_f32 v32, v32
    v_cvt_pk_bf16_f32 v23, v30, v31
    v_mfma_f32_16x16x32_bf16 v[52:55], a[152:155], a[8:11], v[52:55]
    ds_read_b64_tr_b16 a[184:185], v3 offset:52416
    ds_read_b64_tr_b16 a[186:187], v3 offset:52928
    v_exp_f32 v33, v33
    v_mfma_f32_16x16x32_bf16 v[52:55], a[156:159], a[12:15], v[52:55]
    ds_read_b64_tr_b16 a[188:189], v3 offset:52448
    ds_read_b64_tr_b16 a[190:191], v3 offset:52960
    v_exp_f32 v34, v34
    v_cvt_pk_bf16_f32 v32, v32, v33
    v_mfma_f32_16x16x32_bf16 v[56:59], a[128:131], a[16:19], v[84:87]
    ds_read_b64_tr_b16 a[64:65], v3 offset:0
    ds_read_b64_tr_b16 a[66:67], v3 offset:512
    v_exp_f32 v35, v35
    v_mfma_f32_16x16x32_bf16 v[56:59], a[132:135], a[20:23], v[56:59]
    ds_read_b64_tr_b16 a[68:69], v3 offset:32
    ds_read_b64_tr_b16 a[70:71], v3 offset:544
    v_exp_f32 v36, v36
    v_cvt_pk_bf16_f32 v33, v34, v35
    v_mfma_f32_16x16x32_bf16 v[56:59], a[136:139], a[24:27], v[56:59]
    ds_read_b64_tr_b16 a[72:73], v3 offset:64
    ds_read_b64_tr_b16 a[74:75], v3 offset:576
    v_exp_f32 v37, v37
    v_mfma_f32_16x16x32_bf16 v[56:59], a[140:143], a[28:31], v[56:59]
    ds_read_b64_tr_b16 a[76:77], v3 offset:96
    ds_read_b64_tr_b16 a[78:79], v3 offset:608
    v_exp_f32 v38, v38
    v_cvt_pk_bf16_f32 v34, v36, v37
    v_mfma_f32_16x16x32_bf16 v[60:63], a[144:147], a[16:19], v[84:87]
    ds_read_b64_tr_b16 a[80:81], v3 offset:128
    ds_read_b64_tr_b16 a[82:83], v3 offset:640
    v_exp_f32 v39, v39
    v_mfma_f32_16x16x32_bf16 v[60:63], a[148:151], a[20:23], v[60:63]
    ds_read_b64_tr_b16 a[84:85], v3 offset:160
    ds_read_b64_tr_b16 a[86:87], v3 offset:672
    v_cvt_pk_bf16_f32 v35, v38, v39
    v_exp_f32 v48, v48
    v_mfma_f32_16x16x32_bf16 v[60:63], a[152:155], a[24:27], v[60:63]
    ds_read_b64_tr_b16 a[88:89], v3 offset:192
    ds_read_b64_tr_b16 a[90:91], v3 offset:704
    v_exp_f32 v49, v49
    v_mfma_f32_16x16x32_bf16 v[60:63], a[156:159], a[28:31], v[60:63]
    ds_read_b64_tr_b16 a[92:93], v3 offset:224
    ds_read_b64_tr_b16 a[94:95], v3 offset:736
    v_exp_f32 v50, v50
    v_cvt_pk_bf16_f32 v48, v48, v49
    v_mfma_f32_16x16x32_bf16 v[64:67], a[128:131], a[32:35], v[88:91]
    v_exp_f32 v51, v51
    v_mfma_f32_16x16x32_bf16 v[64:67], a[132:135], a[36:39], v[64:67]
    v_exp_f32 v52, v52
    v_cvt_pk_bf16_f32 v49, v50, v51
    v_mfma_f32_16x16x32_bf16 v[64:67], a[136:139], a[40:43], v[64:67]
    v_exp_f32 v53, v53
    v_mfma_f32_16x16x32_bf16 v[64:67], a[140:143], a[44:47], v[64:67]
    v_exp_f32 v54, v54
    v_cvt_pk_bf16_f32 v50, v52, v53
    v_mfma_f32_16x16x32_bf16 v[68:71], a[144:147], a[32:35], v[88:91]
    v_exp_f32 v55, v55
    v_mfma_f32_16x16x32_bf16 v[68:71], a[148:151], a[36:39], v[68:71]
    v_exp_f32 v56, v56
    v_cvt_pk_bf16_f32 v51, v54, v55
    v_mfma_f32_16x16x32_bf16 v[68:71], a[152:155], a[40:43], v[68:71]
    v_exp_f32 v57, v57
    v_mfma_f32_16x16x32_bf16 v[68:71], a[156:159], a[44:47], v[68:71]
    v_exp_f32 v58, v58
    v_cvt_pk_bf16_f32 v52, v56, v57
    s_waitcnt lgkmcnt(15)
    v_mfma_f32_16x16x32_bf16 v[128:131], a[160:163], v[16:19], v[128:131]
    v_exp_f32 v59, v59
    v_mfma_f32_16x16x32_bf16 v[132:135], a[164:167], v[16:19], v[132:135]
    v_exp_f32 v60, v60
    v_cvt_pk_bf16_f32 v53, v58, v59
    v_mfma_f32_16x16x32_bf16 v[136:139], a[168:171], v[16:19], v[136:139]
    v_exp_f32 v61, v61
    v_mfma_f32_16x16x32_bf16 v[140:143], a[172:175], v[16:19], v[140:143]
    v_exp_f32 v62, v62
    v_cvt_pk_bf16_f32 v54, v60, v61
    v_mfma_f32_16x16x32_bf16 v[144:147], a[176:179], v[16:19], v[144:147]
    v_exp_f32 v63, v63
    v_mfma_f32_16x16x32_bf16 v[148:151], a[180:183], v[16:19], v[148:151]
    v_exp_f32 v64, v64
    v_cvt_pk_bf16_f32 v55, v62, v63
    v_mfma_f32_16x16x32_bf16 v[152:155], a[184:187], v[16:19], v[152:155]
    v_exp_f32 v65, v65
    v_mfma_f32_16x16x32_bf16 v[156:159], a[188:191], v[16:19], v[156:159]
    v_exp_f32 v66, v66
    v_cvt_pk_bf16_f32 v64, v64, v65
    v_mfma_f32_16x16x32_bf16 v[160:163], a[160:163], v[20:23], v[160:163]
    v_exp_f32 v67, v67
    v_mfma_f32_16x16x32_bf16 v[164:167], a[164:167], v[20:23], v[164:167]
    v_exp_f32 v68, v68
    v_cvt_pk_bf16_f32 v65, v66, v67
    v_mfma_f32_16x16x32_bf16 v[168:171], a[168:171], v[20:23], v[168:171]
    v_exp_f32 v69, v69
    v_mfma_f32_16x16x32_bf16 v[172:175], a[172:175], v[20:23], v[172:175]
    v_exp_f32 v70, v70
    v_cvt_pk_bf16_f32 v66, v68, v69
    v_mfma_f32_16x16x32_bf16 v[176:179], a[176:179], v[20:23], v[176:179]
    v_exp_f32 v71, v71
    v_mfma_f32_16x16x32_bf16 v[180:183], a[180:183], v[20:23], v[180:183]
    v_cvt_pk_bf16_f32 v67, v70, v71
    s_nop 1
    v_smfmac_f32_16x16x64_bf16 a[208:211], a[228:231], v[16:23], v15
    v_mfma_f32_16x16x32_bf16 a[212:215], a[224:227], v[32:35], a[212:215]
    v_smfmac_f32_16x16x64_bf16 a[208:211], a[236:239], v[48:55], v15
    v_mfma_f32_16x16x32_bf16 a[212:215], a[232:235], v[64:67], a[212:215]
    s_waitcnt lgkmcnt(0)
    v_mfma_f32_16x16x32_bf16 v[128:131], a[64:67], v[48:51], v[128:131]
    v_mfma_f32_16x16x32_bf16 v[132:135], a[68:71], v[48:51], v[132:135]
    v_mfma_f32_16x16x32_bf16 v[136:139], a[72:75], v[48:51], v[136:139]
    v_mfma_f32_16x16x32_bf16 v[140:143], a[76:79], v[48:51], v[140:143]
    v_mfma_f32_16x16x32_bf16 v[144:147], a[80:83], v[48:51], v[144:147]
    v_mfma_f32_16x16x32_bf16 v[148:151], a[84:87], v[48:51], v[148:151]
    v_mfma_f32_16x16x32_bf16 v[152:155], a[88:91], v[48:51], v[152:155]
    v_mfma_f32_16x16x32_bf16 v[156:159], a[92:95], v[48:51], v[156:159]
    s_nop 3
    v_accvgpr_read_b32 v112, a208
    v_accvgpr_read_b32 v113, a210
    v_accvgpr_read_b32 v114, a212
    v_accvgpr_read_b32 v116, a209
    v_accvgpr_read_b32 v117, a211
    v_add_f32 v112, v112, v116
    v_add_f32 v113, v113, v117
    v_cmp_nge_f32 vcc, 0x44800000, v112
    v_rcp_f32 v120, v112
    s_nop 0
    s_mov_b64 s[84:85], vcc
    v_cmp_nge_f32 vcc, 0x44800000, v113
    v_rcp_f32 v121, v113
    s_nop 0
    s_or_b64 s[84:85], s[84:85], vcc
    v_cmp_nge_f32 vcc, 0x44800000, v114
    v_rcp_f32 v122, v114
    s_nop 0
    s_or_b64 s[84:85], s[84:85], vcc
    s_mov_b32 s40, s34
    s_cbranch_scc1 L_el3_1
    v_mfma_f32_16x16x32_bf16 v[184:187], a[184:187], v[20:23], v[184:187]
    v_mul_f32 v128, v120, v128
    v_mul_f32 v129, v120, v129
    v_mul_f32 v130, v120, v130
    v_mfma_f32_16x16x32_bf16 v[188:191], a[188:191], v[20:23], v[188:191]
    v_mul_f32 v131, v120, v131
    v_mul_f32 v132, v120, v132
    v_mul_f32 v133, v120, v133
    v_mfma_f32_16x16x32_bf16 v[160:163], a[64:67], v[52:55], v[160:163]
    v_mul_f32 v134, v120, v134
    v_mul_f32 v135, v120, v135
    v_cvt_pk_bf16_f32 v128, v128, v129
    v_mfma_f32_16x16x32_bf16 v[164:167], a[68:71], v[52:55], v[164:167]
    v_cvt_pk_bf16_f32 v129, v130, v131
    v_mul_f32 v136, v120, v136
    v_mul_f32 v137, v120, v137
    v_mfma_f32_16x16x32_bf16 v[168:171], a[72:75], v[52:55], v[168:171]
    v_mul_f32 v138, v120, v138
    v_mul_f32 v139, v120, v139
    v_cvt_pk_bf16_f32 v132, v132, v133
    v_mfma_f32_16x16x32_bf16 v[172:175], a[76:79], v[52:55], v[172:175]
    v_cvt_pk_bf16_f32 v133, v134, v135
    ds_write_b64 v11, v[128:129] offset:0
    v_mul_f32 v140, v120, v140
    v_mfma_f32_16x16x32_bf16 v[176:179], a[80:83], v[52:55], v[176:179]
    v_mul_f32 v141, v120, v141
    v_mul_f32 v142, v120, v142
    v_mul_f32 v143, v120, v143
    v_mfma_f32_16x16x32_bf16 v[180:183], a[84:87], v[52:55], v[180:183]
    v_cvt_pk_bf16_f32 v136, v136, v137
    v_cvt_pk_bf16_f32 v137, v138, v139
    ds_write_b64 v11, v[132:133] offset:32
    v_mfma_f32_16x16x32_bf16 v[184:187], a[88:91], v[52:55], v[184:187]
    v_mul_f32 v144, v120, v144
    v_mul_f32 v145, v120, v145
    v_mul_f32 v146, v120, v146
    v_mfma_f32_16x16x32_bf16 v[188:191], a[92:95], v[52:55], v[188:191]
    v_mul_f32 v147, v120, v147
    v_cvt_pk_bf16_f32 v140, v140, v141
    v_cvt_pk_bf16_f32 v141, v142, v143
    ds_write_b64 v11, v[136:137] offset:64
    v_mul_f32 v148, v120, v148
    v_mul_f32 v149, v120, v149
    v_mul_f32 v150, v120, v150
    v_mul_f32 v151, v120, v151
    v_cvt_pk_bf16_f32 v144, v144, v145
    v_cvt_pk_bf16_f32 v145, v146, v147
    ds_write_b64 v11, v[140:141] offset:96
    v_mul_f32 v152, v120, v152
    v_mul_f32 v153, v120, v153
    v_mul_f32 v154, v120, v154
    v_mul_f32 v155, v120, v155
    v_cvt_pk_bf16_f32 v148, v148, v149
    v_cvt_pk_bf16_f32 v149, v150, v151
    ds_write_b64 v11, v[144:145] offset:128
    v_mul_f32 v156, v120, v156
    v_mul_f32 v157, v120, v157
    v_mul_f32 v158, v120, v158
    v_mul_f32 v159, v120, v159
    v_cvt_pk_bf16_f32 v152, v152, v153
    v_cvt_pk_bf16_f32 v153, v154, v155
    ds_write_b64 v11, v[148:149] offset:160
    v_cvt_pk_bf16_f32 v156, v156, v157
    v_cvt_pk_bf16_f32 v157, v158, v159
    ds_write_b64 v11, v[152:153] offset:192
    ds_write_b64 v11, v[156:157] offset:224
    ds_read_b128 v[128:131], v12 offset:0
    ds_read_b128 v[132:135], v12 offset:1088
    ds_read_b128 v[136:139], v12 offset:2176
    ds_read_b128 v[140:143], v12 offset:3264
    v_mfma_f32_16x16x32_bf16 v[192:195], a[160:163], v[32:35], v[192:195]
    v_mul_f32 v160, v121, v160
    v_mul_f32 v161, v121, v161
    v_mul_f32 v162, v121, v162
    v_mfma_f32_16x16x32_bf16 v[196:199], a[164:167], v[32:35], v[196:199]
    v_mul_f32 v163, v121, v163
    v_mul_f32 v164, v121, v164
    v_mul_f32 v165, v121, v165
    v_mfma_f32_16x16x32_bf16 v[200:203], a[168:171], v[32:35], v[200:203]
    v_mul_f32 v166, v121, v166
    v_mul_f32 v167, v121, v167
    v_cvt_pk_bf16_f32 v160, v160, v161
    v_mfma_f32_16x16x32_bf16 v[204:207], a[172:175], v[32:35], v[204:207]
    v_cvt_pk_bf16_f32 v161, v162, v163
    v_mul_f32 v168, v121, v168
    v_mul_f32 v169, v121, v169
    v_mfma_f32_16x16x32_bf16 v[208:211], a[176:179], v[32:35], v[208:211]
    v_mul_f32 v170, v121, v170
    v_mul_f32 v171, v121, v171
    v_cvt_pk_bf16_f32 v164, v164, v165
    v_mfma_f32_16x16x32_bf16 v[212:215], a[180:183], v[32:35], v[212:215]
    v_cvt_pk_bf16_f32 v165, v166, v167
    ds_write_b64 v11, v[160:161] offset:4352
    s_waitcnt lgkmcnt(4)
    buffer_store_dwordx4 v[128:131], v13, s[16:19], s40 offen sc0 sc1
    s_add_u32 s40, s40, 16384
    v_mul_f32 v172, v121, v172
    v_mfma_f32_16x16x32_bf16 v[216:219], a[184:187], v[32:35], v[216:219]
    v_mul_f32 v173, v121, v173
    v_mul_f32 v174, v121, v174
    v_mul_f32 v175, v121, v175
    v_mfma_f32_16x16x32_bf16 v[220:223], a[188:191], v[32:35], v[220:223]
    v_cvt_pk_bf16_f32 v168, v168, v169
    v_cvt_pk_bf16_f32 v169, v170, v171
    ds_write_b64 v11, v[164:165] offset:4384
    v_mfma_f32_16x16x32_bf16 v[192:195], a[64:67], v[64:67], v[192:195]
    v_mul_f32 v176, v121, v176
    v_mul_f32 v177, v121, v177
    v_mul_f32 v178, v121, v178
    v_mfma_f32_16x16x32_bf16 v[196:199], a[68:71], v[64:67], v[196:199]
    v_mul_f32 v179, v121, v179
    v_cvt_pk_bf16_f32 v172, v172, v173
    v_cvt_pk_bf16_f32 v173, v174, v175
    v_mfma_f32_16x16x32_bf16 v[200:203], a[72:75], v[64:67], v[200:203]
    ds_write_b64 v11, v[168:169] offset:4416
    s_waitcnt lgkmcnt(5)
    buffer_store_dwordx4 v[132:135], v13, s[16:19], s40 offen sc0 sc1
    s_add_u32 s40, s40, 16384
    v_mul_f32 v180, v121, v180
    v_mul_f32 v181, v121, v181
    v_mfma_f32_16x16x32_bf16 v[204:207], a[76:79], v[64:67], v[204:207]
    v_mul_f32 v182, v121, v182
    v_mul_f32 v183, v121, v183
    v_cvt_pk_bf16_f32 v176, v176, v177
    v_mfma_f32_16x16x32_bf16 v[208:211], a[80:83], v[64:67], v[208:211]
    v_cvt_pk_bf16_f32 v177, v178, v179
    ds_write_b64 v11, v[172:173] offset:4448
    v_mul_f32 v184, v121, v184
    v_mfma_f32_16x16x32_bf16 v[212:215], a[84:87], v[64:67], v[212:215]
    v_mul_f32 v185, v121, v185
    v_mul_f32 v186, v121, v186
    v_mul_f32 v187, v121, v187
    v_mfma_f32_16x16x32_bf16 v[216:219], a[88:91], v[64:67], v[216:219]
    v_cvt_pk_bf16_f32 v180, v180, v181
    v_cvt_pk_bf16_f32 v181, v182, v183
    ds_write_b64 v11, v[176:177] offset:4480
    s_waitcnt lgkmcnt(6)
    buffer_store_dwordx4 v[136:139], v13, s[16:19], s40 offen sc0 sc1
    s_add_u32 s40, s40, 16384
    v_mfma_f32_16x16x32_bf16 v[220:223], a[92:95], v[64:67], v[220:223]
    v_mul_f32 v188, v121, v188
    v_mul_f32 v189, v121, v189
    v_mul_f32 v190, v121, v190
    v_mul_f32 v191, v121, v191
    v_cvt_pk_bf16_f32 v184, v184, v185
    v_cvt_pk_bf16_f32 v185, v186, v187
    ds_write_b64 v11, v[180:181] offset:4512
    v_cvt_pk_bf16_f32 v188, v188, v189
    v_cvt_pk_bf16_f32 v189, v190, v191
    ds_write_b64 v11, v[184:185] offset:4544
    s_waitcnt lgkmcnt(7)
    buffer_store_dwordx4 v[140:143], v13, s[16:19], s40 offen sc0 sc1
    s_add_u32 s40, s40, 16384
    ds_write_b64 v11, v[188:189] offset:4576
    ds_read_b128 v[160:163], v12 offset:4352
    ds_read_b128 v[164:167], v12 offset:5440
    ds_read_b128 v[168:171], v12 offset:6528
    ds_read_b128 v[172:175], v12 offset:7616
    v_mul_f32 v192, v122, v192
    v_mul_f32 v193, v122, v193
    v_mul_f32 v194, v122, v194
    v_mul_f32 v195, v122, v195
    v_mul_f32 v196, v122, v196
    v_mul_f32 v197, v122, v197
    v_mul_f32 v198, v122, v198
    v_mul_f32 v199, v122, v199
    v_cvt_pk_bf16_f32 v192, v192, v193
    v_cvt_pk_bf16_f32 v193, v194, v195
    v_mul_f32 v200, v122, v200
    v_mul_f32 v201, v122, v201
    v_mul_f32 v202, v122, v202
    v_mul_f32 v203, v122, v203
    v_cvt_pk_bf16_f32 v196, v196, v197
    v_cvt_pk_bf16_f32 v197, v198, v199
    ds_write_b64 v11, v[192:193] offset:8704
    s_waitcnt lgkmcnt(4)
    buffer_store_dwordx4 v[160:163], v13, s[16:19], s40 offen sc0 sc1
    s_add_u32 s40, s40, 16384
    v_mul_f32 v204, v122, v204
    v_mul_f32 v205, v122, v205
    v_mul_f32 v206, v122, v206
    v_mul_f32 v207, v122, v207
    v_cvt_pk_bf16_f32 v200, v200, v201
    v_cvt_pk_bf16_f32 v201, v202, v203
    ds_write_b64 v11, v[196:197] offset:8736
    v_mul_f32 v208, v122, v208
    v_mul_f32 v209, v122, v209
    v_mul_f32 v210, v122, v210
    v_mul_f32 v211, v122, v211
    v_cvt_pk_bf16_f32 v204, v204, v205
    v_cvt_pk_bf16_f32 v205, v206, v207
    ds_write_b64 v11, v[200:201] offset:8768
    s_waitcnt lgkmcnt(5)
    buffer_store_dwordx4 v[164:167], v13, s[16:19], s40 offen sc0 sc1
    s_add_u32 s40, s40, 16384
    v_mul_f32 v212, v122, v212
    v_mul_f32 v213, v122, v213
    v_mul_f32 v214, v122, v214
    v_mul_f32 v215, v122, v215
    v_cvt_pk_bf16_f32 v208, v208, v209
    v_cvt_pk_bf16_f32 v209, v210, v211
    ds_write_b64 v11, v[204:205] offset:8800
    v_mul_f32 v216, v122, v216
    v_mul_f32 v217, v122, v217
    v_mul_f32 v218, v122, v218
    v_mul_f32 v219, v122, v219
    v_cvt_pk_bf16_f32 v212, v212, v213
    v_cvt_pk_bf16_f32 v213, v214, v215
    ds_write_b64 v11, v[208:209] offset:8832
    s_waitcnt lgkmcnt(6)
    buffer_store_dwordx4 v[168:171], v13, s[16:19], s40 offen sc0 sc1
    s_add_u32 s40, s40, 16384
    v_mul_f32 v220, v122, v220
    v_mul_f32 v221, v122, v221
    v_mul_f32 v222, v122, v222
    v_mul_f32 v223, v122, v223
    v_cvt_pk_bf16_f32 v216, v216, v217
    v_cvt_pk_bf16_f32 v217, v218, v219
    ds_write_b64 v11, v[212:213] offset:8864
    v_cvt_pk_bf16_f32 v220, v220, v221
    v_cvt_pk_bf16_f32 v221, v222, v223
    ds_write_b64 v11, v[216:217] offset:8896
    s_waitcnt lgkmcnt(7)
    buffer_store_dwordx4 v[172:175], v13, s[16:19], s40 offen sc0 sc1
    s_add_u32 s40, s40, 16384
    ds_write_b64 v11, v[220:221] offset:8928
    ds_read_b128 v[192:195], v12 offset:8704
    ds_read_b128 v[196:199], v12 offset:9792
    ds_read_b128 v[200:203], v12 offset:10880
    ds_read_b128 v[204:207], v12 offset:11968
    s_waitcnt lgkmcnt(3)
    buffer_store_dwordx4 v[192:195], v13, s[16:19], s40 offen sc0 sc1
    s_add_u32 s40, s40, 16384
    s_waitcnt lgkmcnt(2)
    buffer_store_dwordx4 v[196:199], v13, s[16:19], s40 offen sc0 sc1
    s_add_u32 s40, s40, 16384
    s_waitcnt lgkmcnt(1)
    buffer_store_dwordx4 v[200:203], v13, s[16:19], s40 offen sc0 sc1
    s_add_u32 s40, s40, 16384
    s_waitcnt lgkmcnt(0)
    buffer_store_dwordx4 v[204:207], v13, s[16:19], s40 offen sc0 sc1
    s_add_u32 s40, s40, 16384
    s_endpgm
L_e2_0:
    s_mov_b32 s44, 0
    s_waitcnt vmcnt(4)
    s_barrier
L_e2_0_0:
    v_mfma_f32_16x16x32_bf16 v[16:19], a[128:131], a[0:3], v[80:83]
    ds_read_b64_tr_b16 a[160:161], v3 offset:0
    ds_read_b64_tr_b16 a[162:163], v3 offset:512
    v_exp_f32 v55, v55
    v_mfma_f32_16x16x32_bf16 v[16:19], a[132:135], a[4:7], v[16:19]
    ds_read_b64_tr_b16 a[164:165], v3 offset:32
    ds_read_b64_tr_b16 a[166:167], v3 offset:544
    v_exp_f32 v56, v56
    v_cvt_pk_bf16_f32 v51, v54, v55
    v_mfma_f32_16x16x32_bf16 v[16:19], a[136:139], a[8:11], v[16:19]
    ds_read_b64_tr_b16 a[168:169], v3 offset:64
    ds_read_b64_tr_b16 a[170:171], v3 offset:576
    v_exp_f32 v57, v57
    v_mfma_f32_16x16x32_bf16 v[16:19], a[140:143], a[12:15], v[16:19]
    ds_read_b64_tr_b16 a[172:173], v3 offset:96
    ds_read_b64_tr_b16 a[174:175], v3 offset:608
    v_exp_f32 v58, v58
    v_cvt_pk_bf16_f32 v52, v56, v57
    v_mfma_f32_16x16x32_bf16 v[20:23], a[144:147], a[0:3], v[80:83]
    ds_read_b64_tr_b16 a[176:177], v3 offset:128
    ds_read_b64_tr_b16 a[178:179], v3 offset:640
    v_exp_f32 v59, v59
    v_mfma_f32_16x16x32_bf16 v[20:23], a[148:151], a[4:7], v[20:23]
    ds_read_b64_tr_b16 a[180:181], v3 offset:160
    ds_read_b64_tr_b16 a[182:183], v3 offset:672
    v_exp_f32 v60, v60
    v_cvt_pk_bf16_f32 v53, v58, v59
    v_mfma_f32_16x16x32_bf16 v[20:23], a[152:155], a[8:11], v[20:23]
    ds_read_b64_tr_b16 a[184:185], v3 offset:192
    ds_read_b64_tr_b16 a[186:187], v3 offset:704
    v_exp_f32 v61, v61
    v_mfma_f32_16x16x32_bf16 v[20:23], a[156:159], a[12:15], v[20:23]
    ds_read_b64_tr_b16 a[188:189], v3 offset:224
    ds_read_b64_tr_b16 a[190:191], v3 offset:736
    v_exp_f32 v62, v62
    v_cvt_pk_bf16_f32 v54, v60, v61
    v_mfma_f32_16x16x32_bf16 v[24:27], a[128:131], a[16:19], v[84:87]
    ds_read_b64_tr_b16 a[64:65], v3 offset:17408
    ds_read_b64_tr_b16 a[66:67], v3 offset:17920
    v_exp_f32 v63, v63
    v_mfma_f32_16x16x32_bf16 v[24:27], a[132:135], a[20:23], v[24:27]
    ds_read_b64_tr_b16 a[68:69], v3 offset:17440
    ds_read_b64_tr_b16 a[70:71], v3 offset:17952
    v_cvt_pk_bf16_f32 v55, v62, v63
    v_mfma_f32_16x16x32_bf16 v[24:27], a[136:139], a[24:27], v[24:27]
    ds_read_b64_tr_b16 a[72:73], v3 offset:17472
    ds_read_b64_tr_b16 a[74:75], v3 offset:17984
    v_mfma_f32_16x16x32_bf16 v[24:27], a[140:143], a[28:31], v[24:27]
    ds_read_b64_tr_b16 a[76:77], v3 offset:17504
    ds_read_b64_tr_b16 a[78:79], v3 offset:18016
    v_mfma_f32_16x16x32_bf16 v[28:31], a[144:147], a[16:19], v[84:87]
    ds_read_b64_tr_b16 a[80:81], v3 offset:17536
    ds_read_b64_tr_b16 a[82:83], v3 offset:18048
    v_exp_f32 v16, v16
    v_mfma_f32_16x16x32_bf16 v[28:31], a[148:151], a[20:23], v[28:31]
    ds_read_b64_tr_b16 a[84:85], v3 offset:17568
    ds_read_b64_tr_b16 a[86:87], v3 offset:18080
    v_exp_f32 v17, v17
    v_mfma_f32_16x16x32_bf16 v[28:31], a[152:155], a[24:27], v[28:31]
    ds_read_b64_tr_b16 a[88:89], v3 offset:17600
    ds_read_b64_tr_b16 a[90:91], v3 offset:18112
    v_exp_f32 v18, v18
    v_cvt_pk_bf16_f32 v16, v16, v17
    v_mfma_f32_16x16x32_bf16 v[28:31], a[156:159], a[28:31], v[28:31]
    ds_read_b64_tr_b16 a[92:93], v3 offset:17632
    ds_read_b64_tr_b16 a[94:95], v3 offset:18144
    v_exp_f32 v19, v19
    s_waitcnt lgkmcnt(15)
    v_mfma_f32_16x16x32_bf16 v[128:131], a[160:163], v[48:51], v[128:131]
    v_exp_f32 v20, v20
    v_cvt_pk_bf16_f32 v17, v18, v19
    v_mfma_f32_16x16x32_bf16 v[132:135], a[164:167], v[48:51], v[132:135]
    v_exp_f32 v21, v21
    v_mfma_f32_16x16x32_bf16 v[136:139], a[168:171], v[48:51], v[136:139]
    v_exp_f32 v22, v22
    v_cvt_pk_bf16_f32 v18, v20, v21
    v_mfma_f32_16x16x32_bf16 v[140:143], a[172:175], v[48:51], v[140:143]
    v_exp_f32 v23, v23
    v_mfma_f32_16x16x32_bf16 v[144:147], a[176:179], v[48:51], v[144:147]
    v_exp_f32 v24, v24
    v_cvt_pk_bf16_f32 v19, v22, v23
    v_mfma_f32_16x16x32_bf16 v[148:151], a[180:183], v[48:51], v[148:151]
    v_exp_f32 v25, v25
    v_mfma_f32_16x16x32_bf16 v[152:155], a[184:187], v[48:51], v[152:155]
    v_exp_f32 v26, v26
    v_cvt_pk_bf16_f32 v20, v24, v25
    v_mfma_f32_16x16x32_bf16 v[156:159], a[188:191], v[48:51], v[156:159]
    v_exp_f32 v27, v27
    v_mfma_f32_16x16x32_bf16 v[160:163], a[160:163], v[52:55], v[160:163]
    v_exp_f32 v28, v28
    v_cvt_pk_bf16_f32 v21, v26, v27
    v_mfma_f32_16x16x32_bf16 v[164:167], a[164:167], v[52:55], v[164:167]
    v_exp_f32 v29, v29
    v_mfma_f32_16x16x32_bf16 v[168:171], a[168:171], v[52:55], v[168:171]
    v_exp_f32 v30, v30
    v_cvt_pk_bf16_f32 v22, v28, v29
    v_mfma_f32_16x16x32_bf16 v[172:175], a[172:175], v[52:55], v[172:175]
    v_exp_f32 v31, v31
    v_mfma_f32_16x16x32_bf16 v[176:179], a[176:179], v[52:55], v[176:179]
    v_cvt_pk_bf16_f32 v23, v30, v31
    s_nop 1
    v_smfmac_f32_16x16x64_bf16 a[208:211], a[228:231], v[48:55], v15
    v_smfmac_f32_16x16x64_bf16 a[208:211], a[236:239], v[16:23], v15
    s_waitcnt lgkmcnt(0)
    v_mfma_f32_16x16x32_bf16 v[128:131], a[64:67], v[16:19], v[128:131]
    v_mfma_f32_16x16x32_bf16 v[132:135], a[68:71], v[16:19], v[132:135]
    v_mfma_f32_16x16x32_bf16 v[136:139], a[72:75], v[16:19], v[136:139]
    v_mfma_f32_16x16x32_bf16 v[140:143], a[76:79], v[16:19], v[140:143]
    v_mfma_f32_16x16x32_bf16 v[144:147], a[80:83], v[16:19], v[144:147]
    v_mfma_f32_16x16x32_bf16 v[148:151], a[84:87], v[16:19], v[148:151]
    v_mfma_f32_16x16x32_bf16 v[152:155], a[88:91], v[16:19], v[152:155]
    v_mfma_f32_16x16x32_bf16 v[156:159], a[92:95], v[16:19], v[156:159]
    s_nop 3
    v_accvgpr_read_b32 v112, a208
    v_accvgpr_read_b32 v113, a210
    v_accvgpr_read_b32 v116, a209
    v_accvgpr_read_b32 v117, a211
    v_add_f32 v112, v112, v116
    v_add_f32 v113, v113, v117
    v_cmp_nge_f32 vcc, 0x44800000, v112
    v_rcp_f32 v120, v112
    s_nop 0
    s_mov_b64 s[84:85], vcc
    v_cmp_nge_f32 vcc, 0x44800000, v113
    v_rcp_f32 v121, v113
    s_nop 0
    s_or_b64 s[84:85], s[84:85], vcc
    s_mov_b32 s40, s34
    s_cbranch_scc1 L_el2_0
    v_mfma_f32_16x16x32_bf16 v[180:183], a[180:183], v[52:55], v[180:183]
    v_mul_f32 v128, v120, v128
    v_mul_f32 v129, v120, v129
    v_mul_f32 v130, v120, v130
    v_mfma_f32_16x16x32_bf16 v[184:187], a[184:187], v[52:55], v[184:187]
    v_mul_f32 v131, v120, v131
    v_mul_f32 v132, v120, v132
    v_mul_f32 v133, v120, v133
    v_mfma_f32_16x16x32_bf16 v[188:191], a[188:191], v[52:55], v[188:191]
    v_mul_f32 v134, v120, v134
    v_mul_f32 v135, v120, v135
    v_cvt_pk_bf16_f32 v128, v128, v129
    v_mfma_f32_16x16x32_bf16 v[160:163], a[64:67], v[20:23], v[160:163]
    v_cvt_pk_bf16_f32 v129, v130, v131
    v_mul_f32 v136, v120, v136
    v_mul_f32 v137, v120, v137
    v_mfma_f32_16x16x32_bf16 v[164:167], a[68:71], v[20:23], v[164:167]
    v_mul_f32 v138, v120, v138
    v_mul_f32 v139, v120, v139
    v_cvt_pk_bf16_f32 v132, v132, v133
    v_mfma_f32_16x16x32_bf16 v[168:171], a[72:75], v[20:23], v[168:171]
    v_cvt_pk_bf16_f32 v133, v134, v135
    ds_write_b64 v11, v[128:129] offset:0
    v_mul_f32 v140, v120, v140
    v_mfma_f32_16x16x32_bf16 v[172:175], a[76:79], v[20:23], v[172:175]
    v_mul_f32 v141, v120, v141
    v_mul_f32 v142, v120, v142
    v_mul_f32 v143, v120, v143
    v_mfma_f32_16x16x32_bf16 v[176:179], a[80:83], v[20:23], v[176:179]
    v_cvt_pk_bf16_f32 v136, v136, v137
    v_cvt_pk_bf16_f32 v137, v138, v139
    ds_write_b64 v11, v[132:133] offset:32
    v_mfma_f32_16x16x32_bf16 v[180:183], a[84:87], v[20:23], v[180:183]
    v_mul_f32 v144, v120, v144
    v_mul_f32 v145, v120, v145
    v_mul_f32 v146, v120, v146
    v_mfma_f32_16x16x32_bf16 v[184:187], a[88:91], v[20:23], v[184:187]
    v_mul_f32 v147, v120, v147
    v_cvt_pk_bf16_f32 v140, v140, v141
    v_cvt_pk_bf16_f32 v141, v142, v143
    v_mfma_f32_16x16x32_bf16 v[188:191], a[92:95], v[20:23], v[188:191]
    ds_write_b64 v11, v[136:137] offset:64
    v_mul_f32 v148, v120, v148
    v_mul_f32 v149, v120, v149
    v_mul_f32 v150, v120, v150
    v_mul_f32 v151, v120, v151
    v_cvt_pk_bf16_f32 v144, v144, v145
    v_cvt_pk_bf16_f32 v145, v146, v147
    ds_write_b64 v11, v[140:141] offset:96
    v_mul_f32 v152, v120, v152
    v_mul_f32 v153, v120, v153
    v_mul_f32 v154, v120, v154
    v_mul_f32 v155, v120, v155
    v_cvt_pk_bf16_f32 v148, v148, v149
    v_cvt_pk_bf16_f32 v149, v150, v151
    ds_write_b64 v11, v[144:145] offset:128
    v_mul_f32 v156, v120, v156
    v_mul_f32 v157, v120, v157
    v_mul_f32 v158, v120, v158
    v_mul_f32 v159, v120, v159
    v_cvt_pk_bf16_f32 v152, v152, v153
    v_cvt_pk_bf16_f32 v153, v154, v155
    ds_write_b64 v11, v[148:149] offset:160
    v_cvt_pk_bf16_f32 v156, v156, v157
    v_cvt_pk_bf16_f32 v157, v158, v159
    ds_write_b64 v11, v[152:153] offset:192
    ds_write_b64 v11, v[156:157] offset:224
    ds_read_b128 v[128:131], v12 offset:0
    ds_read_b128 v[132:135], v12 offset:1088
    ds_read_b128 v[136:139], v12 offset:2176
    ds_read_b128 v[140:143], v12 offset:3264
    v_mul_f32 v160, v121, v160
    v_mul_f32 v161, v121, v161
    v_mul_f32 v162, v121, v162
    v_mul_f32 v163, v121, v163
    v_mul_f32 v164, v121, v164
    v_mul_f32 v165, v121, v165
    v_mul_f32 v166, v121, v166
    v_mul_f32 v167, v121, v167
    v_cvt_pk_bf16_f32 v160, v160, v161
    v_cvt_pk_bf16_f32 v161, v162, v163
    v_mul_f32 v168, v121, v168
    v_mul_f32 v169, v121, v169
    v_mul_f32 v170, v121, v170
    v_mul_f32 v171, v121, v171
    v_cvt_pk_bf16_f32 v164, v164, v165
    v_cvt_pk_bf16_f32 v165, v166, v167
    ds_write_b64 v11, v[160:161] offset:4352
    s_waitcnt lgkmcnt(4)
    buffer_store_dwordx4 v[128:131], v13, s[16:19], s40 offen sc0 sc1
    s_add_u32 s40, s40, 16384
    v_mul_f32 v172, v121, v172
    v_mul_f32 v173, v121, v173
    v_mul_f32 v174, v121, v174
    v_mul_f32 v175, v121, v175
    v_cvt_pk_bf16_f32 v168, v168, v169
    v_cvt_pk_bf16_f32 v169, v170, v171
    ds_write_b64 v11, v[164:165] offset:4384
    v_mul_f32 v176, v121, v176
    v_mul_f32 v177, v121, v177
    v_mul_f32 v178, v121, v178
    v_mul_f32 v179, v121, v179
    v_cvt_pk_bf16_f32 v172, v172, v173
    v_cvt_pk_bf16_f32 v173, v174, v175
    ds_write_b64 v11, v[168:169] offset:4416
    s_waitcnt lgkmcnt(5)
    buffer_store_dwordx4 v[132:135], v13, s[16:19], s40 offen sc0 sc1
    s_add_u32 s40, s40, 16384
    v_mul_f32 v180, v121, v180
    v_mul_f32 v181, v121, v181
    v_mul_f32 v182, v121, v182
    v_mul_f32 v183, v121, v183
    v_cvt_pk_bf16_f32 v176, v176, v177
    v_cvt_pk_bf16_f32 v177, v178, v179
    ds_write_b64 v11, v[172:173] offset:4448
    v_mul_f32 v184, v121, v184
    v_mul_f32 v185, v121, v185
    v_mul_f32 v186, v121, v186
    v_mul_f32 v187, v121, v187
    v_cvt_pk_bf16_f32 v180, v180, v181
    v_cvt_pk_bf16_f32 v181, v182, v183
    ds_write_b64 v11, v[176:177] offset:4480
    s_waitcnt lgkmcnt(6)
    buffer_store_dwordx4 v[136:139], v13, s[16:19], s40 offen sc0 sc1
    s_add_u32 s40, s40, 16384
    v_mul_f32 v188, v121, v188
    v_mul_f32 v189, v121, v189
    v_mul_f32 v190, v121, v190
    v_mul_f32 v191, v121, v191
    v_cvt_pk_bf16_f32 v184, v184, v185
    v_cvt_pk_bf16_f32 v185, v186, v187
    ds_write_b64 v11, v[180:181] offset:4512
    v_cvt_pk_bf16_f32 v188, v188, v189
    v_cvt_pk_bf16_f32 v189, v190, v191
    ds_write_b64 v11, v[184:185] offset:4544
    s_waitcnt lgkmcnt(7)
    buffer_store_dwordx4 v[140:143], v13, s[16:19], s40 offen sc0 sc1
    s_add_u32 s40, s40, 16384
    ds_write_b64 v11, v[188:189] offset:4576
    ds_read_b128 v[160:163], v12 offset:4352
    ds_read_b128 v[164:167], v12 offset:5440
    ds_read_b128 v[168:171], v12 offset:6528
    ds_read_b128 v[172:175], v12 offset:7616
    s_waitcnt lgkmcnt(3)
    buffer_store_dwordx4 v[160:163], v13, s[16:19], s40 offen sc0 sc1
    s_add_u32 s40, s40, 16384
    s_waitcnt lgkmcnt(2)
    buffer_store_dwordx4 v[164:167], v13, s[16:19], s40 offen sc0 sc1
    s_add_u32 s40, s40, 16384
    s_waitcnt lgkmcnt(1)
    buffer_store_dwordx4 v[168:171], v13, s[16:19], s40 offen sc0 sc1
    s_add_u32 s40, s40, 16384
    s_waitcnt lgkmcnt(0)
    buffer_store_dwordx4 v[172:175], v13, s[16:19], s40 offen sc0 sc1
    s_add_u32 s40, s40, 16384
    s_endpgm
L_e2_1:
    s_mov_b32 s44, 1
    s_waitcnt vmcnt(4)
    s_barrier
L_e2_1_0:
    v_mfma_f32_16x16x32_bf16 v[48:51], a[128:131], a[0:3], v[80:83]
    ds_read_b64_tr_b16 a[160:161], v3 offset:17408
    ds_read_b64_tr_b16 a[162:163], v3 offset:17920
    v_exp_f32 v23, v23
    v_mfma_f32_16x16x32_bf16 v[48:51], a[132:135], a[4:7], v[48:51]
    ds_read_b64_tr_b16 a[164:165], v3 offset:17440
    ds_read_b64_tr_b16 a[166:167], v3 offset:17952
    v_exp_f32 v24, v24
    v_cvt_pk_bf16_f32 v19, v22, v23
    v_mfma_f32_16x16x32_bf16 v[48:51], a[136:139], a[8:11], v[48:51]
    ds_read_b64_tr_b16 a[168:169], v3 offset:17472
    ds_read_b64_tr_b16 a[170:171], v3 offset:17984
    v_exp_f32 v25, v25
    v_mfma_f32_16x16x32_bf16 v[48:51], a[140:143], a[12:15], v[48:51]
    ds_read_b64_tr_b16 a[172:173], v3 offset:17504
    ds_read_b64_tr_b16 a[174:175], v3 offset:18016
    v_exp_f32 v26, v26
    v_cvt_pk_bf16_f32 v20, v24, v25
    v_mfma_f32_16x16x32_bf16 v[52:55], a[144:147], a[0:3], v[80:83]
    ds_read_b64_tr_b16 a[176:177], v3 offset:17536
    ds_read_b64_tr_b16 a[178:179], v3 offset:18048
    v_exp_f32 v27, v27
    v_mfma_f32_16x16x32_bf16 v[52:55], a[148:151], a[4:7], v[52:55]
    ds_read_b64_tr_b16 a[180:181], v3 offset:17568
    ds_read_b64_tr_b16 a[182:183], v3 offset:18080
    v_exp_f32 v28, v28
    v_cvt_pk_bf16_f32 v21, v26, v27
    v_mfma_f32_16x16x32_bf16 v[52:55], a[152:155], a[8:11], v[52:55]
    ds_read_b64_tr_b16 a[184:185], v3 offset:17600
    ds_read_b64_tr_b16 a[186:187], v3 offset:18112
    v_exp_f32 v29, v29
    v_mfma_f32_16x16x32_bf16 v[52:55], a[156:159], a[12:15], v[52:55]
    ds_read_b64_tr_b16 a[188:189], v3 offset:17632
    ds_read_b64_tr_b16 a[190:191], v3 offset:18144
    v_exp_f32 v30, v30
    v_cvt_pk_bf16_f32 v22, v28, v29
    v_mfma_f32_16x16x32_bf16 v[56:59], a[128:131], a[16:19], v[84:87]
    ds_read_b64_tr_b16 a[64:65], v3 offset:34816
    ds_read_b64_tr_b16 a[66:67], v3 offset:35328
    v_exp_f32 v31, v31
    v_mfma_f32_16x16x32_bf16 v[56:59], a[132:135], a[20:23], v[56:59]
    ds_read_b64_tr_b16 a[68:69], v3 offset:34848
    ds_read_b64_tr_b16 a[70:71], v3 offset:35360
    v_cvt_pk_bf16_f32 v23, v30, v31
    v_mfma_f32_16x16x32_bf16 v[56:59], a[136:139], a[24:27], v[56:59]
    ds_read_b64_tr_b16 a[72:73], v3 offset:34880
    ds_read_b64_tr_b16 a[74:75], v3 offset:35392
    v_mfma_f32_16x16x32_bf16 v[56:59], a[140:143], a[28:31], v[56:59]
    ds_read_b64_tr_b16 a[76:77], v3 offset:34912
    ds_read_b64_tr_b16 a[78:79], v3 offset:35424
    v_mfma_f32_16x16x32_bf16 v[60:63], a[144:147], a[16:19], v[84:87]
    ds_read_b64_tr_b16 a[80:81], v3 offset:34944
    ds_read_b64_tr_b16 a[82:83], v3 offset:35456
    v_exp_f32 v48, v48
    v_mfma_f32_16x16x32_bf16 v[60:63], a[148:151], a[20:23], v[60:63]
    ds_read_b64_tr_b16 a[84:85], v3 offset:34976
    ds_read_b64_tr_b16 a[86:87], v3 offset:35488
    v_exp_f32 v49, v49
    v_mfma_f32_16x16x32_bf16 v[60:63], a[152:155], a[24:27], v[60:63]
    ds_read_b64_tr_b16 a[88:89], v3 offset:35008
    ds_read_b64_tr_b16 a[90:91], v3 offset:35520
    v_exp_f32 v50, v50
    v_cvt_pk_bf16_f32 v48, v48, v49
    v_mfma_f32_16x16x32_bf16 v[60:63], a[156:159], a[28:31], v[60:63]
    ds_read_b64_tr_b16 a[92:93], v3 offset:35040
    ds_read_b64_tr_b16 a[94:95], v3 offset:35552
    v_exp_f32 v51, v51
    s_waitcnt lgkmcnt(15)
    v_mfma_f32_16x16x32_bf16 v[128:131], a[160:163], v[16:19], v[128:131]
    v_exp_f32 v52, v52
    v_cvt_pk_bf16_f32 v49, v50, v51
    v_mfma_f32_16x16x32_bf16 v[132:135], a[164:167], v[16:19], v[132:135]
    v_exp_f32 v53, v53
    v_mfma_f32_16x16x32_bf16 v[136:139], a[168:171], v[16:19], v[136:139]
    v_exp_f32 v54, v54
    v_cvt_pk_bf16_f32 v50, v52, v53
    v_mfma_f32_16x16x32_bf16 v[140:143], a[172:175], v[16:19], v[140:143]
    v_exp_f32 v55, v55
    v_mfma_f32_16x16x32_bf16 v[144:147], a[176:179], v[16:19], v[144:147]
    v_exp_f32 v56, v56
    v_cvt_pk_bf16_f32 v51, v54, v55
    v_mfma_f32_16x16x32_bf16 v[148:151], a[180:183], v[16:19], v[148:151]
    v_exp_f32 v57, v57
    v_mfma_f32_16x16x32_bf16 v[152:155], a[184:187], v[16:19], v[152:155]
    v_exp_f32 v58, v58
    v_cvt_pk_bf16_f32 v52, v56, v57
    v_mfma_f32_16x16x32_bf16 v[156:159], a[188:191], v[16:19], v[156:159]
    v_exp_f32 v59, v59
    v_mfma_f32_16x16x32_bf16 v[160:163], a[160:163], v[20:23], v[160:163]
    v_exp_f32 v60, v60
    v_cvt_pk_bf16_f32 v53, v58, v59
    v_mfma_f32_16x16x32_bf16 v[164:167], a[164:167], v[20:23], v[164:167]
    v_exp_f32 v61, v61
    v_mfma_f32_16x16x32_bf16 v[168:171], a[168:171], v[20:23], v[168:171]
    v_exp_f32 v62, v62
    v_cvt_pk_bf16_f32 v54, v60, v61
    v_mfma_f32_16x16x32_bf16 v[172:175], a[172:175], v[20:23], v[172:175]
    v_exp_f32 v63, v63
    v_mfma_f32_16x16x32_bf16 v[176:179], a[176:179], v[20:23], v[176:179]
    v_cvt_pk_bf16_f32 v55, v62, v63
    s_nop 1
    v_smfmac_f32_16x16x64_bf16 a[208:211], a[228:231], v[16:23], v15
    v_smfmac_f32_16x16x64_bf16 a[208:211], a[236:239], v[48:55], v15
    s_waitcnt lgkmcnt(0)
    v_mfma_f32_16x16x32_bf16 v[128:131], a[64:67], v[48:51], v[128:131]
    v_mfma_f32_16x16x32_bf16 v[132:135], a[68:71], v[48:51], v[132:135]
    v_mfma_f32_16x16x32_bf16 v[136:139], a[72:75], v[48:51], v[136:139]
    v_mfma_f32_16x16x32_bf16 v[140:143], a[76:79], v[48:51], v[140:143]
    v_mfma_f32_16x16x32_bf16 v[144:147], a[80:83], v[48:51], v[144:147]
    v_mfma_f32_16x16x32_bf16 v[148:151], a[84:87], v[48:51], v[148:151]
    v_mfma_f32_16x16x32_bf16 v[152:155], a[88:91], v[48:51], v[152:155]
    v_mfma_f32_16x16x32_bf16 v[156:159], a[92:95], v[48:51], v[156:159]
    s_nop 3
    v_accvgpr_read_b32 v112, a208
    v_accvgpr_read_b32 v113, a210
    v_accvgpr_read_b32 v116, a209
    v_accvgpr_read_b32 v117, a211
    v_add_f32 v112, v112, v116
    v_add_f32 v113, v113, v117
    v_cmp_nge_f32 vcc, 0x44800000, v112
    v_rcp_f32 v120, v112
    s_nop 0
    s_mov_b64 s[84:85], vcc
    v_cmp_nge_f32 vcc, 0x44800000, v113
    v_rcp_f32 v121, v113
    s_nop 0
    s_or_b64 s[84:85], s[84:85], vcc
    s_mov_b32 s40, s34
    s_cbranch_scc1 L_el2_1
    v_mfma_f32_16x16x32_bf16 v[180:183], a[180:183], v[20:23], v[180:183]
    v_mul_f32 v128, v120, v128
    v_mul_f32 v129, v120, v129
    v_mul_f32 v130, v120, v130
    v_mfma_f32_16x16x32_bf16 v[184:187], a[184:187], v[20:23], v[184:187]
    v_mul_f32 v131, v120, v131
    v_mul_f32 v132, v120, v132
    v_mul_f32 v133, v120, v133
    v_mfma_f32_16x16x32_bf16 v[188:191], a[188:191], v[20:23], v[188:191]
    v_mul_f32 v134, v120, v134
    v_mul_f32 v135, v120, v135
    v_cvt_pk_bf16_f32 v128, v128, v129
    v_mfma_f32_16x16x32_bf16 v[160:163], a[64:67], v[52:55], v[160:163]
    v_cvt_pk_bf16_f32 v129, v130, v131
    v_mul_f32 v136, v120, v136
    v_mul_f32 v137, v120, v137
    v_mfma_f32_16x16x32_bf16 v[164:167], a[68:71], v[52:55], v[164:167]
    v_mul_f32 v138, v120, v138
    v_mul_f32 v139, v120, v139
    v_cvt_pk_bf16_f32 v132, v132, v133
    v_mfma_f32_16x16x32_bf16 v[168:171], a[72:75], v[52:55], v[168:171]
    v_cvt_pk_bf16_f32 v133, v134, v135
    ds_write_b64 v11, v[128:129] offset:0
    v_mul_f32 v140, v120, v140
    v_mfma_f32_16x16x32_bf16 v[172:175], a[76:79], v[52:55], v[172:175]
    v_mul_f32 v141, v120, v141
    v_mul_f32 v142, v120, v142
    v_mul_f32 v143, v120, v143
    v_mfma_f32_16x16x32_bf16 v[176:179], a[80:83], v[52:55], v[176:179]
    v_cvt_pk_bf16_f32 v136, v136, v137
    v_cvt_pk_bf16_f32 v137, v138, v139
    ds_write_b64 v11, v[132:133] offset:32
    v_mfma_f32_16x16x32_bf16 v[180:183], a[84:87], v[52:55], v[180:183]
    v_mul_f32 v144, v120, v144
    v_mul_f32 v145, v120, v145
    v_mul_f32 v146, v120, v146
    v_mfma_f32_16x16x32_bf16 v[184:187], a[88:91], v[52:55], v[184:187]
    v_mul_f32 v147, v120, v147
    v_cvt_pk_bf16_f32 v140, v140, v141
    v_cvt_pk_bf16_f32 v141, v142, v143
    v_mfma_f32_16x16x32_bf16 v[188:191], a[92:95], v[52:55], v[188:191]
    ds_write_b64 v11, v[136:137] offset:64
    v_mul_f32 v148, v120, v148
    v_mul_f32 v149, v120, v149
    v_mul_f32 v150, v120, v150
    v_mul_f32 v151, v120, v151
    v_cvt_pk_bf16_f32 v144, v144, v145
    v_cvt_pk_bf16_f32 v145, v146, v147
    ds_write_b64 v11, v[140:141] offset:96
    v_mul_f32 v152, v120, v152
    v_mul_f32 v153, v120, v153
    v_mul_f32 v154, v120, v154
    v_mul_f32 v155, v120, v155
    v_cvt_pk_bf16_f32 v148, v148, v149
    v_cvt_pk_bf16_f32 v149, v150, v151
    ds_write_b64 v11, v[144:145] offset:128
    v_mul_f32 v156, v120, v156
    v_mul_f32 v157, v120, v157
    v_mul_f32 v158, v120, v158
    v_mul_f32 v159, v120, v159
    v_cvt_pk_bf16_f32 v152, v152, v153
    v_cvt_pk_bf16_f32 v153, v154, v155
    ds_write_b64 v11, v[148:149] offset:160
    v_cvt_pk_bf16_f32 v156, v156, v157
    v_cvt_pk_bf16_f32 v157, v158, v159
    ds_write_b64 v11, v[152:153] offset:192
    ds_write_b64 v11, v[156:157] offset:224
    ds_read_b128 v[128:131], v12 offset:0
    ds_read_b128 v[132:135], v12 offset:1088
    ds_read_b128 v[136:139], v12 offset:2176
    ds_read_b128 v[140:143], v12 offset:3264
    v_mul_f32 v160, v121, v160
    v_mul_f32 v161, v121, v161
    v_mul_f32 v162, v121, v162
    v_mul_f32 v163, v121, v163
    v_mul_f32 v164, v121, v164
    v_mul_f32 v165, v121, v165
    v_mul_f32 v166, v121, v166
    v_mul_f32 v167, v121, v167
    v_cvt_pk_bf16_f32 v160, v160, v161
    v_cvt_pk_bf16_f32 v161, v162, v163
    v_mul_f32 v168, v121, v168
    v_mul_f32 v169, v121, v169
    v_mul_f32 v170, v121, v170
    v_mul_f32 v171, v121, v171
    v_cvt_pk_bf16_f32 v164, v164, v165
    v_cvt_pk_bf16_f32 v165, v166, v167
    ds_write_b64 v11, v[160:161] offset:4352
    s_waitcnt lgkmcnt(4)
    buffer_store_dwordx4 v[128:131], v13, s[16:19], s40 offen sc0 sc1
    s_add_u32 s40, s40, 16384
    v_mul_f32 v172, v121, v172
    v_mul_f32 v173, v121, v173
    v_mul_f32 v174, v121, v174
    v_mul_f32 v175, v121, v175
    v_cvt_pk_bf16_f32 v168, v168, v169
    v_cvt_pk_bf16_f32 v169, v170, v171
    ds_write_b64 v11, v[164:165] offset:4384
    v_mul_f32 v176, v121, v176
    v_mul_f32 v177, v121, v177
    v_mul_f32 v178, v121, v178
    v_mul_f32 v179, v121, v179
    v_cvt_pk_bf16_f32 v172, v172, v173
    v_cvt_pk_bf16_f32 v173, v174, v175
    ds_write_b64 v11, v[168:169] offset:4416
    s_waitcnt lgkmcnt(5)
    buffer_store_dwordx4 v[132:135], v13, s[16:19], s40 offen sc0 sc1
    s_add_u32 s40, s40, 16384
    v_mul_f32 v180, v121, v180
    v_mul_f32 v181, v121, v181
    v_mul_f32 v182, v121, v182
    v_mul_f32 v183, v121, v183
    v_cvt_pk_bf16_f32 v176, v176, v177
    v_cvt_pk_bf16_f32 v177, v178, v179
    ds_write_b64 v11, v[172:173] offset:4448
    v_mul_f32 v184, v121, v184
    v_mul_f32 v185, v121, v185
    v_mul_f32 v186, v121, v186
    v_mul_f32 v187, v121, v187
    v_cvt_pk_bf16_f32 v180, v180, v181
    v_cvt_pk_bf16_f32 v181, v182, v183
    ds_write_b64 v11, v[176:177] offset:4480
    s_waitcnt lgkmcnt(6)
    buffer_store_dwordx4 v[136:139], v13, s[16:19], s40 offen sc0 sc1
    s_add_u32 s40, s40, 16384
    v_mul_f32 v188, v121, v188
    v_mul_f32 v189, v121, v189
    v_mul_f32 v190, v121, v190
    v_mul_f32 v191, v121, v191
    v_cvt_pk_bf16_f32 v184, v184, v185
    v_cvt_pk_bf16_f32 v185, v186, v187
    ds_write_b64 v11, v[180:181] offset:4512
    v_cvt_pk_bf16_f32 v188, v188, v189
    v_cvt_pk_bf16_f32 v189, v190, v191
    ds_write_b64 v11, v[184:185] offset:4544
    s_waitcnt lgkmcnt(7)
    buffer_store_dwordx4 v[140:143], v13, s[16:19], s40 offen sc0 sc1
    s_add_u32 s40, s40, 16384
    ds_write_b64 v11, v[188:189] offset:4576
    ds_read_b128 v[160:163], v12 offset:4352
    ds_read_b128 v[164:167], v12 offset:5440
    ds_read_b128 v[168:171], v12 offset:6528
    ds_read_b128 v[172:175], v12 offset:7616
    s_waitcnt lgkmcnt(3)
    buffer_store_dwordx4 v[160:163], v13, s[16:19], s40 offen sc0 sc1
    s_add_u32 s40, s40, 16384
    s_waitcnt lgkmcnt(2)
    buffer_store_dwordx4 v[164:167], v13, s[16:19], s40 offen sc0 sc1
    s_add_u32 s40, s40, 16384
    s_waitcnt lgkmcnt(1)
    buffer_store_dwordx4 v[168:171], v13, s[16:19], s40 offen sc0 sc1
    s_add_u32 s40, s40, 16384
    s_waitcnt lgkmcnt(0)
    buffer_store_dwordx4 v[172:175], v13, s[16:19], s40 offen sc0 sc1
    s_add_u32 s40, s40, 16384
    s_endpgm
L_e1_3:
    s_mov_b32 s44, 3
    s_waitcnt vmcnt(4)
    s_barrier
L_e1_3_0:
    v_mfma_f32_16x16x32_bf16 v[48:51], a[128:131], a[0:3], v[80:83]
    ds_read_b64_tr_b16 a[160:161], v3 offset:52224
    ds_read_b64_tr_b16 a[162:163], v3 offset:52736
    ds_read_b64_tr_b16 a[164:165], v3 offset:52256
    ds_read_b64_tr_b16 a[166:167], v3 offset:52768
    v_exp_f32 v20, v20
    v_mfma_f32_16x16x32_bf16 v[48:51], a[132:135], a[4:7], v[48:51]
    ds_read_b64_tr_b16 a[168:169], v3 offset:52288
    ds_read_b64_tr_b16 a[170:171], v3 offset:52800
    ds_read_b64_tr_b16 a[172:173], v3 offset:52320
    ds_read_b64_tr_b16 a[174:175], v3 offset:52832
    v_exp_f32 v21, v21
    v_mfma_f32_16x16x32_bf16 v[48:51], a[136:139], a[8:11], v[48:51]
    ds_read_b64_tr_b16 a[176:177], v3 offset:52352
    ds_read_b64_tr_b16 a[178:179], v3 offset:52864
    ds_read_b64_tr_b16 a[180:181], v3 offset:52384
    ds_read_b64_tr_b16 a[182:183], v3 offset:52896
    v_exp_f32 v22, v22
    v_cvt_pk_bf16_f32 v18, v20, v21
    v_mfma_f32_16x16x32_bf16 v[48:51], a[140:143], a[12:15], v[48:51]
    ds_read_b64_tr_b16 a[184:185], v3 offset:52416
    ds_read_b64_tr_b16 a[186:187], v3 offset:52928
    ds_read_b64_tr_b16 a[188:189], v3 offset:52448
    ds_read_b64_tr_b16 a[190:191], v3 offset:52960
    v_exp_f32 v23, v23
    v_mfma_f32_16x16x32_bf16 v[52:55], a[144:147], a[0:3], v[80:83]
    ds_read_b64_tr_b16 a[64:65], v3 offset:0
    ds_read_b64_tr_b16 a[66:67], v3 offset:512
    ds_read_b64_tr_b16 a[68:69], v3 offset:32
    ds_read_b64_tr_b16 a[70:71], v3 offset:544
    v_cvt_pk_bf16_f32 v19, v22, v23
    v_mfma_f32_16x16x32_bf16 v[52:55], a[148:151], a[4:7], v[52:55]
    ds_read_b64_tr_b16 a[72:73], v3 offset:64
    ds_read_b64_tr_b16 a[74:75], v3 offset:576
    ds_read_b64_tr_b16 a[76:77], v3 offset:96
    ds_read_b64_tr_b16 a[78:79], v3 offset:608
    v_mfma_f32_16x16x32_bf16 v[52:55], a[152:155], a[8:11], v[52:55]
    ds_read_b64_tr_b16 a[80:81], v3 offset:128
    ds_read_b64_tr_b16 a[82:83], v3 offset:640
    ds_read_b64_tr_b16 a[84:85], v3 offset:160
    ds_read_b64_tr_b16 a[86:87], v3 offset:672
    v_mfma_f32_16x16x32_bf16 v[52:55], a[156:159], a[12:15], v[52:55]
    ds_read_b64_tr_b16 a[88:89], v3 offset:192
    ds_read_b64_tr_b16 a[90:91], v3 offset:704
    ds_read_b64_tr_b16 a[92:93], v3 offset:224
    ds_read_b64_tr_b16 a[94:95], v3 offset:736
    s_waitcnt lgkmcnt(15)
    v_mfma_f32_16x16x32_bf16 v[128:131], a[160:163], v[16:19], v[128:131]
    v_mfma_f32_16x16x32_bf16 v[132:135], a[164:167], v[16:19], v[132:135]
    v_mfma_f32_16x16x32_bf16 v[136:139], a[168:171], v[16:19], v[136:139]
    v_mfma_f32_16x16x32_bf16 v[140:143], a[172:175], v[16:19], v[140:143]
    v_mfma_f32_16x16x32_bf16 v[144:147], a[176:179], v[16:19], v[144:147]
    v_exp_f32 v48, v48
    v_mfma_f32_16x16x32_bf16 v[148:151], a[180:183], v[16:19], v[148:151]
    v_exp_f32 v49, v49
    v_mfma_f32_16x16x32_bf16 v[152:155], a[184:187], v[16:19], v[152:155]
    v_exp_f32 v50, v50
    v_cvt_pk_bf16_f32 v48, v48, v49
    v_mfma_f32_16x16x32_bf16 v[156:159], a[188:191], v[16:19], v[156:159]
    v_exp_f32 v51, v51
    v_exp_f32 v52, v52
    s_nop 0
    v_cvt_pk_bf16_f32 v49, v50, v51
    v_exp_f32 v53, v53
    v_exp_f32 v54, v54
    s_nop 0
    v_cvt_pk_bf16_f32 v50, v52, v53
    v_exp_f32 v55, v55
    s_nop 0
    v_cvt_pk_bf16_f32 v51, v54, v55
    s_nop 1
    v_mfma_f32_16x16x32_bf16 a[208:211], a[224:227], v[16:19], a[208:211]
    v_mfma_f32_16x16x32_bf16 a[208:211], a[232:235], v[48:51], a[208:211]
    s_waitcnt lgkmcnt(0)
    v_mfma_f32_16x16x32_bf16 v[128:131], a[64:67], v[48:51], v[128:131]
    v_mfma_f32_16x16x32_bf16 v[132:135], a[68:71], v[48:51], v[132:135]
    v_mfma_f32_16x16x32_bf16 v[136:139], a[72:75], v[48:51], v[136:139]
    v_mfma_f32_16x16x32_bf16 v[140:143], a[76:79], v[48:51], v[140:143]
    v_mfma_f32_16x16x32_bf16 v[144:147], a[80:83], v[48:51], v[144:147]
    v_mfma_f32_16x16x32_bf16 v[148:151], a[84:87], v[48:51], v[148:151]
    v_mfma_f32_16x16x32_bf16 v[152:155], a[88:91], v[48:51], v[152:155]
    v_mfma_f32_16x16x32_bf16 v[156:159], a[92:95], v[48:51], v[156:159]
    s_nop 3
    v_accvgpr_read_b32 v112, a208
    v_cmp_nge_f32 vcc, 0x44800000, v112
    v_rcp_f32 v120, v112
    s_nop 0
    s_mov_b64 s[84:85], vcc
    s_cmp_lg_u64 s[84:85], 0
    s_mov_b32 s40, s34
    s_cbranch_scc1 L_el1_1
    v_mul_f32 v128, v120, v128
    v_mul_f32 v129, v120, v129
    v_mul_f32 v130, v120, v130
    v_mul_f32 v131, v120, v131
    v_mul_f32 v132, v120, v132
    v_mul_f32 v133, v120, v133
    v_mul_f32 v134, v120, v134
    v_mul_f32 v135, v120, v135
    v_cvt_pk_bf16_f32 v128, v128, v129
    v_cvt_pk_bf16_f32 v129, v130, v131
    v_mul_f32 v136, v120, v136
    v_mul_f32 v137, v120, v137
    v_mul_f32 v138, v120, v138
    v_mul_f32 v139, v120, v139
    v_cvt_pk_bf16_f32 v132, v132, v133
    v_cvt_pk_bf16_f32 v133, v134, v135
    ds_write_b64 v11, v[128:129] offset:0
    v_mul_f32 v140, v120, v140
    v_mul_f32 v141, v120, v141
    v_mul_f32 v142, v120, v142
    v_mul_f32 v143, v120, v143
    v_cvt_pk_bf16_f32 v136, v136, v137
    v_cvt_pk_bf16_f32 v137, v138, v139
    ds_write_b64 v11, v[132:133] offset:32
    v_mul_f32 v144, v120, v144
    v_mul_f32 v145, v120, v145
    v_mul_f32 v146, v120, v146
    v_mul_f32 v147, v120, v147
    v_cvt_pk_bf16_f32 v140, v140, v141
    v_cvt_pk_bf16_f32 v141, v142, v143
    ds_write_b64 v11, v[136:137] offset:64
    v_mul_f32 v148, v120, v148
    v_mul_f32 v149, v120, v149
    v_mul_f32 v150, v120, v150
    v_mul_f32 v151, v120, v151
    v_cvt_pk_bf16_f32 v144, v144, v145
    v_cvt_pk_bf16_f32 v145, v146, v147
    ds_write_b64 v11, v[140:141] offset:96
    v_mul_f32 v152, v120, v152
    v_mul_f32 v153, v120, v153
    v_mul_f32 v154, v120, v154
    v_mul_f32 v155, v120, v155
    v_cvt_pk_bf16_f32 v148, v148, v149
    v_cvt_pk_bf16_f32 v149, v150, v151
    ds_write_b64 v11, v[144:145] offset:128
    v_mul_f32 v156, v120, v156
    v_mul_f32 v157, v120, v157
    v_mul_f32 v158, v120, v158
    v_mul_f32 v159, v120, v159
    v_cvt_pk_bf16_f32 v152, v152, v153
    v_cvt_pk_bf16_f32 v153, v154, v155
    ds_write_b64 v11, v[148:149] offset:160
    v_cvt_pk_bf16_f32 v156, v156, v157
    v_cvt_pk_bf16_f32 v157, v158, v159
    ds_write_b64 v11, v[152:153] offset:192
    ds_write_b64 v11, v[156:157] offset:224
    ds_read_b128 v[128:131], v12 offset:0
    ds_read_b128 v[132:135], v12 offset:1088
    ds_read_b128 v[136:139], v12 offset:2176
    ds_read_b128 v[140:143], v12 offset:3264
    s_waitcnt lgkmcnt(3)
    buffer_store_dwordx4 v[128:131], v13, s[16:19], s40 offen sc0 sc1
    s_add_u32 s40, s40, 16384
    s_waitcnt lgkmcnt(2)
    buffer_store_dwordx4 v[132:135], v13, s[16:19], s40 offen sc0 sc1
    s_add_u32 s40, s40, 16384
    s_waitcnt lgkmcnt(1)
    buffer_store_dwordx4 v[136:139], v13, s[16:19], s40 offen sc0 sc1
    s_add_u32 s40, s40, 16384
    s_waitcnt lgkmcnt(0)
    buffer_store_dwordx4 v[140:143], v13, s[16:19], s40 offen sc0 sc1
    s_add_u32 s40, s40, 16384
    s_endpgm
L_cold:
L_adv0:
    s_cmp_eq_u32 s81, 0
    s_cbranch_scc1 L_fin
    s_mov_b32 s80, s81
    s_mov_b32 s81, s82
    s_mov_b32 s82, 0
    s_add_u32 s47, s47, 1
    s_mov_b32 s42, s89
    s_mov_b32 s43, s90
    s_mov_b32 s18, s90
    s_mov_b32 s34, s91
    s_mov_b32 s88, s93
    s_bfe_u32 s37, s80, 0xa000d
    s_add_u32 s36, s37, 31
    s_lshr_b32 s36, s36, 5
    s_sub_u32 s31, s36, 1
    s_lshl_b32 s39, s31, 5
    s_sub_u32 s35, s37, s39
    s_mov_b32 s46, 0
    s_mov_b32 s99, s33
    s_and_b32 s38, s81, 0x1fff
    s_bfe_u32 s39, s81, 0xa000d
    s_add_u32 s39, s38, s39
    s_lshl_b32 s90, s39, 12
    s_bfe_u32 s39, s81, 0x1001e
    s_lshl_b32 s39, s39, 8
    s_add_u32 s39, s39, s45
    s_lshl_b32 s89, s38, 12
    s_add_u32 s89, s89, s39
    s_bfe_u32 s93, s81, 0x3001b
    s_bfe_u32 s39, s81, 0x40017
    s_lshl_b32 s39, s39, 2
    s_mul_i32 s38, s87, s93
    s_add_u32 s39, s39, s38
    s_lshl_b32 s91, s39, 16
    s_add_u32 s91, s91, s89
    s_lshl_b32 s38, s87, 14
    s_sub_u32 s86, s91, s38
    s_mov_b64 s[4:5], s[64:65]
    s_mov_b32 s6, s90
    s_cmp_eq_u32 s90, 0
    s_cselect_b32 s32, 4, 4
    s_subb_u32 s31, s31, 0
    s_lshl_b32 s38, s93, 2
    s_max_u32 s38, s38, 1
    s_sub_u32 s38, s38, 1
    s_mul_i32 s100, s38, 1056
    s_add_u32 s100, s100, s99
    s_lshl_b32 s96, s38, 14
    s_add_u32 s96, s96, s86
    s_cmp_eq_u32 s88, 2
    s_cbranch_scc1 L_p2_0
    s_branch L_p3_0
L_p2_0:
    v_accvgpr_mov_b32 a232, a240
    v_accvgpr_mov_b32 a233, a241
    v_accvgpr_mov_b32 a234, a242
    v_accvgpr_mov_b32 a235, a243
    v_accvgpr_mov_b32 a236, a244
    v_accvgpr_mov_b32 a237, a245
    v_accvgpr_mov_b32 a238, a246
    v_accvgpr_mov_b32 a239, a247
    v_mfma_f32_16x16x32_bf16 v[16:19], a[128:131], a[0:3], 0
    v_mfma_f32_16x16x32_bf16 v[16:19], a[132:135], a[4:7], v[16:19]
    v_mfma_f32_16x16x32_bf16 v[16:19], a[136:139], a[8:11], v[16:19]
    v_mfma_f32_16x16x32_bf16 v[16:19], a[140:143], a[12:15], v[16:19]
    v_mfma_f32_16x16x32_bf16 v[20:23], a[144:147], a[0:3], 0
    v_mfma_f32_16x16x32_bf16 v[20:23], a[148:151], a[4:7], v[20:23]
    v_mfma_f32_16x16x32_bf16 v[20:23], a[152:155], a[8:11], v[20:23]
    v_mfma_f32_16x16x32_bf16 v[20:23], a[156:159], a[12:15], v[20:23]
    v_mfma_f32_16x16x32_bf16 v[24:27], a[128:131], a[16:19], 0
    v_mfma_f32_16x16x32_bf16 v[24:27], a[132:135], a[20:23], v[24:27]
    v_mfma_f32_16x16x32_bf16 v[24:27], a[136:139], a[24:27], v[24:27]
    v_mfma_f32_16x16x32_bf16 v[24:27], a[140:143], a[28:31], v[24:27]
    v_mfma_f32_16x16x32_bf16 v[28:31], a[144:147], a[16:19], 0
    v_mfma_f32_16x16x32_bf16 v[28:31], a[148:151], a[20:23], v[28:31]
    v_mfma_f32_16x16x32_bf16 v[28:31], a[152:155], a[24:27], v[28:31]
    v_mfma_f32_16x16x32_bf16 v[28:31], a[156:159], a[28:31], v[28:31]
    ds_read_b128 a[128:131], v1 offset:0
    ds_read_b128 a[132:135], v1 offset:64
    ds_read_b128 a[136:139], v2 offset:0
    ds_read_b128 a[140:143], v2 offset:64
    ds_read_b128 a[144:147], v1 offset:4224
    ds_read_b128 a[148:151], v1 offset:4288
    ds_read_b128 a[152:155], v2 offset:4224
    ds_read_b128 a[156:159], v2 offset:4288
    v_mfma_f32_32x32x16_bf16 a[208:223], v[124:127], v[124:127], 0
    v_max3_f32 v112, v16, v17, v18
    v_max3_f32 v116, v19, v20, v21
    v_max3_f32 v112, v112, v22, v23
    v_max_f32 v112, v112, v116
    v_mov_b32 v116, v112
    s_nop 1
    v_permlane32_swap_b32 v112, v116
    v_max_f32 v112, v112, v116
    v_mov_b32 v116, v112
    s_nop 1
    v_permlane16_swap_b32 v112, v116
    v_max_f32 v112, v112, v116
    v_sub_f32 v16, v16, v112
    v_sub_f32 v17, v17, v112
    v_sub_f32 v18, v18, v112
    v_sub_f32 v19, v19, v112
    v_sub_f32 v20, v20, v112
    v_sub_f32 v21, v21, v112
    v_sub_f32 v22, v22, v112
    v_sub_f32 v23, v23, v112
    v_sub_f32 v80, 0, v112
    v_sub_f32 v81, 0, v112
    v_sub_f32 v82, 0, v112
    v_sub_f32 v83, 0, v112
    v_exp_f32 v16, v16
    v_exp_f32 v17, v17
    v_exp_f32 v18, v18
    v_cvt_pk_bf16_f32 v16, v16, v17
    v_exp_f32 v19, v19
    v_exp_f32 v20, v20
    v_cvt_pk_bf16_f32 v17, v18, v19
    v_exp_f32 v21, v21
    v_exp_f32 v22, v22
    v_cvt_pk_bf16_f32 v18, v20, v21
    v_max3_f32 v113, v24, v25, v26
    v_max3_f32 v117, v27, v28, v29
    v_max3_f32 v113, v113, v30, v31
    v_max_f32 v113, v113, v117
    v_mov_b32 v117, v113
    s_nop 1
    v_permlane32_swap_b32 v113, v117
    v_max_f32 v113, v113, v117
    v_mov_b32 v117, v113
    s_nop 1
    v_permlane16_swap_b32 v113, v117
    v_max_f32 v113, v113, v117
    v_sub_f32 v24, v24, v113
    v_sub_f32 v25, v25, v113
    v_sub_f32 v26, v26, v113
    v_sub_f32 v27, v27, v113
    v_sub_f32 v28, v28, v113
    v_sub_f32 v29, v29, v113
    v_sub_f32 v30, v30, v113
    v_sub_f32 v31, v31, v113
    v_sub_f32 v84, 0, v113
    v_sub_f32 v85, 0, v113
    v_sub_f32 v86, 0, v113
    v_sub_f32 v87, 0, v113
    s_waitcnt lgkmcnt(0)
    s_branch L_itb2_1
L_p3_0:
    v_accvgpr_mov_b32 a232, a240
    v_accvgpr_mov_b32 a233, a241
    v_accvgpr_mov_b32 a234, a242
    v_accvgpr_mov_b32 a235, a243
    v_accvgpr_mov_b32 a236, a244
    v_accvgpr_mov_b32 a237, a245
    v_accvgpr_mov_b32 a238, a246
    v_accvgpr_mov_b32 a239, a247
    v_mfma_f32_16x16x32_bf16 v[16:19], a[128:131], a[0:3], 0
    v_mfma_f32_16x16x32_bf16 v[16:19], a[132:135], a[4:7], v[16:19]
    v_mfma_f32_16x16x32_bf16 v[16:19], a[136:139], a[8:11], v[16:19]
    v_mfma_f32_16x16x32_bf16 v[16:19], a[140:143], a[12:15], v[16:19]
    v_mfma_f32_16x16x32_bf16 v[20:23], a[144:147], a[0:3], 0
    v_mfma_f32_16x16x32_bf16 v[20:23], a[148:151], a[4:7], v[20:23]
    v_mfma_f32_16x16x32_bf16 v[20:23], a[152:155], a[8:11], v[20:23]
    v_mfma_f32_16x16x32_bf16 v[20:23], a[156:159], a[12:15], v[20:23]
    v_mfma_f32_16x16x32_bf16 v[24:27], a[128:131], a[16:19], 0
    v_mfma_f32_16x16x32_bf16 v[24:27], a[132:135], a[20:23], v[24:27]
    v_mfma_f32_16x16x32_bf16 v[24:27], a[136:139], a[24:27], v[24:27]
    v_mfma_f32_16x16x32_bf16 v[24:27], a[140:143], a[28:31], v[24:27]
    v_mfma_f32_16x16x32_bf16 v[28:31], a[144:147], a[16:19], 0
    v_mfma_f32_16x16x32_bf16 v[28:31], a[148:151], a[20:23], v[28:31]
    v_mfma_f32_16x16x32_bf16 v[28:31], a[152:155], a[24:27], v[28:31]
    v_mfma_f32_16x16x32_bf16 v[28:31], a[156:159], a[28:31], v[28:31]
    v_mfma_f32_16x16x32_bf16 v[32:35], a[128:131], a[32:35], 0
    v_mfma_f32_16x16x32_bf16 v[32:35], a[132:135], a[36:39], v[32:35]
    v_mfma_f32_16x16x32_bf16 v[32:35], a[136:139], a[40:43], v[32:35]
    v_mfma_f32_16x16x32_bf16 v[32:35], a[140:143], a[44:47], v[32:35]
    v_mfma_f32_16x16x32_bf16 v[36:39], a[144:147], a[32:35], 0
    v_mfma_f32_16x16x32_bf16 v[36:39], a[148:151], a[36:39], v[36:39]
    v_mfma_f32_16x16x32_bf16 v[36:39], a[152:155], a[40:43], v[36:39]
    v_mfma_f32_16x16x32_bf16 v[36:39], a[156:159], a[44:47], v[36:39]
    ds_read_b128 a[128:131], v1 offset:0
    ds_read_b128 a[132:135], v1 offset:64
    ds_read_b128 a[136:139], v2 offset:0
    ds_read_b128 a[140:143], v2 offset:64
    ds_read_b128 a[144:147], v1 offset:4224
    ds_read_b128 a[148:151], v1 offset:4288
    ds_read_b128 a[152:155], v2 offset:4224
    ds_read_b128 a[156:159], v2 offset:4288
    v_mfma_f32_32x32x16_bf16 a[208:223], v[124:127], v[124:127], 0
    v_max3_f32 v112, v16, v17, v18
    v_max3_f32 v116, v19, v20, v21
    v_max3_f32 v112, v112, v22, v23
    v_max_f32 v112, v112, v116
    v_mov_b32 v116, v112
    s_nop 1
    v_permlane32_swap_b32 v112, v116
    v_max_f32 v112, v112, v116
    v_mov_b32 v116, v112
    s_nop 1
    v_permlane16_swap_b32 v112, v116
    v_max_f32 v112, v112, v116
    v_sub_f32 v16, v16, v112
    v_sub_f32 v17, v17, v112
    v_sub_f32 v18, v18, v112
    v_sub_f32 v19, v19, v112
    v_sub_f32 v20, v20, v112
    v_sub_f32 v21, v21, v112
    v_sub_f32 v22, v22, v112
    v_sub_f32 v23, v23, v112
    v_sub_f32 v80, 0, v112
    v_sub_f32 v81, 0, v112
    v_sub_f32 v82, 0, v112
    v_sub_f32 v83, 0, v112
    v_exp_f32 v16, v16
    v_exp_f32 v17, v17
    v_exp_f32 v18, v18
    v_cvt_pk_bf16_f32 v16, v16, v17
    v_exp_f32 v19, v19
    v_exp_f32 v20, v20
    v_cvt_pk_bf16_f32 v17, v18, v19
    v_exp_f32 v21, v21
    v_exp_f32 v22, v22
    v_cvt_pk_bf16_f32 v18, v20, v21
    v_exp_f32 v23, v23
    s_nop 0
    v_cvt_pk_bf16_f32 v19, v22, v23
    v_max3_f32 v113, v24, v25, v26
    v_max3_f32 v117, v27, v28, v29
    v_max3_f32 v113, v113, v30, v31
    v_max_f32 v113, v113, v117
    v_mov_b32 v117, v113
    s_nop 1
    v_permlane32_swap_b32 v113, v117
    v_max_f32 v113, v113, v117
    v_mov_b32 v117, v113
    s_nop 1
    v_permlane16_swap_b32 v113, v117
    v_max_f32 v113, v113, v117
    v_sub_f32 v24, v24, v113
    v_sub_f32 v25, v25, v113
    v_sub_f32 v26, v26, v113
    v_sub_f32 v27, v27, v113
    v_sub_f32 v28, v28, v113
    v_sub_f32 v29, v29, v113
    v_sub_f32 v30, v30, v113
    v_sub_f32 v31, v31, v113
    v_sub_f32 v84, 0, v113
    v_sub_f32 v85, 0, v113
    v_sub_f32 v86, 0, v113
    v_sub_f32 v87, 0, v113
    v_exp_f32 v24, v24
    v_exp_f32 v25, v25
    v_exp_f32 v26, v26
    v_cvt_pk_bf16_f32 v20, v24, v25
    v_max3_f32 v114, v32, v33, v34
    v_max3_f32 v118, v35, v36, v37
    v_max3_f32 v114, v114, v38, v39
    v_max_f32 v114, v114, v118
    v_mov_b32 v118, v114
    s_nop 1
    v_permlane32_swap_b32 v114, v118
    v_max_f32 v114, v114, v118
    v_mov_b32 v118, v114
    s_nop 1
    v_permlane16_swap_b32 v114, v118
    v_max_f32 v114, v114, v118
    v_sub_f32 v32, v32, v114
    v_sub_f32 v33, v33, v114
    v_sub_f32 v34, v34, v114
    v_sub_f32 v35, v35, v114
    v_sub_f32 v36, v36, v114
    v_sub_f32 v37, v37, v114
    v_sub_f32 v38, v38, v114
    v_sub_f32 v39, v39, v114
    v_sub_f32 v88, 0, v114
    v_sub_f32 v89, 0, v114
    v_sub_f32 v90, 0, v114
    v_sub_f32 v91, 0, v114
    s_waitcnt lgkmcnt(0)
    s_branch L_itb3_1
L_adv1:
    s_cmp_eq_u32 s81, 0
    s_cbranch_scc1 L_fin
    s_mov_b32 s80, s81
    s_mov_b32 s81, s82
    s_mov_b32 s82, 0
    s_add_u32 s47, s47, 1
    s_mov_b32 s42, s89
    s_mov_b32 s43, s90
    s_mov_b32 s18, s90
    s_mov_b32 s34, s91
    s_mov_b32 s88, s93
    s_bfe_u32 s37, s80, 0xa000d
    s_add_u32 s36, s37, 31
    s_lshr_b32 s36, s36, 5
    s_sub_u32 s31, s36, 1
    s_lshl_b32 s39, s31, 5
    s_sub_u32 s35, s37, s39
    s_mov_b32 s46, 0
    s_mov_b32 s99, s33
    s_and_b32 s38, s81, 0x1fff
    s_bfe_u32 s39, s81, 0xa000d
    s_add_u32 s39, s38, s39
    s_lshl_b32 s90, s39, 12
    s_bfe_u32 s39, s81, 0x1001e
    s_lshl_b32 s39, s39, 8
    s_add_u32 s39, s39, s45
    s_lshl_b32 s89, s38, 12
    s_add_u32 s89, s89, s39
    s_bfe_u32 s93, s81, 0x3001b
    s_bfe_u32 s39, s81, 0x40017
    s_lshl_b32 s39, s39, 2
    s_mul_i32 s38, s87, s93
    s_add_u32 s39, s39, s38
    s_lshl_b32 s91, s39, 16
    s_add_u32 s91, s91, s89
    s_lshl_b32 s38, s87, 14
    s_sub_u32 s86, s91, s38
    s_mov_b64 s[4:5], s[64:65]
    s_mov_b32 s6, s90
    s_cmp_eq_u32 s90, 0
    s_cselect_b32 s32, 4, 4
    s_subb_u32 s31, s31, 0
    s_lshl_b32 s38, s93, 2
    s_max_u32 s38, s38, 1
    s_sub_u32 s38, s38, 1
    s_mul_i32 s100, s38, 1056
    s_add_u32 s100, s100, s99
    s_lshl_b32 s96, s38, 14
    s_add_u32 s96, s96, s86
    s_cmp_eq_u32 s88, 1
    s_cbranch_scc1 L_p1_1
    s_branch L_p2_1
L_p1_1:
    v_accvgpr_mov_b32 a232, a240
    v_accvgpr_mov_b32 a233, a241
    v_accvgpr_mov_b32 a234, a242
    v_accvgpr_mov_b32 a235, a243
    v_accvgpr_mov_b32 a236, a244
    v_accvgpr_mov_b32 a237, a245
    v_accvgpr_mov_b32 a238, a246
    v_accvgpr_mov_b32 a239, a247
    v_mfma_f32_16x16x32_bf16 v[48:51], a[128:131], a[0:3], 0
    v_mfma_f32_16x16x32_bf16 v[48:51], a[132:135], a[4:7], v[48:51]
    v_mfma_f32_16x16x32_bf16 v[48:51], a[136:139], a[8:11], v[48:51]
    v_mfma_f32_16x16x32_bf16 v[48:51], a[140:143], a[12:15], v[48:51]
    v_mfma_f32_16x16x32_bf16 v[52:55], a[144:147], a[0:3], 0
    v_mfma_f32_16x16x32_bf16 v[52:55], a[148:151], a[4:7], v[52:55]
    v_mfma_f32_16x16x32_bf16 v[52:55], a[152:155], a[8:11], v[52:55]
    v_mfma_f32_16x16x32_bf16 v[52:55], a[156:159], a[12:15], v[52:55]
    ds_read_b128 a[128:131], v1 offset:17408
    ds_read_b128 a[132:135], v1 offset:17472
    ds_read_b128 a[136:139], v2 offset:17408
    ds_read_b128 a[140:143], v2 offset:17472
    ds_read_b128 a[144:147], v1 offset:21632
    ds_read_b128 a[148:151], v1 offset:21696
    ds_read_b128 a[152:155], v2 offset:21632
    ds_read_b128 a[156:159], v2 offset:21696
    v_mfma_f32_32x32x16_bf16 a[208:223], v[124:127], v[124:127], 0
    v_max3_f32 v112, v48, v49, v50
    v_max3_f32 v116, v51, v52, v53
    v_max3_f32 v112, v112, v54, v55
    v_max_f32 v112, v112, v116
    v_mov_b32 v116, v112
    s_nop 1
    v_permlane32_swap_b32 v112, v116
    v_max_f32 v112, v112, v116
    v_mov_b32 v116, v112
    s_nop 1
    v_permlane16_swap_b32 v112, v116
    v_max_f32 v112, v112, v116
    v_sub_f32 v48, v48, v112
    v_sub_f32 v49, v49, v112
    v_sub_f32 v50, v50, v112
    v_sub_f32 v51, v51, v112
    v_sub_f32 v52, v52, v112
    v_sub_f32 v53, v53, v112
    v_sub_f32 v54, v54, v112
    v_sub_f32 v55, v55, v112
    v_sub_f32 v80, 0, v112
    v_sub_f32 v81, 0, v112
    v_sub_f32 v82, 0, v112
    v_sub_f32 v83, 0, v112
    v_exp_f32 v48, v48
    v_exp_f32 v49, v49
    v_exp_f32 v50, v50
    v_cvt_pk_bf16_f32 v48, v48, v49
    v_exp_f32 v51, v51
    s_nop 0
    v_cvt_pk_bf16_f32 v49, v50, v51
    s_waitcnt lgkmcnt(0)
    s_branch L_itb1_2
L_p2_1:
    v_accvgpr_mov_b32 a232, a240
    v_accvgpr_mov_b32 a233, a241
    v_accvgpr_mov_b32 a234, a242
    v_accvgpr_mov_b32 a235, a243
    v_accvgpr_mov_b32 a236, a244
    v_accvgpr_mov_b32 a237, a245
    v_accvgpr_mov_b32 a238, a246
    v_accvgpr_mov_b32 a239, a247
    v_mfma_f32_16x16x32_bf16 v[48:51], a[128:131], a[0:3], 0
    v_mfma_f32_16x16x32_bf16 v[48:51], a[132:135], a[4:7], v[48:51]
    v_mfma_f32_16x16x32_bf16 v[48:51], a[136:139], a[8:11], v[48:51]
    v_mfma_f32_16x16x32_bf16 v[48:51], a[140:143], a[12:15], v[48:51]
    v_mfma_f32_16x16x32_bf16 v[52:55], a[144:147], a[0:3], 0
    v_mfma_f32_16x16x32_bf16 v[52:55], a[148:151], a[4:7], v[52:55]
    v_mfma_f32_16x16x32_bf16 v[52:55], a[152:155], a[8:11], v[52:55]
    v_mfma_f32_16x16x32_bf16 v[52:55], a[156:159], a[12:15], v[52:55]
    v_mfma_f32_16x16x32_bf16 v[56:59], a[128:131], a[16:19], 0
    v_mfma_f32_16x16x32_bf16 v[56:59], a[132:135], a[20:23], v[56:59]
    v_mfma_f32_16x16x32_bf16 v[56:59], a[136:139], a[24:27], v[56:59]
    v_mfma_f32_16x16x32_bf16 v[56:59], a[140:143], a[28:31], v[56:59]
    v_mfma_f32_16x16x32_bf16 v[60:63], a[144:147], a[16:19], 0
    v_mfma_f32_16x16x32_bf16 v[60:63], a[148:151], a[20:23], v[60:63]
    v_mfma_f32_16x16x32_bf16 v[60:63], a[152:155], a[24:27], v[60:63]
    v_mfma_f32_16x16x32_bf16 v[60:63], a[156:159], a[28:31], v[60:63]
    ds_read_b128 a[128:131], v1 offset:17408
    ds_read_b128 a[132:135], v1 offset:17472
    ds_read_b128 a[136:139], v2 offset:17408
    ds_read_b128 a[140:143], v2 offset:17472
    ds_read_b128 a[144:147], v1 offset:21632
    ds_read_b128 a[148:151], v1 offset:21696
    ds_read_b128 a[152:155], v2 offset:21632
    ds_read_b128 a[156:159], v2 offset:21696
    v_mfma_f32_32x32x16_bf16 a[208:223], v[124:127], v[124:127], 0
    v_max3_f32 v112, v48, v49, v50
    v_max3_f32 v116, v51, v52, v53
    v_max3_f32 v112, v112, v54, v55
    v_max_f32 v112, v112, v116
    v_mov_b32 v116, v112
    s_nop 1
    v_permlane32_swap_b32 v112, v116
    v_max_f32 v112, v112, v116
    v_mov_b32 v116, v112
    s_nop 1
    v_permlane16_swap_b32 v112, v116
    v_max_f32 v112, v112, v116
    v_sub_f32 v48, v48, v112
    v_sub_f32 v49, v49, v112
    v_sub_f32 v50, v50, v112
    v_sub_f32 v51, v51, v112
    v_sub_f32 v52, v52, v112
    v_sub_f32 v53, v53, v112
    v_sub_f32 v54, v54, v112
    v_sub_f32 v55, v55, v112
    v_sub_f32 v80, 0, v112
    v_sub_f32 v81, 0, v112
    v_sub_f32 v82, 0, v112
    v_sub_f32 v83, 0, v112
    v_exp_f32 v48, v48
    v_exp_f32 v49, v49
    v_exp_f32 v50, v50
    v_cvt_pk_bf16_f32 v48, v48, v49
    v_exp_f32 v51, v51
    v_exp_f32 v52, v52
    v_cvt_pk_bf16_f32 v49, v50, v51
    v_exp_f32 v53, v53
    v_exp_f32 v54, v54
    v_cvt_pk_bf16_f32 v50, v52, v53
    v_max3_f32 v113, v56, v57, v58
    v_max3_f32 v117, v59, v60, v61
    v_max3_f32 v113, v113, v62, v63
    v_max_f32 v113, v113, v117
    v_mov_b32 v117, v113
    s_nop 1
    v_permlane32_swap_b32 v113, v117
    v_max_f32 v113, v113, v117
    v_mov_b32 v117, v113
    s_nop 1
    v_permlane16_swap_b32 v113, v117
    v_max_f32 v113, v113, v117
    v_sub_f32 v56, v56, v113
    v_sub_f32 v57, v57, v113
    v_sub_f32 v58, v58, v113
    v_sub_f32 v59, v59, v113
    v_sub_f32 v60, v60, v113
    v_sub_f32 v61, v61, v113
    v_sub_f32 v62, v62, v113
    v_sub_f32 v63, v63, v113
    v_sub_f32 v84, 0, v113
    v_sub_f32 v85, 0, v113
    v_sub_f32 v86, 0, v113
    v_sub_f32 v87, 0, v113
    s_waitcnt lgkmcnt(0)
    s_branch L_itb2_2
L_adv2:
    s_cmp_eq_u32 s81, 0
    s_cbranch_scc1 L_fin
    s_mov_b32 s80, s81
    s_mov_b32 s81, s82
    s_mov_b32 s82, 0
    s_add_u32 s47, s47, 1
    s_mov_b32 s42, s89
    s_mov_b32 s43, s90
    s_mov_b32 s18, s90
    s_mov_b32 s34, s91
    s_mov_b32 s88, s93
    s_bfe_u32 s37, s80, 0xa000d
    s_add_u32 s36, s37, 31
    s_lshr_b32 s36, s36, 5
    s_sub_u32 s31, s36, 1
    s_lshl_b32 s39, s31, 5
    s_sub_u32 s35, s37, s39
    s_mov_b32 s46, 0
    s_mov_b32 s99, s33
    s_and_b32 s38, s81, 0x1fff
    s_bfe_u32 s39, s81, 0xa000d
    s_add_u32 s39, s38, s39
    s_lshl_b32 s90, s39, 12
    s_bfe_u32 s39, s81, 0x1001e
    s_lshl_b32 s39, s39, 8
    s_add_u32 s39, s39, s45
    s_lshl_b32 s89, s38, 12
    s_add_u32 s89, s89, s39
    s_bfe_u32 s93, s81, 0x3001b
    s_bfe_u32 s39, s81, 0x40017
    s_lshl_b32 s39, s39, 2
    s_mul_i32 s38, s87, s93
    s_add_u32 s39, s39, s38
    s_lshl_b32 s91, s39, 16
    s_add_u32 s91, s91, s89
    s_lshl_b32 s38, s87, 14
    s_sub_u32 s86, s91, s38
    s_mov_b64 s[4:5], s[64:65]
    s_mov_b32 s6, s90
    s_cmp_eq_u32 s90, 0
    s_cselect_b32 s32, 4, 4
    s_subb_u32 s31, s31, 0
    s_lshl_b32 s38, s93, 2
    s_max_u32 s38, s38, 1
    s_sub_u32 s38, s38, 1
    s_mul_i32 s100, s38, 1056
    s_add_u32 s100, s100, s99
    s_lshl_b32 s96, s38, 14
    s_add_u32 s96, s96, s86
    s_branch L_p3_2
L_p3_2:
    v_accvgpr_mov_b32 a232, a240
    v_accvgpr_mov_b32 a233, a241
    v_accvgpr_mov_b32 a234, a242
    v_accvgpr_mov_b32 a235, a243
    v_accvgpr_mov_b32 a236, a244
    v_accvgpr_mov_b32 a237, a245
    v_accvgpr_mov_b32 a238, a246
    v_accvgpr_mov_b32 a239, a247
    v_mfma_f32_16x16x32_bf16 v[16:19], a[128:131], a[0:3], 0
    v_mfma_f32_16x16x32_bf16 v[16:19], a[132:135], a[4:7], v[16:19]
    v_mfma_f32_16x16x32_bf16 v[16:19], a[136:139], a[8:11], v[16:19]
    v_mfma_f32_16x16x32_bf16 v[16:19], a[140:143], a[12:15], v[16:19]
    v_mfma_f32_16x16x32_bf16 v[20:23], a[144:147], a[0:3], 0
    v_mfma_f32_16x16x32_bf16 v[20:23], a[148:151], a[4:7], v[20:23]
    v_mfma_f32_16x16x32_bf16 v[20:23], a[152:155], a[8:11], v[20:23]
    v_mfma_f32_16x16x32_bf16 v[20:23], a[156:159], a[12:15], v[20:23]
    v_mfma_f32_16x16x32_bf16 v[24:27], a[128:131], a[16:19], 0
    v_mfma_f32_16x16x32_bf16 v[24:27], a[132:135], a[20:23], v[24:27]
    v_mfma_f32_16x16x32_bf16 v[24:27], a[136:139], a[24:27], v[24:27]
    v_mfma_f32_16x16x32_bf16 v[24:27], a[140:143], a[28:31], v[24:27]
    v_mfma_f32_16x16x32_bf16 v[28:31], a[144:147], a[16:19], 0
    v_mfma_f32_16x16x32_bf16 v[28:31], a[148:151], a[20:23], v[28:31]
    v_mfma_f32_16x16x32_bf16 v[28:31], a[152:155], a[24:27], v[28:31]
    v_mfma_f32_16x16x32_bf16 v[28:31], a[156:159], a[28:31], v[28:31]
    v_mfma_f32_16x16x32_bf16 v[32:35], a[128:131], a[32:35], 0
    v_mfma_f32_16x16x32_bf16 v[32:35], a[132:135], a[36:39], v[32:35]
    v_mfma_f32_16x16x32_bf16 v[32:35], a[136:139], a[40:43], v[32:35]
    v_mfma_f32_16x16x32_bf16 v[32:35], a[140:143], a[44:47], v[32:35]
    v_mfma_f32_16x16x32_bf16 v[36:39], a[144:147], a[32:35], 0
    v_mfma_f32_16x16x32_bf16 v[36:39], a[148:151], a[36:39], v[36:39]
    v_mfma_f32_16x16x32_bf16 v[36:39], a[152:155], a[40:43], v[36:39]
    v_mfma_f32_16x16x32_bf16 v[36:39], a[156:159], a[44:47], v[36:39]
    ds_read_b128 a[128:131], v1 offset:34816
    ds_read_b128 a[132:135], v1 offset:34880
    ds_read_b128 a[136:139], v2 offset:34816
    ds_read_b128 a[140:143], v2 offset:34880
    ds_read_b128 a[144:147], v1 offset:39040
    ds_read_b128 a[148:151], v1 offset:39104
    ds_read_b128 a[152:155], v2 offset:39040
    ds_read_b128 a[156:159], v2 offset:39104
    v_mfma_f32_32x32x16_bf16 a[208:223], v[124:127], v[124:127], 0
    v_max3_f32 v112, v16, v17, v18
    v_max3_f32 v116, v19, v20, v21
    v_max3_f32 v112, v112, v22, v23
    v_max_f32 v112, v112, v116
    v_mov_b32 v116, v112
    s_nop 1
    v_permlane32_swap_b32 v112, v116
    v_max_f32 v112, v112, v116
    v_mov_b32 v116, v112
    s_nop 1
    v_permlane16_swap_b32 v112, v116
    v_max_f32 v112, v112, v116
    v_sub_f32 v16, v16, v112
    v_sub_f32 v17, v17, v112
    v_sub_f32 v18, v18, v112
    v_sub_f32 v19, v19, v112
    v_sub_f32 v20, v20, v112
    v_sub_f32 v21, v21, v112
    v_sub_f32 v22, v22, v112
    v_sub_f32 v23, v23, v112
    v_sub_f32 v80, 0, v112
    v_sub_f32 v81, 0, v112
    v_sub_f32 v82, 0, v112
    v_sub_f32 v83, 0, v112
    v_exp_f32 v16, v16
    v_exp_f32 v17, v17
    v_exp_f32 v18, v18
    v_cvt_pk_bf16_f32 v16, v16, v17
    v_exp_f32 v19, v19
    v_exp_f32 v20, v20
    v_cvt_pk_bf16_f32 v17, v18, v19
    v_exp_f32 v21, v21
    v_exp_f32 v22, v22
    v_cvt_pk_bf16_f32 v18, v20, v21
    v_exp_f32 v23, v23
    s_nop 0
    v_cvt_pk_bf16_f32 v19, v22, v23
    v_max3_f32 v113, v24, v25, v26
    v_max3_f32 v117, v27, v28, v29
    v_max3_f32 v113, v113, v30, v31
    v_max_f32 v113, v113, v117
    v_mov_b32 v117, v113
    s_nop 1
    v_permlane32_swap_b32 v113, v117
    v_max_f32 v113, v113, v117
    v_mov_b32 v117, v113
    s_nop 1
    v_permlane16_swap_b32 v113, v117
    v_max_f32 v113, v113, v117
    v_sub_f32 v24, v24, v113
    v_sub_f32 v25, v25, v113
    v_sub_f32 v26, v26, v113
    v_sub_f32 v27, v27, v113
    v_sub_f32 v28, v28, v113
    v_sub_f32 v29, v29, v113
    v_sub_f32 v30, v30, v113
    v_sub_f32 v31, v31, v113
    v_sub_f32 v84, 0, v113
    v_sub_f32 v85, 0, v113
    v_sub_f32 v86, 0, v113
    v_sub_f32 v87, 0, v113
    v_exp_f32 v24, v24
    v_exp_f32 v25, v25
    v_exp_f32 v26, v26
    v_cvt_pk_bf16_f32 v20, v24, v25
    v_max3_f32 v114, v32, v33, v34
    v_max3_f32 v118, v35, v36, v37
    v_max3_f32 v114, v114, v38, v39
    v_max_f32 v114, v114, v118
    v_mov_b32 v118, v114
    s_nop 1
    v_permlane32_swap_b32 v114, v118
    v_max_f32 v114, v114, v118
    v_mov_b32 v118, v114
    s_nop 1
    v_permlane16_swap_b32 v114, v118
    v_max_f32 v114, v114, v118
    v_sub_f32 v32, v32, v114
    v_sub_f32 v33, v33, v114
    v_sub_f32 v34, v34, v114
    v_sub_f32 v35, v35, v114
    v_sub_f32 v36, v36, v114
    v_sub_f32 v37, v37, v114
    v_sub_f32 v38, v38, v114
    v_sub_f32 v39, v39, v114
    v_sub_f32 v88, 0, v114
    v_sub_f32 v89, 0, v114
    v_sub_f32 v90, 0, v114
    v_sub_f32 v91, 0, v114
    s_waitcnt lgkmcnt(0)
    s_branch L_itb3_3
L_adv3:
    s_cmp_eq_u32 s81, 0
    s_cbranch_scc1 L_fin
    s_mov_b32 s80, s81
    s_mov_b32 s81, s82
    s_mov_b32 s82, 0
    s_add_u32 s47, s47, 1
    s_mov_b32 s42, s89
    s_mov_b32 s43, s90
    s_mov_b32 s18, s90
    s_mov_b32 s34, s91
    s_mov_b32 s88, s93
    s_bfe_u32 s37, s80, 0xa000d
    s_add_u32 s36, s37, 31
    s_lshr_b32 s36, s36, 5
    s_sub_u32 s31, s36, 1
    s_lshl_b32 s39, s31, 5
    s_sub_u32 s35, s37, s39
    s_mov_b32 s46, 0
    s_mov_b32 s99, s33
    s_and_b32 s38, s81, 0x1fff
    s_bfe_u32 s39, s81, 0xa000d
    s_add_u32 s39, s38, s39
    s_lshl_b32 s90, s39, 12
    s_bfe_u32 s39, s81, 0x1001e
    s_lshl_b32 s39, s39, 8
    s_add_u32 s39, s39, s45
    s_lshl_b32 s89, s38, 12
    s_add_u32 s89, s89, s39
    s_bfe_u32 s93, s81, 0x3001b
    s_bfe_u32 s39, s81, 0x40017
    s_lshl_b32 s39, s39, 2
    s_mul_i32 s38, s87, s93
    s_add_u32 s39, s39, s38
    s_lshl_b32 s91, s39, 16
    s_add_u32 s91, s91, s89
    s_lshl_b32 s38, s87, 14
    s_sub_u32 s86, s91, s38
    s_mov_b64 s[4:5], s[64:65]
    s_mov_b32 s6, s90
    s_cmp_eq_u32 s90, 0
    s_cselect_b32 s32, 4, 4
    s_subb_u32 s31, s31, 0
    s_lshl_b32 s38, s93, 2
    s_max_u32 s38, s38, 1
    s_sub_u32 s38, s38, 1
    s_mul_i32 s100, s38, 1056
    s_add_u32 s100, s100, s99
    s_lshl_b32 s96, s38, 14
    s_add_u32 s96, s96, s86
    s_branch L_p3_3
L_p3_3:
    v_accvgpr_mov_b32 a232, a240
    v_accvgpr_mov_b32 a233, a241
    v_accvgpr_mov_b32 a234, a242
    v_accvgpr_mov_b32 a235, a243
    v_accvgpr_mov_b32 a236, a244
    v_accvgpr_mov_b32 a237, a245
    v_accvgpr_mov_b32 a238, a246
    v_accvgpr_mov_b32 a239, a247
    v_mfma_f32_16x16x32_bf16 v[48:51], a[128:131], a[0:3], 0
    v_mfma_f32_16x16x32_bf16 v[48:51], a[132:135], a[4:7], v[48:51]
    v_mfma_f32_16x16x32_bf16 v[48:51], a[136:139], a[8:11], v[48:51]
    v_mfma_f32_16x16x32_bf16 v[48:51], a[140:143], a[12:15], v[48:51]
    v_mfma_f32_16x16x32_bf16 v[52:55], a[144:147], a[0:3], 0
    v_mfma_f32_16x16x32_bf16 v[52:55], a[148:151], a[4:7], v[52:55]
    v_mfma_f32_16x16x32_bf16 v[52:55], a[152:155], a[8:11], v[52:55]
    v_mfma_f32_16x16x32_bf16 v[52:55], a[156:159], a[12:15], v[52:55]
    v_mfma_f32_16x16x32_bf16 v[56:59], a[128:131], a[16:19], 0
    v_mfma_f32_16x16x32_bf16 v[56:59], a[132:135], a[20:23], v[56:59]
    v_mfma_f32_16x16x32_bf16 v[56:59], a[136:139], a[24:27], v[56:59]
    v_mfma_f32_16x16x32_bf16 v[56:59], a[140:143], a[28:31], v[56:59]
    v_mfma_f32_16x16x32_bf16 v[60:63], a[144:147], a[16:19], 0
    v_mfma_f32_16x16x32_bf16 v[60:63], a[148:151], a[20:23], v[60:63]
    v_mfma_f32_16x16x32_bf16 v[60:63], a[152:155], a[24:27], v[60:63]
    v_mfma_f32_16x16x32_bf16 v[60:63], a[156:159], a[28:31], v[60:63]
    v_mfma_f32_16x16x32_bf16 v[64:67], a[128:131], a[32:35], 0
    v_mfma_f32_16x16x32_bf16 v[64:67], a[132:135], a[36:39], v[64:67]
    v_mfma_f32_16x16x32_bf16 v[64:67], a[136:139], a[40:43], v[64:67]
    v_mfma_f32_16x16x32_bf16 v[64:67], a[140:143], a[44:47], v[64:67]
    v_mfma_f32_16x16x32_bf16 v[68:71], a[144:147], a[32:35], 0
    v_mfma_f32_16x16x32_bf16 v[68:71], a[148:151], a[36:39], v[68:71]
    v_mfma_f32_16x16x32_bf16 v[68:71], a[152:155], a[40:43], v[68:71]
    v_mfma_f32_16x16x32_bf16 v[68:71], a[156:159], a[44:47], v[68:71]
    ds_read_b128 a[128:131], v1 offset:52224
    ds_read_b128 a[132:135], v1 offset:52288
    ds_read_b128 a[136:139], v2 offset:52224
    ds_read_b128 a[140:143], v2 offset:52288
    ds_read_b128 a[144:147], v1 offset:56448
    ds_read_b128 a[148:151], v1 offset:56512
    ds_read_b128 a[152:155], v2 offset:56448
    ds_read_b128 a[156:159], v2 offset:56512
    v_mfma_f32_32x32x16_bf16 a[208:223], v[124:127], v[124:127], 0
    v_max3_f32 v112, v48, v49, v50
    v_max3_f32 v116, v51, v52, v53
    v_max3_f32 v112, v112, v54, v55
    v_max_f32 v112, v112, v116
    v_mov_b32 v116, v112
    s_nop 1
    v_permlane32_swap_b32 v112, v116
    v_max_f32 v112, v112, v116
    v_mov_b32 v116, v112
    s_nop 1
    v_permlane16_swap_b32 v112, v116
    v_max_f32 v112, v112, v116
    v_sub_f32 v48, v48, v112
    v_sub_f32 v49, v49, v112
    v_sub_f32 v50, v50, v112
    v_sub_f32 v51, v51, v112
    v_sub_f32 v52, v52, v112
    v_sub_f32 v53, v53, v112
    v_sub_f32 v54, v54, v112
    v_sub_f32 v55, v55, v112
    v_sub_f32 v80, 0, v112
    v_sub_f32 v81, 0, v112
    v_sub_f32 v82, 0, v112
    v_sub_f32 v83, 0, v112
    v_exp_f32 v48, v48
    v_exp_f32 v49, v49
    v_exp_f32 v50, v50
    v_cvt_pk_bf16_f32 v48, v48, v49
    v_exp_f32 v51, v51
    v_exp_f32 v52, v52
    v_cvt_pk_bf16_f32 v49, v50, v51
    v_exp_f32 v53, v53
    v_exp_f32 v54, v54
    v_cvt_pk_bf16_f32 v50, v52, v53
    v_exp_f32 v55, v55
    s_nop 0
    v_cvt_pk_bf16_f32 v51, v54, v55
    v_max3_f32 v113, v56, v57, v58
    v_max3_f32 v117, v59, v60, v61
    v_max3_f32 v113, v113, v62, v63
    v_max_f32 v113, v113, v117
    v_mov_b32 v117, v113
    s_nop 1
    v_permlane32_swap_b32 v113, v117
    v_max_f32 v113, v113, v117
    v_mov_b32 v117, v113
    s_nop 1
    v_permlane16_swap_b32 v113, v117
    v_max_f32 v113, v113, v117
    v_sub_f32 v56, v56, v113
    v_sub_f32 v57, v57, v113
    v_sub_f32 v58, v58, v113
    v_sub_f32 v59, v59, v113
    v_sub_f32 v60, v60, v113
    v_sub_f32 v61, v61, v113
    v_sub_f32 v62, v62, v113
    v_sub_f32 v63, v63, v113
    v_sub_f32 v84, 0, v113
    v_sub_f32 v85, 0, v113
    v_sub_f32 v86, 0, v113
    v_sub_f32 v87, 0, v113
    v_exp_f32 v56, v56
    v_exp_f32 v57, v57
    v_exp_f32 v58, v58
    v_cvt_pk_bf16_f32 v52, v56, v57
    v_max3_f32 v114, v64, v65, v66
    v_max3_f32 v118, v67, v68, v69
    v_max3_f32 v114, v114, v70, v71
    v_max_f32 v114, v114, v118
    v_mov_b32 v118, v114
    s_nop 1
    v_permlane32_swap_b32 v114, v118
    v_max_f32 v114, v114, v118
    v_mov_b32 v118, v114
    s_nop 1
    v_permlane16_swap_b32 v114, v118
    v_max_f32 v114, v114, v118
    v_sub_f32 v64, v64, v114
    v_sub_f32 v65, v65, v114
    v_sub_f32 v66, v66, v114
    v_sub_f32 v67, v67, v114
    v_sub_f32 v68, v68, v114
    v_sub_f32 v69, v69, v114
    v_sub_f32 v70, v70, v114
    v_sub_f32 v71, v71, v114
    v_sub_f32 v88, 0, v114
    v_sub_f32 v89, 0, v114
    v_sub_f32 v90, 0, v114
    v_sub_f32 v91, 0, v114
    s_waitcnt lgkmcnt(0)
    s_branch L_itb3_0
L_fin:
    s_endpgm
L_el1_1:
    s_branch L_slow
L_el2_0:
    v_mfma_f32_16x16x32_bf16 v[180:183], a[180:183], v[52:55], v[180:183]
    v_mfma_f32_16x16x32_bf16 v[184:187], a[184:187], v[52:55], v[184:187]
    v_mfma_f32_16x16x32_bf16 v[188:191], a[188:191], v[52:55], v[188:191]
    v_mfma_f32_16x16x32_bf16 v[160:163], a[64:67], v[20:23], v[160:163]
    v_mfma_f32_16x16x32_bf16 v[164:167], a[68:71], v[20:23], v[164:167]
    v_mfma_f32_16x16x32_bf16 v[168:171], a[72:75], v[20:23], v[168:171]
    v_mfma_f32_16x16x32_bf16 v[172:175], a[76:79], v[20:23], v[172:175]
    v_mfma_f32_16x16x32_bf16 v[176:179], a[80:83], v[20:23], v[176:179]
    v_mfma_f32_16x16x32_bf16 v[180:183], a[84:87], v[20:23], v[180:183]
    v_mfma_f32_16x16x32_bf16 v[184:187], a[88:91], v[20:23], v[184:187]
    v_mfma_f32_16x16x32_bf16 v[188:191], a[92:95], v[20:23], v[188:191]
    s_branch L_slow
L_el2_1:
    v_mfma_f32_16x16x32_bf16 v[180:183], a[180:183], v[20:23], v[180:183]
    v_mfma_f32_16x16x32_bf16 v[184:187], a[184:187], v[20:23], v[184:187]
    v_mfma_f32_16x16x32_bf16 v[188:191], a[188:191], v[20:23], v[188:191]
    v_mfma_f32_16x16x32_bf16 v[160:163], a[64:67], v[52:55], v[160:163]
    v_mfma_f32_16x16x32_bf16 v[164:167], a[68:71], v[52:55], v[164:167]
    v_mfma_f32_16x16x32_bf16 v[168:171], a[72:75], v[52:55], v[168:171]
    v_mfma_f32_16x16x32_bf16 v[172:175], a[76:79], v[52:55], v[172:175]
    v_mfma_f32_16x16x32_bf16 v[176:179], a[80:83], v[52:55], v[176:179]
    v_mfma_f32_16x16x32_bf16 v[180:183], a[84:87], v[52:55], v[180:183]
    v_mfma_f32_16x16x32_bf16 v[184:187], a[88:91], v[52:55], v[184:187]
    v_mfma_f32_16x16x32_bf16 v[188:191], a[92:95], v[52:55], v[188:191]
    s_branch L_slow
L_el3_0:
    v_mfma_f32_16x16x32_bf16 v[184:187], a[184:187], v[52:55], v[184:187]
    v_mfma_f32_16x16x32_bf16 v[188:191], a[188:191], v[52:55], v[188:191]
    v_mfma_f32_16x16x32_bf16 v[160:163], a[64:67], v[20:23], v[160:163]
    v_mfma_f32_16x16x32_bf16 v[164:167], a[68:71], v[20:23], v[164:167]
    v_mfma_f32_16x16x32_bf16 v[168:171], a[72:75], v[20:23], v[168:171]
    v_mfma_f32_16x16x32_bf16 v[172:175], a[76:79], v[20:23], v[172:175]
    v_mfma_f32_16x16x32_bf16 v[176:179], a[80:83], v[20:23], v[176:179]
    v_mfma_f32_16x16x32_bf16 v[180:183], a[84:87], v[20:23], v[180:183]
    v_mfma_f32_16x16x32_bf16 v[184:187], a[88:91], v[20:23], v[184:187]
    v_mfma_f32_16x16x32_bf16 v[188:191], a[92:95], v[20:23], v[188:191]
    v_mfma_f32_16x16x32_bf16 v[192:195], a[160:163], v[64:67], v[192:195]
    v_mfma_f32_16x16x32_bf16 v[196:199], a[164:167], v[64:67], v[196:199]
    v_mfma_f32_16x16x32_bf16 v[200:203], a[168:171], v[64:67], v[200:203]
    v_mfma_f32_16x16x32_bf16 v[204:207], a[172:175], v[64:67], v[204:207]
    v_mfma_f32_16x16x32_bf16 v[208:211], a[176:179], v[64:67], v[208:211]
    v_mfma_f32_16x16x32_bf16 v[212:215], a[180:183], v[64:67], v[212:215]
    v_mfma_f32_16x16x32_bf16 v[216:219], a[184:187], v[64:67], v[216:219]
    v_mfma_f32_16x16x32_bf16 v[220:223], a[188:191], v[64:67], v[220:223]
    v_mfma_f32_16x16x32_bf16 v[192:195], a[64:67], v[32:35], v[192:195]
    v_mfma_f32_16x16x32_bf16 v[196:199], a[68:71], v[32:35], v[196:199]
    v_mfma_f32_16x16x32_bf16 v[200:203], a[72:75], v[32:35], v[200:203]
    v_mfma_f32_16x16x32_bf16 v[204:207], a[76:79], v[32:35], v[204:207]
    v_mfma_f32_16x16x32_bf16 v[208:211], a[80:83], v[32:35], v[208:211]
    v_mfma_f32_16x16x32_bf16 v[212:215], a[84:87], v[32:35], v[212:215]
    v_mfma_f32_16x16x32_bf16 v[216:219], a[88:91], v[32:35], v[216:219]
    v_mfma_f32_16x16x32_bf16 v[220:223], a[92:95], v[32:35], v[220:223]
    s_branch L_slow
L_el3_1:
    v_mfma_f32_16x16x32_bf16 v[184:187], a[184:187], v[20:23], v[184:187]
    v_mfma_f32_16x16x32_bf16 v[188:191], a[188:191], v[20:23], v[188:191]
    v_mfma_f32_16x16x32_bf16 v[160:163], a[64:67], v[52:55], v[160:163]
    v_mfma_f32_16x16x32_bf16 v[164:167], a[68:71], v[52:55], v[164:167]
    v_mfma_f32_16x16x32_bf16 v[168:171], a[72:75], v[52:55], v[168:171]
    v_mfma_f32_16x16x32_bf16 v[172:175], a[76:79], v[52:55], v[172:175]
    v_mfma_f32_16x16x32_bf16 v[176:179], a[80:83], v[52:55], v[176:179]
    v_mfma_f32_16x16x32_bf16 v[180:183], a[84:87], v[52:55], v[180:183]
    v_mfma_f32_16x16x32_bf16 v[184:187], a[88:91], v[52:55], v[184:187]
    v_mfma_f32_16x16x32_bf16 v[188:191], a[92:95], v[52:55], v[188:191]
    v_mfma_f32_16x16x32_bf16 v[192:195], a[160:163], v[32:35], v[192:195]
    v_mfma_f32_16x16x32_bf16 v[196:199], a[164:167], v[32:35], v[196:199]
    v_mfma_f32_16x16x32_bf16 v[200:203], a[168:171], v[32:35], v[200:203]
    v_mfma_f32_16x16x32_bf16 v[204:207], a[172:175], v[32:35], v[204:207]
    v_mfma_f32_16x16x32_bf16 v[208:211], a[176:179], v[32:35], v[208:211]
    v_mfma_f32_16x16x32_bf16 v[212:215], a[180:183], v[32:35], v[212:215]
    v_mfma_f32_16x16x32_bf16 v[216:219], a[184:187], v[32:35], v[216:219]
    v_mfma_f32_16x16x32_bf16 v[220:223], a[188:191], v[32:35], v[220:223]
    v_mfma_f32_16x16x32_bf16 v[192:195], a[64:67], v[64:67], v[192:195]
    v_mfma_f32_16x16x32_bf16 v[196:199], a[68:71], v[64:67], v[196:199]
    v_mfma_f32_16x16x32_bf16 v[200:203], a[72:75], v[64:67], v[200:203]
    v_mfma_f32_16x16x32_bf16 v[204:207], a[76:79], v[64:67], v[204:207]
    v_mfma_f32_16x16x32_bf16 v[208:211], a[80:83], v[64:67], v[208:211]
    v_mfma_f32_16x16x32_bf16 v[212:215], a[84:87], v[64:67], v[212:215]
    v_mfma_f32_16x16x32_bf16 v[216:219], a[88:91], v[64:67], v[216:219]
    v_mfma_f32_16x16x32_bf16 v[220:223], a[92:95], v[64:67], v[220:223]
    s_branch L_slow
L_el4_0:
    v_mfma_f32_16x16x32_bf16 v[180:183], a[180:183], v[52:55], v[180:183]
    v_mfma_f32_16x16x32_bf16 v[184:187], a[184:187], v[52:55], v[184:187]
    v_mfma_f32_16x16x32_bf16 v[188:191], a[188:191], v[52:55], v[188:191]
    v_mfma_f32_16x16x32_bf16 v[160:163], a[64:67], v[20:23], v[160:163]
    v_mfma_f32_16x16x32_bf16 v[164:167], a[68:71], v[20:23], v[164:167]
    v_mfma_f32_16x16x32_bf16 v[168:171], a[72:75], v[20:23], v[168:171]
    v_mfma_f32_16x16x32_bf16 v[172:175], a[76:79], v[20:23], v[172:175]
    v_mfma_f32_16x16x32_bf16 v[176:179], a[80:83], v[20:23], v[176:179]
    v_mfma_f32_16x16x32_bf16 v[180:183], a[84:87], v[20:23], v[180:183]
    v_mfma_f32_16x16x32_bf16 v[184:187], a[88:91], v[20:23], v[184:187]
    v_mfma_f32_16x16x32_bf16 v[188:191], a[92:95], v[20:23], v[188:191]
    v_mfma_f32_16x16x32_bf16 v[192:195], a[160:163], v[64:67], v[192:195]
    v_mfma_f32_16x16x32_bf16 v[196:199], a[164:167], v[64:67], v[196:199]
    v_mfma_f32_16x16x32_bf16 v[200:203], a[168:171], v[64:67], v[200:203]
    v_mfma_f32_16x16x32_bf16 v[204:207], a[172:175], v[64:67], v[204:207]
    v_mfma_f32_16x16x32_bf16 v[208:211], a[176:179], v[64:67], v[208:211]
    v_mfma_f32_16x16x32_bf16 v[212:215], a[180:183], v[64:67], v[212:215]
    v_mfma_f32_16x16x32_bf16 v[216:219], a[184:187], v[64:67], v[216:219]
    v_mfma_f32_16x16x32_bf16 v[220:223], a[188:191], v[64:67], v[220:223]
    v_mfma_f32_16x16x32_bf16 v[192:195], a[64:67], v[32:35], v[192:195]
    v_mfma_f32_16x16x32_bf16 v[196:199], a[68:71], v[32:35], v[196:199]
    v_mfma_f32_16x16x32_bf16 v[200:203], a[72:75], v[32:35], v[200:203]
    v_mfma_f32_16x16x32_bf16 v[204:207], a[76:79], v[32:35], v[204:207]
    v_mfma_f32_16x16x32_bf16 v[208:211], a[80:83], v[32:35], v[208:211]
    v_mfma_f32_16x16x32_bf16 v[212:215], a[84:87], v[32:35], v[212:215]
    v_mfma_f32_16x16x32_bf16 v[216:219], a[88:91], v[32:35], v[216:219]
    v_mfma_f32_16x16x32_bf16 v[220:223], a[92:95], v[32:35], v[220:223]
    v_mfma_f32_16x16x32_bf16 v[224:227], a[160:163], v[68:71], v[224:227]
    v_mfma_f32_16x16x32_bf16 v[228:231], a[164:167], v[68:71], v[228:231]
    v_mfma_f32_16x16x32_bf16 v[232:235], a[168:171], v[68:71], v[232:235]
    v_mfma_f32_16x16x32_bf16 v[236:239], a[172:175], v[68:71], v[236:239]
    v_mfma_f32_16x16x32_bf16 v[240:243], a[176:179], v[68:71], v[240:243]
    v_mfma_f32_16x16x32_bf16 v[244:247], a[180:183], v[68:71], v[244:247]
    v_mfma_f32_16x16x32_bf16 v[248:251], a[184:187], v[68:71], v[248:251]
    v_mfma_f32_16x16x32_bf16 v[252:255], a[188:191], v[68:71], v[252:255]
    v_mfma_f32_16x16x32_bf16 v[224:227], a[64:67], v[36:39], v[224:227]
    v_mfma_f32_16x16x32_bf16 v[228:231], a[68:71], v[36:39], v[228:231]
    v_mfma_f32_16x16x32_bf16 v[232:235], a[72:75], v[36:39], v[232:235]
    v_mfma_f32_16x16x32_bf16 v[236:239], a[76:79], v[36:39], v[236:239]
    v_mfma_f32_16x16x32_bf16 v[240:243], a[80:83], v[36:39], v[240:243]
    v_mfma_f32_16x16x32_bf16 v[244:247], a[84:87], v[36:39], v[244:247]
    v_mfma_f32_16x16x32_bf16 v[248:251], a[88:91], v[36:39], v[248:251]
    v_mfma_f32_16x16x32_bf16 v[252:255], a[92:95], v[36:39], v[252:255]
    s_branch L_slow
L_el4_1:
    v_mfma_f32_16x16x32_bf16 v[180:183], a[180:183], v[20:23], v[180:183]
    v_mfma_f32_16x16x32_bf16 v[184:187], a[184:187], v[20:23], v[184:187]
    v_mfma_f32_16x16x32_bf16 v[188:191], a[188:191], v[20:23], v[188:191]
    v_mfma_f32_16x16x32_bf16 v[160:163], a[64:67], v[52:55], v[160:163]
    v_mfma_f32_16x16x32_bf16 v[164:167], a[68:71], v[52:55], v[164:167]
    v_mfma_f32_16x16x32_bf16 v[168:171], a[72:75], v[52:55], v[168:171]
    v_mfma_f32_16x16x32_bf16 v[172:175], a[76:79], v[52:55], v[172:175]
    v_mfma_f32_16x16x32_bf16 v[176:179], a[80:83], v[52:55], v[176:179]
    v_mfma_f32_16x16x32_bf16 v[180:183], a[84:87], v[52:55], v[180:183]
    v_mfma_f32_16x16x32_bf16 v[184:187], a[88:91], v[52:55], v[184:187]
    v_mfma_f32_16x16x32_bf16 v[188:191], a[92:95], v[52:55], v[188:191]
    v_mfma_f32_16x16x32_bf16 v[192:195], a[160:163], v[32:35], v[192:195]
    v_mfma_f32_16x16x32_bf16 v[196:199], a[164:167], v[32:35], v[196:199]
    v_mfma_f32_16x16x32_bf16 v[200:203], a[168:171], v[32:35], v[200:203]
    v_mfma_f32_16x16x32_bf16 v[204:207], a[172:175], v[32:35], v[204:207]
    v_mfma_f32_16x16x32_bf16 v[208:211], a[176:179], v[32:35], v[208:211]
    v_mfma_f32_16x16x32_bf16 v[212:215], a[180:183], v[32:35], v[212:215]
    v_mfma_f32_16x16x32_bf16 v[216:219], a[184:187], v[32:35], v[216:219]
    v_mfma_f32_16x16x32_bf16 v[220:223], a[188:191], v[32:35], v[220:223]
    v_mfma_f32_16x16x32_bf16 v[192:195], a[64:67], v[64:67], v[192:195]
    v_mfma_f32_16x16x32_bf16 v[196:199], a[68:71], v[64:67], v[196:199]
    v_mfma_f32_16x16x32_bf16 v[200:203], a[72:75], v[64:67], v[200:203]
    v_mfma_f32_16x16x32_bf16 v[204:207], a[76:79], v[64:67], v[204:207]
    v_mfma_f32_16x16x32_bf16 v[208:211], a[80:83], v[64:67], v[208:211]
    v_mfma_f32_16x16x32_bf16 v[212:215], a[84:87], v[64:67], v[212:215]
    v_mfma_f32_16x16x32_bf16 v[216:219], a[88:91], v[64:67], v[216:219]
    v_mfma_f32_16x16x32_bf16 v[220:223], a[92:95], v[64:67], v[220:223]
    v_mfma_f32_16x16x32_bf16 v[224:227], a[160:163], v[36:39], v[224:227]
    v_mfma_f32_16x16x32_bf16 v[228:231], a[164:167], v[36:39], v[228:231]
    v_mfma_f32_16x16x32_bf16 v[232:235], a[168:171], v[36:39], v[232:235]
    v_mfma_f32_16x16x32_bf16 v[236:239], a[172:175], v[36:39], v[236:239]
    v_mfma_f32_16x16x32_bf16 v[240:243], a[176:179], v[36:39], v[240:243]
    v_mfma_f32_16x16x32_bf16 v[244:247], a[180:183], v[36:39], v[244:247]
    v_mfma_f32_16x16x32_bf16 v[248:251], a[184:187], v[36:39], v[248:251]
    v_mfma_f32_16x16x32_bf16 v[252:255], a[188:191], v[36:39], v[252:255]
    v_mfma_f32_16x16x32_bf16 v[224:227], a[64:67], v[68:71], v[224:227]
    v_mfma_f32_16x16x32_bf16 v[228:231], a[68:71], v[68:71], v[228:231]
    v_mfma_f32_16x16x32_bf16 v[232:235], a[72:75], v[68:71], v[232:235]
    v_mfma_f32_16x16x32_bf16 v[236:239], a[76:79], v[68:71], v[236:239]
    v_mfma_f32_16x16x32_bf16 v[240:243], a[80:83], v[68:71], v[240:243]
    v_mfma_f32_16x16x32_bf16 v[244:247], a[84:87], v[68:71], v[244:247]
    v_mfma_f32_16x16x32_bf16 v[248:251], a[88:91], v[68:71], v[248:251]
    v_mfma_f32_16x16x32_bf16 v[252:255], a[92:95], v[68:71], v[252:255]
    s_branch L_slow
L_es2_0:
    v_mfma_f32_16x16x32_bf16 v[160:163], a[160:163], v[52:55], v[160:163]
    v_mfma_f32_16x16x32_bf16 v[164:167], a[164:167], v[52:55], v[164:167]
    v_mfma_f32_16x16x32_bf16 v[168:171], a[168:171], v[52:55], v[168:171]
    v_mfma_f32_16x16x32_bf16 v[172:175], a[172:175], v[52:55], v[172:175]
    v_mfma_f32_16x16x32_bf16 v[176:179], a[176:179], v[52:55], v[176:179]
    v_mfma_f32_16x16x32_bf16 v[180:183], a[180:183], v[52:55], v[180:183]
    v_mfma_f32_16x16x32_bf16 v[184:187], a[184:187], v[52:55], v[184:187]
    v_mfma_f32_16x16x32_bf16 v[188:191], a[188:191], v[52:55], v[188:191]
    s_branch L_slow
L_es3_0:
    v_mfma_f32_16x16x32_bf16 v[160:163], a[160:163], v[52:55], v[160:163]
    v_mfma_f32_16x16x32_bf16 v[164:167], a[164:167], v[52:55], v[164:167]
    v_mfma_f32_16x16x32_bf16 v[168:171], a[168:171], v[52:55], v[168:171]
    v_mfma_f32_16x16x32_bf16 v[172:175], a[172:175], v[52:55], v[172:175]
    v_mfma_f32_16x16x32_bf16 v[176:179], a[176:179], v[52:55], v[176:179]
    v_mfma_f32_16x16x32_bf16 v[180:183], a[180:183], v[52:55], v[180:183]
    v_mfma_f32_16x16x32_bf16 v[184:187], a[184:187], v[52:55], v[184:187]
    v_mfma_f32_16x16x32_bf16 v[188:191], a[188:191], v[52:55], v[188:191]
    v_mfma_f32_16x16x32_bf16 v[192:195], a[160:163], v[64:67], v[192:195]
    v_mfma_f32_16x16x32_bf16 v[196:199], a[164:167], v[64:67], v[196:199]
    v_mfma_f32_16x16x32_bf16 v[200:203], a[168:171], v[64:67], v[200:203]
    v_mfma_f32_16x16x32_bf16 v[204:207], a[172:175], v[64:67], v[204:207]
    v_mfma_f32_16x16x32_bf16 v[208:211], a[176:179], v[64:67], v[208:211]
    v_mfma_f32_16x16x32_bf16 v[212:215], a[180:183], v[64:67], v[212:215]
    v_mfma_f32_16x16x32_bf16 v[216:219], a[184:187], v[64:67], v[216:219]
    v_mfma_f32_16x16x32_bf16 v[220:223], a[188:191], v[64:67], v[220:223]
    s_branch L_slow
L_es4_0:
    v_mfma_f32_16x16x32_bf16 v[160:163], a[160:163], v[52:55], v[160:163]
    v_mfma_f32_16x16x32_bf16 v[164:167], a[164:167], v[52:55], v[164:167]
    v_mfma_f32_16x16x32_bf16 v[168:171], a[168:171], v[52:55], v[168:171]
    v_mfma_f32_16x16x32_bf16 v[172:175], a[172:175], v[52:55], v[172:175]
    v_mfma_f32_16x16x32_bf16 v[176:179], a[176:179], v[52:55], v[176:179]
    v_mfma_f32_16x16x32_bf16 v[180:183], a[180:183], v[52:55], v[180:183]
    v_mfma_f32_16x16x32_bf16 v[184:187], a[184:187], v[52:55], v[184:187]
    v_mfma_f32_16x16x32_bf16 v[188:191], a[188:191], v[52:55], v[188:191]
    v_mfma_f32_16x16x32_bf16 v[192:195], a[160:163], v[64:67], v[192:195]
    v_mfma_f32_16x16x32_bf16 v[196:199], a[164:167], v[64:67], v[196:199]
    v_mfma_f32_16x16x32_bf16 v[200:203], a[168:171], v[64:67], v[200:203]
    v_mfma_f32_16x16x32_bf16 v[204:207], a[172:175], v[64:67], v[204:207]
    v_mfma_f32_16x16x32_bf16 v[208:211], a[176:179], v[64:67], v[208:211]
    v_mfma_f32_16x16x32_bf16 v[212:215], a[180:183], v[64:67], v[212:215]
    v_mfma_f32_16x16x32_bf16 v[216:219], a[184:187], v[64:67], v[216:219]
    v_mfma_f32_16x16x32_bf16 v[220:223], a[188:191], v[64:67], v[220:223]
    v_mfma_f32_16x16x32_bf16 v[224:227], a[160:163], v[68:71], v[224:227]
    v_mfma_f32_16x16x32_bf16 v[228:231], a[164:167], v[68:71], v[228:231]
    v_mfma_f32_16x16x32_bf16 v[232:235], a[168:171], v[68:71], v[232:235]
    v_mfma_f32_16x16x32_bf16 v[236:239], a[172:175], v[68:71], v[236:239]
    v_mfma_f32_16x16x32_bf16 v[240:243], a[176:179], v[68:71], v[240:243]
    v_mfma_f32_16x16x32_bf16 v[244:247], a[180:183], v[68:71], v[244:247]
    v_mfma_f32_16x16x32_bf16 v[248:251], a[184:187], v[68:71], v[248:251]
    v_mfma_f32_16x16x32_bf16 v[252:255], a[188:191], v[68:71], v[252:255]
    s_branch L_slow
L_es1_1:
    s_branch L_slow
L_es2_1:
    v_mfma_f32_16x16x32_bf16 v[160:163], a[160:163], v[20:23], v[160:163]
    v_mfma_f32_16x16x32_bf16 v[164:167], a[164:167], v[20:23], v[164:167]
    v_mfma_f32_16x16x32_bf16 v[168:171], a[168:171], v[20:23], v[168:171]
    v_mfma_f32_16x16x32_bf16 v[172:175], a[172:175], v[20:23], v[172:175]
    v_mfma_f32_16x16x32_bf16 v[176:179], a[176:179], v[20:23], v[176:179]
    v_mfma_f32_16x16x32_bf16 v[180:183], a[180:183], v[20:23], v[180:183]
    v_mfma_f32_16x16x32_bf16 v[184:187], a[184:187], v[20:23], v[184:187]
    v_mfma_f32_16x16x32_bf16 v[188:191], a[188:191], v[20:23], v[188:191]
    s_branch L_slow
L_es3_1:
    v_mfma_f32_16x16x32_bf16 v[160:163], a[160:163], v[20:23], v[160:163]
    v_mfma_f32_16x16x32_bf16 v[164:167], a[164:167], v[20:23], v[164:167]
    v_mfma_f32_16x16x32_bf16 v[168:171], a[168:171], v[20:23], v[168:171]
    v_mfma_f32_16x16x32_bf16 v[172:175], a[172:175], v[20:23], v[172:175]
    v_mfma_f32_16x16x32_bf16 v[176:179], a[176:179], v[20:23], v[176:179]
    v_mfma_f32_16x16x32_bf16 v[180:183], a[180:183], v[20:23], v[180:183]
    v_mfma_f32_16x16x32_bf16 v[184:187], a[184:187], v[20:23], v[184:187]
    v_mfma_f32_16x16x32_bf16 v[188:191], a[188:191], v[20:23], v[188:191]
    v_mfma_f32_16x16x32_bf16 v[192:195], a[160:163], v[32:35], v[192:195]
    v_mfma_f32_16x16x32_bf16 v[196:199], a[164:167], v[32:35], v[196:199]
    v_mfma_f32_16x16x32_bf16 v[200:203], a[168:171], v[32:35], v[200:203]
    v_mfma_f32_16x16x32_bf16 v[204:207], a[172:175], v[32:35], v[204:207]
    v_mfma_f32_16x16x32_bf16 v[208:211], a[176:179], v[32:35], v[208:211]
    v_mfma_f32_16x16x32_bf16 v[212:215], a[180:183], v[32:35], v[212:215]
    v_mfma_f32_16x16x32_bf16 v[216:219], a[184:187], v[32:35], v[216:219]
    v_mfma_f32_16x16x32_bf16 v[220:223], a[188:191], v[32:35], v[220:223]
    s_branch L_slow
L_es4_1:
    v_mfma_f32_16x16x32_bf16 v[160:163], a[160:163], v[20:23], v[160:163]
    v_mfma_f32_16x16x32_bf16 v[164:167], a[164:167], v[20:23], v[164:167]
    v_mfma_f32_16x16x32_bf16 v[168:171], a[168:171], v[20:23], v[168:171]
    v_mfma_f32_16x16x32_bf16 v[172:175], a[172:175], v[20:23], v[172:175]
    v_mfma_f32_16x16x32_bf16 v[176:179], a[176:179], v[20:23], v[176:179]
    v_mfma_f32_16x16x32_bf16 v[180:183], a[180:183], v[20:23], v[180:183]
    v_mfma_f32_16x16x32_bf16 v[184:187], a[184:187], v[20:23], v[184:187]
    v_mfma_f32_16x16x32_bf16 v[188:191], a[188:191], v[20:23], v[188:191]
    v_mfma_f32_16x16x32_bf16 v[192:195], a[160:163], v[32:35], v[192:195]
    v_mfma_f32_16x16x32_bf16 v[196:199], a[164:167], v[32:35], v[196:199]
    v_mfma_f32_16x16x32_bf16 v[200:203], a[168:171], v[32:35], v[200:203]
    v_mfma_f32_16x16x32_bf16 v[204:207], a[172:175], v[32:35], v[204:207]
    v_mfma_f32_16x16x32_bf16 v[208:211], a[176:179], v[32:35], v[208:211]
    v_mfma_f32_16x16x32_bf16 v[212:215], a[180:183], v[32:35], v[212:215]
    v_mfma_f32_16x16x32_bf16 v[216:219], a[184:187], v[32:35], v[216:219]
    v_mfma_f32_16x16x32_bf16 v[220:223], a[188:191], v[32:35], v[220:223]
    v_mfma_f32_16x16x32_bf16 v[224:227], a[160:163], v[36:39], v[224:227]
    v_mfma_f32_16x16x32_bf16 v[228:231], a[164:167], v[36:39], v[228:231]
    v_mfma_f32_16x16x32_bf16 v[232:235], a[168:171], v[36:39], v[232:235]
    v_mfma_f32_16x16x32_bf16 v[236:239], a[172:175], v[36:39], v[236:239]
    v_mfma_f32_16x16x32_bf16 v[240:243], a[176:179], v[36:39], v[240:243]
    v_mfma_f32_16x16x32_bf16 v[244:247], a[180:183], v[36:39], v[244:247]
    v_mfma_f32_16x16x32_bf16 v[248:251], a[184:187], v[36:39], v[248:251]
    v_mfma_f32_16x16x32_bf16 v[252:255], a[188:191], v[36:39], v[252:255]
    s_branch L_slow
L_slow:
    s_waitcnt vmcnt(8) lgkmcnt(0)
    s_nop 7
    v_mul_f32 v128, v120, v128
    v_mul_f32 v129, v120, v129
    v_mul_f32 v130, v120, v130
    v_mul_f32 v131, v120, v131
    v_mul_f32 v132, v120, v132
    v_mul_f32 v133, v120, v133
    v_mul_f32 v134, v120, v134
    v_mul_f32 v135, v120, v135
    v_cvt_pk_bf16_f32 v128, v128, v129
    v_cvt_pk_bf16_f32 v129, v130, v131
    v_mul_f32 v136, v120, v136
    v_mul_f32 v137, v120, v137
    v_mul_f32 v138, v120, v138
    v_mul_f32 v139, v120, v139
    v_cvt_pk_bf16_f32 v132, v132, v133
    v_cvt_pk_bf16_f32 v133, v134, v135
    ds_write_b64 v11, v[128:129] offset:0
    v_mul_f32 v140, v120, v140
    v_mul_f32 v141, v120, v141
    v_mul_f32 v142, v120, v142
    v_mul_f32 v143, v120, v143
    v_cvt_pk_bf16_f32 v136, v136, v137
    v_cvt_pk_bf16_f32 v137, v138, v139
    ds_write_b64 v11, v[132:133] offset:32
    v_mul_f32 v144, v120, v144
    v_mul_f32 v145, v120, v145
    v_mul_f32 v146, v120, v146
    v_mul_f32 v147, v120, v147
    v_cvt_pk_bf16_f32 v140, v140, v141
    v_cvt_pk_bf16_f32 v141, v142, v143
    ds_write_b64 v11, v[136:137] offset:64
    v_mul_f32 v148, v120, v148
    v_mul_f32 v149, v120, v149
    v_mul_f32 v150, v120, v150
    v_mul_f32 v151, v120, v151
    v_cvt_pk_bf16_f32 v144, v144, v145
    v_cvt_pk_bf16_f32 v145, v146, v147
    ds_write_b64 v11, v[140:141] offset:96
    v_mul_f32 v152, v120, v152
    v_mul_f32 v153, v120, v153
    v_mul_f32 v154, v120, v154
    v_mul_f32 v155, v120, v155
    v_cvt_pk_bf16_f32 v148, v148, v149
    v_cvt_pk_bf16_f32 v149, v150, v151
    ds_write_b64 v11, v[144:145] offset:128
    v_mul_f32 v156, v120, v156
    v_mul_f32 v157, v120, v157
    v_mul_f32 v158, v120, v158
    v_mul_f32 v159, v120, v159
    v_cvt_pk_bf16_f32 v152, v152, v153
    v_cvt_pk_bf16_f32 v153, v154, v155
    ds_write_b64 v11, v[148:149] offset:160
    v_cvt_pk_bf16_f32 v156, v156, v157
    v_cvt_pk_bf16_f32 v157, v158, v159
    ds_write_b64 v11, v[152:153] offset:192
    ds_write_b64 v11, v[156:157] offset:224
    v_mul_f32 v160, v121, v160
    v_mul_f32 v161, v121, v161
    v_mul_f32 v162, v121, v162
    v_mul_f32 v163, v121, v163
    v_mul_f32 v164, v121, v164
    v_mul_f32 v165, v121, v165
    v_mul_f32 v166, v121, v166
    v_mul_f32 v167, v121, v167
    v_cvt_pk_bf16_f32 v160, v160, v161
    v_cvt_pk_bf16_f32 v161, v162, v163
    v_mul_f32 v168, v121, v168
    v_mul_f32 v169, v121, v169
    v_mul_f32 v170, v121, v170
    v_mul_f32 v171, v121, v171
    v_cvt_pk_bf16_f32 v164, v164, v165
    v_cvt_pk_bf16_f32 v165, v166, v167
    ds_write_b64 v11, v[160:161] offset:4352
    v_mul_f32 v172, v121, v172
    v_mul_f32 v173, v121, v173
    v_mul_f32 v174, v121, v174
    v_mul_f32 v175, v121, v175
    v_cvt_pk_bf16_f32 v168, v168, v169
    v_cvt_pk_bf16_f32 v169, v170, v171
    ds_write_b64 v11, v[164:165] offset:4384
    v_mul_f32 v176, v121, v176
    v_mul_f32 v177, v121, v177
    v_mul_f32 v178, v121, v178
    v_mul_f32 v179, v121, v179
    v_cvt_pk_bf16_f32 v172, v172, v173
    v_cvt_pk_bf16_f32 v173, v174, v175
    ds_write_b64 v11, v[168:169] offset:4416
    v_mul_f32 v180, v121, v180
    v_mul_f32 v181, v121, v181
    v_mul_f32 v182, v121, v182
    v_mul_f32 v183, v121, v183
    v_cvt_pk_bf16_f32 v176, v176, v177
    v_cvt_pk_bf16_f32 v177, v178, v179
    ds_write_b64 v11, v[172:173] offset:4448
    v_mul_f32 v184, v121, v184
    v_mul_f32 v185, v121, v185
    v_mul_f32 v186, v121, v186
    v_mul_f32 v187, v121, v187
    v_cvt_pk_bf16_f32 v180, v180, v181
    v_cvt_pk_bf16_f32 v181, v182, v183
    ds_write_b64 v11, v[176:177] offset:4480
    v_mul_f32 v188, v121, v188
    v_mul_f32 v189, v121, v189
    v_mul_f32 v190, v121, v190
    v_mul_f32 v191, v121, v191
    v_cvt_pk_bf16_f32 v184, v184, v185
    v_cvt_pk_bf16_f32 v185, v186, v187
    ds_write_b64 v11, v[180:181] offset:4512
    v_cvt_pk_bf16_f32 v188, v188, v189
    v_cvt_pk_bf16_f32 v189, v190, v191
    ds_write_b64 v11, v[184:185] offset:4544
    ds_write_b64 v11, v[188:189] offset:4576
    v_mul_f32 v192, v122, v192
    v_mul_f32 v193, v122, v193
    v_mul_f32 v194, v122, v194
    v_mul_f32 v195, v122, v195
    v_mul_f32 v196, v122, v196
    v_mul_f32 v197, v122, v197
    v_mul_f32 v198, v122, v198
    v_mul_f32 v199, v122, v199
    v_cvt_pk_bf16_f32 v192, v192, v193
    v_cvt_pk_bf16_f32 v193, v194, v195
    v_mul_f32 v200, v122, v200
    v_mul_f32 v201, v122, v201
    v_mul_f32 v202, v122, v202
    v_mul_f32 v203, v122, v203
    v_cvt_pk_bf16_f32 v196, v196, v197
    v_cvt_pk_bf16_f32 v197, v198, v199
    ds_write_b64 v11, v[192:193] offset:8704
    v_mul_f32 v204, v122, v204
    v_mul_f32 v205, v122, v205
    v_mul_f32 v206, v122, v206
    v_mul_f32 v207, v122, v207
    v_cvt_pk_bf16_f32 v200, v200, v201
    v_cvt_pk_bf16_f32 v201, v202, v203
    ds_write_b64 v11, v[196:197] offset:8736
    v_mul_f32 v208, v122, v208
    v_mul_f32 v209, v122, v209
    v_mul_f32 v210, v122, v210
    v_mul_f32 v211, v122, v211
    v_cvt_pk_bf16_f32 v204, v204, v205
    v_cvt_pk_bf16_f32 v205, v206, v207
    ds_write_b64 v11, v[200:201] offset:8768
    v_mul_f32 v212, v122, v212
    v_mul_f32 v213, v122, v213
    v_mul_f32 v214, v122, v214
    v_mul_f32 v215, v122, v215
    v_cvt_pk_bf16_f32 v208, v208, v209
    v_cvt_pk_bf16_f32 v209, v210, v211
    ds_write_b64 v11, v[204:205] offset:8800
    v_mul_f32 v216, v122, v216
    v_mul_f32 v217, v122, v217
    v_mul_f32 v218, v122, v218
    v_mul_f32 v219, v122, v219
    v_cvt_pk_bf16_f32 v212, v212, v213
    v_cvt_pk_bf16_f32 v213, v214, v215
    ds_write_b64 v11, v[208:209] offset:8832
    v_mul_f32 v220, v122, v220
    v_mul_f32 v221, v122, v221
    v_mul_f32 v222, v122, v222
    v_mul_f32 v223, v122, v223
    v_cvt_pk_bf16_f32 v216, v216, v217
    v_cvt_pk_bf16_f32 v217, v218, v219
    ds_write_b64 v11, v[212:213] offset:8864
    v_cvt_pk_bf16_f32 v220, v220, v221
    v_cvt_pk_bf16_f32 v221, v222, v223
    ds_write_b64 v11, v[216:217] offset:8896
    ds_write_b64 v11, v[220:221] offset:8928
    v_mul_f32 v224, v123, v224
    v_mul_f32 v225, v123, v225
    v_mul_f32 v226, v123, v226
    v_mul_f32 v227, v123, v227
    v_mul_f32 v228, v123, v228
    v_mul_f32 v229, v123, v229
    v_mul_f32 v230, v123, v230
    v_mul_f32 v231, v123, v231
    v_cvt_pk_bf16_f32 v224, v224, v225
    v_cvt_pk_bf16_f32 v225, v226, v227
    v_mul_f32 v232, v123, v232
    v_mul_f32 v233, v123, v233
    v_mul_f32 v234, v123, v234
    v_mul_f32 v235, v123, v235
    v_cvt_pk_bf16_f32 v228, v228, v229
    v_cvt_pk_bf16_f32 v229, v230, v231
    ds_write_b64 v11, v[224:225] offset:13056
    v_mul_f32 v236, v123, v236
    v_mul_f32 v237, v123, v237
    v_mul_f32 v238, v123, v238
    v_mul_f32 v239, v123, v239
    v_cvt_pk_bf16_f32 v232, v232, v233
    v_cvt_pk_bf16_f32 v233, v234, v235
    ds_write_b64 v11, v[228:229] offset:13088
    v_mul_f32 v240, v123, v240
    v_mul_f32 v241, v123, v241
    v_mul_f32 v242, v123, v242
    v_mul_f32 v243, v123, v243
    v_cvt_pk_bf16_f32 v236, v236, v237
    v_cvt_pk_bf16_f32 v237, v238, v239
    ds_write_b64 v11, v[232:233] offset:13120
    v_mul_f32 v244, v123, v244
    v_mul_f32 v245, v123, v245
    v_mul_f32 v246, v123, v246
    v_mul_f32 v247, v123, v247
    v_cvt_pk_bf16_f32 v240, v240, v241
    v_cvt_pk_bf16_f32 v241, v242, v243
    ds_write_b64 v11, v[236:237] offset:13152
    v_mul_f32 v248, v123, v248
    v_mul_f32 v249, v123, v249
    v_mul_f32 v250, v123, v250
    v_mul_f32 v251, v123, v251
    v_cvt_pk_bf16_f32 v244, v244, v245
    v_cvt_pk_bf16_f32 v245, v246, v247
    ds_write_b64 v11, v[240:241] offset:13184
    v_mul_f32 v252, v123, v252
    v_mul_f32 v253, v123, v253
    v_mul_f32 v254, v123, v254
    v_mul_f32 v255, v123, v255
    v_cvt_pk_bf16_f32 v248, v248, v249
    v_cvt_pk_bf16_f32 v249, v250, v251
    ds_write_b64 v11, v[244:245] offset:13216
    v_cvt_pk_bf16_f32 v252, v252, v253
    v_cvt_pk_bf16_f32 v253, v254, v255
    ds_write_b64 v11, v[248:249] offset:13248
    ds_write_b64 v11, v[252:253] offset:13280
    s_cmp_eq_u32 s46, 0
    s_cbranch_scc0 L_sstore
    s_mov_b64 s[84:85], 0
    ds_read_b128 v[16:19], v12 offset:0
    ds_read_b128 v[20:23], v12 offset:1088
    ds_read_b128 v[24:27], v12 offset:2176
    ds_read_b128 v[28:31], v12 offset:3264
    v_cmp_ngt_f32 vcc, 0x71800000, v112
    v_mov_b32 v116, 0
    s_nop 0
    s_or_b64 s[84:85], s[84:85], vcc
    s_waitcnt lgkmcnt(0)
    v_pk_maximum3_f16 v116, v116, v16, v17
    v_pk_maximum3_f16 v116, v116, v18, v19
    v_pk_maximum3_f16 v116, v116, v20, v21
    v_pk_maximum3_f16 v116, v116, v22, v23
    v_pk_maximum3_f16 v116, v116, v24, v25
    v_pk_maximum3_f16 v116, v116, v26, v27
    v_pk_maximum3_f16 v116, v116, v28, v29
    v_pk_maximum3_f16 v116, v116, v30, v31
    v_and_b32 v117, 0x7c00, v116
    v_and_b32 v118, 0x7c000000, v116
    v_cmp_eq_u32 vcc, 0x7c00, v117
    s_nop 1
    s_or_b64 s[84:85], s[84:85], vcc
    v_cmp_eq_u32 vcc, 0x7c000000, v118
    s_nop 1
    s_or_b64 s[84:85], s[84:85], vcc
    s_cmp_le_u32 s88, 1
    s_cbranch_scc1 L_sdec
    ds_read_b128 v[16:19], v12 offset:4352
    ds_read_b128 v[20:23], v12 offset:5440
    ds_read_b128 v[24:27], v12 offset:6528
    ds_read_b128 v[28:31], v12 offset:7616
    v_cmp_ngt_f32 vcc, 0x71800000, v113
    v_mov_b32 v116, 0
    s_nop 0
    s_or_b64 s[84:85], s[84:85], vcc
    s_waitcnt lgkmcnt(0)
    v_pk_maximum3_f16 v116, v116, v16, v17
    v_pk_maximum3_f16 v116, v116, v18, v19
    v_pk_maximum3_f16 v116, v116, v20, v21
    v_pk_maximum3_f16 v116, v116, v22, v23
    v_pk_maximum3_f16 v116, v116, v24, v25
    v_pk_maximum3_f16 v116, v116, v26, v27
    v_pk_maximum3_f16 v116, v116, v28, v29
    v_pk_maximum3_f16 v116, v116, v30, v31
    v_and_b32 v117, 0x7c00, v116
    v_and_b32 v118, 0x7c000000, v116
    v_cmp_eq_u32 vcc, 0x7c00, v117
    s_nop 1
    s_or_b64 s[84:85], s[84:85], vcc
    v_cmp_eq_u32 vcc, 0x7c000000, v118
    s_nop 1
    s_or_b64 s[84:85], s[84:85], vcc
    s_cmp_le_u32 s88, 2
    s_cbranch_scc1 L_sdec
    ds_read_b128 v[16:19], v12 offset:8704
    ds_read_b128 v[20:23], v12 offset:9792
    ds_read_b128 v[24:27], v12 offset:10880
    ds_read_b128 v[28:31], v12 offset:11968
    v_cmp_ngt_f32 vcc, 0x71800000, v114
    v_mov_b32 v116, 0
    s_nop 0
    s_or_b64 s[84:85], s[84:85], vcc
    s_waitcnt lgkmcnt(0)
    v_pk_maximum3_f16 v116, v116, v16, v17
    v_pk_maximum3_f16 v116, v116, v18, v19
    v_pk_maximum3_f16 v116, v116, v20, v21
    v_pk_maximum3_f16 v116, v116, v22, v23
    v_pk_maximum3_f16 v116, v116, v24, v25
    v_pk_maximum3_f16 v116, v116, v26, v27
    v_pk_maximum3_f16 v116, v116, v28, v29
    v_pk_maximum3_f16 v116, v116, v30, v31
    v_and_b32 v117, 0x7c00, v116
    v_and_b32 v118, 0x7c000000, v116
    v_cmp_eq_u32 vcc, 0x7c00, v117
    s_nop 1
    s_or_b64 s[84:85], s[84:85], vcc
    v_cmp_eq_u32 vcc, 0x7c000000, v118
    s_nop 1
    s_or_b64 s[84:85], s[84:85], vcc
    s_cmp_le_u32 s88, 3
    s_cbranch_scc1 L_sdec
    ds_read_b128 v[16:19], v12 offset:13056
    ds_read_b128 v[20:23], v12 offset:14144
    ds_read_b128 v[24:27], v12 offset:15232
    ds_read_b128 v[28:31], v12 offset:16320
    v_cmp_ngt_f32 vcc, 0x71800000, v115
    v_mov_b32 v116, 0
    s_nop 0
    s_or_b64 s[84:85], s[84:85], vcc
    s_waitcnt lgkmcnt(0)
    v_pk_maximum3_f16 v116, v116, v16, v17
    v_pk_maximum3_f16 v116, v116, v18, v19
    v_pk_maximum3_f16 v116, v116, v20, v21
    v_pk_maximum3_f16 v116, v116, v22, v23
    v_pk_maximum3_f16 v116, v116, v24, v25
    v_pk_maximum3_f16 v116, v116, v26, v27
    v_pk_maximum3_f16 v116, v116, v28, v29
    v_pk_maximum3_f16 v116, v116, v30, v31
    v_and_b32 v117, 0x7c00, v116
    v_and_b32 v118, 0x7c000000, v116
    v_cmp_eq_u32 vcc, 0x7c00, v117
    s_nop 1
    s_or_b64 s[84:85], s[84:85], vcc
    v_cmp_eq_u32 vcc, 0x7c000000, v118
    s_nop 1
    s_or_b64 s[84:85], s[84:85], vcc
L_sdec:
    s_cmp_lg_u64 s[84:85], 0
    s_cbranch_scc1 L_fb
L_sstore:
    s_mov_b32 s40, s34
    ds_read_b128 v[16:19], v12 offset:0
    ds_read_b128 v[20:23], v12 offset:1088
    ds_read_b128 v[24:27], v12 offset:2176
    ds_read_b128 v[28:31], v12 offset:3264
    s_waitcnt lgkmcnt(3)
    buffer_store_dwordx4 v[16:19], v13, s[16:19], s40 offen sc0 sc1
    s_add_u32 s40, s40, 16384
    s_waitcnt lgkmcnt(2)
    buffer_store_dwordx4 v[20:23], v13, s[16:19], s40 offen sc0 sc1
    s_add_u32 s40, s40, 16384
    s_waitcnt lgkmcnt(1)
    buffer_store_dwordx4 v[24:27], v13, s[16:19], s40 offen sc0 sc1
    s_add_u32 s40, s40, 16384
    s_waitcnt lgkmcnt(0)
    buffer_store_dwordx4 v[28:31], v13, s[16:19], s40 offen sc0 sc1
    s_add_u32 s40, s40, 16384
    s_cmp_le_u32 s88, 1
    s_cbranch_scc1 L_sret
    ds_read_b128 v[32:35], v12 offset:4352
    ds_read_b128 v[36:39], v12 offset:5440
    ds_read_b128 v[40:43], v12 offset:6528
    ds_read_b128 v[44:47], v12 offset:7616
    s_waitcnt lgkmcnt(3)
    buffer_store_dwordx4 v[32:35], v13, s[16:19], s40 offen sc0 sc1
    s_add_u32 s40, s40, 16384
    s_waitcnt lgkmcnt(2)
    buffer_store_dwordx4 v[36:39], v13, s[16:19], s40 offen sc0 sc1
    s_add_u32 s40, s40, 16384
    s_waitcnt lgkmcnt(1)
    buffer_store_dwordx4 v[40:43], v13, s[16:19], s40 offen sc0 sc1
    s_add_u32 s40, s40, 16384
    s_waitcnt lgkmcnt(0)
    buffer_store_dwordx4 v[44:47], v13, s[16:19], s40 offen sc0 sc1
    s_add_u32 s40, s40, 16384
    s_cmp_le_u32 s88, 2
    s_cbranch_scc1 L_sret
    ds_read_b128 v[48:51], v12 offset:8704
    ds_read_b128 v[52:55], v12 offset:9792
    ds_read_b128 v[56:59], v12 offset:10880
    ds_read_b128 v[60:63], v12 offset:11968
    s_waitcnt lgkmcnt(3)
    buffer_store_dwordx4 v[48:51], v13, s[16:19], s40 offen sc0 sc1
    s_add_u32 s40, s40, 16384
    s_waitcnt lgkmcnt(2)
    buffer_store_dwordx4 v[52:55], v13, s[16:19], s40 offen sc0 sc1
    s_add_u32 s40, s40, 16384
    s_waitcnt lgkmcnt(1)
    buffer_store_dwordx4 v[56:59], v13, s[16:19], s40 offen sc0 sc1
    s_add_u32 s40, s40, 16384
    s_waitcnt lgkmcnt(0)
    buffer_store_dwordx4 v[60:63], v13, s[16:19], s40 offen sc0 sc1
    s_add_u32 s40, s40, 16384
    s_cmp_le_u32 s88, 3
    s_cbranch_scc1 L_sret
    ds_read_b128 v[64:67], v12 offset:13056
    ds_read_b128 v[68:71], v12 offset:14144
    ds_read_b128 v[72:75], v12 offset:15232
    ds_read_b128 v[76:79], v12 offset:16320
    s_waitcnt lgkmcnt(3)
    buffer_store_dwordx4 v[64:67], v13, s[16:19], s40 offen sc0 sc1
    s_add_u32 s40, s40, 16384
    s_waitcnt lgkmcnt(2)
    buffer_store_dwordx4 v[68:71], v13, s[16:19], s40 offen sc0 sc1
    s_add_u32 s40, s40, 16384
    s_waitcnt lgkmcnt(1)
    buffer_store_dwordx4 v[72:75], v13, s[16:19], s40 offen sc0 sc1
    s_add_u32 s40, s40, 16384
    s_waitcnt lgkmcnt(0)
    buffer_store_dwordx4 v[76:79], v13, s[16:19], s40 offen sc0 sc1
    s_add_u32 s40, s40, 16384
L_sret:
    v_mfma_f32_32x32x16_bf16 v[128:143], a[192:195], a[64:67], 0
    v_mfma_f32_32x32x16_bf16 v[128:143], a[196:199], a[68:71], v[128:143]
    v_mfma_f32_32x32x16_bf16 v[128:143], a[200:203], a[64:67], v[128:143]
    v_mfma_f32_32x32x16_bf16 v[128:143], a[204:207], a[68:71], v[128:143]
    v_mfma_f32_32x32x16_bf16 v[144:159], a[192:195], a[72:75], 0
    v_mfma_f32_32x32x16_bf16 v[144:159], a[196:199], a[76:79], v[144:159]
    v_mfma_f32_32x32x16_bf16 v[144:159], a[200:203], a[72:75], v[144:159]
    v_mfma_f32_32x32x16_bf16 v[144:159], a[204:207], a[76:79], v[144:159]
    v_mfma_f32_32x32x16_bf16 v[160:175], a[192:195], a[80:83], 0
    v_mfma_f32_32x32x16_bf16 v[160:175], a[196:199], a[84:87], v[160:175]
    v_mfma_f32_32x32x16_bf16 v[160:175], a[200:203], a[80:83], v[160:175]
    v_mfma_f32_32x32x16_bf16 v[160:175], a[204:207], a[84:87], v[160:175]
    v_mfma_f32_32x32x16_bf16 v[176:191], a[192:195], a[88:91], 0
    v_mfma_f32_32x32x16_bf16 v[176:191], a[196:199], a[92:95], v[176:191]
    v_mfma_f32_32x32x16_bf16 v[176:191], a[200:203], a[88:91], v[176:191]
    v_mfma_f32_32x32x16_bf16 v[176:191], a[204:207], a[92:95], v[176:191]
    v_mfma_f32_32x32x16_bf16 v[192:207], a[192:195], a[96:99], 0
    v_mfma_f32_32x32x16_bf16 v[192:207], a[196:199], a[100:103], v[192:207]
    v_mfma_f32_32x32x16_bf16 v[192:207], a[200:203], a[96:99], v[192:207]
    v_mfma_f32_32x32x16_bf16 v[192:207], a[204:207], a[100:103], v[192:207]
    v_mfma_f32_32x32x16_bf16 v[208:223], a[192:195], a[104:107], 0
    v_mfma_f32_32x32x16_bf16 v[208:223], a[196:199], a[108:111], v[208:223]
    v_mfma_f32_32x32x16_bf16 v[208:223], a[200:203], a[104:107], v[208:223]
    v_mfma_f32_32x32x16_bf16 v[208:223], a[204:207], a[108:111], v[208:223]
    v_mfma_f32_32x32x16_bf16 v[224:239], a[192:195], a[112:115], 0
    v_mfma_f32_32x32x16_bf16 v[224:239], a[196:199], a[116:119], v[224:239]
    v_mfma_f32_32x32x16_bf16 v[224:239], a[200:203], a[112:115], v[224:239]
    v_mfma_f32_32x32x16_bf16 v[224:239], a[204:207], a[116:119], v[224:239]
    v_mfma_f32_32x32x16_bf16 v[240:255], a[192:195], a[120:123], 0
    v_mfma_f32_32x32x16_bf16 v[240:255], a[196:199], a[124:127], v[240:255]
    v_mfma_f32_32x32x16_bf16 v[240:255], a[200:203], a[120:123], v[240:255]
    v_mfma_f32_32x32x16_bf16 v[240:255], a[204:207], a[124:127], v[240:255]
    s_nop 15
    v_cvt_pk_bf16_f32 v128, v128, v129
    v_cvt_pk_bf16_f32 v129, v130, v131
    v_cvt_pk_bf16_f32 v130, v132, v133
    v_cvt_pk_bf16_f32 v131, v134, v135
    v_cvt_pk_bf16_f32 v132, v136, v137
    v_cvt_pk_bf16_f32 v133, v138, v139
    v_cvt_pk_bf16_f32 v134, v140, v141
    v_cvt_pk_bf16_f32 v135, v142, v143
    v_accvgpr_write_b32 a0, v128
    v_accvgpr_write_b32 a1, v129
    v_accvgpr_write_b32 a2, v130
    v_accvgpr_write_b32 a3, v131
    v_accvgpr_write_b32 a4, v132
    v_accvgpr_write_b32 a5, v133
    v_accvgpr_write_b32 a6, v134
    v_accvgpr_write_b32 a7, v135
    v_mfma_f32_32x32x16_bf16 v[128:143], v[124:127], v[124:127], 0
    v_cvt_pk_bf16_f32 v144, v144, v145
    v_cvt_pk_bf16_f32 v145, v146, v147
    v_cvt_pk_bf16_f32 v146, v148, v149
    v_cvt_pk_bf16_f32 v147, v150, v151
    v_cvt_pk_bf16_f32 v148, v152, v153
    v_cvt_pk_bf16_f32 v149, v154, v155
    v_cvt_pk_bf16_f32 v150, v156, v157
    v_cvt_pk_bf16_f32 v151, v158, v159
    v_accvgpr_write_b32 a8, v144
    v_accvgpr_write_b32 a9, v145
    v_accvgpr_write_b32 a10, v146
    v_accvgpr_write_b32 a11, v147
    v_accvgpr_write_b32 a12, v148
    v_accvgpr_write_b32 a13, v149
    v_accvgpr_write_b32 a14, v150
    v_accvgpr_write_b32 a15, v151
    v_mfma_f32_32x32x16_bf16 v[144:159], v[124:127], v[124:127], 0
    v_cvt_pk_bf16_f32 v160, v160, v161
    v_cvt_pk_bf16_f32 v161, v162, v163
    v_cvt_pk_bf16_f32 v162, v164, v165
    v_cvt_pk_bf16_f32 v163, v166, v167
    v_cvt_pk_bf16_f32 v164, v168, v169
    v_cvt_pk_bf16_f32 v165, v170, v171
    v_cvt_pk_bf16_f32 v166, v172, v173
    v_cvt_pk_bf16_f32 v167, v174, v175
    v_accvgpr_write_b32 a16, v160
    v_accvgpr_write_b32 a17, v161
    v_accvgpr_write_b32 a18, v162
    v_accvgpr_write_b32 a19, v163
    v_accvgpr_write_b32 a20, v164
    v_accvgpr_write_b32 a21, v165
    v_accvgpr_write_b32 a22, v166
    v_accvgpr_write_b32 a23, v167
    v_mfma_f32_32x32x16_bf16 v[160:175], v[124:127], v[124:127], 0
    v_cvt_pk_bf16_f32 v176, v176, v177
    v_cvt_pk_bf16_f32 v177, v178, v179
    v_cvt_pk_bf16_f32 v178, v180, v181
    v_cvt_pk_bf16_f32 v179, v182, v183
    v_cvt_pk_bf16_f32 v180, v184, v185
    v_cvt_pk_bf16_f32 v181, v186, v187
    v_cvt_pk_bf16_f32 v182, v188, v189
    v_cvt_pk_bf16_f32 v183, v190, v191
    v_accvgpr_write_b32 a24, v176
    v_accvgpr_write_b32 a25, v177
    v_accvgpr_write_b32 a26, v178
    v_accvgpr_write_b32 a27, v179
    v_accvgpr_write_b32 a28, v180
    v_accvgpr_write_b32 a29, v181
    v_accvgpr_write_b32 a30, v182
    v_accvgpr_write_b32 a31, v183
    v_mfma_f32_32x32x16_bf16 v[176:191], v[124:127], v[124:127], 0
    v_cvt_pk_bf16_f32 v192, v192, v193
    v_cvt_pk_bf16_f32 v193, v194, v195
    v_cvt_pk_bf16_f32 v194, v196, v197
    v_cvt_pk_bf16_f32 v195, v198, v199
    v_cvt_pk_bf16_f32 v196, v200, v201
    v_cvt_pk_bf16_f32 v197, v202, v203
    v_cvt_pk_bf16_f32 v198, v204, v205
    v_cvt_pk_bf16_f32 v199, v206, v207
    v_accvgpr_write_b32 a32, v192
    v_accvgpr_write_b32 a33, v193
    v_accvgpr_write_b32 a34, v194
    v_accvgpr_write_b32 a35, v195
    v_accvgpr_write_b32 a36, v196
    v_accvgpr_write_b32 a37, v197
    v_accvgpr_write_b32 a38, v198
    v_accvgpr_write_b32 a39, v199
    v_mfma_f32_32x32x16_bf16 v[192:207], v[124:127], v[124:127], 0
    v_cvt_pk_bf16_f32 v208, v208, v209
    v_cvt_pk_bf16_f32 v209, v210, v211
    v_cvt_pk_bf16_f32 v210, v212, v213
    v_cvt_pk_bf16_f32 v211, v214, v215
    v_cvt_pk_bf16_f32 v212, v216, v217
    v_cvt_pk_bf16_f32 v213, v218, v219
    v_cvt_pk_bf16_f32 v214, v220, v221
    v_cvt_pk_bf16_f32 v215, v222, v223
    v_accvgpr_write_b32 a40, v208
    v_accvgpr_write_b32 a41, v209
    v_accvgpr_write_b32 a42, v210
    v_accvgpr_write_b32 a43, v211
    v_accvgpr_write_b32 a44, v212
    v_accvgpr_write_b32 a45, v213
    v_accvgpr_write_b32 a46, v214
    v_accvgpr_write_b32 a47, v215
    v_mfma_f32_32x32x16_bf16 v[208:223], v[124:127], v[124:127], 0
    v_cvt_pk_bf16_f32 v224, v224, v225
    v_cvt_pk_bf16_f32 v225, v226, v227
    v_cvt_pk_bf16_f32 v226, v228, v229
    v_cvt_pk_bf16_f32 v227, v230, v231
    v_cvt_pk_bf16_f32 v228, v232, v233
    v_cvt_pk_bf16_f32 v229, v234, v235
    v_cvt_pk_bf16_f32 v230, v236, v237
    v_cvt_pk_bf16_f32 v231, v238, v239
    v_accvgpr_write_b32 a48, v224
    v_accvgpr_write_b32 a49, v225
    v_accvgpr_write_b32 a50, v226
    v_accvgpr_write_b32 a51, v227
    v_accvgpr_write_b32 a52, v228
    v_accvgpr_write_b32 a53, v229
    v_accvgpr_write_b32 a54, v230
    v_accvgpr_write_b32 a55, v231
    v_mfma_f32_32x32x16_bf16 v[224:239], v[124:127], v[124:127], 0
    v_cvt_pk_bf16_f32 v240, v240, v241
    v_cvt_pk_bf16_f32 v241, v242, v243
    v_cvt_pk_bf16_f32 v242, v244, v245
    v_cvt_pk_bf16_f32 v243, v246, v247
    v_cvt_pk_bf16_f32 v244, v248, v249
    v_cvt_pk_bf16_f32 v245, v250, v251
    v_cvt_pk_bf16_f32 v246, v252, v253
    v_cvt_pk_bf16_f32 v247, v254, v255
    v_accvgpr_write_b32 a56, v240
    v_accvgpr_write_b32 a57, v241
    v_accvgpr_write_b32 a58, v242
    v_accvgpr_write_b32 a59, v243
    v_accvgpr_write_b32 a60, v244
    v_accvgpr_write_b32 a61, v245
    v_accvgpr_write_b32 a62, v246
    v_accvgpr_write_b32 a63, v247
    v_mfma_f32_32x32x16_bf16 v[240:255], v[124:127], v[124:127], 0
    s_cmp_eq_u32 s44, 0
    s_cbranch_scc1 L_adv0
    s_cmp_eq_u32 s44, 1
    s_cbranch_scc1 L_adv1
    s_cmp_eq_u32 s44, 2
    s_cbranch_scc1 L_adv2
    s_branch L_adv3
L_fb:
    s_mov_b32 s46, 1
    s_sub_u32 s38, s33, 8704
    v_add_u32 v48, s38, v3
    s_lshl_b32 s38, s87, 14
    v_subrev_u32 v49, s38, v4
    s_lshl_b32 s38, s87, 12
    v_subrev_u32 v50, s38, v6
    s_mov_b32 s6, s43
    v_mov_b32 v80, 0
    v_mov_b32 v81, 0
    v_mov_b32 v82, 0
    v_mov_b32 v83, 0
    v_mov_b32 v84, 0
    v_mov_b32 v85, 0
    v_mov_b32 v86, 0
    v_mov_b32 v87, 0
    v_mov_b32 v88, 0
    v_mov_b32 v89, 0
    v_mov_b32 v90, 0
    v_mov_b32 v91, 0
    v_mov_b32 v92, 0
    v_mov_b32 v93, 0
    v_mov_b32 v94, 0
    v_mov_b32 v95, 0
    v_mov_b32 v96, 0
    v_mov_b32 v97, 0
    v_mov_b32 v98, 0
    v_mov_b32 v99, 0
    v_mov_b32 v100, 0
    v_mov_b32 v101, 0
    v_mov_b32 v102, 0
    v_mov_b32 v103, 0
    v_mov_b32 v104, 0
    v_mov_b32 v105, 0
    v_mov_b32 v106, 0
    v_mov_b32 v107, 0
    v_mov_b32 v108, 0
    v_mov_b32 v109, 0
    v_mov_b32 v110, 0
    v_mov_b32 v111, 0
    v_mov_b32 v112, 0xff800000
    v_mov_b32 v113, 0xff800000
    v_mov_b32 v114, 0xff800000
    v_mov_b32 v115, 0xff800000
    v_mfma_f32_32x32x16_bf16 v[128:143], v[124:127], v[124:127], 0
    v_mfma_f32_32x32x16_bf16 v[144:159], v[124:127], v[124:127], 0
    v_mfma_f32_32x32x16_bf16 v[160:175], v[124:127], v[124:127], 0
    v_mfma_f32_32x32x16_bf16 v[176:191], v[124:127], v[124:127], 0
    v_mfma_f32_32x32x16_bf16 v[192:207], v[124:127], v[124:127], 0
    v_mfma_f32_32x32x16_bf16 v[208:223], v[124:127], v[124:127], 0
    v_mfma_f32_32x32x16_bf16 v[224:239], v[124:127], v[124:127], 0
    v_mfma_f32_32x32x16_bf16 v[240:255], v[124:127], v[124:127], 0
    v_mfma_f32_32x32x16_bf16 a[208:223], v[124:127], v[124:127], 0
    s_mov_b32 s37, s42
    s_mov_b32 s31, s36
L_fb1:
    s_cmp_eq_u32 s31, 1
    s_cbranch_scc0 L_fbnm1
    v_sub_u32 v116, s35, v8
    v_mov_b32 v117, 0xff800000
    v_cmp_lt_i32 vcc, 0, v116
    s_nop 0
    v_cmp_lt_i32 s[38:39], 1, v116
    v_cndmask_b32 v80, v117, v80, vcc
    v_cndmask_b32 v88, v117, v88, vcc
    v_cndmask_b32 v96, v117, v96, vcc
    v_cndmask_b32 v104, v117, v104, vcc
    v_cmp_lt_i32 vcc, 2, v116
    v_cndmask_b32 v81, v117, v81, s[38:39]
    v_cndmask_b32 v89, v117, v89, s[38:39]
    v_cndmask_b32 v97, v117, v97, s[38:39]
    v_cndmask_b32 v105, v117, v105, s[38:39]
    v_cmp_lt_i32 s[38:39], 3, v116
    v_cndmask_b32 v82, v117, v82, vcc
    v_cndmask_b32 v90, v117, v90, vcc
    v_cndmask_b32 v98, v117, v98, vcc
    v_cndmask_b32 v106, v117, v106, vcc
    v_cmp_lt_i32 vcc, 16, v116
    v_cndmask_b32 v83, v117, v83, s[38:39]
    v_cndmask_b32 v91, v117, v91, s[38:39]
    v_cndmask_b32 v99, v117, v99, s[38:39]
    v_cndmask_b32 v107, v117, v107, s[38:39]
    v_cmp_lt_i32 s[38:39], 17, v116
    v_cndmask_b32 v84, v117, v84, vcc
    v_cndmask_b32 v92, v117, v92, vcc
    v_cndmask_b32 v100, v117, v100, vcc
    v_cndmask_b32 v108, v117, v108, vcc
    v_cmp_lt_i32 vcc, 18, v116
    v_cndmask_b32 v85, v117, v85, s[38:39]
    v_cndmask_b32 v93, v117, v93, s[38:39]
    v_cndmask_b32 v101, v117, v101, s[38:39]
    v_cndmask_b32 v109, v117, v109, s[38:39]
    v_cmp_lt_i32 s[38:39], 19, v116
    v_cndmask_b32 v86, v117, v86, vcc
    v_cndmask_b32 v94, v117, v94, vcc
    v_cndmask_b32 v102, v117, v102, vcc
    v_cndmask_b32 v110, v117, v110, vcc
    v_cndmask_b32 v87, v117, v87, s[38:39]
    v_cndmask_b32 v95, v117, v95, s[38:39]
    v_cndmask_b32 v103, v117, v103, s[38:39]
    v_cndmask_b32 v111, v117, v111, s[38:39]
    s_nop 1
L_fbnm1:
    s_mov_b64 s[4:5], s[66:67]
    s_mov_b32 s86, s37
    s_add_u32 m0, s33, 0
    s_nop 0
    buffer_load_dwordx4 v49, s[4:7], s86 offen lds
    s_add_u32 m0, s33, 1056
    s_add_u32 s86, s86, 16384
    buffer_load_dwordx4 v49, s[4:7], s86 offen lds
    s_add_u32 m0, s33, 2112
    s_add_u32 s86, s86, 16384
    buffer_load_dwordx4 v49, s[4:7], s86 offen lds
    s_add_u32 m0, s33, 3168
    s_add_u32 s86, s86, 16384
    buffer_load_dwordx4 v49, s[4:7], s86 offen lds
    s_add_u32 m0, s33, 4224
    s_add_u32 s86, s86, 16384
    buffer_load_dwordx4 v49, s[4:7], s86 offen lds
    s_add_u32 m0, s33, 5280
    s_add_u32 s86, s86, 16384
    buffer_load_dwordx4 v49, s[4:7], s86 offen lds
    s_add_u32 m0, s33, 6336
    s_add_u32 s86, s86, 16384
    buffer_load_dwordx4 v49, s[4:7], s86 offen lds
    s_add_u32 m0, s33, 7392
    s_add_u32 s86, s86, 16384
    buffer_load_dwordx4 v49, s[4:7], s86 offen lds
    s_waitcnt vmcnt(0)
    ds_read_b128 a[160:163], v9 offset:0
    ds_read_b128 a[164:167], v9 offset:64
    ds_read_b128 a[168:171], v10 offset:0
    ds_read_b128 a[172:175], v10 offset:64
    ds_read_b128 a[176:179], v9 offset:4224
    ds_read_b128 a[180:183], v9 offset:4288
    ds_read_b128 a[184:187], v10 offset:4224
    ds_read_b128 a[188:191], v10 offset:4288
    s_waitcnt lgkmcnt(0)
    v_mfma_f32_16x16x32_bf16 v[16:19], a[160:163], a[0:3], v[80:83]
    v_mfma_f32_16x16x32_bf16 v[16:19], a[164:167], a[4:7], v[16:19]
    v_mfma_f32_16x16x32_bf16 v[16:19], a[168:171], a[8:11], v[16:19]
    v_mfma_f32_16x16x32_bf16 v[16:19], a[172:175], a[12:15], v[16:19]
    v_mfma_f32_16x16x32_bf16 v[20:23], a[176:179], a[0:3], v[84:87]
    v_mfma_f32_16x16x32_bf16 v[20:23], a[180:183], a[4:7], v[20:23]
    v_mfma_f32_16x16x32_bf16 v[20:23], a[184:187], a[8:11], v[20:23]
    v_mfma_f32_16x16x32_bf16 v[20:23], a[188:191], a[12:15], v[20:23]
    v_mfma_f32_16x16x32_bf16 v[24:27], a[160:163], a[16:19], v[88:91]
    v_mfma_f32_16x16x32_bf16 v[24:27], a[164:167], a[20:23], v[24:27]
    v_mfma_f32_16x16x32_bf16 v[24:27], a[168:171], a[24:27], v[24:27]
    v_mfma_f32_16x16x32_bf16 v[24:27], a[172:175], a[28:31], v[24:27]
    v_mfma_f32_16x16x32_bf16 v[28:31], a[176:179], a[16:19], v[92:95]
    v_mfma_f32_16x16x32_bf16 v[28:31], a[180:183], a[20:23], v[28:31]
    v_mfma_f32_16x16x32_bf16 v[28:31], a[184:187], a[24:27], v[28:31]
    v_mfma_f32_16x16x32_bf16 v[28:31], a[188:191], a[28:31], v[28:31]
    v_mfma_f32_16x16x32_bf16 v[32:35], a[160:163], a[32:35], v[96:99]
    v_mfma_f32_16x16x32_bf16 v[32:35], a[164:167], a[36:39], v[32:35]
    v_mfma_f32_16x16x32_bf16 v[32:35], a[168:171], a[40:43], v[32:35]
    v_mfma_f32_16x16x32_bf16 v[32:35], a[172:175], a[44:47], v[32:35]
    v_mfma_f32_16x16x32_bf16 v[36:39], a[176:179], a[32:35], v[100:103]
    v_mfma_f32_16x16x32_bf16 v[36:39], a[180:183], a[36:39], v[36:39]
    v_mfma_f32_16x16x32_bf16 v[36:39], a[184:187], a[40:43], v[36:39]
    v_mfma_f32_16x16x32_bf16 v[36:39], a[188:191], a[44:47], v[36:39]
    v_mfma_f32_16x16x32_bf16 v[40:43], a[160:163], a[48:51], v[104:107]
    v_mfma_f32_16x16x32_bf16 v[40:43], a[164:167], a[52:55], v[40:43]
    v_mfma_f32_16x16x32_bf16 v[40:43], a[168:171], a[56:59], v[40:43]
    v_mfma_f32_16x16x32_bf16 v[40:43], a[172:175], a[60:63], v[40:43]
    v_mfma_f32_16x16x32_bf16 v[44:47], a[176:179], a[48:51], v[108:111]
    v_mfma_f32_16x16x32_bf16 v[44:47], a[180:183], a[52:55], v[44:47]
    v_mfma_f32_16x16x32_bf16 v[44:47], a[184:187], a[56:59], v[44:47]
    v_mfma_f32_16x16x32_bf16 v[44:47], a[188:191], a[60:63], v[44:47]
    s_nop 15
    v_max3_f32 v112, v112, v16, v17
    v_max3_f32 v113, v113, v24, v25
    v_max3_f32 v114, v114, v32, v33
    v_max3_f32 v115, v115, v40, v41
    v_max3_f32 v112, v112, v18, v19
    v_max3_f32 v113, v113, v26, v27
    v_max3_f32 v114, v114, v34, v35
    v_max3_f32 v115, v115, v42, v43
    v_max3_f32 v112, v112, v20, v21
    v_max3_f32 v113, v113, v28, v29
    v_max3_f32 v114, v114, v36, v37
    v_max3_f32 v115, v115, v44, v45
    v_max3_f32 v112, v112, v22, v23
    v_max3_f32 v113, v113, v30, v31
    v_max3_f32 v114, v114, v38, v39
    v_max3_f32 v115, v115, v46, v47
    s_add_u32 s37, s37, 131072
    s_sub_u32 s31, s31, 1
    s_cmp_eq_u32 s31, 0
    s_cbranch_scc0 L_fb1
    v_mov_b32 v116, v112
    v_mov_b32 v117, v113
    v_mov_b32 v118, v114
    v_mov_b32 v119, v115
    v_permlane32_swap_b32 v112, v116
    v_permlane32_swap_b32 v113, v117
    v_permlane32_swap_b32 v114, v118
    v_permlane32_swap_b32 v115, v119
    v_max_f32 v112, v112, v116
    v_max_f32 v113, v113, v117
    v_max_f32 v114, v114, v118
    v_max_f32 v115, v115, v119
    v_mov_b32 v116, v112
    v_mov_b32 v117, v113
    v_mov_b32 v118, v114
    v_mov_b32 v119, v115
    v_permlane16_swap_b32 v112, v116
    v_permlane16_swap_b32 v113, v117
    v_permlane16_swap_b32 v114, v118
    v_permlane16_swap_b32 v115, v119
    v_max_f32 v112, v112, v116
    v_max_f32 v113, v113, v117
    v_max_f32 v114, v114, v118
    v_max_f32 v115, v115, v119
    v_sub_f32 v80, 0, v112
    v_sub_f32 v81, 0, v112
    v_sub_f32 v82, 0, v112
    v_sub_f32 v83, 0, v112
    v_sub_f32 v84, 0, v112
    v_sub_f32 v85, 0, v112
    v_sub_f32 v86, 0, v112
    v_sub_f32 v87, 0, v112
    v_sub_f32 v88, 0, v113
    v_sub_f32 v89, 0, v113
    v_sub_f32 v90, 0, v113
    v_sub_f32 v91, 0, v113
    v_sub_f32 v92, 0, v113
    v_sub_f32 v93, 0, v113
    v_sub_f32 v94, 0, v113
    v_sub_f32 v95, 0, v113
    v_sub_f32 v96, 0, v114
    v_sub_f32 v97, 0, v114
    v_sub_f32 v98, 0, v114
    v_sub_f32 v99, 0, v114
    v_sub_f32 v100, 0, v114
    v_sub_f32 v101, 0, v114
    v_sub_f32 v102, 0, v114
    v_sub_f32 v103, 0, v114
    v_sub_f32 v104, 0, v115
    v_sub_f32 v105, 0, v115
    v_sub_f32 v106, 0, v115
    v_sub_f32 v107, 0, v115
    v_sub_f32 v108, 0, v115
    v_sub_f32 v109, 0, v115
    v_sub_f32 v110, 0, v115
    v_sub_f32 v111, 0, v115
    s_mov_b32 s37, s42
    s_mov_b32 s31, s36
L_fb2:
    s_cmp_eq_u32 s31, 1
    s_cbranch_scc0 L_fbnm2
    v_sub_u32 v116, s35, v8
    v_mov_b32 v117, 0xff800000
    v_cmp_lt_i32 vcc, 0, v116
    s_nop 0
    v_cmp_lt_i32 s[38:39], 1, v116
    v_cndmask_b32 v80, v117, v80, vcc
    v_cndmask_b32 v88, v117, v88, vcc
    v_cndmask_b32 v96, v117, v96, vcc
    v_cndmask_b32 v104, v117, v104, vcc
    v_cmp_lt_i32 vcc, 2, v116
    v_cndmask_b32 v81, v117, v81, s[38:39]
    v_cndmask_b32 v89, v117, v89, s[38:39]
    v_cndmask_b32 v97, v117, v97, s[38:39]
    v_cndmask_b32 v105, v117, v105, s[38:39]
    v_cmp_lt_i32 s[38:39], 3, v116
    v_cndmask_b32 v82, v117, v82, vcc
    v_cndmask_b32 v90, v117, v90, vcc
    v_cndmask_b32 v98, v117, v98, vcc
    v_cndmask_b32 v106, v117, v106, vcc
    v_cmp_lt_i32 vcc, 16, v116
    v_cndmask_b32 v83, v117, v83, s[38:39]
    v_cndmask_b32 v91, v117, v91, s[38:39]
    v_cndmask_b32 v99, v117, v99, s[38:39]
    v_cndmask_b32 v107, v117, v107, s[38:39]
    v_cmp_lt_i32 s[38:39], 17, v116
    v_cndmask_b32 v84, v117, v84, vcc
    v_cndmask_b32 v92, v117, v92, vcc
    v_cndmask_b32 v100, v117, v100, vcc
    v_cndmask_b32 v108, v117, v108, vcc
    v_cmp_lt_i32 vcc, 18, v116
    v_cndmask_b32 v85, v117, v85, s[38:39]
    v_cndmask_b32 v93, v117, v93, s[38:39]
    v_cndmask_b32 v101, v117, v101, s[38:39]
    v_cndmask_b32 v109, v117, v109, s[38:39]
    v_cmp_lt_i32 s[38:39], 19, v116
    v_cndmask_b32 v86, v117, v86, vcc
    v_cndmask_b32 v94, v117, v94, vcc
    v_cndmask_b32 v102, v117, v102, vcc
    v_cndmask_b32 v110, v117, v110, vcc
    v_cndmask_b32 v87, v117, v87, s[38:39]
    v_cndmask_b32 v95, v117, v95, s[38:39]
    v_cndmask_b32 v103, v117, v103, s[38:39]
    v_cndmask_b32 v111, v117, v111, s[38:39]
    s_nop 1
L_fbnm2:
    s_mov_b64 s[4:5], s[66:67]
    s_mov_b32 s86, s37
    s_add_u32 m0, s33, 0
    s_nop 0
    buffer_load_dwordx4 v49, s[4:7], s86 offen lds
    s_add_u32 m0, s33, 1056
    s_add_u32 s86, s86, 16384
    buffer_load_dwordx4 v49, s[4:7], s86 offen lds
    s_add_u32 m0, s33, 2112
    s_add_u32 s86, s86, 16384
    buffer_load_dwordx4 v49, s[4:7], s86 offen lds
    s_add_u32 m0, s33, 3168
    s_add_u32 s86, s86, 16384
    buffer_load_dwordx4 v49, s[4:7], s86 offen lds
    s_add_u32 m0, s33, 4224
    s_add_u32 s86, s86, 16384
    buffer_load_dwordx4 v49, s[4:7], s86 offen lds
    s_add_u32 m0, s33, 5280
    s_add_u32 s86, s86, 16384
    buffer_load_dwordx4 v49, s[4:7], s86 offen lds
    s_add_u32 m0, s33, 6336
    s_add_u32 s86, s86, 16384
    buffer_load_dwordx4 v49, s[4:7], s86 offen lds
    s_add_u32 m0, s33, 7392
    s_add_u32 s86, s86, 16384
    buffer_load_dwordx4 v49, s[4:7], s86 offen lds
    s_waitcnt vmcnt(0)
    ds_read_b128 a[160:163], v9 offset:0
    ds_read_b128 a[164:167], v9 offset:64
    ds_read_b128 a[168:171], v10 offset:0
    ds_read_b128 a[172:175], v10 offset:64
    ds_read_b128 a[176:179], v9 offset:4224
    ds_read_b128 a[180:183], v9 offset:4288
    ds_read_b128 a[184:187], v10 offset:4224
    ds_read_b128 a[188:191], v10 offset:4288
    s_waitcnt lgkmcnt(0)
    v_mfma_f32_16x16x32_bf16 v[16:19], a[160:163], a[0:3], v[80:83]
    v_mfma_f32_16x16x32_bf16 v[16:19], a[164:167], a[4:7], v[16:19]
    v_mfma_f32_16x16x32_bf16 v[16:19], a[168:171], a[8:11], v[16:19]
    v_mfma_f32_16x16x32_bf16 v[16:19], a[172:175], a[12:15], v[16:19]
    v_mfma_f32_16x16x32_bf16 v[20:23], a[176:179], a[0:3], v[84:87]
    v_mfma_f32_16x16x32_bf16 v[20:23], a[180:183], a[4:7], v[20:23]
    v_mfma_f32_16x16x32_bf16 v[20:23], a[184:187], a[8:11], v[20:23]
    v_mfma_f32_16x16x32_bf16 v[20:23], a[188:191], a[12:15], v[20:23]
    v_mfma_f32_16x16x32_bf16 v[24:27], a[160:163], a[16:19], v[88:91]
    v_mfma_f32_16x16x32_bf16 v[24:27], a[164:167], a[20:23], v[24:27]
    v_mfma_f32_16x16x32_bf16 v[24:27], a[168:171], a[24:27], v[24:27]
    v_mfma_f32_16x16x32_bf16 v[24:27], a[172:175], a[28:31], v[24:27]
    v_mfma_f32_16x16x32_bf16 v[28:31], a[176:179], a[16:19], v[92:95]
    v_mfma_f32_16x16x32_bf16 v[28:31], a[180:183], a[20:23], v[28:31]
    v_mfma_f32_16x16x32_bf16 v[28:31], a[184:187], a[24:27], v[28:31]
    v_mfma_f32_16x16x32_bf16 v[28:31], a[188:191], a[28:31], v[28:31]
    v_mfma_f32_16x16x32_bf16 v[32:35], a[160:163], a[32:35], v[96:99]
    v_mfma_f32_16x16x32_bf16 v[32:35], a[164:167], a[36:39], v[32:35]
    v_mfma_f32_16x16x32_bf16 v[32:35], a[168:171], a[40:43], v[32:35]
    v_mfma_f32_16x16x32_bf16 v[32:35], a[172:175], a[44:47], v[32:35]
    v_mfma_f32_16x16x32_bf16 v[36:39], a[176:179], a[32:35], v[100:103]
    v_mfma_f32_16x16x32_bf16 v[36:39], a[180:183], a[36:39], v[36:39]
    v_mfma_f32_16x16x32_bf16 v[36:39], a[184:187], a[40:43], v[36:39]
    v_mfma_f32_16x16x32_bf16 v[36:39], a[188:191], a[44:47], v[36:39]
    v_mfma_f32_16x16x32_bf16 v[40:43], a[160:163], a[48:51], v[104:107]
    v_mfma_f32_16x16x32_bf16 v[40:43], a[164:167], a[52:55], v[40:43]
    v_mfma_f32_16x16x32_bf16 v[40:43], a[168:171], a[56:59], v[40:43]
    v_mfma_f32_16x16x32_bf16 v[40:43], a[172:175], a[60:63], v[40:43]
    v_mfma_f32_16x16x32_bf16 v[44:47], a[176:179], a[48:51], v[108:111]
    v_mfma_f32_16x16x32_bf16 v[44:47], a[180:183], a[52:55], v[44:47]
    v_mfma_f32_16x16x32_bf16 v[44:47], a[184:187], a[56:59], v[44:47]
    v_mfma_f32_16x16x32_bf16 v[44:47], a[188:191], a[60:63], v[44:47]
    s_nop 15
    v_exp_f32 v16, v16
    v_exp_f32 v17, v17
    v_exp_f32 v18, v18
    v_cvt_pk_bf16_f32 v16, v16, v17
    v_exp_f32 v19, v19
    v_exp_f32 v20, v20
    v_cvt_pk_bf16_f32 v17, v18, v19
    v_exp_f32 v21, v21
    v_exp_f32 v22, v22
    v_cvt_pk_bf16_f32 v18, v20, v21
    v_exp_f32 v23, v23
    v_exp_f32 v24, v24
    v_cvt_pk_bf16_f32 v19, v22, v23
    v_exp_f32 v25, v25
    v_exp_f32 v26, v26
    v_cvt_pk_bf16_f32 v20, v24, v25
    v_exp_f32 v27, v27
    v_exp_f32 v28, v28
    v_cvt_pk_bf16_f32 v21, v26, v27
    v_exp_f32 v29, v29
    v_exp_f32 v30, v30
    v_cvt_pk_bf16_f32 v22, v28, v29
    v_exp_f32 v31, v31
    v_exp_f32 v32, v32
    v_cvt_pk_bf16_f32 v23, v30, v31
    v_exp_f32 v33, v33
    v_exp_f32 v34, v34
    v_cvt_pk_bf16_f32 v32, v32, v33
    v_exp_f32 v35, v35
    v_exp_f32 v36, v36
    v_cvt_pk_bf16_f32 v33, v34, v35
    v_exp_f32 v37, v37
    v_exp_f32 v38, v38
    v_cvt_pk_bf16_f32 v34, v36, v37
    v_exp_f32 v39, v39
    v_exp_f32 v40, v40
    v_cvt_pk_bf16_f32 v35, v38, v39
    v_exp_f32 v41, v41
    v_exp_f32 v42, v42
    v_cvt_pk_bf16_f32 v36, v40, v41
    v_exp_f32 v43, v43
    v_exp_f32 v44, v44
    v_cvt_pk_bf16_f32 v37, v42, v43
    v_exp_f32 v45, v45
    v_exp_f32 v46, v46
    v_cvt_pk_bf16_f32 v38, v44, v45
    v_exp_f32 v47, v47
    s_nop 0
    v_cvt_pk_bf16_f32 v39, v46, v47
    s_mov_b64 s[4:5], s[68:69]
    s_mov_b32 s86, s37
    s_add_u32 m0, s33, 0
    s_nop 0
    buffer_load_dwordx4 v50, s[4:7], s86 offen lds
    s_add_u32 m0, s33, 1056
    s_add_u32 s86, s86, 4096
    buffer_load_dwordx4 v50, s[4:7], s86 offen lds
    s_add_u32 m0, s33, 2112
    s_add_u32 s86, s86, 4096
    buffer_load_dwordx4 v50, s[4:7], s86 offen lds
    s_add_u32 m0, s33, 3168
    s_add_u32 s86, s86, 4096
    buffer_load_dwordx4 v50, s[4:7], s86 offen lds
    s_add_u32 m0, s33, 4224
    s_add_u32 s86, s86, 4096
    buffer_load_dwordx4 v50, s[4:7], s86 offen lds
    s_add_u32 m0, s33, 5280
    s_add_u32 s86, s86, 4096
    buffer_load_dwordx4 v50, s[4:7], s86 offen lds
    s_add_u32 m0, s33, 6336
    s_add_u32 s86, s86, 4096
    buffer_load_dwordx4 v50, s[4:7], s86 offen lds
    s_add_u32 m0, s33, 7392
    s_add_u32 s86, s86, 4096
    buffer_load_dwordx4 v50, s[4:7], s86 offen lds
    s_waitcnt vmcnt(0)
    ds_read_b64_tr_b16 a[160:161], v48 offset:0
    ds_read_b64_tr_b16 a[162:163], v48 offset:512
    ds_read_b64_tr_b16 a[164:165], v48 offset:32
    ds_read_b64_tr_b16 a[166:167], v48 offset:544
    ds_read_b64_tr_b16 a[168:169], v48 offset:64
    ds_read_b64_tr_b16 a[170:171], v48 offset:576
    ds_read_b64_tr_b16 a[172:173], v48 offset:96
    ds_read_b64_tr_b16 a[174:175], v48 offset:608
    ds_read_b64_tr_b16 a[176:177], v48 offset:128
    ds_read_b64_tr_b16 a[178:179], v48 offset:640
    ds_read_b64_tr_b16 a[180:181], v48 offset:160
    ds_read_b64_tr_b16 a[182:183], v48 offset:672
    ds_read_b64_tr_b16 a[184:185], v48 offset:192
    ds_read_b64_tr_b16 a[186:187], v48 offset:704
    ds_read_b64_tr_b16 a[188:189], v48 offset:224
    ds_read_b64_tr_b16 a[190:191], v48 offset:736
    s_waitcnt lgkmcnt(0)
    v_mfma_f32_16x16x32_bf16 v[128:131], a[160:163], v[16:19], v[128:131]
    v_mfma_f32_16x16x32_bf16 v[132:135], a[164:167], v[16:19], v[132:135]
    v_mfma_f32_16x16x32_bf16 v[136:139], a[168:171], v[16:19], v[136:139]
    v_mfma_f32_16x16x32_bf16 v[140:143], a[172:175], v[16:19], v[140:143]
    v_mfma_f32_16x16x32_bf16 v[144:147], a[176:179], v[16:19], v[144:147]
    v_mfma_f32_16x16x32_bf16 v[148:151], a[180:183], v[16:19], v[148:151]
    v_mfma_f32_16x16x32_bf16 v[152:155], a[184:187], v[16:19], v[152:155]
    v_mfma_f32_16x16x32_bf16 v[156:159], a[188:191], v[16:19], v[156:159]
    v_mfma_f32_16x16x32_bf16 a[208:211], a[224:227], v[16:19], a[208:211]
    v_mfma_f32_16x16x32_bf16 v[160:163], a[160:163], v[20:23], v[160:163]
    v_mfma_f32_16x16x32_bf16 v[164:167], a[164:167], v[20:23], v[164:167]
    v_mfma_f32_16x16x32_bf16 v[168:171], a[168:171], v[20:23], v[168:171]
    v_mfma_f32_16x16x32_bf16 v[172:175], a[172:175], v[20:23], v[172:175]
    v_mfma_f32_16x16x32_bf16 v[176:179], a[176:179], v[20:23], v[176:179]
    v_mfma_f32_16x16x32_bf16 v[180:183], a[180:183], v[20:23], v[180:183]
    v_mfma_f32_16x16x32_bf16 v[184:187], a[184:187], v[20:23], v[184:187]
    v_mfma_f32_16x16x32_bf16 v[188:191], a[188:191], v[20:23], v[188:191]
    v_mfma_f32_16x16x32_bf16 a[212:215], a[224:227], v[20:23], a[212:215]
    v_mfma_f32_16x16x32_bf16 v[192:195], a[160:163], v[32:35], v[192:195]
    v_mfma_f32_16x16x32_bf16 v[196:199], a[164:167], v[32:35], v[196:199]
    v_mfma_f32_16x16x32_bf16 v[200:203], a[168:171], v[32:35], v[200:203]
    v_mfma_f32_16x16x32_bf16 v[204:207], a[172:175], v[32:35], v[204:207]
    v_mfma_f32_16x16x32_bf16 v[208:211], a[176:179], v[32:35], v[208:211]
    v_mfma_f32_16x16x32_bf16 v[212:215], a[180:183], v[32:35], v[212:215]
    v_mfma_f32_16x16x32_bf16 v[216:219], a[184:187], v[32:35], v[216:219]
    v_mfma_f32_16x16x32_bf16 v[220:223], a[188:191], v[32:35], v[220:223]
    v_mfma_f32_16x16x32_bf16 a[216:219], a[224:227], v[32:35], a[216:219]
    v_mfma_f32_16x16x32_bf16 v[224:227], a[160:163], v[36:39], v[224:227]
    v_mfma_f32_16x16x32_bf16 v[228:231], a[164:167], v[36:39], v[228:231]
    v_mfma_f32_16x16x32_bf16 v[232:235], a[168:171], v[36:39], v[232:235]
    v_mfma_f32_16x16x32_bf16 v[236:239], a[172:175], v[36:39], v[236:239]
    v_mfma_f32_16x16x32_bf16 v[240:243], a[176:179], v[36:39], v[240:243]
    v_mfma_f32_16x16x32_bf16 v[244:247], a[180:183], v[36:39], v[244:247]
    v_mfma_f32_16x16x32_bf16 v[248:251], a[184:187], v[36:39], v[248:251]
    v_mfma_f32_16x16x32_bf16 v[252:255], a[188:191], v[36:39], v[252:255]
    v_mfma_f32_16x16x32_bf16 a[220:223], a[224:227], v[36:39], a[220:223]
    s_nop 15
    s_add_u32 s37, s37, 131072
    s_sub_u32 s31, s31, 1
    s_cmp_eq_u32 s31, 0
    s_cbranch_scc0 L_fb2
    v_accvgpr_read_b32 v112, a208
    v_accvgpr_read_b32 v113, a212
    v_accvgpr_read_b32 v114, a216
    v_accvgpr_read_b32 v115, a220
    v_cmp_nge_f32 vcc, 0x44800000, v112
    v_rcp_f32 v120, v112
    s_nop 0
    s_mov_b64 s[84:85], vcc
    v_cmp_nge_f32 vcc, 0x44800000, v113
    v_rcp_f32 v121, v113
    s_nop 0
    s_or_b64 s[84:85], s[84:85], vcc
    v_cmp_nge_f32 vcc, 0x44800000, v114
    v_rcp_f32 v122, v114
    s_nop 0
    s_or_b64 s[84:85], s[84:85], vcc
    v_cmp_nge_f32 vcc, 0x44800000, v115
    v_rcp_f32 v123, v115
    s_nop 0
    s_or_b64 s[84:85], s[84:85], vcc
    s_mov_b32 s40, s34
    s_branch L_slow
L_end:
    s_endpgm
.p2align 6
.type L_table,@object
L_table:
.long 0x1a4a0fc4, 0x5846ed8d, 0x00000000, 0x00000000, 0x00fc4000, 0x01214000, 0x010c4000, 0x0002c000
.long 0x5a4a0fc4, 0x1846ed8d, 0x00000000, 0x00000000, 0x00fc4100, 0x01214000, 0x010c4100, 0x0002c000
.long 0x1a634a73, 0x51c2c000, 0x00000000, 0x00000000, 0x00a73000, 0x00d8d000, 0x00b73000, 0x0002c000
.long 0x5a634a73, 0x11c2c000, 0x00000000, 0x00000000, 0x00a73100, 0x00d8d000, 0x00b73100, 0x0002c000
.long 0x1be34a73, 0x52c2c000, 0x00000000, 0x00000000, 0x00a73000, 0x00d8d000, 0x00c33000, 0x0002c000
.long 0x5be34a73, 0x12c2c000, 0x00000000, 0x00000000, 0x00a73100, 0x00d8d000, 0x00c33100, 0x0002c000
.long 0x1d634a73, 0x53c2c000, 0x00000000, 0x00000000, 0x00a73000, 0x00d8d000, 0x00cf3000, 0x0002c000
.long 0x5d634a73, 0x13c2c000, 0x00000000, 0x00000000, 0x00a73100, 0x00d8d000, 0x00cf3100, 0x0002c000
.long 0x19c6ed8d, 0x5b46ed8d, 0x00000000, 0x00000000, 0x00d8d000, 0x00fc4000, 0x00e4d000, 0x0002c000
.long 0x59c6ed8d, 0x1b46ed8d, 0x00000000, 0x00000000, 0x00d8d100, 0x00fc4000, 0x00e4d100, 0x0002c000
.long 0x1bca0fc4, 0x5842c000, 0x00000000, 0x00000000, 0x00fc4000, 0x01214000, 0x01184000, 0x0002c000
.long 0x5bca0fc4, 0x1842c000, 0x00000000, 0x00000000, 0x00fc4100, 0x01214000, 0x01184100, 0x0002c000
.long 0x1c6f8216, 0x581b3214, 0x00000000, 0x00000000, 0x00216000, 0x00592000, 0x00416000, 0x0002c000
.long 0x5c6f8216, 0x181b3214, 0x00000000, 0x00000000, 0x00216100, 0x00592000, 0x00416100, 0x0002c000
.long 0x20634a73, 0x499b3214, 0x00000000, 0x00000000, 0x00a73000, 0x00d8d000, 0x00a73000, 0x0003c000
.long 0x60634a73, 0x099b3214, 0x00000000, 0x00000000, 0x00a73100, 0x00d8d000, 0x00a73100, 0x0003c000
.long 0x204a0fc4, 0x58240592, 0x00000000, 0x00000000, 0x00fc4000, 0x01214000, 0x00fc4000, 0x0003c000
.long 0x604a0fc4, 0x18240592, 0x00000000, 0x00000000, 0x00fc4100, 0x01214000, 0x00fc4100, 0x0003c000
.long 0x207826b2, 0x00000000, 0x00000000, 0x00000000, 0x006b2000, 0x00a73000, 0x006b2000, 0x0003c000
.long 0x607826b2, 0x00000000, 0x00000000, 0x00000000, 0x006b2100, 0x00a73000, 0x006b2100, 0x0003c000
.long 0x227826b2, 0x00000000, 0x00000000, 0x00000000, 0x006b2000, 0x00a73000, 0x007b2000, 0x0003c000
.long 0x627826b2, 0x00000000, 0x00000000, 0x00000000, 0x006b2100, 0x00a73000, 0x007b2100, 0x0003c000
.long 0x247826b2, 0x00000000, 0x00000000, 0x00000000, 0x006b2000, 0x00a73000, 0x008b2000, 0x0003c000
.long 0x647826b2, 0x00000000, 0x00000000, 0x00000000, 0x006b2100, 0x00a73000, 0x008b2100, 0x0003c000
.long 0x267826b2, 0x00000000, 0x00000000, 0x00000000, 0x006b2000, 0x00a73000, 0x009b2000, 0x0003c000
.long 0x667826b2, 0x00000000, 0x00000000, 0x00000000, 0x006b2100, 0x00a73000, 0x009b2100, 0x0003c000
.long 0x1def8216, 0x51a40592, 0x00000000, 0x00000000, 0x00216000, 0x00592000, 0x004d6000, 0x0002c000
.long 0x5def8216, 0x11a40592, 0x00000000, 0x00000000, 0x00216100, 0x00592000, 0x004d6100, 0x0002c000
.long 0x206f8216, 0x00000000, 0x00000000, 0x00000000, 0x00216000, 0x00592000, 0x00216000, 0x0003c000
.long 0x606f8216, 0x00000000, 0x00000000, 0x00000000, 0x00216100, 0x00592000, 0x00216100, 0x0003c000
.long 0x226f8216, 0x00000000, 0x00000000, 0x00000000, 0x00216000, 0x00592000, 0x00316000, 0x0003c000
.long 0x626f8216, 0x00000000, 0x00000000, 0x00000000, 0x00216100, 0x00592000, 0x00316100, 0x0003c000
.section .rodata,"a"
.p2align 6
.amdhsa_kernel standalone__varlen_attn_packed__ragged_kernel
  .amdhsa_next_free_vgpr 512
  .amdhsa_next_free_sgpr 102
  .amdhsa_accum_offset 256
  .amdhsa_group_segment_fixed_size 0
  .amdhsa_kernarg_size 56
  .amdhsa_user_sgpr_count 2
  .amdhsa_user_sgpr_kernarg_segment_ptr 1
  .amdhsa_system_sgpr_workgroup_id_x 1
.end_amdhsa_kernel
```
